```python
import torch

def _softmax(x, axis=-1):
    return torch.softmax(x, dim=axis)
def _gelu(x):
    return torch.nn.functional.gelu(x, approximate="tanh")
def _silu(x):
    return torch.nn.functional.silu(x)
def _sigmoid(x):
    return torch.sigmoid(x)
def _layernorm(x, axis=-1, eps=1e-5):
    m = x.mean(dim=axis, keepdim=True)
    v = x.var(dim=axis, keepdim=True, unbiased=False)
    return (x - m) / torch.sqrt(v + eps)
def _scatter_add(tgt, idx, src, axis=0):
    return tgt.clone().index_add_(axis, idx, src)
def _segment_sum(src, seg, n):
    out = torch.zeros((n,) + src.shape[1:], dtype=src.dtype)
    return out.index_add_(0, seg, src)
def _pad(x, pw):
    flat = tuple(v for pair in reversed(pw) for v in pair)
    return torch.nn.functional.pad(x, flat)

kernel_name = 'standalone__gqa_softmax__near_ridge'

def setup_inputs():

    _w = (lambda a: (lambda t: t.to(torch.bfloat16) if t.is_floating_point() else t)(torch.as_tensor(a)))
    B, Hq, Hkv, Sq, Sk, D = 64, 32, 16, 256, 256, 128
    return {
        "q": _w((lambda *s: torch.randn(*s, dtype=torch.bfloat16) * 0.8)(B, Hq, Sq, D)),
        "k": _w((lambda *s: torch.randn(*s, dtype=torch.bfloat16) * 0.8)(B, Hkv, Sk, D)),
        "v": _w((lambda *s: torch.randn(*s, dtype=torch.bfloat16) * 0.05)(B, Hkv, Sk, D)),
    }

def reference(q, k, v):
    B, Hq, Sq, D = q.shape
    Hkv = k.shape[1]
    rep = Hq // Hkv
    k = (lambda x, n, axis: torch.repeat_interleave(x, n, dim=axis))(k, rep, axis=1)
    v = (lambda x, n, axis: torch.repeat_interleave(x, n, dim=axis))(v, rep, axis=1)
    scale = D ** -0.5
    scores = torch.einsum("bhqd,bhkd->bhqk", q, k) * scale
    p = _softmax(scores, axis=-1)
    return torch.einsum("bhqk,bhkd->bhqd", p, v)
```

```asm
; @launch grid=(256,1,1) block=(256,1,1) lds=163840
.amdgcn_target "amdgcn-amd-amdhsa--gfx950"
.text
.globl standalone__gqa_softmax__near_ridge_kernel
.p2align 8
.type standalone__gqa_softmax__near_ridge_kernel,@function
standalone__gqa_softmax__near_ridge_kernel:
    s_load_dwordx8 s[4:11], s[0:1], 0
    s_cmp_ge_u32 s2, 256
    s_cbranch_scc1 L_end
    v_lshrrev_b32 v1, 6, v0
    v_and_b32 v0, 63, v0
    v_readfirstlane_b32 s32, v1
    v_lshrrev_b32 v5, 4, v0
    v_bfe_u32 v10, v0, 2, 2
    v_and_b32 v6, 3, v0
    v_lshl_add_u32 v8, v5, 2, v6
    v_lshlrev_b32 v8, 4, v8
    v_lshl_add_u32 v246, v10, 8, v8
    v_mov_b32 v13, v246
    v_xor_b32 v247, 32, v246
    s_mov_b32 s34, 0
    s_lshl_b32 s42, s32, 13
    s_add_u32 s42, s42, 131072
    s_add_u32 s43, s42, 4096
    s_bfe_u32 s68, s2, 0x10003
    s_bfe_u32 s39, s2, 0x10004
    s_and_b32 s39, s39, s68
    s_mov_b32 s33, 0
    s_and_b32 s41, s2, 99
    s_bcnt1_i32_b32 s41, s41
    s_bitcmp1_b32 s41, 0
    s_addc_u32 s33, s33, s33
    s_and_b32 s41, s2, 92
    s_bcnt1_i32_b32 s41, s41
    s_bitcmp1_b32 s41, 0
    s_addc_u32 s33, s33, s33
    s_and_b32 s41, s2, 171
    s_bcnt1_i32_b32 s41, s41
    s_bitcmp1_b32 s41, 0
    s_addc_u32 s33, s33, s33
    s_and_b32 s41, s2, 145
    s_bcnt1_i32_b32 s41, s41
    s_bitcmp1_b32 s41, 0
    s_addc_u32 s33, s33, s33
    s_and_b32 s41, s2, 84
    s_bcnt1_i32_b32 s41, s41
    s_bitcmp1_b32 s41, 0
    s_addc_u32 s33, s33, s33
    s_and_b32 s41, s2, 43
    s_bcnt1_i32_b32 s41, s41
    s_bitcmp1_b32 s41, 0
    s_addc_u32 s33, s33, s33
    s_and_b32 s41, s2, 140
    s_bcnt1_i32_b32 s41, s41
    s_bitcmp1_b32 s41, 0
    s_addc_u32 s33, s33, s33
    s_and_b32 s41, s2, 244
    s_bcnt1_i32_b32 s41, s41
    s_bitcmp1_b32 s41, 0
    s_addc_u32 s33, s33, s33
    s_lshl_b32 s40, s32, 8
    s_or_b32 s40, s40, s2
    s_mov_b32 s84, 0
    s_bitcmp1_b32 s40, 9
    s_addc_u32 s84, s84, s84
    s_bitcmp1_b32 s40, 8
    s_addc_u32 s84, s84, s84
    s_and_b32 s41, s40, 63
    s_bcnt1_i32_b32 s41, s41
    s_bitcmp1_b32 s41, 0
    s_addc_u32 s84, s84, s84
    s_and_b32 s41, s40, 108
    s_bcnt1_i32_b32 s41, s41
    s_bitcmp1_b32 s41, 0
    s_addc_u32 s84, s84, s84
    s_and_b32 s41, s40, 99
    s_bcnt1_i32_b32 s41, s41
    s_bitcmp1_b32 s41, 0
    s_addc_u32 s84, s84, s84
    s_lshl_b32 s84, s84, 12
    s_mov_b32 s66, 89
    s_mul_i32 s41, s39, s66
    s_xor_b32 s59, s33, s41
    s_lshl_b32 s59, s59, 16
    s_lshl_b32 s39, s39, 13
    s_lshl_b32 s37, s59, 1
    s_add_u32 s37, s37, s39
    s_getreg_b32 s41, hwreg(HW_REG_XCC_ID)
    s_mov_b32 s36, 2844227157
    s_mov_b32 s40, 1412636928
    s_cmp_eq_u32 s68, 1
    s_cselect_b32 s36, 2289526357, s36
    s_cselect_b32 s40, 857870592, s40
    s_bitcmp1_b32 s41, 0
    s_cselect_b32 s36, s40, s36
    s_lshr_b32 s56, s2, 3
    s_and_b32 s56, s56, 28
    s_lshr_b32 s36, s36, s56
    s_and_b32 s36, s36, 15
    s_mul_i32 s36, s36, 2
    s_sub_u32 s40, s42, 32768
    s_sub_u32 s41, s43, 32768
    s_xor_b32 s80, s37, s84
    s_xor_b32 s81, s80, 4096
    s_xor_b32 s82, s80, 16384
    s_xor_b32 s83, s80, 20480
    s_mov_b32 s14, 0x8000000
    s_mov_b32 s15, 0x20000
    s_waitcnt lgkmcnt(0)
    s_mov_b32 s12, s4
    s_and_b32 s13, s5, 0xffff
    s_mov_b32 m0, s40
    s_nop 0
    buffer_load_dwordx4 v246, s[12:15], s80 offen offset:0 nt lds
    s_mov_b32 m0, s40
    s_nop 0
    buffer_load_dwordx4 v247, s[12:15], s80 offen offset:1024 nt lds
    s_mov_b32 m0, s40
    s_cmp_le_u32 s36, 2
    s_cbranch_scc1 L_ser1
    s_waitcnt vmcnt(1)
L_ser1:
    buffer_load_dwordx4 v246, s[12:15], s80 offen offset:2048 nt lds
    s_mov_b32 m0, s40
    s_cmp_le_u32 s36, 3
    s_cbranch_scc1 L_ser2
    s_waitcnt vmcnt(1)
L_ser2:
    buffer_load_dwordx4 v247, s[12:15], s80 offen offset:3072 nt lds
    s_mov_b32 m0, s41
    s_cmp_le_u32 s36, 4
    s_cbranch_scc1 L_ser3
    s_waitcnt vmcnt(1)
L_ser3:
    buffer_load_dwordx4 v246, s[12:15], s81 offen offset:0 nt lds
    s_mov_b32 m0, s41
    s_cmp_le_u32 s36, 5
    s_cbranch_scc1 L_ser4
    s_waitcnt vmcnt(1)
L_ser4:
    buffer_load_dwordx4 v247, s[12:15], s81 offen offset:1024 nt lds
    s_mov_b32 m0, s41
    s_cmp_le_u32 s36, 6
    s_cbranch_scc1 L_ser5
    s_waitcnt vmcnt(1)
L_ser5:
    buffer_load_dwordx4 v246, s[12:15], s81 offen offset:2048 nt lds
    s_mov_b32 m0, s41
    s_cmp_le_u32 s36, 7
    s_cbranch_scc1 L_ser6
    s_waitcnt vmcnt(1)
L_ser6:
    buffer_load_dwordx4 v247, s[12:15], s81 offen offset:3072 nt lds
    s_getpc_b64 s[72:73]
L_pc7:
    s_add_u32 s72, s72, L_code0-L_pc7
    s_addc_u32 s73, s73, (L_code0-L_pc7)>>32
    v_mbcnt_lo_u32_b32 v222, -1, 0
    v_mbcnt_hi_u32_b32 v222, -1, v222
    v_lshrrev_b32 v222, 2, v222
    v_lshl_add_u32 v222, s32, 4, v222
    v_lshlrev_b32 v222, 7, v222
    v_min_u32 v222, L_ph1s-L_code0, v222
    v_mov_b32 v223, s73
    v_add_co_u32 v222, vcc, s72, v222
    s_nop 1
    v_addc_co_u32 v223, vcc, 0, v223, vcc
    global_load_dword v254, v[222:223], off
L_code0:
    s_mov_b32 m0, s42
    s_cmp_le_u32 s36, 8
    s_cbranch_scc1 L_ser8
    s_waitcnt vmcnt(1)
L_ser8:
    buffer_load_dwordx4 v246, s[12:15], s82 offen offset:0 nt lds
    s_mov_b32 m0, s42
    s_cmp_le_u32 s36, 9
    s_cbranch_scc1 L_ser9
    s_waitcnt vmcnt(1)
L_ser9:
    buffer_load_dwordx4 v247, s[12:15], s82 offen offset:1024 nt lds
    s_mov_b32 m0, s42
    s_cmp_le_u32 s36, 10
    s_cbranch_scc1 L_ser10
    s_waitcnt vmcnt(1)
L_ser10:
    buffer_load_dwordx4 v246, s[12:15], s82 offen offset:2048 nt lds
    s_mov_b32 m0, s42
    s_cmp_le_u32 s36, 11
    s_cbranch_scc1 L_ser11
    s_waitcnt vmcnt(1)
L_ser11:
    buffer_load_dwordx4 v247, s[12:15], s82 offen offset:3072 nt lds
    s_mov_b32 m0, s43
    s_cmp_le_u32 s36, 12
    s_cbranch_scc1 L_ser12
    s_waitcnt vmcnt(1)
L_ser12:
    buffer_load_dwordx4 v246, s[12:15], s83 offen offset:0 nt lds
    s_mov_b32 m0, s43
    s_cmp_le_u32 s36, 13
    s_cbranch_scc1 L_ser13
    s_waitcnt vmcnt(1)
L_ser13:
    buffer_load_dwordx4 v247, s[12:15], s83 offen offset:1024 nt lds
    s_mov_b32 m0, s43
    s_cmp_le_u32 s36, 14
    s_cbranch_scc1 L_ser14
    s_waitcnt vmcnt(1)
L_ser14:
    buffer_load_dwordx4 v246, s[12:15], s83 offen offset:2048 nt lds
    s_mov_b32 m0, s43
    s_cmp_le_u32 s36, 15
    s_cbranch_scc1 L_ser15
    s_waitcnt vmcnt(1)
L_ser15:
    buffer_load_dwordx4 v247, s[12:15], s83 offen offset:3072 nt lds
    s_mov_b32 s60, s59
    s_lshl_b32 s66, s66, 16
    s_xor_b32 s66, s59, s66
    s_lshl_b32 s67, s66, 1
    s_add_u32 s67, s67, s39
    s_lshl_b32 s40, s32, 8
    s_or_b32 s40, s40, s2
    s_mov_b32 s35, 0
    s_bitcmp1_b32 s40, 9
    s_addc_u32 s35, s35, s35
    s_and_b32 s41, s40, 254
    s_bcnt1_i32_b32 s41, s41
    s_bitcmp1_b32 s41, 0
    s_addc_u32 s35, s35, s35
    s_and_b32 s41, s40, 74
    s_bcnt1_i32_b32 s41, s41
    s_bitcmp1_b32 s41, 0
    s_addc_u32 s35, s35, s35
    s_bitcmp1_b32 s40, 8
    s_addc_u32 s35, s35, s35
    s_and_b32 s41, s40, 6
    s_bcnt1_i32_b32 s41, s41
    s_bitcmp1_b32 s41, 0
    s_addc_u32 s35, s35, s35
    s_and_b32 s39, s35, 1
    s_lshl_b32 s39, s39, 5
    v_xor_b32 v241, s39, v13
    v_xor_b32 v255, 32, v241
    s_lshl_b32 s35, s35, 10
    s_mov_b32 s87, 0
    s_and_b32 s41, s2, 226
    s_bcnt1_i32_b32 s41, s41
    s_bitcmp1_b32 s41, 0
    s_addc_u32 s87, s87, s87
    s_lshl_b32 s87, s87, 12
    s_and_b32 s85, s35, 4095
    s_or_b32 s85, s85, s87
    s_bfe_u32 s39, s35, 0x1000c
    s_lshl_b32 s39, s39, 13
    s_or_b32 s85, s85, s39
    s_bfe_u32 s39, s35, 0x1000d
    s_lshl_b32 s39, s39, 14
    s_or_b32 s85, s85, s39
    s_bfe_u32 s39, s35, 0x1000e
    s_lshl_b32 s39, s39, 15
    s_or_b32 s85, s85, s39
    s_sub_u32 s62, s6, 0
    s_subb_u32 s63, s7, 0
    s_add_u32 s16, s62, s59
    s_addc_u32 s17, s63, 0
    s_mov_b32 s18, 65536
    s_mov_b32 s19, 0x20000
    s_sub_u32 s64, s8, 65536
    s_subb_u32 s65, s9, 0
    s_add_u32 s20, s64, s60
    s_addc_u32 s21, s65, 0
    s_mov_b32 s22, 131072
    s_mov_b32 s23, 0x20000
    s_xor_b32 m0, s35, 0
    s_xor_b32 s86, s85, 0
    s_cmp_le_u32 s36, 16
    s_cbranch_scc1 L_ser16
    s_waitcnt vmcnt(1)
L_ser16:
    buffer_load_dwordx4 v241, s[16:19], s86 offen  lds
    s_xor_b32 m0, s35, 1024
    s_xor_b32 s86, s85, 1024
    s_cmp_le_u32 s36, 17
    s_cbranch_scc1 L_ser18
    s_waitcnt vmcnt(1)
L_ser18:
    buffer_load_dwordx4 v255, s[16:19], s86 offen  lds
    s_xor_b32 m0, s35, 4096
    s_xor_b32 s86, s85, 8192
    s_cmp_le_u32 s36, 18
    s_cbranch_scc1 L_ser20
    s_waitcnt vmcnt(1)
L_ser20:
    buffer_load_dwordx4 v241, s[16:19], s86 offen  lds
    s_xor_b32 m0, s35, 5120
    s_xor_b32 s86, s85, 9216
    s_cmp_le_u32 s36, 19
    s_cbranch_scc1 L_ser22
    s_waitcnt vmcnt(1)
L_ser22:
    buffer_load_dwordx4 v255, s[16:19], s86 offen  lds
    s_xor_b32 m0, s35, 8192
    s_xor_b32 s86, s85, 16384
    s_nop 0
    buffer_load_dwordx4 v241, s[16:19], s86 offen  lds
    s_xor_b32 m0, s35, 9216
    s_xor_b32 s86, s85, 17408
    s_nop 0
    buffer_load_dwordx4 v255, s[16:19], s86 offen  lds
    s_xor_b32 m0, s35, 12288
    s_xor_b32 s86, s85, 24576
    s_nop 0
    buffer_load_dwordx4 v241, s[16:19], s86 offen  lds
    s_xor_b32 m0, s35, 13312
    s_xor_b32 s86, s85, 25600
    s_nop 0
    buffer_load_dwordx4 v255, s[16:19], s86 offen  lds
    s_mov_b32 s24, s10
    s_and_b32 s25, s11, 0xffff
    s_mov_b32 s26, 0
    s_mov_b32 s27, 0x20000
    s_mov_b32 s52, 0
    s_mov_b32 s53, 0
    s_mov_b32 s54, 0
    s_mov_b32 s55, 0
    s_mov_b32 s88, 0x3e0293ee
    s_mov_b32 s74, 0x55555555
    s_mov_b32 s76, 0xaaaaaaaa
    s_mov_b32 s89, 0x3e0293ee
    s_mov_b32 s75, 0x55555555
    s_mov_b32 s77, 0xaaaaaaaa
    v_lshrrev_b32 v3, 5, v0
    v_bfe_u32 v4, v0, 4, 1
    v_bfe_u32 v8, v0, 1, 3
    v_lshlrev_b32 v8, 9, v8
    v_lshl_add_u32 v8, v4, 6, v8
    v_and_b32 v11, 1, v0
    v_lshl_add_u32 v8, v11, 5, v8
    v_lshl_add_u32 v243, v3, 4, v8
    v_bfe_u32 v9, v0, 2, 1
    v_lshlrev_b32 v9, 1, v9
    v_xor_b32 v8, v5, v9
    v_lshlrev_b32 v8, 4, v8
    v_lshl_add_u32 v8, v6, 6, v8
    v_lshl_add_u32 v237, v10, 10, v8
    v_add_u32 v239, s42, v237
    v_add_u32 v220, 0xffff8000, v239
    v_lshlrev_b32 v9, 10, v5
    v_lshl_add_u32 v9, v10, 6, v9
    v_lshl_add_u32 v9, v4, 5, v9
    v_lshl_add_u32 v9, v6, 3, v9
    v_add_u32 v244, 65536, v9
    v_xor_b32 v245, 32, v244
    v_cmp_eq_u32 vcc, 0, v6
    v_mov_b32 v9, 0x3f803f80
    s_nop 0
    v_cndmask_b32 v248, 0, v9, vcc
    v_cndmask_b32 v249, 0, v9, vcc
    v_cndmask_b32 v250, 0, v9, vcc
    v_cndmask_b32 v251, 0, v9, vcc
    s_lshr_b32 s56, 1145394534, s56
    s_and_b32 s56, s56, 15
    s_sub_u32 s61, s56, 1
    s_add_u32 s38, s56, 2
    s_waitcnt vmcnt(8)
    ds_read_b128 a[128:131], v220 offset:0
    ds_read_b128 a[132:135], v220 offset:256
    ds_read_b128 a[136:139], v220 offset:512
    ds_read_b128 a[140:143], v220 offset:768
    ds_read_b128 a[144:147], v220 offset:4096
    ds_read_b128 a[148:151], v220 offset:4352
    ds_read_b128 a[152:155], v220 offset:4608
    ds_read_b128 a[156:159], v220 offset:4864
    ds_read_b128 a[192:195], v239 offset:0
    ds_read_b128 a[196:199], v239 offset:256
    ds_read_b128 a[200:203], v239 offset:512
    ds_read_b128 a[204:207], v239 offset:768
    ds_read_b128 a[208:211], v239 offset:4096
    ds_read_b128 a[212:215], v239 offset:4352
    ds_read_b128 a[216:219], v239 offset:4608
    ds_read_b128 a[220:223], v239 offset:4864
    ds_read_b128 a[160:163], v220 offset:0
    ds_read_b128 a[164:167], v220 offset:256
    ds_read_b128 a[168:171], v220 offset:512
    ds_read_b128 a[172:175], v220 offset:768
    ds_read_b128 a[176:179], v220 offset:4096
    ds_read_b128 a[180:183], v220 offset:4352
    ds_read_b128 a[184:187], v220 offset:4608
    ds_read_b128 a[188:191], v220 offset:4864
    s_mov_b32 s57, s37
    s_lshl_b32 s59, s33, 16
    s_add_u32 s59, s59, 16777216
    s_lshl_b32 s39, s59, 1
    s_add_u32 s37, s37, 8192
    s_cmp_eq_u32 s68, 1
    s_cselect_b32 s37, s39, s37
    s_cselect_b32 s60, s59, s60
    s_xor_b32 s80, s37, s84
    s_xor_b32 s81, s80, 4096
    s_xor_b32 s82, s80, 16384
    s_xor_b32 s83, s80, 20480
    s_waitcnt lgkmcnt(0)
    s_waitcnt vmcnt(0)
    s_barrier
    ds_read_b128 a[224:227], v237 offset:0
    ds_read_b128 a[228:231], v237 offset:256
    ds_read_b128 a[232:235], v237 offset:512
    ds_read_b128 a[236:239], v237 offset:768
    s_cmp_eq_u32 s68, 0
    s_cbranch_scc0 L_nt28
    s_getpc_b64 s[72:73]
L_pc28:
    s_add_u32 s72, s72, L_ph1s-L_pc28
    s_addc_u32 s73, s73, (L_ph1s-L_pc28)>>32
    v_mbcnt_lo_u32_b32 v222, -1, 0
    v_mbcnt_hi_u32_b32 v222, -1, v222
    v_lshrrev_b32 v222, 2, v222
    v_lshl_add_u32 v222, s32, 4, v222
    v_lshlrev_b32 v222, 7, v222
    v_min_u32 v222, L_ph2s-L_ph1s, v222
    v_mov_b32 v223, s73
    v_add_co_u32 v222, vcc, s72, v222
    s_nop 1
    v_addc_co_u32 v223, vcc, 0, v223, vcc
    global_load_dword v254, v[222:223], off
L_nt28:
    s_cmp_eq_u32 s68, 1
    s_cbranch_scc0 L_nt29
    s_getpc_b64 s[72:73]
L_pc29:
    s_add_u32 s72, s72, L_ph3s-L_pc29
    s_addc_u32 s73, s73, (L_ph3s-L_pc29)>>32
    v_mbcnt_lo_u32_b32 v222, -1, 0
    v_mbcnt_hi_u32_b32 v222, -1, v222
    v_lshrrev_b32 v222, 2, v222
    v_lshl_add_u32 v222, s32, 4, v222
    v_lshlrev_b32 v222, 7, v222
    v_min_u32 v222, L_ph4s-L_ph3s, v222
    v_mov_b32 v223, s73
    v_add_co_u32 v222, vcc, s72, v222
    s_nop 1
    v_addc_co_u32 v223, vcc, 0, v223, vcc
    global_load_dword v254, v[222:223], off
L_nt29:
    s_waitcnt lgkmcnt(0)
    v_mfma_f32_16x16x32_bf16 v[128:131], a[224:227], a[128:131], 0
    ds_read_b128 a[240:243], v237 offset:4096
    v_mfma_f32_16x16x32_bf16 v[128:131], a[228:231], a[132:135], v[128:131]
    ds_read_b128 a[244:247], v237 offset:4352
    s_xor_b32 s86, s85, 4096
    v_mfma_f32_16x16x32_bf16 v[128:131], a[232:235], a[136:139], v[128:131]
    s_xor_b32 m0, s35, 32768
    v_mfma_f32_16x16x32_bf16 v[128:131], a[236:239], a[140:143], v[128:131]
    buffer_load_dwordx4 v241, s[16:19], s86 offen  lds
    v_mfma_f32_16x16x32_bf16 v[132:135], a[236:239], a[156:159], 0
    ds_read_b128 a[248:251], v237 offset:4608
    v_mfma_f32_16x16x32_bf16 v[132:135], a[232:235], a[152:155], v[132:135]
    ds_read_b128 a[252:255], v237 offset:4864
    s_xor_b32 s86, s85, 5120
    v_mfma_f32_16x16x32_bf16 v[132:135], a[228:231], a[148:151], v[132:135]
    s_xor_b32 m0, s35, 33792
    v_max_f32 v220, v128, v129
    v_max3_f32 v220, v220, v130, v131
    v_mfma_f32_16x16x32_bf16 v[132:135], a[224:227], a[144:147], v[132:135]
    buffer_load_dwordx4 v255, s[16:19], s86 offen  lds
    v_mfma_f32_16x16x32_bf16 v[136:139], a[224:227], a[192:195], 0
    v_mfma_f32_16x16x32_bf16 v[136:139], a[228:231], a[196:199], v[136:139]
    s_xor_b32 s86, s85, 12288
    v_mfma_f32_16x16x32_bf16 v[136:139], a[232:235], a[200:203], v[136:139]
    s_xor_b32 m0, s35, 36864
    v_mfma_f32_16x16x32_bf16 v[136:139], a[236:239], a[204:207], v[136:139]
    buffer_load_dwordx4 v241, s[16:19], s86 offen  lds
    v_max_f32 v221, v132, v133
    v_mfma_f32_16x16x32_bf16 v[140:143], a[236:239], a[220:223], 0
    v_max3_f32 v221, v221, v134, v135
    v_mfma_f32_16x16x32_bf16 v[140:143], a[232:235], a[216:219], v[140:143]
    s_xor_b32 s86, s85, 13312
    v_mfma_f32_16x16x32_bf16 v[140:143], a[228:231], a[212:215], v[140:143]
    s_xor_b32 m0, s35, 37888
    v_max_f32 v222, v136, v137
    v_max3_f32 v222, v222, v138, v139
    v_mfma_f32_16x16x32_bf16 v[140:143], a[224:227], a[208:211], v[140:143]
    s_waitcnt lgkmcnt(0)
    buffer_load_dwordx4 v255, s[16:19], s86 offen  lds
    v_mfma_f32_16x16x32_bf16 v[144:147], a[240:243], a[128:131], 0
    ds_read_b128 a[224:227], v237 offset:8192
    v_mfma_f32_16x16x32_bf16 v[144:147], a[244:247], a[132:135], v[144:147]
    ds_read_b128 a[228:231], v237 offset:8448
    s_xor_b32 s86, s85, 20480
    v_mfma_f32_16x16x32_bf16 v[144:147], a[248:251], a[136:139], v[144:147]
    s_xor_b32 m0, s35, 40960
    v_max_f32 v223, v140, v141
    v_max3_f32 v223, v223, v142, v143
    v_mfma_f32_16x16x32_bf16 v[144:147], a[252:255], a[140:143], v[144:147]
    buffer_load_dwordx4 v241, s[16:19], s86 offen  lds
    v_mfma_f32_16x16x32_bf16 v[148:151], a[252:255], a[156:159], 0
    ds_read_b128 a[232:235], v237 offset:8704
    v_mfma_f32_16x16x32_bf16 v[148:151], a[248:251], a[152:155], v[148:151]
    ds_read_b128 a[236:239], v237 offset:8960
    s_xor_b32 s86, s85, 21504
    v_mfma_f32_16x16x32_bf16 v[148:151], a[244:247], a[148:151], v[148:151]
    s_xor_b32 m0, s35, 41984
    v_permlane32_swap_b32 v220, v221
    v_mfma_f32_16x16x32_bf16 v[148:151], a[240:243], a[144:147], v[148:151]
    buffer_load_dwordx4 v255, s[16:19], s86 offen  lds
    v_permlane32_swap_b32 v222, v223
    v_max_f32 v224, v220, v221
    v_max_f32 v226, v222, v223
    v_mov_b32 v225, v224
    v_mfma_f32_16x16x32_bf16 v[152:155], a[240:243], a[192:195], 0
    v_mov_b32 v227, v226
    v_mfma_f32_16x16x32_bf16 v[152:155], a[244:247], a[196:199], v[152:155]
    s_xor_b32 s86, s85, 28672
    v_permlane16_swap_b32 v224, v225
    v_mfma_f32_16x16x32_bf16 v[152:155], a[248:251], a[200:203], v[152:155]
    s_xor_b32 m0, s35, 45056
    v_permlane16_swap_b32 v226, v227
    v_mfma_f32_16x16x32_bf16 v[152:155], a[252:255], a[204:207], v[152:155]
    buffer_load_dwordx4 v241, s[16:19], s86 offen  lds
    v_max_f32 v224, v224, v225
    v_max_f32 v226, v226, v227
    v_mul_f32 v228, 0xbe0293ee, v224
    v_mul_f32 v232, 0xbe0293ee, v226
    v_mfma_f32_16x16x32_bf16 v[156:159], a[252:255], a[220:223], 0
    v_mul_f32 v230, 0xbe0293ee, v224
    v_mul_f32 v234, 0xbe0293ee, v226
    v_mfma_f32_16x16x32_bf16 v[156:159], a[248:251], a[216:219], v[156:159]
    s_xor_b32 s86, s85, 29696
    v_permlane32_swap_b32 v228, v230
    v_mfma_f32_16x16x32_bf16 v[156:159], a[244:247], a[212:215], v[156:159]
    s_xor_b32 m0, s35, 46080
    v_permlane32_swap_b32 v232, v234
    v_mfma_f32_16x16x32_bf16 v[156:159], a[240:243], a[208:211], v[156:159]
    s_waitcnt lgkmcnt(0)
    buffer_load_dwordx4 v255, s[16:19], s86 offen  lds
    v_fmamk_f32 v128, v128, 0x3e0293ee, v228
    v_fmamk_f32 v129, v129, 0x3e0293ee, v228
    v_exp_f32 v128, v128
    v_pk_fma_f32 v[130:131], v[130:131], s[88:89], v[228:229] op_sel_hi:[1,1,0]
    v_pk_fma_f32 v[132:133], v[132:133], s[88:89], v[230:231] op_sel_hi:[1,1,0]
    v_pk_fma_f32 v[134:135], v[134:135], s[88:89], v[230:231] op_sel_hi:[1,1,0]
    v_pk_fma_f32 v[136:137], v[136:137], s[88:89], v[232:233] op_sel_hi:[1,1,0]
    v_pk_fma_f32 v[138:139], v[138:139], s[88:89], v[232:233] op_sel_hi:[1,1,0]
    v_mfma_f32_16x16x32_bf16 v[160:163], a[224:227], a[128:131], 0
    ds_read_b128 a[240:243], v237 offset:12288
    v_fmamk_f32 v140, v140, 0x3e0293ee, v234
    v_mfma_f32_16x16x32_bf16 v[160:163], a[228:231], a[132:135], v[160:163]
    ds_read_b128 a[244:247], v237 offset:12544
    s_xor_b32 s86, s85, 65536
    v_mfma_f32_16x16x32_bf16 v[160:163], a[232:235], a[136:139], v[160:163]
    s_xor_b32 m0, s35, 65536
    v_exp_f32 v129, v129
    v_mfma_f32_16x16x32_bf16 v[160:163], a[236:239], a[140:143], v[160:163]
    buffer_load_dwordx4 v241, s[20:23], s86 offen  lds
    v_cvt_pk_bf16_f32 v0, v128, v129
    v_exp_f32 v130, v130
    v_exp_f32 v131, v131
    v_exp_f32 v132, v132
    v_mfma_f32_16x16x32_bf16 v[164:167], a[236:239], a[156:159], 0
    ds_read_b128 a[248:251], v237 offset:12800
    v_cvt_pk_bf16_f32 v1, v130, v131
    v_mfma_f32_16x16x32_bf16 v[164:167], a[232:235], a[152:155], v[164:167]
    ds_read_b128 a[252:255], v237 offset:13056
    s_xor_b32 s86, s85, 66560
    v_mfma_f32_16x16x32_bf16 v[164:167], a[228:231], a[148:151], v[164:167]
    s_xor_b32 m0, s35, 66560
    v_exp_f32 v133, v133
    v_mfma_f32_16x16x32_bf16 v[164:167], a[224:227], a[144:147], v[164:167]
    buffer_load_dwordx4 v255, s[20:23], s86 offen  lds
    v_fmamk_f32 v141, v141, 0x3e0293ee, v234
    v_exp_f32 v134, v134
    v_exp_f32 v135, v135
    v_pk_fma_f32 v[142:143], v[142:143], s[88:89], v[234:235] op_sel_hi:[1,1,0]
    v_pk_fma_f32 v[144:145], v[144:145], s[88:89], v[228:229] op_sel_hi:[1,1,0]
    v_pk_fma_f32 v[146:147], v[146:147], s[88:89], v[228:229] op_sel_hi:[1,1,0]
    v_pk_fma_f32 v[148:149], v[148:149], s[88:89], v[230:231] op_sel_hi:[1,1,0]
    v_pk_fma_f32 v[150:151], v[150:151], s[88:89], v[230:231] op_sel_hi:[1,1,0]
    v_exp_f32 v136, v136
    v_exp_f32 v137, v137
    v_cvt_pk_bf16_f32 v4, v132, v133
    v_mfma_f32_16x16x32_bf16 v[168:171], a[224:227], a[192:195], 0
    v_exp_f32 v138, v138
    v_mfma_f32_16x16x32_bf16 v[168:171], a[228:231], a[196:199], v[168:171]
    s_xor_b32 s86, s85, 73728
    v_exp_f32 v139, v139
    v_mfma_f32_16x16x32_bf16 v[168:171], a[232:235], a[200:203], v[168:171]
    s_xor_b32 m0, s35, 69632
    v_exp_f32 v140, v140
    v_mfma_f32_16x16x32_bf16 v[168:171], a[236:239], a[204:207], v[168:171]
    buffer_load_dwordx4 v241, s[20:23], s86 offen  lds
    v_cvt_pk_bf16_f32 v5, v134, v135
    v_exp_f32 v141, v141
    v_cvt_pk_bf16_f32 v8, v136, v137
    v_pk_fma_f32 v[152:153], v[152:153], s[88:89], v[232:233] op_sel_hi:[1,1,0]
    v_pk_fma_f32 v[154:155], v[154:155], s[88:89], v[232:233] op_sel_hi:[1,1,0]
    v_pk_fma_f32 v[156:157], v[156:157], s[88:89], v[234:235] op_sel_hi:[1,1,0]
    v_exp_f32 v142, v142
    v_exp_f32 v143, v143
    v_cvt_pk_bf16_f32 v9, v138, v139
    v_mfma_f32_16x16x32_bf16 v[172:175], a[236:239], a[220:223], 0
    v_exp_f32 v144, v144
    v_mfma_f32_16x16x32_bf16 v[172:175], a[232:235], a[216:219], v[172:175]
    s_xor_b32 s86, s85, 74752
    v_exp_f32 v145, v145
    v_mfma_f32_16x16x32_bf16 v[172:175], a[228:231], a[212:215], v[172:175]
    s_xor_b32 m0, s35, 70656
    v_exp_f32 v146, v146
    v_mfma_f32_16x16x32_bf16 v[172:175], a[224:227], a[208:211], v[172:175]
    s_waitcnt lgkmcnt(0)
    buffer_load_dwordx4 v255, s[20:23], s86 offen  lds
    v_cvt_pk_bf16_f32 v12, v140, v141
    v_exp_f32 v147, v147
    v_pk_fma_f32 v[158:159], v[158:159], s[88:89], v[234:235] op_sel_hi:[1,1,0]
    v_pk_fma_f32 v[160:161], v[160:161], s[88:89], v[228:229] op_sel_hi:[1,1,0]
    v_pk_fma_f32 v[162:163], v[162:163], s[88:89], v[228:229] op_sel_hi:[1,1,0]
    v_cvt_pk_bf16_f32 v13, v142, v143
    v_exp_f32 v148, v148
    v_exp_f32 v149, v149
    v_cvt_pk_bf16_f32 v2, v144, v145
    v_mfma_f32_16x16x32_bf16 v[128:131], a[240:243], a[128:131], 0
    ds_read_b128 a[224:227], v237 offset:16384
    v_cvt_pk_bf16_f32 v3, v146, v147
    v_mfma_f32_16x16x32_bf16 v[128:131], a[244:247], a[132:135], v[128:131]
    ds_read_b128 a[228:231], v237 offset:16640
    s_xor_b32 s86, s85, 81920
    v_mfma_f32_16x16x32_bf16 v[128:131], a[248:251], a[136:139], v[128:131]
    s_xor_b32 m0, s35, 73728
    v_exp_f32 v150, v150
    v_mfma_f32_16x16x32_bf16 v[128:131], a[252:255], a[140:143], v[128:131]
    buffer_load_dwordx4 v241, s[20:23], s86 offen  lds
    v_cvt_pk_bf16_f32 v6, v148, v149
    v_exp_f32 v151, v151
    v_exp_f32 v152, v152
    v_pk_fma_f32 v[164:165], v[164:165], s[88:89], v[230:231] op_sel_hi:[1,1,0]
    v_pk_fma_f32 v[166:167], v[166:167], s[88:89], v[230:231] op_sel_hi:[1,1,0]
    v_exp_f32 v153, v153
    v_exp_f32 v154, v154
    v_exp_f32 v155, v155
    v_mfma_f32_16x16x32_bf16 v[132:135], a[252:255], a[156:159], 0
    ds_read_b128 a[232:235], v237 offset:16896
    v_cvt_pk_bf16_f32 v7, v150, v151
    v_mfma_f32_16x16x32_bf16 v[132:135], a[248:251], a[152:155], v[132:135]
    ds_read_b128 a[236:239], v237 offset:17152
    s_xor_b32 s86, s85, 82944
    v_mfma_f32_16x16x32_bf16 v[132:135], a[244:247], a[148:151], v[132:135]
    s_xor_b32 m0, s35, 74752
    v_exp_f32 v156, v156
    v_mfma_f32_16x16x32_bf16 v[132:135], a[240:243], a[144:147], v[132:135]
    buffer_load_dwordx4 v255, s[20:23], s86 offen  lds
    v_cvt_pk_bf16_f32 v10, v152, v153
    v_exp_f32 v157, v157
    v_exp_f32 v158, v158
    v_pk_fma_f32 v[168:169], v[168:169], s[88:89], v[232:233] op_sel_hi:[1,1,0]
    v_pk_fma_f32 v[170:171], v[170:171], s[88:89], v[232:233] op_sel_hi:[1,1,0]
    v_pk_fma_f32 v[172:173], v[172:173], s[88:89], v[234:235] op_sel_hi:[1,1,0]
    v_exp_f32 v159, v159
    v_cvt_pk_bf16_f32 v11, v154, v155
    v_exp_f32 v160, v160
    v_mfma_f32_16x16x32_bf16 v[136:139], a[240:243], a[192:195], 0
    v_exp_f32 v161, v161
    v_mfma_f32_16x16x32_bf16 v[136:139], a[244:247], a[196:199], v[136:139]
    s_xor_b32 s86, s85, 90112
    v_exp_f32 v162, v162
    v_mfma_f32_16x16x32_bf16 v[136:139], a[248:251], a[200:203], v[136:139]
    s_xor_b32 m0, s35, 77824
    v_exp_f32 v163, v163
    v_mfma_f32_16x16x32_bf16 v[136:139], a[252:255], a[204:207], v[136:139]
    buffer_load_dwordx4 v241, s[20:23], s86 offen  lds
    v_cvt_pk_bf16_f32 v14, v156, v157
    v_cvt_pk_bf16_f32 v15, v158, v159
    v_exp_f32 v164, v164
    v_pk_fma_f32 v[174:175], v[174:175], s[88:89], v[234:235] op_sel_hi:[1,1,0]
    v_pk_fma_f32 v[128:129], v[128:129], s[88:89], v[228:229] op_sel_hi:[1,1,0]
    v_pk_fma_f32 v[130:131], v[130:131], s[88:89], v[228:229] op_sel_hi:[1,1,0]
    v_exp_f32 v165, v165
    v_cvt_pk_bf16_f32 v16, v160, v161
    v_exp_f32 v166, v166
    v_mfma_f32_16x16x32_bf16 v[140:143], a[252:255], a[220:223], 0
    v_exp_f32 v167, v167
    v_mfma_f32_16x16x32_bf16 v[140:143], a[248:251], a[216:219], v[140:143]
    s_xor_b32 s86, s85, 91136
    v_exp_f32 v168, v168
    v_mfma_f32_16x16x32_bf16 v[140:143], a[244:247], a[212:215], v[140:143]
    s_xor_b32 m0, s35, 78848
    v_exp_f32 v169, v169
    v_mfma_f32_16x16x32_bf16 v[140:143], a[240:243], a[208:211], v[140:143]
    s_waitcnt lgkmcnt(0)
    buffer_load_dwordx4 v255, s[20:23], s86 offen  lds
    v_cvt_pk_bf16_f32 v17, v162, v163
    v_cvt_pk_bf16_f32 v20, v164, v165
    v_exp_f32 v170, v170
    v_pk_fma_f32 v[132:133], v[132:133], s[88:89], v[230:231] op_sel_hi:[1,1,0]
    v_pk_fma_f32 v[134:135], v[134:135], s[88:89], v[230:231] op_sel_hi:[1,1,0]
    v_pk_fma_f32 v[136:137], v[136:137], s[88:89], v[232:233] op_sel_hi:[1,1,0]
    v_exp_f32 v171, v171
    v_cvt_pk_bf16_f32 v21, v166, v167
    v_exp_f32 v172, v172
    v_mfma_f32_16x16x32_bf16 v[144:147], a[224:227], a[128:131], 0
    ds_read_b128 a[240:243], v237 offset:20480
    v_cvt_pk_bf16_f32 v24, v168, v169
    v_mfma_f32_16x16x32_bf16 v[144:147], a[228:231], a[132:135], v[144:147]
    ds_read_b128 a[244:247], v237 offset:20736
    v_cvt_pk_bf16_f32 v25, v170, v171
    v_mfma_f32_16x16x32_bf16 v[144:147], a[232:235], a[136:139], v[144:147]
    s_mov_b32 m0, s42
    v_exp_f32 v173, v173
    v_mfma_f32_16x16x32_bf16 v[144:147], a[236:239], a[140:143], v[144:147]
    buffer_load_dwordx4 v246, s[12:15], s80 offen offset:0 nt lds
    v_cvt_pk_bf16_f32 v28, v172, v173
    v_exp_f32 v174, v174
    v_exp_f32 v175, v175
    v_pk_fma_f32 v[138:139], v[138:139], s[88:89], v[232:233] op_sel_hi:[1,1,0]
    v_pk_fma_f32 v[140:141], v[140:141], s[88:89], v[234:235] op_sel_hi:[1,1,0]
    v_pk_fma_f32 v[142:143], v[142:143], s[88:89], v[234:235] op_sel_hi:[1,1,0]
    v_exp_f32 v128, v128
    v_exp_f32 v129, v129
    v_mfma_f32_16x16x32_bf16 v[148:151], a[236:239], a[156:159], 0
    ds_read_b128 a[248:251], v237 offset:20992
    v_cvt_pk_bf16_f32 v29, v174, v175
    v_mfma_f32_16x16x32_bf16 v[148:151], a[232:235], a[152:155], v[148:151]
    ds_read_b128 a[252:255], v237 offset:21248
    v_cvt_pk_bf16_f32 v18, v128, v129
    v_mfma_f32_16x16x32_bf16 v[148:151], a[228:231], a[148:151], v[148:151]
    s_mov_b32 m0, s42
    v_exp_f32 v130, v130
    v_mfma_f32_16x16x32_bf16 v[148:151], a[224:227], a[144:147], v[148:151]
    buffer_load_dwordx4 v247, s[12:15], s80 offen offset:1024 nt lds
    v_fmamk_f32 v144, v144, 0x3e0293ee, v228
    v_exp_f32 v131, v131
    v_exp_f32 v132, v132
    v_exp_f32 v133, v133
    v_exp_f32 v134, v134
    v_exp_f32 v135, v135
    v_cvt_pk_bf16_f32 v19, v130, v131
    v_mfma_f32_16x16x32_bf16 v[152:155], a[224:227], a[192:195], 0
    v_exp_f32 v136, v136
    v_mfma_f32_16x16x32_bf16 v[152:155], a[228:231], a[196:199], v[152:155]
    v_exp_f32 v137, v137
    v_mfma_f32_16x16x32_bf16 v[152:155], a[232:235], a[200:203], v[152:155]
    s_mov_b32 m0, s42
    v_exp_f32 v138, v138
    v_mfma_f32_16x16x32_bf16 v[152:155], a[236:239], a[204:207], v[152:155]
    buffer_load_dwordx4 v246, s[12:15], s80 offen offset:2048 nt lds
    v_cvt_pk_bf16_f32 v22, v132, v133
    v_exp_f32 v139, v139
    v_cvt_pk_bf16_f32 v23, v134, v135
    v_exp_f32 v140, v140
    v_fmamk_f32 v145, v145, 0x3e0293ee, v228
    v_pk_fma_f32 v[146:147], v[146:147], s[88:89], v[228:229] op_sel_hi:[1,1,0]
    v_pk_fma_f32 v[148:149], v[148:149], s[88:89], v[230:231] op_sel_hi:[1,1,0]
    v_pk_fma_f32 v[150:151], v[150:151], s[88:89], v[230:231] op_sel_hi:[1,1,0]
    v_pk_fma_f32 v[152:153], v[152:153], s[88:89], v[232:233] op_sel_hi:[1,1,0]
    v_exp_f32 v141, v141
    v_mfma_f32_16x16x32_bf16 v[156:159], a[236:239], a[220:223], 0
    v_exp_f32 v142, v142
    v_mfma_f32_16x16x32_bf16 v[156:159], a[232:235], a[216:219], v[156:159]
    v_exp_f32 v143, v143
    v_mfma_f32_16x16x32_bf16 v[156:159], a[228:231], a[212:215], v[156:159]
    s_mov_b32 m0, s42
    v_exp_f32 v144, v144
    v_mfma_f32_16x16x32_bf16 v[156:159], a[224:227], a[208:211], v[156:159]
    s_waitcnt lgkmcnt(0)
    buffer_load_dwordx4 v247, s[12:15], s80 offen offset:3072 nt lds
    v_cvt_pk_bf16_f32 v26, v136, v137
    v_cvt_pk_bf16_f32 v27, v138, v139
    v_exp_f32 v145, v145
    v_pk_fma_f32 v[154:155], v[154:155], s[88:89], v[232:233] op_sel_hi:[1,1,0]
    v_cvt_pk_bf16_f32 v30, v140, v141
    v_exp_f32 v146, v146
    v_pk_fma_f32 v[156:157], v[156:157], s[88:89], v[234:235] op_sel_hi:[1,1,0]
    v_pk_fma_f32 v[158:159], v[158:159], s[88:89], v[234:235] op_sel_hi:[1,1,0]
    v_mfma_f32_16x16x32_bf16 v[160:163], a[240:243], a[128:131], 0
    ds_read_b128 a[224:227], v237 offset:24576
    v_cvt_pk_bf16_f32 v31, v142, v143
    v_mfma_f32_16x16x32_bf16 v[160:163], a[244:247], a[132:135], v[160:163]
    ds_read_b128 a[228:231], v237 offset:24832
    v_cvt_pk_bf16_f32 v32, v144, v145
    v_mfma_f32_16x16x32_bf16 v[160:163], a[248:251], a[136:139], v[160:163]
    s_mov_b32 m0, s43
    v_exp_f32 v147, v147
    v_mfma_f32_16x16x32_bf16 v[160:163], a[252:255], a[140:143], v[160:163]
    buffer_load_dwordx4 v246, s[12:15], s81 offen offset:0 nt lds
    v_cvt_pk_bf16_f32 v33, v146, v147
    v_exp_f32 v148, v148
    v_exp_f32 v149, v149
    v_exp_f32 v150, v150
    v_exp_f32 v151, v151
    v_exp_f32 v152, v152
    v_mfma_f32_16x16x32_bf16 v[164:167], a[252:255], a[156:159], 0
    ds_read_b128 a[232:235], v237 offset:25088
    v_cvt_pk_bf16_f32 v36, v148, v149
    v_mfma_f32_16x16x32_bf16 v[164:167], a[248:251], a[152:155], v[164:167]
    ds_read_b128 a[236:239], v237 offset:25344
    v_cvt_pk_bf16_f32 v37, v150, v151
    v_mfma_f32_16x16x32_bf16 v[164:167], a[244:247], a[148:151], v[164:167]
    s_mov_b32 m0, s43
    v_exp_f32 v153, v153
    v_mfma_f32_16x16x32_bf16 v[164:167], a[240:243], a[144:147], v[164:167]
    buffer_load_dwordx4 v247, s[12:15], s81 offen offset:1024 nt lds
    v_cvt_pk_bf16_f32 v40, v152, v153
    v_exp_f32 v154, v154
    v_exp_f32 v155, v155
    v_pk_fma_f32 v[160:161], v[160:161], s[88:89], v[228:229] op_sel_hi:[1,1,0]
    v_pk_fma_f32 v[162:163], v[162:163], s[88:89], v[228:229] op_sel_hi:[1,1,0]
    v_exp_f32 v156, v156
    v_exp_f32 v157, v157
    v_pk_fma_f32 v[164:165], v[164:165], s[88:89], v[230:231] op_sel_hi:[1,1,0]
    v_pk_fma_f32 v[166:167], v[166:167], s[88:89], v[230:231] op_sel_hi:[1,1,0]
    v_exp_f32 v158, v158
    v_mfma_f32_16x16x32_bf16 v[168:171], a[240:243], a[192:195], 0
    v_exp_f32 v159, v159
    v_mfma_f32_16x16x32_bf16 v[168:171], a[244:247], a[196:199], v[168:171]
    v_exp_f32 v160, v160
    v_mfma_f32_16x16x32_bf16 v[168:171], a[248:251], a[200:203], v[168:171]
    s_mov_b32 m0, s43
    v_exp_f32 v161, v161
    v_mfma_f32_16x16x32_bf16 v[168:171], a[252:255], a[204:207], v[168:171]
    buffer_load_dwordx4 v246, s[12:15], s81 offen offset:2048 nt lds
    v_cvt_pk_bf16_f32 v41, v154, v155
    v_cvt_pk_bf16_f32 v44, v156, v157
    v_exp_f32 v162, v162
    v_exp_f32 v163, v163
    v_cvt_pk_bf16_f32 v45, v158, v159
    v_mfma_f32_16x16x32_bf16 v[172:175], a[252:255], a[220:223], 0
    v_exp_f32 v164, v164
    v_mfma_f32_16x16x32_bf16 v[172:175], a[248:251], a[216:219], v[172:175]
    v_exp_f32 v165, v165
    v_mfma_f32_16x16x32_bf16 v[172:175], a[244:247], a[212:215], v[172:175]
    s_mov_b32 m0, s43
    v_exp_f32 v166, v166
    v_mfma_f32_16x16x32_bf16 v[172:175], a[240:243], a[208:211], v[172:175]
    s_waitcnt lgkmcnt(0)
    buffer_load_dwordx4 v247, s[12:15], s81 offen offset:3072 nt lds
    v_cvt_pk_bf16_f32 v34, v160, v161
    v_exp_f32 v167, v167
    v_pk_fma_f32 v[168:169], v[168:169], s[88:89], v[232:233] op_sel_hi:[1,1,0]
    v_pk_fma_f32 v[170:171], v[170:171], s[88:89], v[232:233] op_sel_hi:[1,1,0]
    v_cvt_pk_bf16_f32 v35, v162, v163
    v_mfma_f32_16x16x32_bf16 v[128:131], a[224:227], a[128:131], 0
    ds_read_b128 a[240:243], v237 offset:28672
    v_cvt_pk_bf16_f32 v38, v164, v165
    v_mfma_f32_16x16x32_bf16 v[128:131], a[228:231], a[132:135], v[128:131]
    ds_read_b128 a[244:247], v237 offset:28928
    s_xor_b32 s86, s85, 69632
    v_mfma_f32_16x16x32_bf16 v[128:131], a[232:235], a[136:139], v[128:131]
    s_xor_b32 m0, s35, 98304
    v_exp_f32 v168, v168
    v_mfma_f32_16x16x32_bf16 v[128:131], a[236:239], a[140:143], v[128:131]
    s_cmp_eq_u32 s68, 0
    s_cbranch_scc1 L_sk46
    buffer_load_dwordx4 v241, s[20:23], s86 offen  lds
L_sk46:
    v_cvt_pk_bf16_f32 v39, v166, v167
    v_exp_f32 v169, v169
    v_exp_f32 v170, v170
    v_pk_fma_f32 v[172:173], v[172:173], s[88:89], v[234:235] op_sel_hi:[1,1,0]
    v_pk_fma_f32 v[174:175], v[174:175], s[88:89], v[234:235] op_sel_hi:[1,1,0]
    v_exp_f32 v171, v171
    v_pk_fma_f32 v[128:129], v[128:129], s[88:89], v[228:229] op_sel_hi:[1,1,0]
    v_pk_fma_f32 v[130:131], v[130:131], s[88:89], v[228:229] op_sel_hi:[1,1,0]
    v_mfma_f32_16x16x32_bf16 v[132:135], a[236:239], a[156:159], 0
    ds_read_b128 a[248:251], v237 offset:29184
    v_cvt_pk_bf16_f32 v42, v168, v169
    v_mfma_f32_16x16x32_bf16 v[132:135], a[232:235], a[152:155], v[132:135]
    ds_read_b128 a[252:255], v237 offset:29440
    s_xor_b32 s86, s85, 70656
    v_mfma_f32_16x16x32_bf16 v[132:135], a[228:231], a[148:151], v[132:135]
    s_xor_b32 m0, s35, 99328
    v_exp_f32 v172, v172
    v_mfma_f32_16x16x32_bf16 v[132:135], a[224:227], a[144:147], v[132:135]
    s_cmp_eq_u32 s68, 0
    s_cbranch_scc1 L_sk47
    buffer_load_dwordx4 v255, s[20:23], s86 offen  lds
L_sk47:
    v_cvt_pk_bf16_f32 v43, v170, v171
    v_exp_f32 v173, v173
    v_exp_f32 v174, v174
    v_exp_f32 v175, v175
    v_mfma_f32_16x16x32_bf16 v[136:139], a[224:227], a[192:195], 0
    v_exp_f32 v128, v128
    v_mfma_f32_16x16x32_bf16 v[136:139], a[228:231], a[196:199], v[136:139]
    s_xor_b32 s86, s85, 77824
    v_exp_f32 v129, v129
    v_mfma_f32_16x16x32_bf16 v[136:139], a[232:235], a[200:203], v[136:139]
    s_xor_b32 m0, s35, 102400
    v_exp_f32 v130, v130
    v_mfma_f32_16x16x32_bf16 v[136:139], a[236:239], a[204:207], v[136:139]
    s_cmp_eq_u32 s68, 0
    s_cbranch_scc1 L_sk48
    buffer_load_dwordx4 v241, s[20:23], s86 offen  lds
L_sk48:
    v_cvt_pk_bf16_f32 v46, v172, v173
    v_cvt_pk_bf16_f32 v47, v174, v175
    v_exp_f32 v131, v131
    v_pk_fma_f32 v[132:133], v[132:133], s[88:89], v[230:231] op_sel_hi:[1,1,0]
    v_pk_fma_f32 v[134:135], v[134:135], s[88:89], v[230:231] op_sel_hi:[1,1,0]
    v_mfma_f32_16x16x32_bf16 v[140:143], a[236:239], a[220:223], 0
    v_exp_f32 v132, v132
    v_mfma_f32_16x16x32_bf16 v[140:143], a[232:235], a[216:219], v[140:143]
    s_xor_b32 s86, s85, 78848
    v_exp_f32 v133, v133
    v_mfma_f32_16x16x32_bf16 v[140:143], a[228:231], a[212:215], v[140:143]
    s_xor_b32 m0, s35, 103424
    v_exp_f32 v134, v134
    v_mfma_f32_16x16x32_bf16 v[140:143], a[224:227], a[208:211], v[140:143]
    s_waitcnt lgkmcnt(0)
    s_cmp_eq_u32 s68, 0
    s_cbranch_scc1 L_sk49
    buffer_load_dwordx4 v255, s[20:23], s86 offen  lds
L_sk49:
    v_cvt_pk_bf16_f32 v48, v128, v129
    v_cvt_pk_bf16_f32 v49, v130, v131
    v_exp_f32 v135, v135
    v_pk_fma_f32 v[136:137], v[136:137], s[88:89], v[232:233] op_sel_hi:[1,1,0]
    v_pk_fma_f32 v[138:139], v[138:139], s[88:89], v[232:233] op_sel_hi:[1,1,0]
    v_pk_fma_f32 v[140:141], v[140:141], s[88:89], v[234:235] op_sel_hi:[1,1,0]
    v_pk_fma_f32 v[142:143], v[142:143], s[88:89], v[234:235] op_sel_hi:[1,1,0]
    v_mfma_f32_16x16x32_bf16 v[144:147], a[240:243], a[128:131], 0
    v_exp_f32 v136, v136
    v_mfma_f32_16x16x32_bf16 v[144:147], a[244:247], a[132:135], v[144:147]
    s_xor_b32 s86, s85, 86016
    v_exp_f32 v137, v137
    v_mfma_f32_16x16x32_bf16 v[144:147], a[248:251], a[136:139], v[144:147]
    s_xor_b32 m0, s35, 106496
    v_exp_f32 v138, v138
    v_mfma_f32_16x16x32_bf16 v[144:147], a[252:255], a[140:143], v[144:147]
    s_cmp_eq_u32 s68, 0
    s_cbranch_scc1 L_sk50
    buffer_load_dwordx4 v241, s[20:23], s86 offen  lds
L_sk50:
    v_cvt_pk_bf16_f32 v52, v132, v133
    v_cvt_pk_bf16_f32 v53, v134, v135
    v_exp_f32 v139, v139
    v_mfma_f32_16x16x32_bf16 v[148:151], a[252:255], a[156:159], 0
    v_exp_f32 v140, v140
    v_mfma_f32_16x16x32_bf16 v[148:151], a[248:251], a[152:155], v[148:151]
    s_xor_b32 s86, s85, 87040
    v_exp_f32 v141, v141
    v_mfma_f32_16x16x32_bf16 v[148:151], a[244:247], a[148:151], v[148:151]
    s_xor_b32 m0, s35, 107520
    v_exp_f32 v142, v142
    v_mfma_f32_16x16x32_bf16 v[148:151], a[240:243], a[144:147], v[148:151]
    s_cmp_eq_u32 s68, 0
    s_cbranch_scc1 L_sk51
    buffer_load_dwordx4 v255, s[20:23], s86 offen  lds
L_sk51:
    v_cvt_pk_bf16_f32 v56, v136, v137
    v_cvt_pk_bf16_f32 v57, v138, v139
    v_exp_f32 v143, v143
    v_pk_fma_f32 v[144:145], v[144:145], s[88:89], v[228:229] op_sel_hi:[1,1,0]
    v_pk_fma_f32 v[146:147], v[146:147], s[88:89], v[228:229] op_sel_hi:[1,1,0]
    v_mfma_f32_16x16x32_bf16 v[152:155], a[240:243], a[192:195], 0
    v_exp_f32 v144, v144
    v_mfma_f32_16x16x32_bf16 v[152:155], a[244:247], a[196:199], v[152:155]
    s_xor_b32 s86, s85, 94208
    v_exp_f32 v145, v145
    v_mfma_f32_16x16x32_bf16 v[152:155], a[248:251], a[200:203], v[152:155]
    s_xor_b32 m0, s35, 110592
    v_exp_f32 v146, v146
    v_mfma_f32_16x16x32_bf16 v[152:155], a[252:255], a[204:207], v[152:155]
    s_cmp_eq_u32 s68, 0
    s_cbranch_scc1 L_sk52
    buffer_load_dwordx4 v241, s[20:23], s86 offen  lds
L_sk52:
    v_cvt_pk_bf16_f32 v60, v140, v141
    v_cvt_pk_bf16_f32 v61, v142, v143
    v_exp_f32 v147, v147
    v_pk_fma_f32 v[148:149], v[148:149], s[88:89], v[230:231] op_sel_hi:[1,1,0]
    v_pk_fma_f32 v[150:151], v[150:151], s[88:89], v[230:231] op_sel_hi:[1,1,0]
    v_mfma_f32_16x16x32_bf16 v[156:159], a[252:255], a[220:223], 0
    v_exp_f32 v148, v148
    v_mfma_f32_16x16x32_bf16 v[156:159], a[248:251], a[216:219], v[156:159]
    s_xor_b32 s86, s85, 95232
    v_exp_f32 v149, v149
    v_mfma_f32_16x16x32_bf16 v[156:159], a[244:247], a[212:215], v[156:159]
    s_xor_b32 m0, s35, 111616
    v_exp_f32 v150, v150
    v_mfma_f32_16x16x32_bf16 v[156:159], a[240:243], a[208:211], v[156:159]
    s_cmp_eq_u32 s68, 0
    s_cbranch_scc1 L_sk53
    buffer_load_dwordx4 v255, s[20:23], s86 offen  lds
L_sk53:
    v_cvt_pk_bf16_f32 v50, v144, v145
    v_cvt_pk_bf16_f32 v51, v146, v147
    v_exp_f32 v151, v151
    v_pk_fma_f32 v[152:153], v[152:153], s[88:89], v[232:233] op_sel_hi:[1,1,0]
    v_pk_fma_f32 v[154:155], v[154:155], s[88:89], v[232:233] op_sel_hi:[1,1,0]
    s_cmp_eq_u32 s68, 0
    s_cbranch_scc0 L_w3_y
    s_waitcnt vmcnt(8)
L_w3_y:
    s_waitcnt vmcnt(16)
    s_barrier
    v_mfma_f32_16x16x32_bf16 v[160:163], v[248:251], v[0:3], 0
    ds_read_b128 a[224:227], v237 offset:32768
    v_cvt_pk_bf16_f32 v54, v148, v149
    s_nop 1
    v_mfma_f32_16x16x32_bf16 v[160:163], v[248:251], v[16:19], v[160:163]
    ds_read_b128 a[228:231], v237 offset:33024
    v_cvt_pk_bf16_f32 v55, v150, v151
    s_nop 1
    v_mfma_f32_16x16x32_bf16 v[160:163], v[248:251], v[32:35], v[160:163]
    v_exp_f32 v152, v152
    v_mfma_f32_16x16x32_bf16 v[160:163], v[248:251], v[48:51], v[160:163]
    v_exp_f32 v153, v153
    v_exp_f32 v154, v154
    v_exp_f32 v155, v155
    v_pk_fma_f32 v[156:157], v[156:157], s[88:89], v[234:235] op_sel_hi:[1,1,0]
    v_pk_fma_f32 v[158:159], v[158:159], s[88:89], v[234:235] op_sel_hi:[1,1,0]
    v_mfma_f32_16x16x32_bf16 v[164:167], v[248:251], v[4:7], 0
    ds_read_b128 a[232:235], v237 offset:33280
    v_cvt_pk_bf16_f32 v58, v152, v153
    s_nop 1
    v_mfma_f32_16x16x32_bf16 v[164:167], v[248:251], v[20:23], v[164:167]
    ds_read_b128 a[236:239], v237 offset:33536
    v_cvt_pk_bf16_f32 v59, v154, v155
    s_nop 1
    v_mfma_f32_16x16x32_bf16 v[164:167], v[248:251], v[36:39], v[164:167]
    v_exp_f32 v156, v156
    v_mfma_f32_16x16x32_bf16 v[164:167], v[248:251], v[52:55], v[164:167]
    v_exp_f32 v157, v157
    v_exp_f32 v158, v158
    v_exp_f32 v159, v159
    v_mfma_f32_16x16x32_bf16 v[168:171], v[248:251], v[8:11], 0
    v_cvt_pk_bf16_f32 v62, v156, v157
    v_cvt_pk_bf16_f32 v63, v158, v159
    s_nop 1
    v_mfma_f32_16x16x32_bf16 v[168:171], v[248:251], v[24:27], v[168:171]
    v_mfma_f32_16x16x32_bf16 v[168:171], v[248:251], v[40:43], v[168:171]
    v_mfma_f32_16x16x32_bf16 v[168:171], v[248:251], v[56:59], v[168:171]
    v_mfma_f32_16x16x32_bf16 v[172:175], v[248:251], v[12:15], 0
    v_mfma_f32_16x16x32_bf16 v[172:175], v[248:251], v[28:31], v[172:175]
    v_mfma_f32_16x16x32_bf16 v[172:175], v[248:251], v[44:47], v[172:175]
    v_mfma_f32_16x16x32_bf16 v[172:175], v[248:251], v[60:63], v[172:175]
    s_waitcnt lgkmcnt(0)
    s_add_u32 s16, s62, s59
    s_addc_u32 s17, s63, 0
    s_add_u32 s20, s64, s60
    s_addc_u32 s21, s65, 0
    s_cmp_eq_u32 s68, 1
    s_cbranch_scc1 L_ph3s
L_ph1s:
    s_cmp_lt_u32 s34, 2
    s_cbranch_scc0 L_nt54
    s_getpc_b64 s[72:73]
L_pc54:
    s_add_u32 s72, s72, L_ph2s-L_pc54
    s_addc_u32 s73, s73, (L_ph2s-L_pc54)>>32
    v_mbcnt_lo_u32_b32 v222, -1, 0
    v_mbcnt_hi_u32_b32 v222, -1, v222
    v_lshrrev_b32 v222, 2, v222
    v_lshl_add_u32 v222, s32, 4, v222
    v_lshlrev_b32 v222, 7, v222
    v_min_u32 v222, L_ph3s-L_ph2s, v222
    v_mov_b32 v223, s73
    v_add_co_u32 v222, vcc, s72, v222
    s_nop 1
    v_addc_co_u32 v223, vcc, 0, v223, vcc
    global_load_dword v254, v[222:223], off
L_nt54:
    s_cmp_eq_u32 s34, s61
    s_cbranch_scc0 L_nt55
    s_getpc_b64 s[72:73]
L_pc55:
    s_add_u32 s72, s72, L_ph2f-L_pc55
    s_addc_u32 s73, s73, (L_ph2f-L_pc55)>>32
    v_mbcnt_lo_u32_b32 v222, -1, 0
    v_mbcnt_hi_u32_b32 v222, -1, v222
    v_lshrrev_b32 v222, 2, v222
    v_lshl_add_u32 v222, s32, 4, v222
    v_lshlrev_b32 v222, 7, v222
    v_min_u32 v222, L_ph3f-L_ph2f, v222
    v_mov_b32 v223, s73
    v_add_co_u32 v222, vcc, s72, v222
    s_nop 1
    v_addc_co_u32 v223, vcc, 0, v223, vcc
    global_load_dword v254, v[222:223], off
L_nt55:
    v_mfma_f32_16x16x32_bf16 v[128:131], a[224:227], a[128:131], 0
    ds_read_b128 a[240:243], v237 offset:36864
    v_mfma_f32_16x16x32_bf16 v[128:131], a[228:231], a[132:135], v[128:131]
    ds_read_b128 a[244:247], v237 offset:37120
    s_xor_b32 s86, s85, 69632
    v_mfma_f32_16x16x32_bf16 v[128:131], a[232:235], a[136:139], v[128:131]
    s_xor_b32 m0, s35, 98304
    v_mfma_f32_16x16x32_bf16 v[128:131], a[236:239], a[140:143], v[128:131]
    buffer_load_dwordx4 v241, s[20:23], s86 offen nt lds
    v_max3_f32 v220, v160, v164, v168
    v_mfma_f32_16x16x32_bf16 v[132:135], a[236:239], a[156:159], 0
    ds_read_b128 a[248:251], v237 offset:37376
    v_mfma_f32_16x16x32_bf16 v[132:135], a[232:235], a[152:155], v[132:135]
    ds_read_b128 a[252:255], v237 offset:37632
    v_mfma_f32_16x16x32_bf16 v[132:135], a[228:231], a[148:151], v[132:135]
    v_max_f32 v220, v220, v172
    v_cmp_lt_f32 vcc, 0x5f800000, v220
    v_mfma_f32_16x16x32_bf16 v[132:135], a[224:227], a[144:147], v[132:135]
    s_cbranch_vccnz L_chk56_redo
L_chk56:
    v_fmamk_f32 v128, v128, 0x3e0293ee, v228
    v_mov_b32 v229, v160
    v_mfma_f32_16x16x32_bf16 v[136:139], a[224:227], a[192:195], 0
    v_exp_f32 v128, v128
    v_mfma_f32_16x16x32_bf16 v[136:139], a[228:231], a[196:199], v[136:139]
    s_xor_b32 s86, s85, 70656
    v_mov_b32 v231, v164
    v_fmamk_f32 v129, v129, 0x3e0293ee, v228
    v_mfma_f32_16x16x32_bf16 v[136:139], a[232:235], a[200:203], v[136:139]
    s_xor_b32 m0, s35, 99328
    v_exp_f32 v129, v129
    v_mfma_f32_16x16x32_bf16 v[136:139], a[236:239], a[204:207], v[136:139]
    buffer_load_dwordx4 v255, s[20:23], s86 offen nt lds
    v_mov_b32 v233, v168
    v_fmamk_f32 v130, v130, 0x3e0293ee, v228
    v_mov_b32 v235, v172
    v_mfma_f32_16x16x32_bf16 v[140:143], a[236:239], a[220:223], 0
    v_mfma_f32_16x16x32_bf16 v[140:143], a[232:235], a[216:219], v[140:143]
    v_exp_f32 v130, v130
    v_mfma_f32_16x16x32_bf16 v[140:143], a[228:231], a[212:215], v[140:143]
    v_accvgpr_read_b32 v212, a64
    v_fmamk_f32 v131, v131, 0x3e0293ee, v228
    v_mfma_f32_16x16x32_bf16 v[140:143], a[224:227], a[208:211], v[140:143]
    s_waitcnt lgkmcnt(0)
    v_exp_f32 v131, v131
    v_accvgpr_read_b32 v213, a65
    v_fmamk_f32 v132, v132, 0x3e0293ee, v230
    v_cvt_pk_bf16_f32 v64, v128, v129
    v_mfma_f32_16x16x32_bf16 v[144:147], a[240:243], a[128:131], 0
    ds_read_b64_tr_b16 a[224:225], v244 offset:0
    v_mfma_f32_16x16x32_bf16 v[144:147], a[244:247], a[132:135], v[144:147]
    ds_read_b64_tr_b16 a[226:227], v244 offset:4096
    v_mfma_f32_16x16x32_bf16 v[144:147], a[248:251], a[136:139], v[144:147]
    ds_read_b64_tr_b16 a[228:229], v244 offset:8192
    v_mfma_f32_16x16x32_bf16 v[144:147], a[252:255], a[140:143], v[144:147]
    v_exp_f32 v132, v132
    v_mul_f32 v212, v212, v236
    v_accvgpr_read_b32 v214, a66
    v_fmamk_f32 v133, v133, 0x3e0293ee, v230
    v_mul_f32 v213, v213, v236
    v_fmamk_f32 v134, v134, 0x3e0293ee, v230
    v_accvgpr_read_b32 v215, a67
    v_cvt_pk_bf16_f32 v65, v130, v131
    v_mfma_f32_16x16x32_bf16 v[148:151], a[252:255], a[156:159], 0
    ds_read_b64_tr_b16 a[230:231], v244 offset:12288
    v_mfma_f32_16x16x32_bf16 v[148:151], a[248:251], a[152:155], v[148:151]
    ds_read_b64_tr_b16 a[232:233], v244 offset:16384
    s_xor_b32 s86, s85, 77824
    v_mfma_f32_16x16x32_bf16 v[148:151], a[244:247], a[148:151], v[148:151]
    ds_read_b64_tr_b16 a[234:235], v244 offset:20480
    s_xor_b32 m0, s35, 102400
    v_mfma_f32_16x16x32_bf16 v[148:151], a[240:243], a[144:147], v[148:151]
    buffer_load_dwordx4 v241, s[20:23], s86 offen nt lds
    v_fmamk_f32 v135, v135, 0x3e0293ee, v230
    v_exp_f32 v133, v133
    v_mul_f32 v214, v214, v236
    v_accvgpr_read_b32 v216, a68
    v_exp_f32 v134, v134
    v_fmamk_f32 v136, v136, 0x3e0293ee, v232
    v_cvt_pk_bf16_f32 v68, v132, v133
    v_mul_f32 v215, v215, v236
    v_accvgpr_read_b32 v217, a69
    v_mfma_f32_16x16x32_bf16 v[152:155], a[240:243], a[192:195], 0
    ds_read_b64_tr_b16 a[236:237], v244 offset:24576
    v_mfma_f32_16x16x32_bf16 v[152:155], a[244:247], a[196:199], v[152:155]
    ds_read_b64_tr_b16 a[238:239], v244 offset:28672
    v_mfma_f32_16x16x32_bf16 v[152:155], a[248:251], a[200:203], v[152:155]
    v_exp_f32 v135, v135
    v_mfma_f32_16x16x32_bf16 v[152:155], a[252:255], a[204:207], v[152:155]
    v_exp_f32 v136, v136
    v_fmamk_f32 v137, v137, 0x3e0293ee, v232
    v_cvt_pk_bf16_f32 v180, v212, v213
    v_mul_f32 v216, v216, v236
    v_accvgpr_read_b32 v218, a70
    v_fmamk_f32 v138, v138, 0x3e0293ee, v232
    v_cvt_pk_bf16_f32 v69, v134, v135
    v_mul_f32 v217, v217, v236
    v_exp_f32 v137, v137
    v_mfma_f32_16x16x32_bf16 v[156:159], a[252:255], a[220:223], 0
    v_exp_f32 v138, v138
    v_mfma_f32_16x16x32_bf16 v[156:159], a[248:251], a[216:219], v[156:159]
    v_mfma_f32_16x16x32_bf16 v[156:159], a[244:247], a[212:215], v[156:159]
    v_accvgpr_read_b32 v219, a71
    v_fmamk_f32 v139, v139, 0x3e0293ee, v232
    v_mfma_f32_16x16x32_bf16 v[156:159], a[240:243], a[208:211], v[156:159]
    s_waitcnt lgkmcnt(0)
    v_exp_f32 v139, v139
    v_cvt_pk_bf16_f32 v181, v214, v215
    v_mul_f32 v218, v218, v236
    v_accvgpr_read_b32 v220, a72
    v_fmamk_f32 v140, v140, 0x3e0293ee, v234
    v_cvt_pk_bf16_f32 v72, v136, v137
    v_mfma_f32_16x16x32_bf16 a[0:3], a[224:227], v[0:3], 0
    ds_read_b128 a[240:243], v237 offset:40960
    v_mfma_f32_16x16x32_bf16 a[0:3], a[228:231], v[16:19], a[0:3]
    ds_read_b128 a[244:247], v237 offset:41216
    s_cmp_eq_u32 s34, 0
    s_cbranch_scc0 L_w4_0
    s_waitcnt vmcnt(3)
L_w4_0:
    s_waitcnt vmcnt(9)
    s_xor_b32 s86, s85, 78848
    v_mfma_f32_16x16x32_bf16 a[0:3], a[232:235], v[32:35], a[0:3]
    ds_read_b128 a[160:163], v239 offset:0
    s_xor_b32 m0, s35, 103424
    v_mfma_f32_16x16x32_bf16 a[0:3], a[236:239], v[48:51], a[0:3]
    buffer_load_dwordx4 v255, s[20:23], s86 offen nt lds
    v_mul_f32 v219, v219, v236
    v_fmamk_f32 v141, v141, 0x3e0293ee, v234
    v_accvgpr_read_b32 v221, a73
    v_exp_f32 v140, v140
    v_cvt_pk_bf16_f32 v182, v216, v217
    v_fmamk_f32 v142, v142, 0x3e0293ee, v234
    v_mul_f32 v220, v220, v236
    v_accvgpr_read_b32 v222, a74
    v_cvt_pk_bf16_f32 v73, v138, v139
    v_exp_f32 v141, v141
    v_mfma_f32_16x16x32_bf16 a[16:19], a[236:239], v[52:55], 0
    ds_read_b128 a[248:251], v237 offset:41472
    v_mfma_f32_16x16x32_bf16 a[16:19], a[232:235], v[36:39], a[16:19]
    ds_read_b128 a[252:255], v237 offset:41728
    v_mfma_f32_16x16x32_bf16 a[16:19], a[228:231], v[20:23], a[16:19]
    ds_read_b128 a[164:167], v239 offset:256
    v_mfma_f32_16x16x32_bf16 a[16:19], a[224:227], v[4:7], a[16:19]
    v_exp_f32 v142, v142
    v_fmamk_f32 v143, v143, 0x3e0293ee, v234
    v_mul_f32 v221, v221, v236
    v_accvgpr_read_b32 v223, a75
    v_fmamk_f32 v144, v144, 0x3e0293ee, v228
    v_cvt_pk_bf16_f32 v183, v218, v219
    v_cvt_pk_bf16_f32 v76, v140, v141
    v_mul_f32 v222, v222, v236
    v_accvgpr_read_b32 v224, a76
    v_exp_f32 v143, v143
    v_fmamk_f32 v145, v145, 0x3e0293ee, v228
    v_mfma_f32_16x16x32_bf16 a[32:35], a[224:227], v[8:11], 0
    ds_read_b128 a[168:171], v239 offset:512
    v_mfma_f32_16x16x32_bf16 a[32:35], a[228:231], v[24:27], a[32:35]
    ds_read_b128 a[172:175], v239 offset:768
    v_mfma_f32_16x16x32_bf16 a[32:35], a[232:235], v[40:43], a[32:35]
    ds_read_b128 a[176:179], v239 offset:4096
    v_mfma_f32_16x16x32_bf16 a[32:35], a[236:239], v[56:59], a[32:35]
    v_exp_f32 v144, v144
    v_mul_f32 v223, v223, v236
    v_accvgpr_read_b32 v225, a77
    v_fmamk_f32 v146, v146, 0x3e0293ee, v228
    v_cvt_pk_bf16_f32 v77, v142, v143
    v_cvt_pk_bf16_f32 v196, v220, v221
    v_exp_f32 v145, v145
    v_mul_f32 v224, v224, v236
    v_accvgpr_read_b32 v226, a78
    v_fmamk_f32 v147, v147, 0x3e0293ee, v228
    v_mfma_f32_16x16x32_bf16 a[48:51], a[236:239], v[60:63], 0
    ds_read_b128 a[180:183], v239 offset:4352
    v_mfma_f32_16x16x32_bf16 a[48:51], a[232:235], v[44:47], a[48:51]
    ds_read_b128 a[184:187], v239 offset:4608
    s_xor_b32 s86, s85, 86016
    v_mfma_f32_16x16x32_bf16 a[48:51], a[228:231], v[28:31], a[48:51]
    ds_read_b128 a[188:191], v239 offset:4864
    s_xor_b32 m0, s35, 106496
    v_mfma_f32_16x16x32_bf16 a[48:51], a[224:227], v[12:15], a[48:51]
    s_waitcnt lgkmcnt(7)
    buffer_load_dwordx4 v241, s[20:23], s86 offen nt lds
    v_exp_f32 v146, v146
    v_mul_f32 v225, v225, v236
    v_accvgpr_read_b32 v227, a79
    v_fmamk_f32 v148, v148, 0x3e0293ee, v230
    v_cvt_pk_bf16_f32 v66, v144, v145
    v_exp_f32 v147, v147
    v_cvt_pk_bf16_f32 v197, v222, v223
    v_mul_f32 v226, v226, v236
    v_fmamk_f32 v149, v149, 0x3e0293ee, v230
    v_accvgpr_read_b32 v212, a80
    v_mfma_f32_16x16x32_bf16 v[160:163], a[240:243], a[128:131], 0
    ds_read_b64_tr_b16 a[224:225], v245 offset:0
    v_mfma_f32_16x16x32_bf16 v[160:163], a[244:247], a[132:135], v[160:163]
    ds_read_b64_tr_b16 a[226:227], v245 offset:4096
    v_mfma_f32_16x16x32_bf16 v[160:163], a[248:251], a[136:139], v[160:163]
    ds_read_b64_tr_b16 a[228:229], v245 offset:8192
    v_mfma_f32_16x16x32_bf16 v[160:163], a[252:255], a[140:143], v[160:163]
    v_exp_f32 v148, v148
    v_fmamk_f32 v150, v150, 0x3e0293ee, v230
    v_mul_f32 v227, v227, v236
    v_cvt_pk_bf16_f32 v67, v146, v147
    v_accvgpr_read_b32 v213, a81
    v_exp_f32 v149, v149
    v_cvt_pk_bf16_f32 v198, v224, v225
    v_fmamk_f32 v151, v151, 0x3e0293ee, v230
    v_mul_f32 v212, v212, v238
    v_accvgpr_read_b32 v214, a82
    v_mfma_f32_16x16x32_bf16 v[164:167], a[252:255], a[156:159], 0
    ds_read_b64_tr_b16 a[230:231], v245 offset:12288
    v_mfma_f32_16x16x32_bf16 v[164:167], a[248:251], a[152:155], v[164:167]
    ds_read_b64_tr_b16 a[232:233], v245 offset:16384
    v_mfma_f32_16x16x32_bf16 v[164:167], a[244:247], a[148:151], v[164:167]
    ds_read_b64_tr_b16 a[234:235], v245 offset:20480
    v_mfma_f32_16x16x32_bf16 v[164:167], a[240:243], a[144:147], v[164:167]
    v_exp_f32 v150, v150
    v_fmamk_f32 v152, v152, 0x3e0293ee, v232
    v_cvt_pk_bf16_f32 v70, v148, v149
    v_mul_f32 v213, v213, v238
    v_accvgpr_read_b32 v215, a83
    v_exp_f32 v151, v151
    v_fmamk_f32 v153, v153, 0x3e0293ee, v232
    v_cvt_pk_bf16_f32 v199, v226, v227
    v_mul_f32 v214, v214, v238
    v_exp_f32 v152, v152
    v_mfma_f32_16x16x32_bf16 v[168:171], a[240:243], a[192:195], 0
    ds_read_b64_tr_b16 a[236:237], v245 offset:24576
    v_mfma_f32_16x16x32_bf16 v[168:171], a[244:247], a[196:199], v[168:171]
    ds_read_b64_tr_b16 a[238:239], v245 offset:28672
    s_xor_b32 s86, s85, 87040
    v_mfma_f32_16x16x32_bf16 v[168:171], a[248:251], a[200:203], v[168:171]
    s_xor_b32 m0, s35, 107520
    v_exp_f32 v153, v153
    v_mfma_f32_16x16x32_bf16 v[168:171], a[252:255], a[204:207], v[168:171]
    buffer_load_dwordx4 v255, s[20:23], s86 offen nt lds
    v_accvgpr_read_b32 v216, a84
    v_fmamk_f32 v154, v154, 0x3e0293ee, v232
    v_cvt_pk_bf16_f32 v71, v150, v151
    v_mul_f32 v215, v215, v238
    v_accvgpr_read_b32 v217, a85
    v_fmamk_f32 v155, v155, 0x3e0293ee, v232
    v_cvt_pk_bf16_f32 v184, v212, v213
    v_exp_f32 v154, v154
    v_mfma_f32_16x16x32_bf16 v[172:175], a[252:255], a[220:223], 0
    v_exp_f32 v155, v155
    v_mfma_f32_16x16x32_bf16 v[172:175], a[248:251], a[216:219], v[172:175]
    v_mul_f32 v216, v216, v238
    v_accvgpr_read_b32 v218, a86
    v_mfma_f32_16x16x32_bf16 v[172:175], a[244:247], a[212:215], v[172:175]
    v_mfma_f32_16x16x32_bf16 v[172:175], a[240:243], a[208:211], v[172:175]
    s_waitcnt lgkmcnt(0)
    v_fmamk_f32 v156, v156, 0x3e0293ee, v234
    v_cvt_pk_bf16_f32 v74, v152, v153
    v_mul_f32 v217, v217, v238
    v_fmamk_f32 v157, v157, 0x3e0293ee, v234
    v_accvgpr_read_b32 v219, a87
    v_exp_f32 v156, v156
    v_cvt_pk_bf16_f32 v185, v214, v215
    v_mfma_f32_16x16x32_bf16 a[8:11], a[224:227], v[0:3], 0
    ds_read_b128 a[240:243], v237 offset:45056
    v_mfma_f32_16x16x32_bf16 a[8:11], a[228:231], v[16:19], a[8:11]
    ds_read_b128 a[244:247], v237 offset:45312
    s_xor_b32 s86, s85, 94208
    v_mfma_f32_16x16x32_bf16 a[8:11], a[232:235], v[32:35], a[8:11]
    s_xor_b32 m0, s35, 110592
    v_exp_f32 v157, v157
    v_mfma_f32_16x16x32_bf16 a[8:11], a[236:239], v[48:51], a[8:11]
    buffer_load_dwordx4 v241, s[20:23], s86 offen nt lds
    v_fmamk_f32 v158, v158, 0x3e0293ee, v234
    v_mul_f32 v218, v218, v238
    v_cvt_pk_bf16_f32 v75, v154, v155
    v_accvgpr_read_b32 v220, a88
    v_fmamk_f32 v159, v159, 0x3e0293ee, v234
    v_mul_f32 v219, v219, v238
    v_accvgpr_read_b32 v221, a89
    v_exp_f32 v158, v158
    v_fmamk_f32 v160, v160, 0x3e0293ee, v228
    v_mfma_f32_16x16x32_bf16 a[24:27], a[236:239], v[52:55], 0
    ds_read_b128 a[248:251], v237 offset:45568
    v_mfma_f32_16x16x32_bf16 a[24:27], a[232:235], v[36:39], a[24:27]
    ds_read_b128 a[252:255], v237 offset:45824
    v_mfma_f32_16x16x32_bf16 a[24:27], a[228:231], v[20:23], a[24:27]
    v_exp_f32 v159, v159
    v_mfma_f32_16x16x32_bf16 a[24:27], a[224:227], v[4:7], a[24:27]
    v_exp_f32 v160, v160
    v_cvt_pk_bf16_f32 v186, v216, v217
    v_cvt_pk_bf16_f32 v78, v156, v157
    v_mul_f32 v220, v220, v238
    v_accvgpr_read_b32 v222, a90
    v_fmamk_f32 v161, v161, 0x3e0293ee, v228
    v_mul_f32 v221, v221, v238
    v_accvgpr_read_b32 v223, a91
    v_fmamk_f32 v162, v162, 0x3e0293ee, v228
    v_mfma_f32_16x16x32_bf16 a[40:43], a[224:227], v[8:11], 0
    v_exp_f32 v161, v161
    v_mfma_f32_16x16x32_bf16 a[40:43], a[228:231], v[24:27], a[40:43]
    v_exp_f32 v162, v162
    v_mfma_f32_16x16x32_bf16 a[40:43], a[232:235], v[40:43], a[40:43]
    v_cvt_pk_bf16_f32 v79, v158, v159
    v_cvt_pk_bf16_f32 v187, v218, v219
    v_mfma_f32_16x16x32_bf16 a[40:43], a[236:239], v[56:59], a[40:43]
    v_mul_f32 v222, v222, v238
    v_accvgpr_read_b32 v224, a92
    v_fmamk_f32 v163, v163, 0x3e0293ee, v228
    v_mul_f32 v223, v223, v238
    v_fmamk_f32 v164, v164, 0x3e0293ee, v230
    v_accvgpr_read_b32 v225, a93
    v_cvt_pk_bf16_f32 v80, v160, v161
    v_mfma_f32_16x16x32_bf16 a[56:59], a[236:239], v[60:63], 0
    v_mfma_f32_16x16x32_bf16 a[56:59], a[232:235], v[44:47], a[56:59]
    s_xor_b32 s86, s85, 95232
    v_exp_f32 v163, v163
    v_mfma_f32_16x16x32_bf16 a[56:59], a[228:231], v[28:31], a[56:59]
    s_xor_b32 m0, s35, 111616
    v_exp_f32 v164, v164
    v_mfma_f32_16x16x32_bf16 a[56:59], a[224:227], v[12:15], a[56:59]
    s_waitcnt lgkmcnt(0)
    buffer_load_dwordx4 v255, s[20:23], s86 offen nt lds
    v_cvt_pk_bf16_f32 v200, v220, v221
    v_fmamk_f32 v165, v165, 0x3e0293ee, v230
    v_mul_f32 v224, v224, v238
    v_accvgpr_read_b32 v226, a94
    v_fmamk_f32 v166, v166, 0x3e0293ee, v230
    v_mul_f32 v225, v225, v238
    v_cvt_pk_bf16_f32 v81, v162, v163
    v_accvgpr_read_b32 v227, a95
    v_mfma_f32_16x16x32_bf16 v[128:131], a[240:243], a[128:131], 0
    ds_read_b64_tr_b16 a[224:225], v244 offset:256
    v_mfma_f32_16x16x32_bf16 v[128:131], a[244:247], a[132:135], v[128:131]
    ds_read_b64_tr_b16 a[226:227], v244 offset:4352
    v_mfma_f32_16x16x32_bf16 v[128:131], a[248:251], a[136:139], v[128:131]
    ds_read_b64_tr_b16 a[228:229], v244 offset:8448
    v_mfma_f32_16x16x32_bf16 v[128:131], a[252:255], a[140:143], v[128:131]
    v_exp_f32 v165, v165
    v_fmamk_f32 v167, v167, 0x3e0293ee, v230
    v_cvt_pk_bf16_f32 v201, v222, v223
    v_mul_f32 v226, v226, v238
    v_accvgpr_read_b32 v212, a96
    v_exp_f32 v166, v166
    v_fmamk_f32 v168, v168, 0x3e0293ee, v232
    v_cvt_pk_bf16_f32 v84, v164, v165
    v_mul_f32 v227, v227, v238
    v_mfma_f32_16x16x32_bf16 v[132:135], a[252:255], a[156:159], 0
    ds_read_b64_tr_b16 a[230:231], v244 offset:12544
    v_mfma_f32_16x16x32_bf16 v[132:135], a[248:251], a[152:155], v[132:135]
    ds_read_b64_tr_b16 a[232:233], v244 offset:16640
    v_mfma_f32_16x16x32_bf16 v[132:135], a[244:247], a[148:151], v[132:135]
    ds_read_b64_tr_b16 a[234:235], v244 offset:20736
    v_mfma_f32_16x16x32_bf16 v[132:135], a[240:243], a[144:147], v[132:135]
    v_exp_f32 v167, v167
    v_accvgpr_read_b32 v213, a97
    v_fmamk_f32 v169, v169, 0x3e0293ee, v232
    v_cvt_pk_bf16_f32 v202, v224, v225
    v_exp_f32 v168, v168
    v_mul_f32 v212, v212, v240
    v_accvgpr_read_b32 v214, a98
    v_fmamk_f32 v170, v170, 0x3e0293ee, v232
    v_cvt_pk_bf16_f32 v85, v166, v167
    v_exp_f32 v169, v169
    v_mfma_f32_16x16x32_bf16 v[136:139], a[240:243], a[192:195], 0
    ds_read_b64_tr_b16 a[236:237], v244 offset:24832
    v_mfma_f32_16x16x32_bf16 v[136:139], a[244:247], a[196:199], v[136:139]
    ds_read_b64_tr_b16 a[238:239], v244 offset:28928
    v_mfma_f32_16x16x32_bf16 v[136:139], a[248:251], a[200:203], v[136:139]
    s_mov_b32 m0, s42
    v_exp_f32 v170, v170
    v_mfma_f32_16x16x32_bf16 v[136:139], a[252:255], a[204:207], v[136:139]
    buffer_load_dwordx4 v246, s[12:15], s82 offen offset:0 nt lds
    v_mul_f32 v213, v213, v240
    v_accvgpr_read_b32 v215, a99
    v_fmamk_f32 v171, v171, 0x3e0293ee, v232
    v_cvt_pk_bf16_f32 v203, v226, v227
    v_mul_f32 v214, v214, v240
    v_fmamk_f32 v172, v172, 0x3e0293ee, v234
    v_accvgpr_read_b32 v216, a100
    v_cvt_pk_bf16_f32 v88, v168, v169
    v_exp_f32 v171, v171
    v_mfma_f32_16x16x32_bf16 v[140:143], a[252:255], a[220:223], 0
    v_exp_f32 v172, v172
    v_mfma_f32_16x16x32_bf16 v[140:143], a[248:251], a[216:219], v[140:143]
    v_mfma_f32_16x16x32_bf16 v[140:143], a[244:247], a[212:215], v[140:143]
    v_fmamk_f32 v173, v173, 0x3e0293ee, v234
    v_mul_f32 v215, v215, v240
    v_mfma_f32_16x16x32_bf16 v[140:143], a[240:243], a[208:211], v[140:143]
    s_waitcnt lgkmcnt(0)
    v_exp_f32 v173, v173
    v_accvgpr_read_b32 v217, a101
    v_cvt_pk_bf16_f32 v188, v212, v213
    v_fmamk_f32 v174, v174, 0x3e0293ee, v234
    v_cvt_pk_bf16_f32 v89, v170, v171
    v_mul_f32 v216, v216, v240
    v_accvgpr_read_b32 v218, a102
    v_mfma_f32_16x16x32_bf16 a[4:7], a[224:227], v[0:3], 0
    ds_read_b128 a[240:243], v237 offset:49152
    v_mfma_f32_16x16x32_bf16 a[4:7], a[228:231], v[16:19], a[4:7]
    ds_read_b128 a[244:247], v237 offset:49408
    v_mfma_f32_16x16x32_bf16 a[4:7], a[232:235], v[32:35], a[4:7]
    v_exp_f32 v174, v174
    v_mfma_f32_16x16x32_bf16 a[4:7], a[236:239], v[48:51], a[4:7]
    v_fmamk_f32 v175, v175, 0x3e0293ee, v234
    v_mul_f32 v217, v217, v240
    v_accvgpr_read_b32 v219, a103
    v_fmamk_f32 v128, v128, 0x3e0293ee, v228
    v_cvt_pk_bf16_f32 v92, v172, v173
    v_cvt_pk_bf16_f32 v189, v214, v215
    v_mul_f32 v218, v218, v240
    v_exp_f32 v175, v175
    v_accvgpr_read_b32 v220, a104
    v_fmamk_f32 v129, v129, 0x3e0293ee, v228
    v_mfma_f32_16x16x32_bf16 a[20:23], a[236:239], v[52:55], 0
    ds_read_b128 a[248:251], v237 offset:49664
    v_mfma_f32_16x16x32_bf16 a[20:23], a[232:235], v[36:39], a[20:23]
    ds_read_b128 a[252:255], v237 offset:49920
    v_mfma_f32_16x16x32_bf16 a[20:23], a[228:231], v[20:23], a[20:23]
    s_mov_b32 m0, s42
    v_exp_f32 v128, v128
    v_mfma_f32_16x16x32_bf16 a[20:23], a[224:227], v[4:7], a[20:23]
    buffer_load_dwordx4 v247, s[12:15], s82 offen offset:1024 nt lds
    v_mul_f32 v219, v219, v240
    v_accvgpr_read_b32 v221, a105
    v_fmamk_f32 v130, v130, 0x3e0293ee, v228
    v_cvt_pk_bf16_f32 v93, v174, v175
    v_cvt_pk_bf16_f32 v190, v216, v217
    v_exp_f32 v129, v129
    v_mul_f32 v220, v220, v240
    v_accvgpr_read_b32 v222, a106
    v_fmamk_f32 v131, v131, 0x3e0293ee, v228
    v_mfma_f32_16x16x32_bf16 a[36:39], a[224:227], v[8:11], 0
    v_exp_f32 v130, v130
    v_mfma_f32_16x16x32_bf16 a[36:39], a[228:231], v[24:27], a[36:39]
    v_mfma_f32_16x16x32_bf16 a[36:39], a[232:235], v[40:43], a[36:39]
    v_exp_f32 v131, v131
    v_mfma_f32_16x16x32_bf16 a[36:39], a[236:239], v[56:59], a[36:39]
    v_mul_f32 v221, v221, v240
    v_fmamk_f32 v132, v132, 0x3e0293ee, v230
    v_accvgpr_read_b32 v223, a107
    v_cvt_pk_bf16_f32 v82, v128, v129
    v_cvt_pk_bf16_f32 v191, v218, v219
    v_fmamk_f32 v133, v133, 0x3e0293ee, v230
    v_mul_f32 v222, v222, v240
    v_accvgpr_read_b32 v224, a108
    v_mfma_f32_16x16x32_bf16 a[52:55], a[236:239], v[60:63], 0
    v_exp_f32 v132, v132
    v_mfma_f32_16x16x32_bf16 a[52:55], a[232:235], v[44:47], a[52:55]
    v_exp_f32 v133, v133
    v_mfma_f32_16x16x32_bf16 a[52:55], a[228:231], v[28:31], a[52:55]
    v_fmamk_f32 v134, v134, 0x3e0293ee, v230
    v_cvt_pk_bf16_f32 v83, v130, v131
    v_mfma_f32_16x16x32_bf16 a[52:55], a[224:227], v[12:15], a[52:55]
    s_waitcnt lgkmcnt(0)
    v_exp_f32 v134, v134
    v_mul_f32 v223, v223, v240
    v_accvgpr_read_b32 v225, a109
    v_fmamk_f32 v135, v135, 0x3e0293ee, v230
    v_cvt_pk_bf16_f32 v204, v220, v221
    v_mul_f32 v224, v224, v240
    v_mfma_f32_16x16x32_bf16 v[144:147], a[240:243], a[128:131], 0
    ds_read_b64_tr_b16 a[224:225], v245 offset:256
    v_mfma_f32_16x16x32_bf16 v[144:147], a[244:247], a[132:135], v[144:147]
    ds_read_b64_tr_b16 a[226:227], v245 offset:4352
    v_mfma_f32_16x16x32_bf16 v[144:147], a[248:251], a[136:139], v[144:147]
    ds_read_b64_tr_b16 a[228:229], v245 offset:8448
    s_mov_b32 m0, s42
    v_mfma_f32_16x16x32_bf16 v[144:147], a[252:255], a[140:143], v[144:147]
    buffer_load_dwordx4 v246, s[12:15], s82 offen offset:2048 nt lds
    v_accvgpr_read_b32 v226, a110
    v_fmamk_f32 v136, v136, 0x3e0293ee, v232
    v_cvt_pk_bf16_f32 v86, v132, v133
    v_mul_f32 v225, v225, v240
    v_exp_f32 v135, v135
    v_accvgpr_read_b32 v227, a111
    v_fmamk_f32 v137, v137, 0x3e0293ee, v232
    v_cvt_pk_bf16_f32 v205, v222, v223
    v_exp_f32 v136, v136
    v_mfma_f32_16x16x32_bf16 v[148:151], a[252:255], a[156:159], 0
    ds_read_b64_tr_b16 a[230:231], v245 offset:12544
    v_mfma_f32_16x16x32_bf16 v[148:151], a[248:251], a[152:155], v[148:151]
    ds_read_b64_tr_b16 a[232:233], v245 offset:16640
    v_mfma_f32_16x16x32_bf16 v[148:151], a[244:247], a[148:151], v[148:151]
    ds_read_b64_tr_b16 a[234:235], v245 offset:20736
    v_mfma_f32_16x16x32_bf16 v[148:151], a[240:243], a[144:147], v[148:151]
    v_exp_f32 v137, v137
    v_mul_f32 v226, v226, v240
    v_accvgpr_read_b32 v212, a112
    v_fmamk_f32 v138, v138, 0x3e0293ee, v232
    v_cvt_pk_bf16_f32 v87, v134, v135
    v_mul_f32 v227, v227, v240
    v_fmamk_f32 v139, v139, 0x3e0293ee, v232
    v_accvgpr_read_b32 v213, a113
    v_exp_f32 v138, v138
    v_mfma_f32_16x16x32_bf16 v[152:155], a[240:243], a[192:195], 0
    ds_read_b64_tr_b16 a[236:237], v245 offset:24832
    v_mfma_f32_16x16x32_bf16 v[152:155], a[244:247], a[196:199], v[152:155]
    ds_read_b64_tr_b16 a[238:239], v245 offset:28928
    v_mfma_f32_16x16x32_bf16 v[152:155], a[248:251], a[200:203], v[152:155]
    s_mov_b32 m0, s42
    v_exp_f32 v139, v139
    v_mfma_f32_16x16x32_bf16 v[152:155], a[252:255], a[204:207], v[152:155]
    buffer_load_dwordx4 v247, s[12:15], s82 offen offset:3072 nt lds
    v_cvt_pk_bf16_f32 v206, v224, v225
    v_fmamk_f32 v140, v140, 0x3e0293ee, v234
    v_mul_f32 v212, v212, v242
    v_accvgpr_read_b32 v214, a114
    v_cvt_pk_bf16_f32 v90, v136, v137
    v_fmamk_f32 v141, v141, 0x3e0293ee, v234
    v_mul_f32 v213, v213, v242
    v_accvgpr_read_b32 v215, a115
    v_exp_f32 v140, v140
    v_mfma_f32_16x16x32_bf16 v[156:159], a[252:255], a[220:223], 0
    v_mfma_f32_16x16x32_bf16 v[156:159], a[248:251], a[216:219], v[156:159]
    v_exp_f32 v141, v141
    v_mfma_f32_16x16x32_bf16 v[156:159], a[244:247], a[212:215], v[156:159]
    v_fmamk_f32 v142, v142, 0x3e0293ee, v234
    v_cvt_pk_bf16_f32 v207, v226, v227
    v_mfma_f32_16x16x32_bf16 v[156:159], a[240:243], a[208:211], v[156:159]
    s_waitcnt lgkmcnt(0)
    v_exp_f32 v142, v142
    v_cvt_pk_bf16_f32 v91, v138, v139
    v_mul_f32 v214, v214, v242
    v_accvgpr_read_b32 v216, a116
    v_fmamk_f32 v143, v143, 0x3e0293ee, v234
    v_mul_f32 v215, v215, v242
    v_accvgpr_read_b32 v217, a117
    v_fmamk_f32 v144, v144, 0x3e0293ee, v228
    v_mfma_f32_16x16x32_bf16 a[12:15], a[224:227], v[0:3], 0
    ds_read_b128 a[240:243], v237 offset:53248
    v_mfma_f32_16x16x32_bf16 a[12:15], a[228:231], v[16:19], a[12:15]
    ds_read_b128 a[244:247], v237 offset:53504
    v_mfma_f32_16x16x32_bf16 a[12:15], a[232:235], v[32:35], a[12:15]
    v_exp_f32 v143, v143
    v_mfma_f32_16x16x32_bf16 a[12:15], a[236:239], v[48:51], a[12:15]
    v_exp_f32 v144, v144
    v_cvt_pk_bf16_f32 v94, v140, v141
    v_cvt_pk_bf16_f32 v192, v212, v213
    v_mul_f32 v216, v216, v242
    v_accvgpr_read_b32 v218, a118
    v_fmamk_f32 v145, v145, 0x3e0293ee, v228
    v_mul_f32 v217, v217, v242
    v_accvgpr_read_b32 v219, a119
    v_fmamk_f32 v146, v146, 0x3e0293ee, v228
    v_mfma_f32_16x16x32_bf16 a[28:31], a[236:239], v[52:55], 0
    ds_read_b128 a[248:251], v237 offset:53760
    v_mfma_f32_16x16x32_bf16 a[28:31], a[232:235], v[36:39], a[28:31]
    ds_read_b128 a[252:255], v237 offset:54016
    v_mfma_f32_16x16x32_bf16 a[28:31], a[228:231], v[20:23], a[28:31]
    s_mov_b32 m0, s43
    v_exp_f32 v145, v145
    v_mfma_f32_16x16x32_bf16 a[28:31], a[224:227], v[4:7], a[28:31]
    buffer_load_dwordx4 v246, s[12:15], s83 offen offset:0 nt lds
    v_cvt_pk_bf16_f32 v95, v142, v143
    v_cvt_pk_bf16_f32 v193, v214, v215
    v_mul_f32 v218, v218, v242
    v_fmamk_f32 v147, v147, 0x3e0293ee, v228
    v_accvgpr_read_b32 v220, a120
    v_exp_f32 v146, v146
    v_fmamk_f32 v148, v148, 0x3e0293ee, v230
    v_mul_f32 v219, v219, v242
    v_cvt_pk_bf16_f32 v96, v144, v145
    v_accvgpr_read_b32 v221, a121
    v_mfma_f32_16x16x32_bf16 a[44:47], a[224:227], v[8:11], 0
    v_mfma_f32_16x16x32_bf16 a[44:47], a[228:231], v[24:27], a[44:47]
    v_exp_f32 v147, v147
    v_mfma_f32_16x16x32_bf16 a[44:47], a[232:235], v[40:43], a[44:47]
    v_exp_f32 v148, v148
    v_mfma_f32_16x16x32_bf16 a[44:47], a[236:239], v[56:59], a[44:47]
    v_cvt_pk_bf16_f32 v194, v216, v217
    v_fmamk_f32 v149, v149, 0x3e0293ee, v230
    v_mul_f32 v220, v220, v242
    v_accvgpr_read_b32 v222, a122
    v_fmamk_f32 v150, v150, 0x3e0293ee, v230
    v_cvt_pk_bf16_f32 v97, v146, v147
    v_mul_f32 v221, v221, v242
    v_mfma_f32_16x16x32_bf16 a[60:63], a[236:239], v[60:63], 0
    v_exp_f32 v149, v149
    v_mfma_f32_16x16x32_bf16 a[60:63], a[232:235], v[44:47], a[60:63]
    v_exp_f32 v150, v150
    v_mfma_f32_16x16x32_bf16 a[60:63], a[228:231], v[28:31], a[60:63]
    s_mov_b64 vcc, s[74:75]
    v_mfma_f32_16x16x32_bf16 a[60:63], a[224:227], v[12:15], a[60:63]
    s_waitcnt lgkmcnt(0)
    v_accvgpr_read_b32 v223, a123
    v_fmamk_f32 v151, v151, 0x3e0293ee, v230
    v_cvt_pk_bf16_f32 v195, v218, v219
    v_mul_f32 v222, v222, v242
    v_accvgpr_read_b32 v224, a124
    v_fmamk_f32 v152, v152, 0x3e0293ee, v232
    v_cvt_pk_bf16_f32 v100, v148, v149
    v_mfma_f32_16x16x32_bf16 v[160:163], a[240:243], a[128:131], 0
    ds_read_b64_tr_b16 a[224:225], v244 offset:512
    v_mfma_f32_16x16x32_bf16 v[160:163], a[244:247], a[132:135], v[160:163]
    ds_read_b64_tr_b16 a[226:227], v244 offset:4608
    v_mfma_f32_16x16x32_bf16 v[160:163], a[248:251], a[136:139], v[160:163]
    ds_read_b64_tr_b16 a[228:229], v244 offset:8704
    s_mov_b32 m0, s43
    v_mfma_f32_16x16x32_bf16 v[160:163], a[252:255], a[140:143], v[160:163]
    buffer_load_dwordx4 v247, s[12:15], s83 offen offset:1024 nt lds
    v_mul_f32 v223, v223, v242
    v_exp_f32 v151, v151
    v_accvgpr_read_b32 v225, a125
    v_fmamk_f32 v153, v153, 0x3e0293ee, v232
    v_cvt_pk_bf16_f32 v208, v220, v221
    v_exp_f32 v152, v152
    v_mul_f32 v224, v224, v242
    v_accvgpr_read_b32 v226, a126
    v_fmamk_f32 v154, v154, 0x3e0293ee, v232
    v_cvt_pk_bf16_f32 v101, v150, v151
    v_exp_f32 v153, v153
    v_mfma_f32_16x16x32_bf16 v[164:167], a[252:255], a[156:159], 0
    ds_read_b64_tr_b16 a[230:231], v244 offset:12800
    v_mfma_f32_16x16x32_bf16 v[164:167], a[248:251], a[152:155], v[164:167]
    ds_read_b64_tr_b16 a[232:233], v244 offset:16896
    v_mfma_f32_16x16x32_bf16 v[164:167], a[244:247], a[148:151], v[164:167]
    ds_read_b64_tr_b16 a[234:235], v244 offset:20992
    v_mfma_f32_16x16x32_bf16 v[164:167], a[240:243], a[144:147], v[164:167]
    v_exp_f32 v154, v154
    v_mul_f32 v225, v225, v242
    v_fmamk_f32 v155, v155, 0x3e0293ee, v232
    v_accvgpr_read_b32 v227, a127
    v_cvt_pk_bf16_f32 v209, v222, v223
    v_fmamk_f32 v156, v156, 0x3e0293ee, v234
    v_mul_f32 v226, v226, v242
    v_cvt_pk_bf16_f32 v104, v152, v153
    v_exp_f32 v155, v155
    v_mfma_f32_16x16x32_bf16 v[168:171], a[240:243], a[192:195], 0
    ds_read_b64_tr_b16 a[236:237], v244 offset:25088
    v_mfma_f32_16x16x32_bf16 v[168:171], a[244:247], a[196:199], v[168:171]
    ds_read_b64_tr_b16 a[238:239], v244 offset:29184
    v_mfma_f32_16x16x32_bf16 v[168:171], a[248:251], a[200:203], v[168:171]
    v_exp_f32 v156, v156
    v_mfma_f32_16x16x32_bf16 v[168:171], a[252:255], a[204:207], v[168:171]
    v_fmamk_f32 v157, v157, 0x3e0293ee, v234
    v_mul_f32 v227, v227, v242
    v_cndmask_b32_dpp v176, v196, v180, vcc quad_perm:[1,0,3,2] row_mask:0xf bank_mask:0xf
    v_fmamk_f32 v158, v158, 0x3e0293ee, v234
    v_cvt_pk_bf16_f32 v210, v224, v225
    v_cvt_pk_bf16_f32 v105, v154, v155
    v_cndmask_b32_dpp v177, v197, v181, vcc quad_perm:[1,0,3,2] row_mask:0xf bank_mask:0xf
    v_exp_f32 v157, v157
    v_mfma_f32_16x16x32_bf16 v[172:175], a[252:255], a[220:223], 0
    v_exp_f32 v158, v158
    v_mfma_f32_16x16x32_bf16 v[172:175], a[248:251], a[216:219], v[172:175]
    v_fmamk_f32 v159, v159, 0x3e0293ee, v234
    v_cndmask_b32_dpp v178, v198, v182, vcc quad_perm:[1,0,3,2] row_mask:0xf bank_mask:0xf
    v_mfma_f32_16x16x32_bf16 v[172:175], a[244:247], a[212:215], v[172:175]
    s_mov_b32 m0, s43
    v_exp_f32 v159, v159
    v_mfma_f32_16x16x32_bf16 v[172:175], a[240:243], a[208:211], v[172:175]
    s_waitcnt lgkmcnt(0)
    buffer_load_dwordx4 v246, s[12:15], s83 offen offset:2048 nt lds
    v_cndmask_b32_dpp v179, v199, v183, vcc quad_perm:[1,0,3,2] row_mask:0xf bank_mask:0xf
    v_fmamk_f32 v160, v160, 0x3e0293ee, v228
    v_cvt_pk_bf16_f32 v108, v156, v157
    s_mov_b64 vcc, s[76:77]
    v_cvt_pk_bf16_f32 v211, v226, v227
    v_fmamk_f32 v161, v161, 0x3e0293ee, v228
    v_cndmask_b32_dpp v196, v180, v196, vcc quad_perm:[1,0,3,2] row_mask:0xf bank_mask:0xf
    v_mfma_f32_16x16x32_bf16 a[64:67], a[224:227], v[0:3], 0
    ds_read_b128 a[240:243], v237 offset:57344
    v_mfma_f32_16x16x32_bf16 a[64:67], a[228:231], v[16:19], a[64:67]
    ds_read_b128 a[244:247], v237 offset:57600
    v_mfma_f32_16x16x32_bf16 a[64:67], a[232:235], v[32:35], a[64:67]
    v_exp_f32 v160, v160
    v_mfma_f32_16x16x32_bf16 a[64:67], a[236:239], v[48:51], a[64:67]
    v_exp_f32 v161, v161
    v_cndmask_b32_dpp v197, v181, v197, vcc quad_perm:[1,0,3,2] row_mask:0xf bank_mask:0xf
    v_fmamk_f32 v162, v162, 0x3e0293ee, v228
    v_cvt_pk_bf16_f32 v109, v158, v159
    v_cndmask_b32_dpp v198, v182, v198, vcc quad_perm:[1,0,3,2] row_mask:0xf bank_mask:0xf
    v_cndmask_b32_dpp v199, v183, v199, vcc quad_perm:[1,0,3,2] row_mask:0xf bank_mask:0xf
    v_fmamk_f32 v163, v163, 0x3e0293ee, v228
    v_mfma_f32_16x16x32_bf16 a[80:83], a[236:239], v[52:55], 0
    ds_read_b128 a[248:251], v237 offset:57856
    v_mfma_f32_16x16x32_bf16 a[80:83], a[232:235], v[36:39], a[80:83]
    ds_read_b128 a[252:255], v237 offset:58112
    v_mfma_f32_16x16x32_bf16 a[80:83], a[228:231], v[20:23], a[80:83]
    v_mfma_f32_16x16x32_bf16 a[80:83], a[224:227], v[4:7], a[80:83]
    v_permlane16_swap_b32 v176, v178
    v_exp_f32 v162, v162
    v_fmamk_f32 v164, v164, 0x3e0293ee, v230
    v_cvt_pk_bf16_f32 v98, v160, v161
    v_exp_f32 v163, v163
    v_permlane16_swap_b32 v177, v179
    v_fmamk_f32 v165, v165, 0x3e0293ee, v230
    v_mfma_f32_16x16x32_bf16 a[96:99], a[224:227], v[8:11], 0
    v_exp_f32 v164, v164
    v_mfma_f32_16x16x32_bf16 a[96:99], a[228:231], v[24:27], a[96:99]
    v_exp_f32 v165, v165
    v_mfma_f32_16x16x32_bf16 a[96:99], a[232:235], v[40:43], a[96:99]
    s_mov_b32 m0, s43
    v_permlane16_swap_b32 v196, v198
    v_mfma_f32_16x16x32_bf16 a[96:99], a[236:239], v[56:59], a[96:99]
    buffer_load_dwordx4 v247, s[12:15], s83 offen offset:3072 nt lds
    v_fmamk_f32 v166, v166, 0x3e0293ee, v230
    v_cvt_pk_bf16_f32 v99, v162, v163
    v_fmamk_f32 v167, v167, 0x3e0293ee, v230
    v_mfma_f32_16x16x32_bf16 a[112:115], a[236:239], v[60:63], 0
    v_exp_f32 v166, v166
    v_mfma_f32_16x16x32_bf16 a[112:115], a[232:235], v[44:47], a[112:115]
    v_mfma_f32_16x16x32_bf16 a[112:115], a[228:231], v[28:31], a[112:115]
    v_exp_f32 v167, v167
    v_mfma_f32_16x16x32_bf16 a[112:115], a[224:227], v[12:15], a[112:115]
    s_waitcnt lgkmcnt(0)
    buffer_store_dwordx4 v[176:179], v243, s[24:27], s52 offen offset:128 sc1
    v_permlane16_swap_b32 v197, v199
    v_fmamk_f32 v168, v168, 0x3e0293ee, v232
    v_cvt_pk_bf16_f32 v102, v164, v165
    v_fmamk_f32 v169, v169, 0x3e0293ee, v232
    v_exp_f32 v168, v168
    v_mfma_f32_16x16x32_bf16 v[128:131], a[240:243], a[128:131], 0
    ds_read_b64_tr_b16 a[224:225], v245 offset:512
    v_mfma_f32_16x16x32_bf16 v[128:131], a[244:247], a[132:135], v[128:131]
    ds_read_b64_tr_b16 a[226:227], v245 offset:4608
    v_mfma_f32_16x16x32_bf16 v[128:131], a[248:251], a[136:139], v[128:131]
    ds_read_b64_tr_b16 a[228:229], v245 offset:8704
    v_mfma_f32_16x16x32_bf16 v[128:131], a[252:255], a[140:143], v[128:131]
    s_mov_b64 vcc, s[74:75]
    buffer_store_dwordx4 v[196:199], v243, s[24:27], s52 offen offset:384 sc1
    v_exp_f32 v169, v169
    v_fmamk_f32 v170, v170, 0x3e0293ee, v232
    v_cvt_pk_bf16_f32 v103, v166, v167
    v_fmamk_f32 v171, v171, 0x3e0293ee, v232
    v_exp_f32 v170, v170
    v_mfma_f32_16x16x32_bf16 v[132:135], a[252:255], a[156:159], 0
    ds_read_b64_tr_b16 a[230:231], v245 offset:12800
    v_mfma_f32_16x16x32_bf16 v[132:135], a[248:251], a[152:155], v[132:135]
    ds_read_b64_tr_b16 a[232:233], v245 offset:16896
    v_mfma_f32_16x16x32_bf16 v[132:135], a[244:247], a[148:151], v[132:135]
    ds_read_b64_tr_b16 a[234:235], v245 offset:20992
    v_mfma_f32_16x16x32_bf16 v[132:135], a[240:243], a[144:147], v[132:135]
    v_exp_f32 v171, v171
    v_fmamk_f32 v172, v172, 0x3e0293ee, v234
    v_cvt_pk_bf16_f32 v106, v168, v169
    v_cndmask_b32_dpp v180, v200, v184, vcc quad_perm:[1,0,3,2] row_mask:0xf bank_mask:0xf
    v_fmamk_f32 v173, v173, 0x3e0293ee, v234
    v_cndmask_b32_dpp v181, v201, v185, vcc quad_perm:[1,0,3,2] row_mask:0xf bank_mask:0xf
    v_exp_f32 v172, v172
    v_cndmask_b32_dpp v182, v202, v186, vcc quad_perm:[1,0,3,2] row_mask:0xf bank_mask:0xf
    v_mfma_f32_16x16x32_bf16 v[136:139], a[240:243], a[192:195], 0
    ds_read_b64_tr_b16 a[236:237], v245 offset:25088
    v_mfma_f32_16x16x32_bf16 v[136:139], a[244:247], a[196:199], v[136:139]
    ds_read_b64_tr_b16 a[238:239], v245 offset:29184
    v_mfma_f32_16x16x32_bf16 v[136:139], a[248:251], a[200:203], v[136:139]
    v_exp_f32 v173, v173
    v_mfma_f32_16x16x32_bf16 v[136:139], a[252:255], a[204:207], v[136:139]
    v_fmamk_f32 v174, v174, 0x3e0293ee, v234
    v_cvt_pk_bf16_f32 v107, v170, v171
    v_cndmask_b32_dpp v183, v203, v187, vcc quad_perm:[1,0,3,2] row_mask:0xf bank_mask:0xf
    v_fmamk_f32 v175, v175, 0x3e0293ee, v234
    s_mov_b64 vcc, s[76:77]
    v_exp_f32 v174, v174
    v_cndmask_b32_dpp v200, v184, v200, vcc quad_perm:[1,0,3,2] row_mask:0xf bank_mask:0xf
    v_fmamk_f32 v128, v128, 0x3e0293ee, v228
    v_mfma_f32_16x16x32_bf16 v[140:143], a[252:255], a[220:223], 0
    v_exp_f32 v175, v175
    v_mfma_f32_16x16x32_bf16 v[140:143], a[248:251], a[216:219], v[140:143]
    v_exp_f32 v128, v128
    v_mfma_f32_16x16x32_bf16 v[140:143], a[244:247], a[212:215], v[140:143]
    v_mfma_f32_16x16x32_bf16 v[140:143], a[240:243], a[208:211], v[140:143]
    s_waitcnt lgkmcnt(0)
    v_cvt_pk_bf16_f32 v110, v172, v173
    v_cndmask_b32_dpp v201, v185, v201, vcc quad_perm:[1,0,3,2] row_mask:0xf bank_mask:0xf
    v_cndmask_b32_dpp v202, v186, v202, vcc quad_perm:[1,0,3,2] row_mask:0xf bank_mask:0xf
    v_fmamk_f32 v129, v129, 0x3e0293ee, v228
    v_cndmask_b32_dpp v203, v187, v203, vcc quad_perm:[1,0,3,2] row_mask:0xf bank_mask:0xf
    v_fmamk_f32 v130, v130, 0x3e0293ee, v228
    v_permlane16_swap_b32 v180, v182
    v_mfma_f32_16x16x32_bf16 a[72:75], a[224:227], v[0:3], 0
    ds_read_b128 a[240:243], v237 offset:61440
    v_mfma_f32_16x16x32_bf16 a[72:75], a[228:231], v[16:19], a[72:75]
    ds_read_b128 a[244:247], v237 offset:61696
    v_mfma_f32_16x16x32_bf16 a[72:75], a[232:235], v[32:35], a[72:75]
    s_mov_b32 s58, s57
    v_exp_f32 v129, v129
    v_mfma_f32_16x16x32_bf16 a[72:75], a[236:239], v[48:51], a[72:75]
    s_mov_b32 s57, s37
    v_permlane16_swap_b32 v181, v183
    v_cvt_pk_bf16_f32 v111, v174, v175
    v_fmamk_f32 v131, v131, 0x3e0293ee, v228
    v_exp_f32 v130, v130
    v_fmamk_f32 v132, v132, 0x3e0293ee, v230
    v_cvt_pk_bf16_f32 v112, v128, v129
    v_mfma_f32_16x16x32_bf16 a[88:91], a[236:239], v[52:55], 0
    ds_read_b128 a[248:251], v237 offset:61952
    v_mfma_f32_16x16x32_bf16 a[88:91], a[232:235], v[36:39], a[88:91]
    ds_read_b128 a[252:255], v237 offset:62208
    v_mfma_f32_16x16x32_bf16 a[88:91], a[228:231], v[20:23], a[88:91]
    s_add_u32 s37, s37, 33546240
    v_exp_f32 v131, v131
    v_mfma_f32_16x16x32_bf16 a[88:91], a[224:227], v[4:7], a[88:91]
    s_cmp_eq_u32 s34, 5
    buffer_store_dwordx4 v[180:183], v243, s[24:27], s53 offen offset:128 sc1
    v_exp_f32 v132, v132
    v_permlane16_swap_b32 v200, v202
    v_fmamk_f32 v133, v133, 0x3e0293ee, v230
    v_fmamk_f32 v134, v134, 0x3e0293ee, v230
    v_cvt_pk_bf16_f32 v113, v130, v131
    v_mfma_f32_16x16x32_bf16 a[104:107], a[224:227], v[8:11], 0
    s_cselect_b32 s37, s67, s37
    v_exp_f32 v133, v133
    v_mfma_f32_16x16x32_bf16 a[104:107], a[228:231], v[24:27], a[104:107]
    s_cmp_eq_u32 s34, 5
    v_exp_f32 v134, v134
    v_mfma_f32_16x16x32_bf16 a[104:107], a[232:235], v[40:43], a[104:107]
    s_cselect_b32 s41, 0, 16777216
    v_permlane16_swap_b32 v201, v203
    v_mfma_f32_16x16x32_bf16 a[104:107], a[236:239], v[56:59], a[104:107]
    s_add_u32 s60, s60, s41
    buffer_store_dwordx4 v[200:203], v243, s[24:27], s53 offen offset:384 sc1
    v_fmamk_f32 v135, v135, 0x3e0293ee, v230
    v_exp_f32 v135, v135
    v_fmamk_f32 v136, v136, 0x3e0293ee, v232
    v_cvt_pk_bf16_f32 v116, v132, v133
    v_mfma_f32_16x16x32_bf16 a[120:123], a[236:239], v[60:63], 0
    s_cmp_eq_u32 s34, 5
    v_mfma_f32_16x16x32_bf16 a[120:123], a[232:235], v[44:47], a[120:123]
    s_cselect_b32 s41, s66, s60
    v_exp_f32 v136, v136
    v_mfma_f32_16x16x32_bf16 a[120:123], a[228:231], v[28:31], a[120:123]
    s_mov_b64 vcc, s[74:75]
    v_fmamk_f32 v137, v137, 0x3e0293ee, v232
    v_fmamk_f32 v138, v138, 0x3e0293ee, v232
    v_mfma_f32_16x16x32_bf16 a[120:123], a[224:227], v[12:15], a[120:123]
    s_waitcnt lgkmcnt(0)
    v_exp_f32 v137, v137
    v_cvt_pk_bf16_f32 v117, v134, v135
    v_mfma_f32_16x16x32_bf16 v[144:147], a[240:243], a[128:131], 0
    ds_read_b64_tr_b16 a[224:225], v244 offset:768
    v_mfma_f32_16x16x32_bf16 v[144:147], a[244:247], a[132:135], v[144:147]
    ds_read_b64_tr_b16 a[226:227], v244 offset:4864
    v_mfma_f32_16x16x32_bf16 v[144:147], a[248:251], a[136:139], v[144:147]
    ds_read_b64_tr_b16 a[228:229], v244 offset:8960
    v_mfma_f32_16x16x32_bf16 v[144:147], a[252:255], a[140:143], v[144:147]
    v_exp_f32 v138, v138
    v_fmamk_f32 v139, v139, 0x3e0293ee, v232
    v_cndmask_b32_dpp v184, v204, v188, vcc quad_perm:[1,0,3,2] row_mask:0xf bank_mask:0xf
    v_cndmask_b32_dpp v185, v205, v189, vcc quad_perm:[1,0,3,2] row_mask:0xf bank_mask:0xf
    v_fmamk_f32 v140, v140, 0x3e0293ee, v234
    v_cvt_pk_bf16_f32 v120, v136, v137
    v_cndmask_b32_dpp v186, v206, v190, vcc quad_perm:[1,0,3,2] row_mask:0xf bank_mask:0xf
    v_exp_f32 v139, v139
    v_mfma_f32_16x16x32_bf16 v[148:151], a[252:255], a[156:159], 0
    ds_read_b64_tr_b16 a[230:231], v244 offset:13056
    v_mfma_f32_16x16x32_bf16 v[148:151], a[248:251], a[152:155], v[148:151]
    ds_read_b64_tr_b16 a[232:233], v244 offset:17152
    v_mfma_f32_16x16x32_bf16 v[148:151], a[244:247], a[148:151], v[148:151]
    ds_read_b64_tr_b16 a[234:235], v244 offset:21248
    v_mfma_f32_16x16x32_bf16 v[148:151], a[240:243], a[144:147], v[148:151]
    v_exp_f32 v140, v140
    v_fmamk_f32 v141, v141, 0x3e0293ee, v234
    v_cndmask_b32_dpp v187, v207, v191, vcc quad_perm:[1,0,3,2] row_mask:0xf bank_mask:0xf
    s_mov_b64 vcc, s[76:77]
    v_fmamk_f32 v142, v142, 0x3e0293ee, v234
    v_cvt_pk_bf16_f32 v121, v138, v139
    v_cndmask_b32_dpp v204, v188, v204, vcc quad_perm:[1,0,3,2] row_mask:0xf bank_mask:0xf
    v_exp_f32 v141, v141
    v_mfma_f32_16x16x32_bf16 v[152:155], a[240:243], a[192:195], 0
    ds_read_b64_tr_b16 a[236:237], v244 offset:25344
    v_mfma_f32_16x16x32_bf16 v[152:155], a[244:247], a[196:199], v[152:155]
    ds_read_b64_tr_b16 a[238:239], v244 offset:29440
    v_mfma_f32_16x16x32_bf16 v[152:155], a[248:251], a[200:203], v[152:155]
    s_add_u32 s20, s64, s41
    v_exp_f32 v142, v142
    v_mfma_f32_16x16x32_bf16 v[152:155], a[252:255], a[204:207], v[152:155]
    s_addc_u32 s21, s65, 0
    v_cndmask_b32_dpp v205, v189, v205, vcc quad_perm:[1,0,3,2] row_mask:0xf bank_mask:0xf
    v_fmamk_f32 v143, v143, 0x3e0293ee, v234
    v_cndmask_b32_dpp v206, v190, v206, vcc quad_perm:[1,0,3,2] row_mask:0xf bank_mask:0xf
    v_fmamk_f32 v144, v144, 0x3e0293ee, v228
    v_cndmask_b32_dpp v207, v191, v207, vcc quad_perm:[1,0,3,2] row_mask:0xf bank_mask:0xf
    v_cvt_pk_bf16_f32 v124, v140, v141
    v_exp_f32 v143, v143
    v_permlane16_swap_b32 v184, v186
    v_fmamk_f32 v145, v145, 0x3e0293ee, v228
    v_mfma_f32_16x16x32_bf16 v[156:159], a[252:255], a[220:223], 0
    s_xor_b32 s80, s37, s84
    v_exp_f32 v144, v144
    v_mfma_f32_16x16x32_bf16 v[156:159], a[248:251], a[216:219], v[156:159]
    s_xor_b32 s81, s80, 4096
    v_mfma_f32_16x16x32_bf16 v[156:159], a[244:247], a[212:215], v[156:159]
    s_xor_b32 s82, s80, 16384
    v_permlane16_swap_b32 v185, v187
    v_mfma_f32_16x16x32_bf16 v[156:159], a[240:243], a[208:211], v[156:159]
    s_waitcnt lgkmcnt(0)
    buffer_store_dwordx4 v[184:187], v243, s[24:27], s54 offen offset:128 sc1
    v_exp_f32 v145, v145
    v_permlane16_swap_b32 v204, v206
    v_fmamk_f32 v146, v146, 0x3e0293ee, v228
    v_cvt_pk_bf16_f32 v125, v142, v143
    v_fmamk_f32 v147, v147, 0x3e0293ee, v228
    v_mfma_f32_16x16x32_bf16 a[68:71], a[224:227], v[0:3], 0
    ds_read_b64_tr_b16 a[240:241], v245 offset:768
    v_mfma_f32_16x16x32_bf16 a[68:71], a[228:231], v[16:19], a[68:71]
    ds_read_b64_tr_b16 a[242:243], v245 offset:4864
    v_mfma_f32_16x16x32_bf16 a[68:71], a[232:235], v[32:35], a[68:71]
    ds_read_b64_tr_b16 a[244:245], v245 offset:8960
    v_mfma_f32_16x16x32_bf16 a[68:71], a[236:239], v[48:51], a[68:71]
    s_xor_b32 s83, s80, 20480
    v_exp_f32 v146, v146
    v_fmamk_f32 v148, v148, 0x3e0293ee, v230
    v_cvt_pk_bf16_f32 v114, v144, v145
    v_exp_f32 v147, v147
    v_fmamk_f32 v149, v149, 0x3e0293ee, v230
    v_mfma_f32_16x16x32_bf16 a[84:87], a[236:239], v[52:55], 0
    ds_read_b64_tr_b16 a[246:247], v245 offset:13056
    v_mfma_f32_16x16x32_bf16 a[84:87], a[232:235], v[36:39], a[84:87]
    ds_read_b64_tr_b16 a[248:249], v245 offset:17152
    v_mfma_f32_16x16x32_bf16 a[84:87], a[228:231], v[20:23], a[84:87]
    ds_read_b64_tr_b16 a[250:251], v245 offset:21248
    v_mfma_f32_16x16x32_bf16 a[84:87], a[224:227], v[4:7], a[84:87]
    v_exp_f32 v148, v148
    v_fmamk_f32 v150, v150, 0x3e0293ee, v230
    v_cvt_pk_bf16_f32 v115, v146, v147
    v_permlane16_swap_b32 v205, v207
    v_exp_f32 v149, v149
    v_fmamk_f32 v151, v151, 0x3e0293ee, v230
    v_mfma_f32_16x16x32_bf16 a[100:103], a[224:227], v[8:11], 0
    ds_read_b64_tr_b16 a[252:253], v245 offset:25344
    v_mfma_f32_16x16x32_bf16 a[100:103], a[228:231], v[24:27], a[100:103]
    ds_read_b64_tr_b16 a[254:255], v245 offset:29440
    v_mfma_f32_16x16x32_bf16 a[100:103], a[232:235], v[40:43], a[100:103]
    s_cmp_eq_u32 s34, 6
    v_exp_f32 v150, v150
    v_mfma_f32_16x16x32_bf16 a[100:103], a[236:239], v[56:59], a[100:103]
    s_cselect_b32 s14, 0, s14
    buffer_store_dwordx4 v[204:207], v243, s[24:27], s54 offen offset:384 sc1
    v_exp_f32 v151, v151
    v_fmamk_f32 v152, v152, 0x3e0293ee, v232
    v_cvt_pk_bf16_f32 v118, v148, v149
    v_fmamk_f32 v153, v153, 0x3e0293ee, v232
    s_mov_b64 vcc, s[74:75]
    v_exp_f32 v152, v152
    v_mfma_f32_16x16x32_bf16 a[116:119], a[236:239], v[60:63], 0
    s_cmp_eq_u32 s34, 6
    v_exp_f32 v153, v153
    v_mfma_f32_16x16x32_bf16 a[116:119], a[232:235], v[44:47], a[116:119]
    s_cselect_b32 s18, 0, s18
    v_cndmask_b32_dpp v188, v208, v192, vcc quad_perm:[1,0,3,2] row_mask:0xf bank_mask:0xf
    v_fmamk_f32 v154, v154, 0x3e0293ee, v232
    v_mfma_f32_16x16x32_bf16 a[116:119], a[228:231], v[28:31], a[116:119]
    v_mfma_f32_16x16x32_bf16 a[116:119], a[224:227], v[12:15], a[116:119]
    s_waitcnt lgkmcnt(0)
    v_exp_f32 v154, v154
    v_cvt_pk_bf16_f32 v119, v150, v151
    v_cndmask_b32_dpp v189, v209, v193, vcc quad_perm:[1,0,3,2] row_mask:0xf bank_mask:0xf
    v_fmamk_f32 v155, v155, 0x3e0293ee, v232
    v_cndmask_b32_dpp v190, v210, v194, vcc quad_perm:[1,0,3,2] row_mask:0xf bank_mask:0xf
    v_mfma_f32_16x16x32_bf16 a[76:79], a[240:243], v[0:3], 0
    s_waitcnt vmcnt(6)
    v_exp_f32 v155, v155
    v_mfma_f32_16x16x32_bf16 a[76:79], a[244:247], v[16:19], a[76:79]
    ds_read_b128 a[192:195], v239 offset:0
    v_mfma_f32_16x16x32_bf16 a[76:79], a[248:251], v[32:35], a[76:79]
    ds_read_b128 a[196:199], v239 offset:256
    v_mfma_f32_16x16x32_bf16 a[76:79], a[252:255], v[48:51], a[76:79]
    v_cndmask_b32_dpp v191, v211, v195, vcc quad_perm:[1,0,3,2] row_mask:0xf bank_mask:0xf
    v_fmamk_f32 v156, v156, 0x3e0293ee, v234
    v_cvt_pk_bf16_f32 v122, v152, v153
    s_mov_b64 vcc, s[76:77]
    v_fmamk_f32 v157, v157, 0x3e0293ee, v234
    v_cndmask_b32_dpp v208, v192, v208, vcc quad_perm:[1,0,3,2] row_mask:0xf bank_mask:0xf
    v_exp_f32 v156, v156
    v_cndmask_b32_dpp v209, v193, v209, vcc quad_perm:[1,0,3,2] row_mask:0xf bank_mask:0xf
    v_mfma_f32_16x16x32_bf16 a[92:95], a[252:255], v[52:55], 0
    ds_read_b128 a[200:203], v239 offset:512
    v_mfma_f32_16x16x32_bf16 a[92:95], a[248:251], v[36:39], a[92:95]
    ds_read_b128 a[204:207], v239 offset:768
    v_mfma_f32_16x16x32_bf16 a[92:95], a[244:247], v[20:23], a[92:95]
    ds_read_b128 a[208:211], v239 offset:4096
    v_mfma_f32_16x16x32_bf16 a[92:95], a[240:243], v[4:7], a[92:95]
    v_exp_f32 v157, v157
    v_fmamk_f32 v158, v158, 0x3e0293ee, v234
    v_cvt_pk_bf16_f32 v123, v154, v155
    v_cndmask_b32_dpp v210, v194, v210, vcc quad_perm:[1,0,3,2] row_mask:0xf bank_mask:0xf
    v_cndmask_b32_dpp v211, v195, v211, vcc quad_perm:[1,0,3,2] row_mask:0xf bank_mask:0xf
    v_fmamk_f32 v159, v159, 0x3e0293ee, v234
    v_permlane16_swap_b32 v188, v190
    v_exp_f32 v158, v158
    v_mfma_f32_16x16x32_bf16 a[108:111], a[240:243], v[8:11], 0
    ds_read_b128 a[212:215], v239 offset:4352
    v_mfma_f32_16x16x32_bf16 a[108:111], a[244:247], v[24:27], a[108:111]
    ds_read_b128 a[216:219], v239 offset:4608
    v_mfma_f32_16x16x32_bf16 a[108:111], a[248:251], v[40:43], a[108:111]
    ds_read_b128 a[220:223], v239 offset:4864
    v_mfma_f32_16x16x32_bf16 a[108:111], a[252:255], v[56:59], a[108:111]
    v_exp_f32 v159, v159
    v_cvt_pk_bf16_f32 v126, v156, v157
    v_permlane16_swap_b32 v189, v191
    v_mfma_f32_16x16x32_bf16 a[124:127], a[252:255], v[60:63], 0
    v_permlane16_swap_b32 v208, v210
    v_mfma_f32_16x16x32_bf16 a[124:127], a[248:251], v[44:47], a[124:127]
    v_permlane16_swap_b32 v209, v211
    v_mfma_f32_16x16x32_bf16 a[124:127], a[244:247], v[28:31], a[124:127]
    v_cvt_pk_bf16_f32 v127, v158, v159
    v_mfma_f32_16x16x32_bf16 a[124:127], a[240:243], v[12:15], a[124:127]
    buffer_store_dwordx4 v[188:191], v243, s[24:27], s55 offen offset:128 sc1
    s_barrier
    v_mfma_f32_16x16x32_bf16 v[160:163], v[248:251], v[64:67], 0
    ds_read_b128 a[224:227], v237 offset:0
    v_mfma_f32_16x16x32_bf16 v[160:163], v[248:251], v[80:83], v[160:163]
    ds_read_b128 a[228:231], v237 offset:256
    v_mfma_f32_16x16x32_bf16 v[160:163], v[248:251], v[96:99], v[160:163]
    v_mfma_f32_16x16x32_bf16 v[160:163], v[248:251], v[112:115], v[160:163]
    buffer_store_dwordx4 v[208:211], v243, s[24:27], s55 offen offset:384 sc1
    v_mfma_f32_16x16x32_bf16 v[164:167], v[248:251], v[68:71], 0
    ds_read_b128 a[232:235], v237 offset:512
    v_mfma_f32_16x16x32_bf16 v[164:167], v[248:251], v[84:87], v[164:167]
    ds_read_b128 a[236:239], v237 offset:768
    v_mfma_f32_16x16x32_bf16 v[164:167], v[248:251], v[100:103], v[164:167]
    v_mfma_f32_16x16x32_bf16 v[164:167], v[248:251], v[116:119], v[164:167]
    v_mfma_f32_16x16x32_bf16 v[168:171], v[248:251], v[72:75], 0
    v_mfma_f32_16x16x32_bf16 v[168:171], v[248:251], v[88:91], v[168:171]
    v_mfma_f32_16x16x32_bf16 v[168:171], v[248:251], v[104:107], v[168:171]
    v_mfma_f32_16x16x32_bf16 v[168:171], v[248:251], v[120:123], v[168:171]
    v_mfma_f32_16x16x32_bf16 v[172:175], v[248:251], v[76:79], 0
    v_mfma_f32_16x16x32_bf16 v[172:175], v[248:251], v[92:95], v[172:175]
    v_mfma_f32_16x16x32_bf16 v[172:175], v[248:251], v[108:111], v[172:175]
    v_mfma_f32_16x16x32_bf16 v[172:175], v[248:251], v[124:127], v[172:175]
    s_waitcnt lgkmcnt(0)
    s_add_u32 s34, s34, 1
    s_cmp_eq_u32 s34, s56
    s_cbranch_scc1 L_ph2f
L_ph2s:
    s_cmp_lt_u32 s34, 2
    s_cbranch_scc0 L_nt57
    s_getpc_b64 s[72:73]
L_pc57:
    s_add_u32 s72, s72, L_ph3s-L_pc57
    s_addc_u32 s73, s73, (L_ph3s-L_pc57)>>32
    v_mbcnt_lo_u32_b32 v222, -1, 0
    v_mbcnt_hi_u32_b32 v222, -1, v222
    v_lshrrev_b32 v222, 2, v222
    v_lshl_add_u32 v222, s32, 4, v222
    v_lshlrev_b32 v222, 7, v222
    v_min_u32 v222, L_ph4s-L_ph3s, v222
    v_mov_b32 v223, s73
    v_add_co_u32 v222, vcc, s72, v222
    s_nop 1
    v_addc_co_u32 v223, vcc, 0, v223, vcc
    global_load_dword v254, v[222:223], off
L_nt57:
    v_mfma_f32_16x16x32_bf16 v[128:131], a[224:227], a[160:163], 0
    ds_read_b128 a[240:243], v237 offset:4096
    v_mfma_f32_16x16x32_bf16 v[128:131], a[228:231], a[164:167], v[128:131]
    ds_read_b128 a[244:247], v237 offset:4352
    v_mfma_f32_16x16x32_bf16 v[128:131], a[232:235], a[168:171], v[128:131]
    s_mov_b32 m0, s42
    v_mfma_f32_16x16x32_bf16 v[128:131], a[236:239], a[172:175], v[128:131]
    buffer_load_dwordx4 v246, s[12:15], s80 offen offset:0 nt lds
    v_max3_f32 v220, v160, v164, v168
    v_max_f32 v220, v220, v172
    v_mfma_f32_16x16x32_bf16 v[132:135], a[236:239], a[188:191], 0
    ds_read_b128 a[248:251], v237 offset:4608
    v_mfma_f32_16x16x32_bf16 v[132:135], a[232:235], a[184:187], v[132:135]
    ds_read_b128 a[252:255], v237 offset:4864
    v_mfma_f32_16x16x32_bf16 v[132:135], a[228:231], a[180:183], v[132:135]
    v_cmp_lt_f32 vcc, 0x5f800000, v220
    s_cbranch_vccnz L_chk58_redo
L_chk58:
    v_mfma_f32_16x16x32_bf16 v[132:135], a[224:227], a[176:179], v[132:135]
    v_add_f32 v236, v229, v160
    v_add_f32 v238, v231, v164
    v_add_f32 v240, v233, v168
    v_add_f32 v242, v235, v172
    v_rcp_f32 v236, v236
    v_mfma_f32_16x16x32_bf16 v[136:139], a[224:227], a[192:195], 0
    v_rcp_f32 v238, v238
    v_mfma_f32_16x16x32_bf16 v[136:139], a[228:231], a[196:199], v[136:139]
    v_rcp_f32 v240, v240
    v_mfma_f32_16x16x32_bf16 v[136:139], a[232:235], a[200:203], v[136:139]
    v_rcp_f32 v242, v242
    v_mfma_f32_16x16x32_bf16 v[136:139], a[236:239], a[204:207], v[136:139]
    v_max_f32 v220, v128, v129
    v_max3_f32 v220, v220, v130, v131
    v_mfma_f32_16x16x32_bf16 v[140:143], a[236:239], a[220:223], 0
    v_mfma_f32_16x16x32_bf16 v[140:143], a[232:235], a[216:219], v[140:143]
    v_max_f32 v221, v132, v133
    v_max3_f32 v221, v221, v134, v135
    v_mfma_f32_16x16x32_bf16 v[140:143], a[228:231], a[212:215], v[140:143]
    v_mfma_f32_16x16x32_bf16 v[140:143], a[224:227], a[208:211], v[140:143]
    s_waitcnt lgkmcnt(0)
    v_max_f32 v222, v136, v137
    v_max3_f32 v222, v222, v138, v139
    v_mfma_f32_16x16x32_bf16 v[144:147], a[240:243], a[160:163], 0
    ds_read_b64_tr_b16 a[224:225], v244 offset:32768
    v_mfma_f32_16x16x32_bf16 v[144:147], a[244:247], a[164:167], v[144:147]
    ds_read_b64_tr_b16 a[226:227], v244 offset:36864
    v_mfma_f32_16x16x32_bf16 v[144:147], a[248:251], a[168:171], v[144:147]
    ds_read_b64_tr_b16 a[228:229], v244 offset:40960
    v_mfma_f32_16x16x32_bf16 v[144:147], a[252:255], a[172:175], v[144:147]
    v_max_f32 v223, v140, v141
    v_max3_f32 v223, v223, v142, v143
    v_mfma_f32_16x16x32_bf16 v[148:151], a[252:255], a[188:191], 0
    ds_read_b64_tr_b16 a[230:231], v244 offset:45056
    v_mfma_f32_16x16x32_bf16 v[148:151], a[248:251], a[184:187], v[148:151]
    ds_read_b64_tr_b16 a[232:233], v244 offset:49152
    v_mfma_f32_16x16x32_bf16 v[148:151], a[244:247], a[180:183], v[148:151]
    ds_read_b64_tr_b16 a[234:235], v244 offset:53248
    s_mov_b32 m0, s42
    v_mfma_f32_16x16x32_bf16 v[148:151], a[240:243], a[176:179], v[148:151]
    buffer_load_dwordx4 v247, s[12:15], s80 offen offset:1024 nt lds
    v_permlane32_swap_b32 v220, v221
    v_permlane32_swap_b32 v222, v223
    v_max_f32 v224, v220, v221
    v_max_f32 v226, v222, v223
    v_mov_b32 v225, v224
    v_mfma_f32_16x16x32_bf16 v[152:155], a[240:243], a[192:195], 0
    ds_read_b64_tr_b16 a[236:237], v244 offset:57344
    v_mfma_f32_16x16x32_bf16 v[152:155], a[244:247], a[196:199], v[152:155]
    ds_read_b64_tr_b16 a[238:239], v244 offset:61440
    v_mfma_f32_16x16x32_bf16 v[152:155], a[248:251], a[200:203], v[152:155]
    v_mov_b32 v227, v226
    v_mfma_f32_16x16x32_bf16 v[152:155], a[252:255], a[204:207], v[152:155]
    v_permlane16_swap_b32 v224, v225
    v_permlane16_swap_b32 v226, v227
    v_max_f32 v224, v224, v225
    v_max_f32 v226, v226, v227
    v_mul_f32 v228, 0xbe0293ee, v224
    v_mul_f32 v232, 0xbe0293ee, v226
    v_mfma_f32_16x16x32_bf16 v[156:159], a[252:255], a[220:223], 0
    v_mul_f32 v230, 0xbe0293ee, v224
    v_mul_f32 v234, 0xbe0293ee, v226
    v_mfma_f32_16x16x32_bf16 v[156:159], a[248:251], a[216:219], v[156:159]
    v_mfma_f32_16x16x32_bf16 v[156:159], a[244:247], a[212:215], v[156:159]
    v_permlane32_swap_b32 v228, v230
    v_mfma_f32_16x16x32_bf16 v[156:159], a[240:243], a[208:211], v[156:159]
    s_waitcnt lgkmcnt(0)
    v_permlane32_swap_b32 v232, v234
    v_fmamk_f32 v128, v128, 0x3e0293ee, v228
    s_xor_b32 s52, s58, s84
    v_fmamk_f32 v129, v129, 0x3e0293ee, v228
    v_mfma_f32_16x16x32_bf16 a[0:3], a[224:227], v[64:67], a[0:3]
    ds_read_b128 a[240:243], v237 offset:8192
    v_mfma_f32_16x16x32_bf16 a[0:3], a[228:231], v[80:83], a[0:3]
    ds_read_b128 a[244:247], v237 offset:8448
    v_mfma_f32_16x16x32_bf16 a[0:3], a[232:235], v[96:99], a[0:3]
    s_xor_b32 s53, s52, 4096
    v_exp_f32 v128, v128
    v_mfma_f32_16x16x32_bf16 a[0:3], a[236:239], v[112:115], a[0:3]
    s_xor_b32 s54, s52, 16384
    v_exp_f32 v129, v129
    v_fmamk_f32 v130, v130, 0x3e0293ee, v228
    s_xor_b32 s55, s52, 20480
    s_mov_b32 s26, 0x8000000
    v_fmamk_f32 v131, v131, 0x3e0293ee, v228
    v_mfma_f32_16x16x32_bf16 a[16:19], a[236:239], v[116:119], a[16:19]
    ds_read_b128 a[248:251], v237 offset:8704
    v_mfma_f32_16x16x32_bf16 a[16:19], a[232:235], v[100:103], a[16:19]
    ds_read_b128 a[252:255], v237 offset:8960
    v_mfma_f32_16x16x32_bf16 a[16:19], a[228:231], v[84:87], a[16:19]
    v_exp_f32 v130, v130
    v_mfma_f32_16x16x32_bf16 a[16:19], a[224:227], v[68:71], a[16:19]
    v_exp_f32 v131, v131
    v_fmamk_f32 v132, v132, 0x3e0293ee, v230
    v_cvt_pk_bf16_f32 v0, v128, v129
    v_fmamk_f32 v133, v133, 0x3e0293ee, v230
    v_exp_f32 v132, v132
    v_mfma_f32_16x16x32_bf16 a[32:35], a[224:227], v[72:75], a[32:35]
    v_exp_f32 v133, v133
    v_mfma_f32_16x16x32_bf16 a[32:35], a[228:231], v[88:91], a[32:35]
    v_mfma_f32_16x16x32_bf16 a[32:35], a[232:235], v[104:107], a[32:35]
    s_mov_b32 m0, s42
    v_fmamk_f32 v134, v134, 0x3e0293ee, v230
    v_cvt_pk_bf16_f32 v1, v130, v131
    v_mfma_f32_16x16x32_bf16 a[32:35], a[236:239], v[120:123], a[32:35]
    buffer_load_dwordx4 v246, s[12:15], s80 offen offset:2048 nt lds
    v_fmamk_f32 v135, v135, 0x3e0293ee, v230
    v_exp_f32 v134, v134
    v_fmamk_f32 v136, v136, 0x3e0293ee, v232
    v_mfma_f32_16x16x32_bf16 a[48:51], a[236:239], v[124:127], a[48:51]
    v_exp_f32 v135, v135
    v_mfma_f32_16x16x32_bf16 a[48:51], a[232:235], v[108:111], a[48:51]
    v_exp_f32 v136, v136
    v_mfma_f32_16x16x32_bf16 a[48:51], a[228:231], v[92:95], a[48:51]
    v_cvt_pk_bf16_f32 v4, v132, v133
    v_fmamk_f32 v137, v137, 0x3e0293ee, v232
    v_mfma_f32_16x16x32_bf16 a[48:51], a[224:227], v[76:79], a[48:51]
    s_waitcnt lgkmcnt(0)
    v_exp_f32 v137, v137
    v_fmamk_f32 v138, v138, 0x3e0293ee, v232
    v_cvt_pk_bf16_f32 v5, v134, v135
    v_mfma_f32_16x16x32_bf16 v[160:163], a[240:243], a[160:163], 0
    ds_read_b64_tr_b16 a[224:225], v245 offset:32768
    v_mfma_f32_16x16x32_bf16 v[160:163], a[244:247], a[164:167], v[160:163]
    ds_read_b64_tr_b16 a[226:227], v245 offset:36864
    v_mfma_f32_16x16x32_bf16 v[160:163], a[248:251], a[168:171], v[160:163]
    ds_read_b64_tr_b16 a[228:229], v245 offset:40960
    v_mfma_f32_16x16x32_bf16 v[160:163], a[252:255], a[172:175], v[160:163]
    v_exp_f32 v138, v138
    v_fmamk_f32 v139, v139, 0x3e0293ee, v232
    v_fmamk_f32 v140, v140, 0x3e0293ee, v234
    v_cvt_pk_bf16_f32 v8, v136, v137
    v_exp_f32 v139, v139
    v_mfma_f32_16x16x32_bf16 v[164:167], a[252:255], a[188:191], 0
    ds_read_b64_tr_b16 a[230:231], v245 offset:45056
    v_mfma_f32_16x16x32_bf16 v[164:167], a[248:251], a[184:187], v[164:167]
    ds_read_b64_tr_b16 a[232:233], v245 offset:49152
    v_mfma_f32_16x16x32_bf16 v[164:167], a[244:247], a[180:183], v[164:167]
    ds_read_b64_tr_b16 a[234:235], v245 offset:53248
    v_mfma_f32_16x16x32_bf16 v[164:167], a[240:243], a[176:179], v[164:167]
    v_exp_f32 v140, v140
    v_fmamk_f32 v141, v141, 0x3e0293ee, v234
    v_fmamk_f32 v142, v142, 0x3e0293ee, v234
    v_cvt_pk_bf16_f32 v9, v138, v139
    v_exp_f32 v141, v141
    v_fmamk_f32 v143, v143, 0x3e0293ee, v234
    v_mfma_f32_16x16x32_bf16 v[168:171], a[240:243], a[192:195], 0
    ds_read_b64_tr_b16 a[236:237], v245 offset:57344
    v_mfma_f32_16x16x32_bf16 v[168:171], a[244:247], a[196:199], v[168:171]
    ds_read_b64_tr_b16 a[238:239], v245 offset:61440
    v_mfma_f32_16x16x32_bf16 v[168:171], a[248:251], a[200:203], v[168:171]
    v_exp_f32 v142, v142
    v_mfma_f32_16x16x32_bf16 v[168:171], a[252:255], a[204:207], v[168:171]
    v_exp_f32 v143, v143
    v_fmamk_f32 v144, v144, 0x3e0293ee, v228
    v_cvt_pk_bf16_f32 v12, v140, v141
    v_fmamk_f32 v145, v145, 0x3e0293ee, v228
    v_mfma_f32_16x16x32_bf16 v[172:175], a[252:255], a[220:223], 0
    v_mfma_f32_16x16x32_bf16 v[172:175], a[248:251], a[216:219], v[172:175]
    v_exp_f32 v144, v144
    v_mfma_f32_16x16x32_bf16 v[172:175], a[244:247], a[212:215], v[172:175]
    s_mov_b32 m0, s42
    v_exp_f32 v145, v145
    v_mfma_f32_16x16x32_bf16 v[172:175], a[240:243], a[208:211], v[172:175]
    s_waitcnt lgkmcnt(0)
    buffer_load_dwordx4 v247, s[12:15], s80 offen offset:3072 nt lds
    v_fmamk_f32 v146, v146, 0x3e0293ee, v228
    v_cvt_pk_bf16_f32 v13, v142, v143
    v_fmamk_f32 v147, v147, 0x3e0293ee, v228
    v_exp_f32 v146, v146
    v_mfma_f32_16x16x32_bf16 a[8:11], a[224:227], v[64:67], a[8:11]
    ds_read_b128 a[240:243], v237 offset:12288
    v_mfma_f32_16x16x32_bf16 a[8:11], a[228:231], v[80:83], a[8:11]
    ds_read_b128 a[244:247], v237 offset:12544
    v_mfma_f32_16x16x32_bf16 a[8:11], a[232:235], v[96:99], a[8:11]
    v_exp_f32 v147, v147
    v_mfma_f32_16x16x32_bf16 a[8:11], a[236:239], v[112:115], a[8:11]
    v_fmamk_f32 v148, v148, 0x3e0293ee, v230
    v_cvt_pk_bf16_f32 v2, v144, v145
    v_fmamk_f32 v149, v149, 0x3e0293ee, v230
    v_exp_f32 v148, v148
    v_fmamk_f32 v150, v150, 0x3e0293ee, v230
    v_mfma_f32_16x16x32_bf16 a[24:27], a[236:239], v[116:119], a[24:27]
    ds_read_b128 a[248:251], v237 offset:12800
    v_mfma_f32_16x16x32_bf16 a[24:27], a[232:235], v[100:103], a[24:27]
    ds_read_b128 a[252:255], v237 offset:13056
    v_mfma_f32_16x16x32_bf16 a[24:27], a[228:231], v[84:87], a[24:27]
    v_exp_f32 v149, v149
    v_mfma_f32_16x16x32_bf16 a[24:27], a[224:227], v[68:71], a[24:27]
    v_exp_f32 v150, v150
    v_cvt_pk_bf16_f32 v3, v146, v147
    v_fmamk_f32 v151, v151, 0x3e0293ee, v230
    v_fmamk_f32 v152, v152, 0x3e0293ee, v232
    v_cvt_pk_bf16_f32 v6, v148, v149
    v_mfma_f32_16x16x32_bf16 a[40:43], a[224:227], v[72:75], a[40:43]
    v_mfma_f32_16x16x32_bf16 a[40:43], a[228:231], v[88:91], a[40:43]
    v_exp_f32 v151, v151
    v_mfma_f32_16x16x32_bf16 a[40:43], a[232:235], v[104:107], a[40:43]
    v_exp_f32 v152, v152
    v_mfma_f32_16x16x32_bf16 a[40:43], a[236:239], v[120:123], a[40:43]
    v_fmamk_f32 v153, v153, 0x3e0293ee, v232
    v_fmamk_f32 v154, v154, 0x3e0293ee, v232
    v_cvt_pk_bf16_f32 v7, v150, v151
    v_exp_f32 v153, v153
    v_fmamk_f32 v155, v155, 0x3e0293ee, v232
    v_mfma_f32_16x16x32_bf16 a[56:59], a[236:239], v[124:127], a[56:59]
    v_exp_f32 v154, v154
    v_mfma_f32_16x16x32_bf16 a[56:59], a[232:235], v[108:111], a[56:59]
    v_exp_f32 v155, v155
    v_mfma_f32_16x16x32_bf16 a[56:59], a[228:231], v[92:95], a[56:59]
    v_mfma_f32_16x16x32_bf16 a[56:59], a[224:227], v[76:79], a[56:59]
    s_waitcnt lgkmcnt(0)
    v_fmamk_f32 v156, v156, 0x3e0293ee, v234
    v_cvt_pk_bf16_f32 v10, v152, v153
    v_fmamk_f32 v157, v157, 0x3e0293ee, v234
    v_mfma_f32_16x16x32_bf16 v[128:131], a[240:243], a[160:163], 0
    ds_read_b64_tr_b16 a[224:225], v244 offset:33024
    v_mfma_f32_16x16x32_bf16 v[128:131], a[244:247], a[164:167], v[128:131]
    ds_read_b64_tr_b16 a[226:227], v244 offset:37120
    v_mfma_f32_16x16x32_bf16 v[128:131], a[248:251], a[168:171], v[128:131]
    ds_read_b64_tr_b16 a[228:229], v244 offset:41216
    s_mov_b32 m0, s43
    v_mfma_f32_16x16x32_bf16 v[128:131], a[252:255], a[172:175], v[128:131]
    buffer_load_dwordx4 v246, s[12:15], s81 offen offset:0 nt lds
    v_fmamk_f32 v158, v158, 0x3e0293ee, v234
    v_exp_f32 v156, v156
    v_cvt_pk_bf16_f32 v11, v154, v155
    v_exp_f32 v157, v157
    v_fmamk_f32 v159, v159, 0x3e0293ee, v234
    v_mfma_f32_16x16x32_bf16 v[132:135], a[252:255], a[188:191], 0
    ds_read_b64_tr_b16 a[230:231], v244 offset:45312
    v_mfma_f32_16x16x32_bf16 v[132:135], a[248:251], a[184:187], v[132:135]
    ds_read_b64_tr_b16 a[232:233], v244 offset:49408
    v_mfma_f32_16x16x32_bf16 v[132:135], a[244:247], a[180:183], v[132:135]
    ds_read_b64_tr_b16 a[234:235], v244 offset:53504
    v_mfma_f32_16x16x32_bf16 v[132:135], a[240:243], a[176:179], v[132:135]
    v_exp_f32 v158, v158
    v_fmamk_f32 v160, v160, 0x3e0293ee, v228
    v_cvt_pk_bf16_f32 v14, v156, v157
    v_exp_f32 v159, v159
    v_fmamk_f32 v161, v161, 0x3e0293ee, v228
    v_exp_f32 v160, v160
    v_fmamk_f32 v162, v162, 0x3e0293ee, v228
    v_mfma_f32_16x16x32_bf16 v[136:139], a[240:243], a[192:195], 0
    ds_read_b64_tr_b16 a[236:237], v244 offset:57600
    v_mfma_f32_16x16x32_bf16 v[136:139], a[244:247], a[196:199], v[136:139]
    ds_read_b64_tr_b16 a[238:239], v244 offset:61696
    v_mfma_f32_16x16x32_bf16 v[136:139], a[248:251], a[200:203], v[136:139]
    v_exp_f32 v161, v161
    v_mfma_f32_16x16x32_bf16 v[136:139], a[252:255], a[204:207], v[136:139]
    v_exp_f32 v162, v162
    v_cvt_pk_bf16_f32 v15, v158, v159
    v_fmamk_f32 v163, v163, 0x3e0293ee, v228
    v_fmamk_f32 v164, v164, 0x3e0293ee, v230
    v_mfma_f32_16x16x32_bf16 v[140:143], a[252:255], a[220:223], 0
    v_exp_f32 v163, v163
    v_mfma_f32_16x16x32_bf16 v[140:143], a[248:251], a[216:219], v[140:143]
    v_exp_f32 v164, v164
    v_mfma_f32_16x16x32_bf16 v[140:143], a[244:247], a[212:215], v[140:143]
    v_cvt_pk_bf16_f32 v16, v160, v161
    v_fmamk_f32 v165, v165, 0x3e0293ee, v230
    v_mfma_f32_16x16x32_bf16 v[140:143], a[240:243], a[208:211], v[140:143]
    s_waitcnt lgkmcnt(0)
    v_exp_f32 v165, v165
    v_fmamk_f32 v166, v166, 0x3e0293ee, v230
    v_cvt_pk_bf16_f32 v17, v162, v163
    v_mfma_f32_16x16x32_bf16 a[4:7], a[224:227], v[64:67], a[4:7]
    ds_read_b128 a[240:243], v237 offset:16384
    v_mfma_f32_16x16x32_bf16 a[4:7], a[228:231], v[80:83], a[4:7]
    ds_read_b128 a[244:247], v237 offset:16640
    v_mfma_f32_16x16x32_bf16 a[4:7], a[232:235], v[96:99], a[4:7]
    v_exp_f32 v166, v166
    v_mfma_f32_16x16x32_bf16 a[4:7], a[236:239], v[112:115], a[4:7]
    v_fmamk_f32 v167, v167, 0x3e0293ee, v230
    v_fmamk_f32 v168, v168, 0x3e0293ee, v232
    v_cvt_pk_bf16_f32 v20, v164, v165
    v_exp_f32 v167, v167
    v_fmamk_f32 v169, v169, 0x3e0293ee, v232
    v_mfma_f32_16x16x32_bf16 a[20:23], a[236:239], v[116:119], a[20:23]
    ds_read_b128 a[248:251], v237 offset:16896
    v_mfma_f32_16x16x32_bf16 a[20:23], a[232:235], v[100:103], a[20:23]
    ds_read_b128 a[252:255], v237 offset:17152
    v_mfma_f32_16x16x32_bf16 a[20:23], a[228:231], v[84:87], a[20:23]
    s_mov_b32 m0, s43
    v_mfma_f32_16x16x32_bf16 a[20:23], a[224:227], v[68:71], a[20:23]
    buffer_load_dwordx4 v247, s[12:15], s81 offen offset:1024 nt lds
    v_fmamk_f32 v170, v170, 0x3e0293ee, v232
    v_exp_f32 v168, v168
    v_cvt_pk_bf16_f32 v21, v166, v167
    v_exp_f32 v169, v169
    v_fmamk_f32 v171, v171, 0x3e0293ee, v232
    v_mfma_f32_16x16x32_bf16 a[36:39], a[224:227], v[72:75], a[36:39]
    v_exp_f32 v170, v170
    v_mfma_f32_16x16x32_bf16 a[36:39], a[228:231], v[88:91], a[36:39]
    v_exp_f32 v171, v171
    v_mfma_f32_16x16x32_bf16 a[36:39], a[232:235], v[104:107], a[36:39]
    v_fmamk_f32 v172, v172, 0x3e0293ee, v234
    v_cvt_pk_bf16_f32 v24, v168, v169
    v_mfma_f32_16x16x32_bf16 a[36:39], a[236:239], v[120:123], a[36:39]
    v_exp_f32 v172, v172
    v_fmamk_f32 v173, v173, 0x3e0293ee, v234
    v_mfma_f32_16x16x32_bf16 a[52:55], a[236:239], v[124:127], a[52:55]
    v_exp_f32 v173, v173
    v_mfma_f32_16x16x32_bf16 a[52:55], a[232:235], v[108:111], a[52:55]
    v_mfma_f32_16x16x32_bf16 a[52:55], a[228:231], v[92:95], a[52:55]
    v_fmamk_f32 v174, v174, 0x3e0293ee, v234
    v_cvt_pk_bf16_f32 v25, v170, v171
    v_mfma_f32_16x16x32_bf16 a[52:55], a[224:227], v[76:79], a[52:55]
    s_waitcnt lgkmcnt(0)
    v_exp_f32 v174, v174
    v_fmamk_f32 v175, v175, 0x3e0293ee, v234
    v_fmamk_f32 v128, v128, 0x3e0293ee, v228
    v_mfma_f32_16x16x32_bf16 v[144:147], a[240:243], a[160:163], 0
    ds_read_b64_tr_b16 a[224:225], v245 offset:33024
    v_mfma_f32_16x16x32_bf16 v[144:147], a[244:247], a[164:167], v[144:147]
    ds_read_b64_tr_b16 a[226:227], v245 offset:37120
    v_mfma_f32_16x16x32_bf16 v[144:147], a[248:251], a[168:171], v[144:147]
    ds_read_b64_tr_b16 a[228:229], v245 offset:41216
    v_mfma_f32_16x16x32_bf16 v[144:147], a[252:255], a[172:175], v[144:147]
    v_exp_f32 v175, v175
    v_cvt_pk_bf16_f32 v28, v172, v173
    v_fmamk_f32 v129, v129, 0x3e0293ee, v228
    v_exp_f32 v128, v128
    v_fmamk_f32 v130, v130, 0x3e0293ee, v228
    v_mfma_f32_16x16x32_bf16 v[148:151], a[252:255], a[188:191], 0
    ds_read_b64_tr_b16 a[230:231], v245 offset:45312
    v_mfma_f32_16x16x32_bf16 v[148:151], a[248:251], a[184:187], v[148:151]
    ds_read_b64_tr_b16 a[232:233], v245 offset:49408
    v_mfma_f32_16x16x32_bf16 v[148:151], a[244:247], a[180:183], v[148:151]
    ds_read_b64_tr_b16 a[234:235], v245 offset:53504
    v_mfma_f32_16x16x32_bf16 v[148:151], a[240:243], a[176:179], v[148:151]
    v_exp_f32 v129, v129
    v_cvt_pk_bf16_f32 v29, v174, v175
    v_fmamk_f32 v131, v131, 0x3e0293ee, v228
    v_exp_f32 v130, v130
    v_fmamk_f32 v132, v132, 0x3e0293ee, v230
    v_cvt_pk_bf16_f32 v18, v128, v129
    v_exp_f32 v131, v131
    v_mfma_f32_16x16x32_bf16 v[152:155], a[240:243], a[192:195], 0
    ds_read_b64_tr_b16 a[236:237], v245 offset:57600
    v_mfma_f32_16x16x32_bf16 v[152:155], a[244:247], a[196:199], v[152:155]
    ds_read_b64_tr_b16 a[238:239], v245 offset:61696
    v_mfma_f32_16x16x32_bf16 v[152:155], a[248:251], a[200:203], v[152:155]
    s_mov_b32 m0, s43
    v_exp_f32 v132, v132
    v_mfma_f32_16x16x32_bf16 v[152:155], a[252:255], a[204:207], v[152:155]
    buffer_load_dwordx4 v246, s[12:15], s81 offen offset:2048 nt lds
    v_fmamk_f32 v133, v133, 0x3e0293ee, v230
    v_fmamk_f32 v134, v134, 0x3e0293ee, v230
    v_cvt_pk_bf16_f32 v19, v130, v131
    v_exp_f32 v133, v133
    v_fmamk_f32 v135, v135, 0x3e0293ee, v230
    v_mfma_f32_16x16x32_bf16 v[156:159], a[252:255], a[220:223], 0
    v_exp_f32 v134, v134
    v_mfma_f32_16x16x32_bf16 v[156:159], a[248:251], a[216:219], v[156:159]
    v_exp_f32 v135, v135
    v_mfma_f32_16x16x32_bf16 v[156:159], a[244:247], a[212:215], v[156:159]
    v_mfma_f32_16x16x32_bf16 v[156:159], a[240:243], a[208:211], v[156:159]
    s_waitcnt lgkmcnt(0)
    v_fmamk_f32 v136, v136, 0x3e0293ee, v232
    v_cvt_pk_bf16_f32 v22, v132, v133
    v_fmamk_f32 v137, v137, 0x3e0293ee, v232
    v_mfma_f32_16x16x32_bf16 a[12:15], a[224:227], v[64:67], a[12:15]
    ds_read_b128 a[240:243], v237 offset:20480
    v_mfma_f32_16x16x32_bf16 a[12:15], a[228:231], v[80:83], a[12:15]
    ds_read_b128 a[244:247], v237 offset:20736
    v_mfma_f32_16x16x32_bf16 a[12:15], a[232:235], v[96:99], a[12:15]
    v_exp_f32 v136, v136
    v_mfma_f32_16x16x32_bf16 a[12:15], a[236:239], v[112:115], a[12:15]
    v_exp_f32 v137, v137
    v_fmamk_f32 v138, v138, 0x3e0293ee, v232
    v_cvt_pk_bf16_f32 v23, v134, v135
    v_fmamk_f32 v139, v139, 0x3e0293ee, v232
    v_exp_f32 v138, v138
    v_mfma_f32_16x16x32_bf16 a[28:31], a[236:239], v[116:119], a[28:31]
    ds_read_b128 a[248:251], v237 offset:20992
    v_mfma_f32_16x16x32_bf16 a[28:31], a[232:235], v[100:103], a[28:31]
    ds_read_b128 a[252:255], v237 offset:21248
    v_mfma_f32_16x16x32_bf16 a[28:31], a[228:231], v[84:87], a[28:31]
    v_exp_f32 v139, v139
    v_mfma_f32_16x16x32_bf16 a[28:31], a[224:227], v[68:71], a[28:31]
    v_fmamk_f32 v140, v140, 0x3e0293ee, v234
    v_cvt_pk_bf16_f32 v26, v136, v137
    v_fmamk_f32 v141, v141, 0x3e0293ee, v234
    v_exp_f32 v140, v140
    v_fmamk_f32 v142, v142, 0x3e0293ee, v234
    v_mfma_f32_16x16x32_bf16 a[44:47], a[224:227], v[72:75], a[44:47]
    v_exp_f32 v141, v141
    v_mfma_f32_16x16x32_bf16 a[44:47], a[228:231], v[88:91], a[44:47]
    v_exp_f32 v142, v142
    v_mfma_f32_16x16x32_bf16 a[44:47], a[232:235], v[104:107], a[44:47]
    v_cvt_pk_bf16_f32 v27, v138, v139
    v_fmamk_f32 v143, v143, 0x3e0293ee, v234
    v_mfma_f32_16x16x32_bf16 a[44:47], a[236:239], v[120:123], a[44:47]
    v_exp_f32 v143, v143
    v_fmamk_f32 v144, v144, 0x3e0293ee, v228
    v_cvt_pk_bf16_f32 v30, v140, v141
    v_mfma_f32_16x16x32_bf16 a[60:63], a[236:239], v[124:127], a[60:63]
    v_mfma_f32_16x16x32_bf16 a[60:63], a[232:235], v[108:111], a[60:63]
    v_exp_f32 v144, v144
    v_mfma_f32_16x16x32_bf16 a[60:63], a[228:231], v[92:95], a[60:63]
    s_mov_b32 m0, s43
    v_fmamk_f32 v145, v145, 0x3e0293ee, v228
    v_fmamk_f32 v146, v146, 0x3e0293ee, v228
    v_mfma_f32_16x16x32_bf16 a[60:63], a[224:227], v[76:79], a[60:63]
    s_waitcnt lgkmcnt(0)
    buffer_load_dwordx4 v247, s[12:15], s81 offen offset:3072 nt lds
    v_cvt_pk_bf16_f32 v31, v142, v143
    v_exp_f32 v145, v145
    v_mfma_f32_16x16x32_bf16 v[160:163], a[240:243], a[160:163], 0
    ds_read_b64_tr_b16 a[224:225], v244 offset:33280
    v_mfma_f32_16x16x32_bf16 v[160:163], a[244:247], a[164:167], v[160:163]
    ds_read_b64_tr_b16 a[226:227], v244 offset:37376
    v_mfma_f32_16x16x32_bf16 v[160:163], a[248:251], a[168:171], v[160:163]
    ds_read_b64_tr_b16 a[228:229], v244 offset:41472
    v_mfma_f32_16x16x32_bf16 v[160:163], a[252:255], a[172:175], v[160:163]
    v_exp_f32 v146, v146
    v_fmamk_f32 v147, v147, 0x3e0293ee, v228
    v_fmamk_f32 v148, v148, 0x3e0293ee, v230
    v_cvt_pk_bf16_f32 v32, v144, v145
    v_exp_f32 v147, v147
    v_fmamk_f32 v149, v149, 0x3e0293ee, v230
    v_mfma_f32_16x16x32_bf16 v[164:167], a[252:255], a[188:191], 0
    ds_read_b64_tr_b16 a[230:231], v244 offset:45568
    v_mfma_f32_16x16x32_bf16 v[164:167], a[248:251], a[184:187], v[164:167]
    ds_read_b64_tr_b16 a[232:233], v244 offset:49664
    v_mfma_f32_16x16x32_bf16 v[164:167], a[244:247], a[180:183], v[164:167]
    ds_read_b64_tr_b16 a[234:235], v244 offset:53760
    v_mfma_f32_16x16x32_bf16 v[164:167], a[240:243], a[176:179], v[164:167]
    v_exp_f32 v148, v148
    v_fmamk_f32 v150, v150, 0x3e0293ee, v230
    v_cvt_pk_bf16_f32 v33, v146, v147
    v_exp_f32 v149, v149
    v_fmamk_f32 v151, v151, 0x3e0293ee, v230
    v_accvgpr_read_b32 v212, a0
    v_mfma_f32_16x16x32_bf16 v[168:171], a[240:243], a[192:195], 0
    ds_read_b64_tr_b16 a[236:237], v244 offset:57856
    v_mfma_f32_16x16x32_bf16 v[168:171], a[244:247], a[196:199], v[168:171]
    ds_read_b64_tr_b16 a[238:239], v244 offset:61952
    v_mfma_f32_16x16x32_bf16 v[168:171], a[248:251], a[200:203], v[168:171]
    v_exp_f32 v150, v150
    v_mfma_f32_16x16x32_bf16 v[168:171], a[252:255], a[204:207], v[168:171]
    v_exp_f32 v151, v151
    v_accvgpr_read_b32 v213, a1
    v_fmamk_f32 v152, v152, 0x3e0293ee, v232
    v_cvt_pk_bf16_f32 v36, v148, v149
    v_accvgpr_read_b32 v214, a2
    v_fmamk_f32 v153, v153, 0x3e0293ee, v232
    v_mul_f32 v212, v212, v236
    v_accvgpr_read_b32 v215, a3
    v_exp_f32 v152, v152
    v_mfma_f32_16x16x32_bf16 v[172:175], a[252:255], a[220:223], 0
    v_exp_f32 v153, v153
    v_mfma_f32_16x16x32_bf16 v[172:175], a[248:251], a[216:219], v[172:175]
    v_mfma_f32_16x16x32_bf16 v[172:175], a[244:247], a[212:215], v[172:175]
    v_fmamk_f32 v154, v154, 0x3e0293ee, v232
    v_mul_f32 v213, v213, v236
    v_mfma_f32_16x16x32_bf16 v[172:175], a[240:243], a[208:211], v[172:175]
    s_waitcnt lgkmcnt(0)
    v_exp_f32 v154, v154
    v_cvt_pk_bf16_f32 v37, v150, v151
    v_accvgpr_read_b32 v216, a4
    v_fmamk_f32 v155, v155, 0x3e0293ee, v232
    v_mul_f32 v214, v214, v236
    v_accvgpr_read_b32 v217, a5
    v_fmamk_f32 v156, v156, 0x3e0293ee, v234
    v_mul_f32 v215, v215, v236
    v_mfma_f32_16x16x32_bf16 a[64:67], a[224:227], v[64:67], a[64:67]
    ds_read_b128 a[240:243], v237 offset:24576
    v_mfma_f32_16x16x32_bf16 a[64:67], a[228:231], v[80:83], a[64:67]
    ds_read_b128 a[244:247], v237 offset:24832
    v_mfma_f32_16x16x32_bf16 a[64:67], a[232:235], v[96:99], a[64:67]
    v_exp_f32 v155, v155
    v_mfma_f32_16x16x32_bf16 a[64:67], a[236:239], v[112:115], a[64:67]
    v_exp_f32 v156, v156
    v_accvgpr_read_b32 v218, a6
    v_cvt_pk_bf16_f32 v40, v152, v153
    v_mul_f32 v216, v216, v236
    v_fmamk_f32 v157, v157, 0x3e0293ee, v234
    v_accvgpr_read_b32 v219, a7
    v_cvt_pk_bf16_f32 v180, v212, v213
    v_mul_f32 v217, v217, v236
    v_fmamk_f32 v158, v158, 0x3e0293ee, v234
    v_accvgpr_read_b32 v220, a8
    v_cvt_pk_bf16_f32 v41, v154, v155
    v_mfma_f32_16x16x32_bf16 a[80:83], a[236:239], v[116:119], a[80:83]
    ds_read_b128 a[248:251], v237 offset:25088
    v_mfma_f32_16x16x32_bf16 a[80:83], a[232:235], v[100:103], a[80:83]
    ds_read_b128 a[252:255], v237 offset:25344
    v_mfma_f32_16x16x32_bf16 a[80:83], a[228:231], v[84:87], a[80:83]
    v_exp_f32 v157, v157
    v_mfma_f32_16x16x32_bf16 a[80:83], a[224:227], v[68:71], a[80:83]
    v_exp_f32 v158, v158
    v_mul_f32 v218, v218, v236
    v_fmamk_f32 v159, v159, 0x3e0293ee, v234
    v_accvgpr_read_b32 v221, a9
    v_cvt_pk_bf16_f32 v181, v214, v215
    v_mul_f32 v219, v219, v236
    v_accvgpr_read_b32 v222, a10
    v_fmamk_f32 v160, v160, 0x3e0293ee, v228
    v_cvt_pk_bf16_f32 v44, v156, v157
    v_mul_f32 v220, v220, v236
    v_exp_f32 v159, v159
    v_accvgpr_read_b32 v223, a11
    v_fmamk_f32 v161, v161, 0x3e0293ee, v228
    v_mfma_f32_16x16x32_bf16 a[96:99], a[224:227], v[72:75], a[96:99]
    v_exp_f32 v160, v160
    v_mfma_f32_16x16x32_bf16 a[96:99], a[228:231], v[88:91], a[96:99]
    v_mfma_f32_16x16x32_bf16 a[96:99], a[232:235], v[104:107], a[96:99]
    v_exp_f32 v161, v161
    v_mfma_f32_16x16x32_bf16 a[96:99], a[236:239], v[120:123], a[96:99]
    v_cvt_pk_bf16_f32 v182, v216, v217
    v_mul_f32 v221, v221, v236
    v_accvgpr_read_b32 v224, a12
    v_fmamk_f32 v162, v162, 0x3e0293ee, v228
    v_mul_f32 v222, v222, v236
    v_cvt_pk_bf16_f32 v45, v158, v159
    v_accvgpr_read_b32 v225, a13
    v_fmamk_f32 v163, v163, 0x3e0293ee, v228
    v_cvt_pk_bf16_f32 v183, v218, v219
    v_mul_f32 v223, v223, v236
    v_mfma_f32_16x16x32_bf16 a[112:115], a[236:239], v[124:127], a[112:115]
    v_exp_f32 v162, v162
    v_mfma_f32_16x16x32_bf16 a[112:115], a[232:235], v[108:111], a[112:115]
    v_exp_f32 v163, v163
    v_mfma_f32_16x16x32_bf16 a[112:115], a[228:231], v[92:95], a[112:115]
    v_accvgpr_read_b32 v226, a14
    v_fmamk_f32 v164, v164, 0x3e0293ee, v230
    v_mfma_f32_16x16x32_bf16 a[112:115], a[224:227], v[76:79], a[112:115]
    s_waitcnt lgkmcnt(0)
    v_exp_f32 v164, v164
    v_mul_f32 v224, v224, v236
    v_accvgpr_read_b32 v227, a15
    v_cvt_pk_bf16_f32 v34, v160, v161
    v_cvt_pk_bf16_f32 v196, v220, v221
    v_fmamk_f32 v165, v165, 0x3e0293ee, v230
    v_mul_f32 v225, v225, v236
    v_accvgpr_read_b32 v212, a16
    v_mfma_f32_16x16x32_bf16 v[128:131], a[240:243], a[160:163], 0
    ds_read_b64_tr_b16 a[224:225], v245 offset:33280
    v_mfma_f32_16x16x32_bf16 v[128:131], a[244:247], a[164:167], v[128:131]
    ds_read_b64_tr_b16 a[226:227], v245 offset:37376
    v_mfma_f32_16x16x32_bf16 v[128:131], a[248:251], a[168:171], v[128:131]
    ds_read_b64_tr_b16 a[228:229], v245 offset:41472
    v_mfma_f32_16x16x32_bf16 v[128:131], a[252:255], a[172:175], v[128:131]
    s_mov_b64 vcc, s[74:75]
    v_exp_f32 v165, v165
    v_mul_f32 v226, v226, v236
    v_fmamk_f32 v166, v166, 0x3e0293ee, v230
    v_accvgpr_read_b32 v213, a17
    v_cvt_pk_bf16_f32 v35, v162, v163
    v_cvt_pk_bf16_f32 v197, v222, v223
    v_mul_f32 v227, v227, v236
    v_fmamk_f32 v167, v167, 0x3e0293ee, v230
    v_accvgpr_read_b32 v214, a18
    v_mul_f32 v212, v212, v238
    v_exp_f32 v166, v166
    v_fmamk_f32 v168, v168, 0x3e0293ee, v232
    v_accvgpr_read_b32 v215, a19
    v_mfma_f32_16x16x32_bf16 v[132:135], a[252:255], a[188:191], 0
    ds_read_b64_tr_b16 a[230:231], v245 offset:45568
    v_mfma_f32_16x16x32_bf16 v[132:135], a[248:251], a[184:187], v[132:135]
    ds_read_b64_tr_b16 a[232:233], v245 offset:49664
    v_mfma_f32_16x16x32_bf16 v[132:135], a[244:247], a[180:183], v[132:135]
    ds_read_b64_tr_b16 a[234:235], v245 offset:53760
    v_mfma_f32_16x16x32_bf16 v[132:135], a[240:243], a[176:179], v[132:135]
    v_exp_f32 v167, v167
    v_cvt_pk_bf16_f32 v38, v164, v165
    v_cvt_pk_bf16_f32 v198, v224, v225
    v_mul_f32 v213, v213, v238
    v_accvgpr_read_b32 v216, a20
    v_fmamk_f32 v169, v169, 0x3e0293ee, v232
    v_mul_f32 v214, v214, v238
    v_exp_f32 v168, v168
    v_accvgpr_read_b32 v217, a21
    v_fmamk_f32 v170, v170, 0x3e0293ee, v232
    v_cvt_pk_bf16_f32 v199, v226, v227
    v_mul_f32 v215, v215, v238
    v_mfma_f32_16x16x32_bf16 v[136:139], a[240:243], a[192:195], 0
    ds_read_b64_tr_b16 a[236:237], v245 offset:57856
    v_mfma_f32_16x16x32_bf16 v[136:139], a[244:247], a[196:199], v[136:139]
    ds_read_b64_tr_b16 a[238:239], v245 offset:61952
    v_mfma_f32_16x16x32_bf16 v[136:139], a[248:251], a[200:203], v[136:139]
    v_exp_f32 v169, v169
    v_mfma_f32_16x16x32_bf16 v[136:139], a[252:255], a[204:207], v[136:139]
    v_exp_f32 v170, v170
    v_cvt_pk_bf16_f32 v39, v166, v167
    v_accvgpr_read_b32 v218, a22
    v_fmamk_f32 v171, v171, 0x3e0293ee, v232
    v_mul_f32 v216, v216, v238
    v_cndmask_b32_dpp v176, v196, v180, vcc quad_perm:[1,0,3,2] row_mask:0xf bank_mask:0xf
    v_accvgpr_read_b32 v219, a23
    v_cndmask_b32_dpp v177, v197, v181, vcc quad_perm:[1,0,3,2] row_mask:0xf bank_mask:0xf
    v_fmamk_f32 v172, v172, 0x3e0293ee, v234
    v_cvt_pk_bf16_f32 v184, v212, v213
    v_mul_f32 v217, v217, v238
    v_cndmask_b32_dpp v178, v198, v182, vcc quad_perm:[1,0,3,2] row_mask:0xf bank_mask:0xf
    v_accvgpr_read_b32 v220, a24
    v_cvt_pk_bf16_f32 v42, v168, v169
    v_cndmask_b32_dpp v179, v199, v183, vcc quad_perm:[1,0,3,2] row_mask:0xf bank_mask:0xf
    v_exp_f32 v171, v171
    v_mfma_f32_16x16x32_bf16 v[140:143], a[252:255], a[220:223], 0
    s_mov_b64 vcc, s[76:77]
    v_mfma_f32_16x16x32_bf16 v[140:143], a[248:251], a[216:219], v[140:143]
    v_exp_f32 v172, v172
    v_mfma_f32_16x16x32_bf16 v[140:143], a[244:247], a[212:215], v[140:143]
    v_fmamk_f32 v173, v173, 0x3e0293ee, v234
    v_mul_f32 v218, v218, v238
    v_mfma_f32_16x16x32_bf16 v[140:143], a[240:243], a[208:211], v[140:143]
    s_waitcnt lgkmcnt(0)
    v_exp_f32 v173, v173
    v_cndmask_b32_dpp v196, v180, v196, vcc quad_perm:[1,0,3,2] row_mask:0xf bank_mask:0xf
    v_accvgpr_read_b32 v221, a25
    v_cndmask_b32_dpp v197, v181, v197, vcc quad_perm:[1,0,3,2] row_mask:0xf bank_mask:0xf
    v_cvt_pk_bf16_f32 v185, v214, v215
    v_mul_f32 v219, v219, v238
    v_fmamk_f32 v174, v174, 0x3e0293ee, v234
    v_cndmask_b32_dpp v198, v182, v198, vcc quad_perm:[1,0,3,2] row_mask:0xf bank_mask:0xf
    v_accvgpr_read_b32 v222, a26
    v_cndmask_b32_dpp v199, v183, v199, vcc quad_perm:[1,0,3,2] row_mask:0xf bank_mask:0xf
    v_cvt_pk_bf16_f32 v43, v170, v171
    v_permlane16_swap_b32 v176, v178
    v_mul_f32 v220, v220, v238
    v_fmamk_f32 v175, v175, 0x3e0293ee, v234
    v_mfma_f32_16x16x32_bf16 a[72:75], a[224:227], v[64:67], a[72:75]
    ds_read_b128 a[240:243], v237 offset:28672
    v_mfma_f32_16x16x32_bf16 a[72:75], a[228:231], v[80:83], a[72:75]
    ds_read_b128 a[244:247], v237 offset:28928
    v_mfma_f32_16x16x32_bf16 a[72:75], a[232:235], v[96:99], a[72:75]
    v_permlane16_swap_b32 v177, v179
    v_mfma_f32_16x16x32_bf16 a[72:75], a[236:239], v[112:115], a[72:75]
    buffer_store_dwordx4 v[176:179], v243, s[24:27], s52 offen offset:0 sc1
    v_exp_f32 v174, v174
    v_exp_f32 v175, v175
    v_accvgpr_read_b32 v223, a27
    v_cvt_pk_bf16_f32 v186, v216, v217
    v_mul_f32 v221, v221, v238
    v_fmamk_f32 v128, v128, 0x3e0293ee, v228
    v_accvgpr_read_b32 v224, a28
    v_cvt_pk_bf16_f32 v46, v172, v173
    v_mul_f32 v222, v222, v238
    v_accvgpr_read_b32 v225, a29
    v_fmamk_f32 v129, v129, 0x3e0293ee, v228
    v_permlane16_swap_b32 v196, v198
    v_cvt_pk_bf16_f32 v187, v218, v219
    v_mfma_f32_16x16x32_bf16 a[88:91], a[236:239], v[116:119], a[88:91]
    ds_read_b128 a[248:251], v237 offset:29184
    v_mfma_f32_16x16x32_bf16 a[88:91], a[232:235], v[100:103], a[88:91]
    ds_read_b128 a[252:255], v237 offset:29440
    v_mfma_f32_16x16x32_bf16 a[88:91], a[228:231], v[84:87], a[88:91]
    v_exp_f32 v128, v128
    v_mfma_f32_16x16x32_bf16 a[88:91], a[224:227], v[68:71], a[88:91]
    v_permlane16_swap_b32 v197, v199
    v_mul_f32 v223, v223, v238
    v_accvgpr_read_b32 v226, a30
    v_fmamk_f32 v130, v130, 0x3e0293ee, v228
    v_mul_f32 v224, v224, v238
    v_cvt_pk_bf16_f32 v47, v174, v175
    v_accvgpr_read_b32 v227, a31
    v_exp_f32 v129, v129
    v_fmamk_f32 v131, v131, 0x3e0293ee, v228
    v_cvt_pk_bf16_f32 v200, v220, v221
    v_mul_f32 v225, v225, v238
    v_accvgpr_read_b32 v212, a32
    v_exp_f32 v130, v130
    v_mfma_f32_16x16x32_bf16 a[104:107], a[224:227], v[72:75], a[104:107]
    s_mov_b64 vcc, s[74:75]
    v_mfma_f32_16x16x32_bf16 a[104:107], a[228:231], v[88:91], a[104:107]
    v_exp_f32 v131, v131
    v_mfma_f32_16x16x32_bf16 a[104:107], a[232:235], v[104:107], a[104:107]
    v_fmamk_f32 v132, v132, 0x3e0293ee, v230
    v_mul_f32 v226, v226, v238
    v_mfma_f32_16x16x32_bf16 a[104:107], a[236:239], v[120:123], a[104:107]
    buffer_store_dwordx4 v[196:199], v243, s[24:27], s52 offen offset:256 sc1
    v_exp_f32 v132, v132
    v_cvt_pk_bf16_f32 v48, v128, v129
    v_accvgpr_read_b32 v213, a33
    v_fmamk_f32 v133, v133, 0x3e0293ee, v230
    v_cvt_pk_bf16_f32 v201, v222, v223
    v_mul_f32 v227, v227, v238
    v_accvgpr_read_b32 v214, a34
    v_mul_f32 v212, v212, v240
    v_fmamk_f32 v134, v134, 0x3e0293ee, v230
    v_mfma_f32_16x16x32_bf16 a[120:123], a[236:239], v[124:127], a[120:123]
    v_exp_f32 v133, v133
    v_mfma_f32_16x16x32_bf16 a[120:123], a[232:235], v[108:111], a[120:123]
    v_exp_f32 v134, v134
    v_mfma_f32_16x16x32_bf16 a[120:123], a[228:231], v[92:95], a[120:123]
    v_mfma_f32_16x16x32_bf16 a[120:123], a[224:227], v[76:79], a[120:123]
    s_waitcnt lgkmcnt(0)
    v_accvgpr_read_b32 v215, a35
    v_cvt_pk_bf16_f32 v49, v130, v131
    v_cvt_pk_bf16_f32 v202, v224, v225
    v_mul_f32 v213, v213, v240
    v_fmamk_f32 v135, v135, 0x3e0293ee, v230
    v_accvgpr_read_b32 v216, a36
    v_mul_f32 v214, v214, v240
    v_fmamk_f32 v136, v136, 0x3e0293ee, v232
    v_accvgpr_read_b32 v217, a37
    v_mfma_f32_16x16x32_bf16 v[144:147], a[240:243], a[160:163], 0
    ds_read_b64_tr_b16 a[224:225], v244 offset:33536
    v_mfma_f32_16x16x32_bf16 v[144:147], a[244:247], a[164:167], v[144:147]
    ds_read_b64_tr_b16 a[226:227], v244 offset:37632
    v_mfma_f32_16x16x32_bf16 v[144:147], a[248:251], a[168:171], v[144:147]
    ds_read_b64_tr_b16 a[228:229], v244 offset:41728
    v_mfma_f32_16x16x32_bf16 v[144:147], a[252:255], a[172:175], v[144:147]
    v_exp_f32 v135, v135
    v_cvt_pk_bf16_f32 v52, v132, v133
    v_cvt_pk_bf16_f32 v203, v226, v227
    v_mul_f32 v215, v215, v240
    v_accvgpr_read_b32 v218, a38
    v_fmamk_f32 v137, v137, 0x3e0293ee, v232
    v_mul_f32 v216, v216, v240
    v_exp_f32 v136, v136
    v_cndmask_b32_dpp v180, v200, v184, vcc quad_perm:[1,0,3,2] row_mask:0xf bank_mask:0xf
    v_accvgpr_read_b32 v219, a39
    v_fmamk_f32 v138, v138, 0x3e0293ee, v232
    v_cndmask_b32_dpp v181, v201, v185, vcc quad_perm:[1,0,3,2] row_mask:0xf bank_mask:0xf
    v_cvt_pk_bf16_f32 v188, v212, v213
    v_mul_f32 v217, v217, v240
    v_cvt_pk_bf16_f32 v53, v134, v135
    v_cndmask_b32_dpp v182, v202, v186, vcc quad_perm:[1,0,3,2] row_mask:0xf bank_mask:0xf
    v_exp_f32 v137, v137
    v_accvgpr_read_b32 v220, a40
    v_mfma_f32_16x16x32_bf16 v[148:151], a[252:255], a[188:191], 0
    ds_read_b64_tr_b16 a[230:231], v244 offset:45824
    v_mfma_f32_16x16x32_bf16 v[148:151], a[248:251], a[184:187], v[148:151]
    ds_read_b64_tr_b16 a[232:233], v244 offset:49920
    v_mfma_f32_16x16x32_bf16 v[148:151], a[244:247], a[180:183], v[148:151]
    ds_read_b64_tr_b16 a[234:235], v244 offset:54016
    v_mfma_f32_16x16x32_bf16 v[148:151], a[240:243], a[176:179], v[148:151]
    v_exp_f32 v138, v138
    v_cndmask_b32_dpp v183, v203, v187, vcc quad_perm:[1,0,3,2] row_mask:0xf bank_mask:0xf
    v_fmamk_f32 v139, v139, 0x3e0293ee, v232
    s_mov_b64 vcc, s[76:77]
    v_mul_f32 v218, v218, v240
    v_cndmask_b32_dpp v200, v184, v200, vcc quad_perm:[1,0,3,2] row_mask:0xf bank_mask:0xf
    v_accvgpr_read_b32 v221, a41
    v_cndmask_b32_dpp v201, v185, v201, vcc quad_perm:[1,0,3,2] row_mask:0xf bank_mask:0xf
    v_fmamk_f32 v140, v140, 0x3e0293ee, v234
    v_cvt_pk_bf16_f32 v189, v214, v215
    v_mul_f32 v219, v219, v240
    v_cndmask_b32_dpp v202, v186, v202, vcc quad_perm:[1,0,3,2] row_mask:0xf bank_mask:0xf
    v_cvt_pk_bf16_f32 v56, v136, v137
    v_accvgpr_read_b32 v222, a42
    v_cndmask_b32_dpp v203, v187, v203, vcc quad_perm:[1,0,3,2] row_mask:0xf bank_mask:0xf
    v_exp_f32 v139, v139
    v_fmamk_f32 v141, v141, 0x3e0293ee, v234
    v_permlane16_swap_b32 v180, v182
    v_mul_f32 v220, v220, v240
    v_mfma_f32_16x16x32_bf16 v[152:155], a[240:243], a[192:195], 0
    ds_read_b64_tr_b16 a[236:237], v244 offset:58112
    v_mfma_f32_16x16x32_bf16 v[152:155], a[244:247], a[196:199], v[152:155]
    ds_read_b64_tr_b16 a[238:239], v244 offset:62208
    v_mfma_f32_16x16x32_bf16 v[152:155], a[248:251], a[200:203], v[152:155]
    v_permlane16_swap_b32 v181, v183
    v_mfma_f32_16x16x32_bf16 v[152:155], a[252:255], a[204:207], v[152:155]
    buffer_store_dwordx4 v[180:183], v243, s[24:27], s53 offen offset:0 sc1
    v_exp_f32 v140, v140
    v_exp_f32 v141, v141
    v_accvgpr_read_b32 v223, a43
    v_cvt_pk_bf16_f32 v190, v216, v217
    v_fmamk_f32 v142, v142, 0x3e0293ee, v234
    v_mul_f32 v221, v221, v240
    v_accvgpr_read_b32 v224, a44
    v_cvt_pk_bf16_f32 v57, v138, v139
    v_mul_f32 v222, v222, v240
    v_fmamk_f32 v143, v143, 0x3e0293ee, v234
    v_accvgpr_read_b32 v225, a45
    v_permlane16_swap_b32 v200, v202
    v_mfma_f32_16x16x32_bf16 v[156:159], a[252:255], a[220:223], 0
    v_exp_f32 v142, v142
    v_mfma_f32_16x16x32_bf16 v[156:159], a[248:251], a[216:219], v[156:159]
    v_permlane16_swap_b32 v201, v203
    v_mfma_f32_16x16x32_bf16 v[156:159], a[244:247], a[212:215], v[156:159]
    v_exp_f32 v143, v143
    v_mfma_f32_16x16x32_bf16 v[156:159], a[240:243], a[208:211], v[156:159]
    s_waitcnt lgkmcnt(0)
    buffer_store_dwordx4 v[200:203], v243, s[24:27], s53 offen offset:256 sc1
    v_cvt_pk_bf16_f32 v191, v218, v219
    v_mul_f32 v223, v223, v240
    v_fmamk_f32 v144, v144, 0x3e0293ee, v228
    v_accvgpr_read_b32 v226, a46
    v_cvt_pk_bf16_f32 v60, v140, v141
    v_mul_f32 v224, v224, v240
    v_fmamk_f32 v145, v145, 0x3e0293ee, v228
    v_accvgpr_read_b32 v227, a47
    v_cvt_pk_bf16_f32 v204, v220, v221
    v_mul_f32 v225, v225, v240
    v_exp_f32 v144, v144
    v_mfma_f32_16x16x32_bf16 a[68:71], a[224:227], v[64:67], a[68:71]
    ds_read_b64_tr_b16 a[240:241], v245 offset:33536
    v_mfma_f32_16x16x32_bf16 a[68:71], a[228:231], v[80:83], a[68:71]
    ds_read_b64_tr_b16 a[242:243], v245 offset:37632
    v_mfma_f32_16x16x32_bf16 a[68:71], a[232:235], v[96:99], a[68:71]
    ds_read_b64_tr_b16 a[244:245], v245 offset:41728
    v_mfma_f32_16x16x32_bf16 a[68:71], a[236:239], v[112:115], a[68:71]
    s_mov_b64 vcc, s[74:75]
    v_exp_f32 v145, v145
    v_accvgpr_read_b32 v212, a48
    v_fmamk_f32 v146, v146, 0x3e0293ee, v228
    v_mul_f32 v226, v226, v240
    v_cvt_pk_bf16_f32 v61, v142, v143
    v_accvgpr_read_b32 v213, a49
    v_fmamk_f32 v147, v147, 0x3e0293ee, v228
    v_cvt_pk_bf16_f32 v205, v222, v223
    v_mul_f32 v227, v227, v240
    v_accvgpr_read_b32 v214, a50
    v_exp_f32 v146, v146
    v_fmamk_f32 v148, v148, 0x3e0293ee, v230
    v_mfma_f32_16x16x32_bf16 a[84:87], a[236:239], v[116:119], a[84:87]
    ds_read_b64_tr_b16 a[246:247], v245 offset:45824
    v_mfma_f32_16x16x32_bf16 a[84:87], a[232:235], v[100:103], a[84:87]
    ds_read_b64_tr_b16 a[248:249], v245 offset:49920
    v_mfma_f32_16x16x32_bf16 a[84:87], a[228:231], v[84:87], a[84:87]
    ds_read_b64_tr_b16 a[250:251], v245 offset:54016
    v_mfma_f32_16x16x32_bf16 a[84:87], a[224:227], v[68:71], a[84:87]
    v_exp_f32 v147, v147
    v_mul_f32 v212, v212, v242
    v_cvt_pk_bf16_f32 v50, v144, v145
    v_accvgpr_read_b32 v215, a51
    v_fmamk_f32 v149, v149, 0x3e0293ee, v230
    v_cvt_pk_bf16_f32 v206, v224, v225
    v_mul_f32 v213, v213, v242
    v_accvgpr_read_b32 v216, a52
    v_exp_f32 v148, v148
    v_fmamk_f32 v150, v150, 0x3e0293ee, v230
    v_mul_f32 v214, v214, v242
    v_accvgpr_read_b32 v217, a53
    v_cvt_pk_bf16_f32 v51, v146, v147
    v_mfma_f32_16x16x32_bf16 a[100:103], a[224:227], v[72:75], a[100:103]
    ds_read_b64_tr_b16 a[252:253], v245 offset:58112
    v_mfma_f32_16x16x32_bf16 a[100:103], a[228:231], v[88:91], a[100:103]
    ds_read_b64_tr_b16 a[254:255], v245 offset:62208
    v_mfma_f32_16x16x32_bf16 a[100:103], a[232:235], v[104:107], a[100:103]
    v_exp_f32 v149, v149
    v_mfma_f32_16x16x32_bf16 a[100:103], a[236:239], v[120:123], a[100:103]
    v_exp_f32 v150, v150
    v_cvt_pk_bf16_f32 v207, v226, v227
    v_mul_f32 v215, v215, v242
    v_fmamk_f32 v151, v151, 0x3e0293ee, v230
    v_accvgpr_read_b32 v218, a54
    v_mul_f32 v216, v216, v242
    v_fmamk_f32 v152, v152, 0x3e0293ee, v232
    v_cndmask_b32_dpp v184, v204, v188, vcc quad_perm:[1,0,3,2] row_mask:0xf bank_mask:0xf
    v_accvgpr_read_b32 v219, a55
    v_cndmask_b32_dpp v185, v205, v189, vcc quad_perm:[1,0,3,2] row_mask:0xf bank_mask:0xf
    v_cvt_pk_bf16_f32 v54, v148, v149
    v_cvt_pk_bf16_f32 v192, v212, v213
    v_mul_f32 v217, v217, v242
    v_exp_f32 v151, v151
    v_cndmask_b32_dpp v186, v206, v190, vcc quad_perm:[1,0,3,2] row_mask:0xf bank_mask:0xf
    v_mfma_f32_16x16x32_bf16 a[116:119], a[236:239], v[124:127], a[116:119]
    v_mfma_f32_16x16x32_bf16 a[116:119], a[232:235], v[108:111], a[116:119]
    v_exp_f32 v152, v152
    v_mfma_f32_16x16x32_bf16 a[116:119], a[228:231], v[92:95], a[116:119]
    v_fmamk_f32 v153, v153, 0x3e0293ee, v232
    v_accvgpr_read_b32 v220, a56
    v_mfma_f32_16x16x32_bf16 a[116:119], a[224:227], v[76:79], a[116:119]
    s_waitcnt lgkmcnt(0)
    v_exp_f32 v153, v153
    v_cndmask_b32_dpp v187, v207, v191, vcc quad_perm:[1,0,3,2] row_mask:0xf bank_mask:0xf
    s_mov_b64 vcc, s[76:77]
    v_mul_f32 v218, v218, v242
    v_cndmask_b32_dpp v204, v188, v204, vcc quad_perm:[1,0,3,2] row_mask:0xf bank_mask:0xf
    v_accvgpr_read_b32 v221, a57
    v_fmamk_f32 v154, v154, 0x3e0293ee, v232
    v_cndmask_b32_dpp v205, v189, v205, vcc quad_perm:[1,0,3,2] row_mask:0xf bank_mask:0xf
    v_cvt_pk_bf16_f32 v193, v214, v215
    v_cvt_pk_bf16_f32 v55, v150, v151
    v_mul_f32 v219, v219, v242
    v_cndmask_b32_dpp v206, v190, v206, vcc quad_perm:[1,0,3,2] row_mask:0xf bank_mask:0xf
    v_accvgpr_read_b32 v222, a58
    v_cndmask_b32_dpp v207, v191, v207, vcc quad_perm:[1,0,3,2] row_mask:0xf bank_mask:0xf
    v_fmamk_f32 v155, v155, 0x3e0293ee, v232
    v_mfma_f32_16x16x32_bf16 a[76:79], a[240:243], v[64:67], a[76:79]
    v_permlane16_swap_b32 v184, v186
    v_mfma_f32_16x16x32_bf16 a[76:79], a[244:247], v[80:83], a[76:79]
    v_exp_f32 v154, v154
    v_mfma_f32_16x16x32_bf16 a[76:79], a[248:251], v[96:99], a[76:79]
    v_mfma_f32_16x16x32_bf16 a[76:79], a[252:255], v[112:115], a[76:79]
    v_permlane16_swap_b32 v185, v187
    v_mul_f32 v220, v220, v242
    v_accvgpr_read_b32 v223, a59
    v_fmamk_f32 v156, v156, 0x3e0293ee, v234
    v_cvt_pk_bf16_f32 v194, v216, v217
    v_mul_f32 v221, v221, v242
    v_cvt_pk_bf16_f32 v58, v152, v153
    v_accvgpr_read_b32 v224, a60
    v_exp_f32 v155, v155
    v_fmamk_f32 v157, v157, 0x3e0293ee, v234
    v_mul_f32 v222, v222, v242
    v_accvgpr_read_b32 v225, a61
    v_mfma_f32_16x16x32_bf16 a[92:95], a[252:255], v[116:119], a[92:95]
    v_exp_f32 v156, v156
    v_mfma_f32_16x16x32_bf16 a[92:95], a[248:251], v[100:103], a[92:95]
    v_permlane16_swap_b32 v204, v206
    v_mfma_f32_16x16x32_bf16 a[92:95], a[244:247], v[84:87], a[92:95]
    v_permlane16_swap_b32 v205, v207
    v_mfma_f32_16x16x32_bf16 a[92:95], a[240:243], v[68:71], a[92:95]
    buffer_store_dwordx4 v[184:187], v243, s[24:27], s54 offen offset:0 sc1
    v_exp_f32 v157, v157
    v_fmamk_f32 v158, v158, 0x3e0293ee, v234
    v_cvt_pk_bf16_f32 v195, v218, v219
    v_mul_f32 v223, v223, v242
    v_accvgpr_read_b32 v226, a62
    v_cvt_pk_bf16_f32 v59, v154, v155
    v_fmamk_f32 v159, v159, 0x3e0293ee, v234
    v_mul_f32 v224, v224, v242
    v_accvgpr_read_b32 v227, a63
    v_exp_f32 v158, v158
    v_cvt_pk_bf16_f32 v208, v220, v221
    v_mul_f32 v225, v225, v242
    v_mfma_f32_16x16x32_bf16 a[108:111], a[240:243], v[72:75], a[108:111]
    s_mov_b64 vcc, s[74:75]
    v_exp_f32 v159, v159
    v_mfma_f32_16x16x32_bf16 a[108:111], a[244:247], v[88:91], a[108:111]
    v_mfma_f32_16x16x32_bf16 a[108:111], a[248:251], v[104:107], a[108:111]
    v_cvt_pk_bf16_f32 v62, v156, v157
    v_mul_f32 v226, v226, v242
    v_mfma_f32_16x16x32_bf16 a[108:111], a[252:255], v[120:123], a[108:111]
    buffer_store_dwordx4 v[204:207], v243, s[24:27], s54 offen offset:256 sc1
    v_cvt_pk_bf16_f32 v209, v222, v223
    v_mul_f32 v227, v227, v242
    v_cvt_pk_bf16_f32 v63, v158, v159
    v_cvt_pk_bf16_f32 v210, v224, v225
    v_mfma_f32_16x16x32_bf16 a[124:127], a[252:255], v[124:127], a[124:127]
    v_cvt_pk_bf16_f32 v211, v226, v227
    v_mfma_f32_16x16x32_bf16 a[124:127], a[248:251], v[108:111], a[124:127]
    v_mfma_f32_16x16x32_bf16 a[124:127], a[244:247], v[92:95], a[124:127]
    v_cndmask_b32_dpp v188, v208, v192, vcc quad_perm:[1,0,3,2] row_mask:0xf bank_mask:0xf
    v_cndmask_b32_dpp v189, v209, v193, vcc quad_perm:[1,0,3,2] row_mask:0xf bank_mask:0xf
    v_mfma_f32_16x16x32_bf16 a[124:127], a[240:243], v[76:79], a[124:127]
    v_cndmask_b32_dpp v190, v210, v194, vcc quad_perm:[1,0,3,2] row_mask:0xf bank_mask:0xf
    v_cndmask_b32_dpp v191, v211, v195, vcc quad_perm:[1,0,3,2] row_mask:0xf bank_mask:0xf
    s_barrier
    v_mfma_f32_16x16x32_bf16 v[160:163], v[248:251], v[0:3], 0
    ds_read_b128 a[224:227], v237 offset:32768
    v_mfma_f32_16x16x32_bf16 v[160:163], v[248:251], v[16:19], v[160:163]
    ds_read_b128 a[228:231], v237 offset:33024
    v_mfma_f32_16x16x32_bf16 v[160:163], v[248:251], v[32:35], v[160:163]
    s_mov_b64 vcc, s[76:77]
    v_cndmask_b32_dpp v208, v192, v208, vcc quad_perm:[1,0,3,2] row_mask:0xf bank_mask:0xf
    v_cndmask_b32_dpp v209, v193, v209, vcc quad_perm:[1,0,3,2] row_mask:0xf bank_mask:0xf
    v_mfma_f32_16x16x32_bf16 v[160:163], v[248:251], v[48:51], v[160:163]
    v_cndmask_b32_dpp v210, v194, v210, vcc quad_perm:[1,0,3,2] row_mask:0xf bank_mask:0xf
    v_cndmask_b32_dpp v211, v195, v211, vcc quad_perm:[1,0,3,2] row_mask:0xf bank_mask:0xf
    v_mfma_f32_16x16x32_bf16 v[164:167], v[248:251], v[4:7], 0
    ds_read_b128 a[232:235], v237 offset:33280
    v_mfma_f32_16x16x32_bf16 v[164:167], v[248:251], v[20:23], v[164:167]
    ds_read_b128 a[236:239], v237 offset:33536
    v_mfma_f32_16x16x32_bf16 v[164:167], v[248:251], v[36:39], v[164:167]
    v_mfma_f32_16x16x32_bf16 v[164:167], v[248:251], v[52:55], v[164:167]
    v_permlane16_swap_b32 v188, v190
    v_permlane16_swap_b32 v189, v191
    v_permlane16_swap_b32 v208, v210
    v_permlane16_swap_b32 v209, v211
    v_mfma_f32_16x16x32_bf16 v[168:171], v[248:251], v[8:11], 0
    v_mfma_f32_16x16x32_bf16 v[168:171], v[248:251], v[24:27], v[168:171]
    v_mfma_f32_16x16x32_bf16 v[168:171], v[248:251], v[40:43], v[168:171]
    v_mfma_f32_16x16x32_bf16 v[168:171], v[248:251], v[56:59], v[168:171]
    buffer_store_dwordx4 v[188:191], v243, s[24:27], s55 offen offset:0 sc1
    v_mfma_f32_16x16x32_bf16 v[172:175], v[248:251], v[12:15], 0
    v_mfma_f32_16x16x32_bf16 v[172:175], v[248:251], v[28:31], v[172:175]
    v_mfma_f32_16x16x32_bf16 v[172:175], v[248:251], v[44:47], v[172:175]
    v_mfma_f32_16x16x32_bf16 v[172:175], v[248:251], v[60:63], v[172:175]
    s_waitcnt lgkmcnt(0)
    buffer_store_dwordx4 v[208:211], v243, s[24:27], s55 offen offset:256 sc1
L_ph3s:
    s_cmp_lt_u32 s34, 2
    s_cbranch_scc0 L_nt59
    s_getpc_b64 s[72:73]
L_pc59:
    s_add_u32 s72, s72, L_ph4s-L_pc59
    s_addc_u32 s73, s73, (L_ph4s-L_pc59)>>32
    v_mbcnt_lo_u32_b32 v222, -1, 0
    v_mbcnt_hi_u32_b32 v222, -1, v222
    v_lshrrev_b32 v222, 2, v222
    v_lshl_add_u32 v222, s32, 4, v222
    v_lshlrev_b32 v222, 7, v222
    v_min_u32 v222, L_ph5s-L_ph4s, v222
    v_mov_b32 v223, s73
    v_add_co_u32 v222, vcc, s72, v222
    s_nop 1
    v_addc_co_u32 v223, vcc, 0, v223, vcc
    global_load_dword v254, v[222:223], off
L_nt59:
    s_cmp_eq_u32 s34, s61
    s_cbranch_scc0 L_nt60
    s_getpc_b64 s[72:73]
L_pc60:
    s_add_u32 s72, s72, L_ph4f-L_pc60
    s_addc_u32 s73, s73, (L_ph4f-L_pc60)>>32
    v_mbcnt_lo_u32_b32 v222, -1, 0
    v_mbcnt_hi_u32_b32 v222, -1, v222
    v_lshrrev_b32 v222, 2, v222
    v_lshl_add_u32 v222, s32, 4, v222
    v_lshlrev_b32 v222, 7, v222
    v_min_u32 v222, L_ph5f-L_ph4f, v222
    v_mov_b32 v223, s73
    v_add_co_u32 v222, vcc, s72, v222
    s_nop 1
    v_addc_co_u32 v223, vcc, 0, v223, vcc
    global_load_dword v254, v[222:223], off
L_nt60:
    v_mfma_f32_16x16x32_bf16 v[128:131], a[224:227], a[160:163], 0
    ds_read_b128 a[240:243], v237 offset:36864
    v_mfma_f32_16x16x32_bf16 v[128:131], a[228:231], a[164:167], v[128:131]
    ds_read_b128 a[244:247], v237 offset:37120
    s_xor_b32 s86, s85, 0
    v_mfma_f32_16x16x32_bf16 v[128:131], a[232:235], a[168:171], v[128:131]
    s_xor_b32 m0, s35, 0
    v_mfma_f32_16x16x32_bf16 v[128:131], a[236:239], a[172:175], v[128:131]
    buffer_load_dwordx4 v241, s[16:19], s86 offen nt lds
    v_max3_f32 v220, v160, v164, v168
    v_mfma_f32_16x16x32_bf16 v[132:135], a[236:239], a[188:191], 0
    ds_read_b128 a[248:251], v237 offset:37376
    v_mfma_f32_16x16x32_bf16 v[132:135], a[232:235], a[184:187], v[132:135]
    ds_read_b128 a[252:255], v237 offset:37632
    v_mfma_f32_16x16x32_bf16 v[132:135], a[228:231], a[180:183], v[132:135]
    v_max_f32 v220, v220, v172
    v_cmp_lt_f32 vcc, 0x5f800000, v220
    v_mfma_f32_16x16x32_bf16 v[132:135], a[224:227], a[176:179], v[132:135]
    s_cbranch_vccnz L_chk61_redo
L_chk61:
    v_fmamk_f32 v128, v128, 0x3e0293ee, v228
    v_mov_b32 v229, v160
    v_mfma_f32_16x16x32_bf16 v[136:139], a[224:227], a[192:195], 0
    v_exp_f32 v128, v128
    v_mfma_f32_16x16x32_bf16 v[136:139], a[228:231], a[196:199], v[136:139]
    s_xor_b32 s86, s85, 1024
    v_mov_b32 v231, v164
    v_fmamk_f32 v129, v129, 0x3e0293ee, v228
    v_mfma_f32_16x16x32_bf16 v[136:139], a[232:235], a[200:203], v[136:139]
    s_xor_b32 m0, s35, 1024
    v_exp_f32 v129, v129
    v_mfma_f32_16x16x32_bf16 v[136:139], a[236:239], a[204:207], v[136:139]
    buffer_load_dwordx4 v255, s[16:19], s86 offen nt lds
    v_mov_b32 v233, v168
    v_fmamk_f32 v130, v130, 0x3e0293ee, v228
    v_mov_b32 v235, v172
    v_mfma_f32_16x16x32_bf16 v[140:143], a[236:239], a[220:223], 0
    v_mfma_f32_16x16x32_bf16 v[140:143], a[232:235], a[216:219], v[140:143]
    v_exp_f32 v130, v130
    v_mfma_f32_16x16x32_bf16 v[140:143], a[228:231], a[212:215], v[140:143]
    v_accvgpr_read_b32 v212, a64
    v_fmamk_f32 v131, v131, 0x3e0293ee, v228
    v_mfma_f32_16x16x32_bf16 v[140:143], a[224:227], a[208:211], v[140:143]
    s_waitcnt lgkmcnt(0)
    v_exp_f32 v131, v131
    v_accvgpr_read_b32 v213, a65
    v_fmamk_f32 v132, v132, 0x3e0293ee, v230
    v_cvt_pk_bf16_f32 v64, v128, v129
    v_mfma_f32_16x16x32_bf16 v[144:147], a[240:243], a[160:163], 0
    ds_read_b64_tr_b16 a[224:225], v244 offset:0
    v_mfma_f32_16x16x32_bf16 v[144:147], a[244:247], a[164:167], v[144:147]
    ds_read_b64_tr_b16 a[226:227], v244 offset:4096
    v_mfma_f32_16x16x32_bf16 v[144:147], a[248:251], a[168:171], v[144:147]
    ds_read_b64_tr_b16 a[228:229], v244 offset:8192
    v_mfma_f32_16x16x32_bf16 v[144:147], a[252:255], a[172:175], v[144:147]
    v_exp_f32 v132, v132
    v_mul_f32 v212, v212, v236
    v_accvgpr_read_b32 v214, a66
    v_fmamk_f32 v133, v133, 0x3e0293ee, v230
    v_mul_f32 v213, v213, v236
    v_fmamk_f32 v134, v134, 0x3e0293ee, v230
    v_accvgpr_read_b32 v215, a67
    v_cvt_pk_bf16_f32 v65, v130, v131
    v_mfma_f32_16x16x32_bf16 v[148:151], a[252:255], a[188:191], 0
    ds_read_b64_tr_b16 a[230:231], v244 offset:12288
    v_mfma_f32_16x16x32_bf16 v[148:151], a[248:251], a[184:187], v[148:151]
    ds_read_b64_tr_b16 a[232:233], v244 offset:16384
    s_xor_b32 s86, s85, 8192
    v_mfma_f32_16x16x32_bf16 v[148:151], a[244:247], a[180:183], v[148:151]
    ds_read_b64_tr_b16 a[234:235], v244 offset:20480
    s_xor_b32 m0, s35, 4096
    v_mfma_f32_16x16x32_bf16 v[148:151], a[240:243], a[176:179], v[148:151]
    buffer_load_dwordx4 v241, s[16:19], s86 offen nt lds
    v_fmamk_f32 v135, v135, 0x3e0293ee, v230
    v_exp_f32 v133, v133
    v_mul_f32 v214, v214, v236
    v_accvgpr_read_b32 v216, a68
    v_exp_f32 v134, v134
    v_fmamk_f32 v136, v136, 0x3e0293ee, v232
    v_cvt_pk_bf16_f32 v68, v132, v133
    v_mul_f32 v215, v215, v236
    v_accvgpr_read_b32 v217, a69
    v_mfma_f32_16x16x32_bf16 v[152:155], a[240:243], a[192:195], 0
    ds_read_b64_tr_b16 a[236:237], v244 offset:24576
    v_mfma_f32_16x16x32_bf16 v[152:155], a[244:247], a[196:199], v[152:155]
    ds_read_b64_tr_b16 a[238:239], v244 offset:28672
    v_mfma_f32_16x16x32_bf16 v[152:155], a[248:251], a[200:203], v[152:155]
    v_exp_f32 v135, v135
    v_mfma_f32_16x16x32_bf16 v[152:155], a[252:255], a[204:207], v[152:155]
    v_exp_f32 v136, v136
    v_fmamk_f32 v137, v137, 0x3e0293ee, v232
    v_cvt_pk_bf16_f32 v180, v212, v213
    v_mul_f32 v216, v216, v236
    v_accvgpr_read_b32 v218, a70
    v_fmamk_f32 v138, v138, 0x3e0293ee, v232
    v_cvt_pk_bf16_f32 v69, v134, v135
    v_mul_f32 v217, v217, v236
    v_exp_f32 v137, v137
    v_mfma_f32_16x16x32_bf16 v[156:159], a[252:255], a[220:223], 0
    v_exp_f32 v138, v138
    v_mfma_f32_16x16x32_bf16 v[156:159], a[248:251], a[216:219], v[156:159]
    v_mfma_f32_16x16x32_bf16 v[156:159], a[244:247], a[212:215], v[156:159]
    v_accvgpr_read_b32 v219, a71
    v_fmamk_f32 v139, v139, 0x3e0293ee, v232
    v_mfma_f32_16x16x32_bf16 v[156:159], a[240:243], a[208:211], v[156:159]
    s_waitcnt lgkmcnt(0)
    v_exp_f32 v139, v139
    v_cvt_pk_bf16_f32 v181, v214, v215
    v_mul_f32 v218, v218, v236
    v_accvgpr_read_b32 v220, a72
    v_fmamk_f32 v140, v140, 0x3e0293ee, v234
    v_cvt_pk_bf16_f32 v72, v136, v137
    v_mfma_f32_16x16x32_bf16 a[0:3], a[224:227], v[0:3], 0
    ds_read_b128 a[240:243], v237 offset:40960
    v_mfma_f32_16x16x32_bf16 a[0:3], a[228:231], v[16:19], a[0:3]
    ds_read_b128 a[244:247], v237 offset:41216
    s_waitcnt vmcnt(11)
    s_xor_b32 s86, s85, 9216
    v_mfma_f32_16x16x32_bf16 a[0:3], a[232:235], v[32:35], a[0:3]
    ds_read_b128 a[128:131], v239 offset:0
    s_xor_b32 m0, s35, 5120
    v_mfma_f32_16x16x32_bf16 a[0:3], a[236:239], v[48:51], a[0:3]
    buffer_load_dwordx4 v255, s[16:19], s86 offen nt lds
    v_mul_f32 v219, v219, v236
    v_fmamk_f32 v141, v141, 0x3e0293ee, v234
    v_accvgpr_read_b32 v221, a73
    v_exp_f32 v140, v140
    v_cvt_pk_bf16_f32 v182, v216, v217
    v_fmamk_f32 v142, v142, 0x3e0293ee, v234
    v_mul_f32 v220, v220, v236
    v_accvgpr_read_b32 v222, a74
    v_cvt_pk_bf16_f32 v73, v138, v139
    v_exp_f32 v141, v141
    v_mfma_f32_16x16x32_bf16 a[16:19], a[236:239], v[52:55], 0
    ds_read_b128 a[248:251], v237 offset:41472
    v_mfma_f32_16x16x32_bf16 a[16:19], a[232:235], v[36:39], a[16:19]
    ds_read_b128 a[252:255], v237 offset:41728
    v_mfma_f32_16x16x32_bf16 a[16:19], a[228:231], v[20:23], a[16:19]
    ds_read_b128 a[132:135], v239 offset:256
    v_mfma_f32_16x16x32_bf16 a[16:19], a[224:227], v[4:7], a[16:19]
    v_exp_f32 v142, v142
    v_fmamk_f32 v143, v143, 0x3e0293ee, v234
    v_mul_f32 v221, v221, v236
    v_accvgpr_read_b32 v223, a75
    v_fmamk_f32 v144, v144, 0x3e0293ee, v228
    v_cvt_pk_bf16_f32 v183, v218, v219
    v_cvt_pk_bf16_f32 v76, v140, v141
    v_mul_f32 v222, v222, v236
    v_accvgpr_read_b32 v224, a76
    v_exp_f32 v143, v143
    v_fmamk_f32 v145, v145, 0x3e0293ee, v228
    v_mfma_f32_16x16x32_bf16 a[32:35], a[224:227], v[8:11], 0
    ds_read_b128 a[136:139], v239 offset:512
    v_mfma_f32_16x16x32_bf16 a[32:35], a[228:231], v[24:27], a[32:35]
    ds_read_b128 a[140:143], v239 offset:768
    v_mfma_f32_16x16x32_bf16 a[32:35], a[232:235], v[40:43], a[32:35]
    ds_read_b128 a[144:147], v239 offset:4096
    v_mfma_f32_16x16x32_bf16 a[32:35], a[236:239], v[56:59], a[32:35]
    v_exp_f32 v144, v144
    v_mul_f32 v223, v223, v236
    v_accvgpr_read_b32 v225, a77
    v_fmamk_f32 v146, v146, 0x3e0293ee, v228
    v_cvt_pk_bf16_f32 v77, v142, v143
    v_cvt_pk_bf16_f32 v196, v220, v221
    v_exp_f32 v145, v145
    v_mul_f32 v224, v224, v236
    v_accvgpr_read_b32 v226, a78
    v_fmamk_f32 v147, v147, 0x3e0293ee, v228
    v_mfma_f32_16x16x32_bf16 a[48:51], a[236:239], v[60:63], 0
    ds_read_b128 a[148:151], v239 offset:4352
    v_mfma_f32_16x16x32_bf16 a[48:51], a[232:235], v[44:47], a[48:51]
    ds_read_b128 a[152:155], v239 offset:4608
    s_xor_b32 s86, s85, 16384
    v_mfma_f32_16x16x32_bf16 a[48:51], a[228:231], v[28:31], a[48:51]
    ds_read_b128 a[156:159], v239 offset:4864
    s_xor_b32 m0, s35, 8192
    v_mfma_f32_16x16x32_bf16 a[48:51], a[224:227], v[12:15], a[48:51]
    s_waitcnt lgkmcnt(7)
    buffer_load_dwordx4 v241, s[16:19], s86 offen nt lds
    v_exp_f32 v146, v146
    v_mul_f32 v225, v225, v236
    v_accvgpr_read_b32 v227, a79
    v_fmamk_f32 v148, v148, 0x3e0293ee, v230
    v_cvt_pk_bf16_f32 v66, v144, v145
    v_exp_f32 v147, v147
    v_cvt_pk_bf16_f32 v197, v222, v223
    v_mul_f32 v226, v226, v236
    v_fmamk_f32 v149, v149, 0x3e0293ee, v230
    v_accvgpr_read_b32 v212, a80
    v_mfma_f32_16x16x32_bf16 v[160:163], a[240:243], a[160:163], 0
    ds_read_b64_tr_b16 a[224:225], v245 offset:0
    v_mfma_f32_16x16x32_bf16 v[160:163], a[244:247], a[164:167], v[160:163]
    ds_read_b64_tr_b16 a[226:227], v245 offset:4096
    v_mfma_f32_16x16x32_bf16 v[160:163], a[248:251], a[168:171], v[160:163]
    ds_read_b64_tr_b16 a[228:229], v245 offset:8192
    v_mfma_f32_16x16x32_bf16 v[160:163], a[252:255], a[172:175], v[160:163]
    v_exp_f32 v148, v148
    v_fmamk_f32 v150, v150, 0x3e0293ee, v230
    v_mul_f32 v227, v227, v236
    v_cvt_pk_bf16_f32 v67, v146, v147
    v_accvgpr_read_b32 v213, a81
    v_exp_f32 v149, v149
    v_cvt_pk_bf16_f32 v198, v224, v225
    v_fmamk_f32 v151, v151, 0x3e0293ee, v230
    v_mul_f32 v212, v212, v238
    v_accvgpr_read_b32 v214, a82
    v_mfma_f32_16x16x32_bf16 v[164:167], a[252:255], a[188:191], 0
    ds_read_b64_tr_b16 a[230:231], v245 offset:12288
    v_mfma_f32_16x16x32_bf16 v[164:167], a[248:251], a[184:187], v[164:167]
    ds_read_b64_tr_b16 a[232:233], v245 offset:16384
    v_mfma_f32_16x16x32_bf16 v[164:167], a[244:247], a[180:183], v[164:167]
    ds_read_b64_tr_b16 a[234:235], v245 offset:20480
    v_mfma_f32_16x16x32_bf16 v[164:167], a[240:243], a[176:179], v[164:167]
    v_exp_f32 v150, v150
    v_fmamk_f32 v152, v152, 0x3e0293ee, v232
    v_cvt_pk_bf16_f32 v70, v148, v149
    v_mul_f32 v213, v213, v238
    v_accvgpr_read_b32 v215, a83
    v_exp_f32 v151, v151
    v_fmamk_f32 v153, v153, 0x3e0293ee, v232
    v_cvt_pk_bf16_f32 v199, v226, v227
    v_mul_f32 v214, v214, v238
    v_exp_f32 v152, v152
    v_mfma_f32_16x16x32_bf16 v[168:171], a[240:243], a[192:195], 0
    ds_read_b64_tr_b16 a[236:237], v245 offset:24576
    v_mfma_f32_16x16x32_bf16 v[168:171], a[244:247], a[196:199], v[168:171]
    ds_read_b64_tr_b16 a[238:239], v245 offset:28672
    s_xor_b32 s86, s85, 17408
    v_mfma_f32_16x16x32_bf16 v[168:171], a[248:251], a[200:203], v[168:171]
    s_xor_b32 m0, s35, 9216
    v_exp_f32 v153, v153
    v_mfma_f32_16x16x32_bf16 v[168:171], a[252:255], a[204:207], v[168:171]
    buffer_load_dwordx4 v255, s[16:19], s86 offen nt lds
    v_accvgpr_read_b32 v216, a84
    v_fmamk_f32 v154, v154, 0x3e0293ee, v232
    v_cvt_pk_bf16_f32 v71, v150, v151
    v_mul_f32 v215, v215, v238
    v_accvgpr_read_b32 v217, a85
    v_fmamk_f32 v155, v155, 0x3e0293ee, v232
    v_cvt_pk_bf16_f32 v184, v212, v213
    v_exp_f32 v154, v154
    v_mfma_f32_16x16x32_bf16 v[172:175], a[252:255], a[220:223], 0
    v_exp_f32 v155, v155
    v_mfma_f32_16x16x32_bf16 v[172:175], a[248:251], a[216:219], v[172:175]
    v_mul_f32 v216, v216, v238
    v_accvgpr_read_b32 v218, a86
    v_mfma_f32_16x16x32_bf16 v[172:175], a[244:247], a[212:215], v[172:175]
    v_mfma_f32_16x16x32_bf16 v[172:175], a[240:243], a[208:211], v[172:175]
    s_waitcnt lgkmcnt(0)
    v_fmamk_f32 v156, v156, 0x3e0293ee, v234
    v_cvt_pk_bf16_f32 v74, v152, v153
    v_mul_f32 v217, v217, v238
    v_fmamk_f32 v157, v157, 0x3e0293ee, v234
    v_accvgpr_read_b32 v219, a87
    v_exp_f32 v156, v156
    v_cvt_pk_bf16_f32 v185, v214, v215
    v_mfma_f32_16x16x32_bf16 a[8:11], a[224:227], v[0:3], 0
    ds_read_b128 a[240:243], v237 offset:45056
    v_mfma_f32_16x16x32_bf16 a[8:11], a[228:231], v[16:19], a[8:11]
    ds_read_b128 a[244:247], v237 offset:45312
    s_xor_b32 s86, s85, 24576
    v_mfma_f32_16x16x32_bf16 a[8:11], a[232:235], v[32:35], a[8:11]
    s_xor_b32 m0, s35, 12288
    v_exp_f32 v157, v157
    v_mfma_f32_16x16x32_bf16 a[8:11], a[236:239], v[48:51], a[8:11]
    buffer_load_dwordx4 v241, s[16:19], s86 offen nt lds
    v_fmamk_f32 v158, v158, 0x3e0293ee, v234
    v_mul_f32 v218, v218, v238
    v_cvt_pk_bf16_f32 v75, v154, v155
    v_accvgpr_read_b32 v220, a88
    v_fmamk_f32 v159, v159, 0x3e0293ee, v234
    v_mul_f32 v219, v219, v238
    v_accvgpr_read_b32 v221, a89
    v_exp_f32 v158, v158
    v_fmamk_f32 v160, v160, 0x3e0293ee, v228
    v_mfma_f32_16x16x32_bf16 a[24:27], a[236:239], v[52:55], 0
    ds_read_b128 a[248:251], v237 offset:45568
    v_mfma_f32_16x16x32_bf16 a[24:27], a[232:235], v[36:39], a[24:27]
    ds_read_b128 a[252:255], v237 offset:45824
    v_mfma_f32_16x16x32_bf16 a[24:27], a[228:231], v[20:23], a[24:27]
    v_exp_f32 v159, v159
    v_mfma_f32_16x16x32_bf16 a[24:27], a[224:227], v[4:7], a[24:27]
    v_exp_f32 v160, v160
    v_cvt_pk_bf16_f32 v186, v216, v217
    v_cvt_pk_bf16_f32 v78, v156, v157
    v_mul_f32 v220, v220, v238
    v_accvgpr_read_b32 v222, a90
    v_fmamk_f32 v161, v161, 0x3e0293ee, v228
    v_mul_f32 v221, v221, v238
    v_accvgpr_read_b32 v223, a91
    v_fmamk_f32 v162, v162, 0x3e0293ee, v228
    v_mfma_f32_16x16x32_bf16 a[40:43], a[224:227], v[8:11], 0
    v_exp_f32 v161, v161
    v_mfma_f32_16x16x32_bf16 a[40:43], a[228:231], v[24:27], a[40:43]
    v_exp_f32 v162, v162
    v_mfma_f32_16x16x32_bf16 a[40:43], a[232:235], v[40:43], a[40:43]
    v_cvt_pk_bf16_f32 v79, v158, v159
    v_cvt_pk_bf16_f32 v187, v218, v219
    v_mfma_f32_16x16x32_bf16 a[40:43], a[236:239], v[56:59], a[40:43]
    v_mul_f32 v222, v222, v238
    v_accvgpr_read_b32 v224, a92
    v_fmamk_f32 v163, v163, 0x3e0293ee, v228
    v_mul_f32 v223, v223, v238
    v_fmamk_f32 v164, v164, 0x3e0293ee, v230
    v_accvgpr_read_b32 v225, a93
    v_cvt_pk_bf16_f32 v80, v160, v161
    v_mfma_f32_16x16x32_bf16 a[56:59], a[236:239], v[60:63], 0
    v_mfma_f32_16x16x32_bf16 a[56:59], a[232:235], v[44:47], a[56:59]
    s_xor_b32 s86, s85, 25600
    v_exp_f32 v163, v163
    v_mfma_f32_16x16x32_bf16 a[56:59], a[228:231], v[28:31], a[56:59]
    s_xor_b32 m0, s35, 13312
    v_exp_f32 v164, v164
    v_mfma_f32_16x16x32_bf16 a[56:59], a[224:227], v[12:15], a[56:59]
    s_waitcnt lgkmcnt(0)
    buffer_load_dwordx4 v255, s[16:19], s86 offen nt lds
    v_cvt_pk_bf16_f32 v200, v220, v221
    v_fmamk_f32 v165, v165, 0x3e0293ee, v230
    v_mul_f32 v224, v224, v238
    v_accvgpr_read_b32 v226, a94
    v_fmamk_f32 v166, v166, 0x3e0293ee, v230
    v_mul_f32 v225, v225, v238
    v_cvt_pk_bf16_f32 v81, v162, v163
    v_accvgpr_read_b32 v227, a95
    v_mfma_f32_16x16x32_bf16 v[128:131], a[240:243], a[160:163], 0
    ds_read_b64_tr_b16 a[224:225], v244 offset:256
    v_mfma_f32_16x16x32_bf16 v[128:131], a[244:247], a[164:167], v[128:131]
    ds_read_b64_tr_b16 a[226:227], v244 offset:4352
    v_mfma_f32_16x16x32_bf16 v[128:131], a[248:251], a[168:171], v[128:131]
    ds_read_b64_tr_b16 a[228:229], v244 offset:8448
    v_mfma_f32_16x16x32_bf16 v[128:131], a[252:255], a[172:175], v[128:131]
    v_exp_f32 v165, v165
    v_fmamk_f32 v167, v167, 0x3e0293ee, v230
    v_cvt_pk_bf16_f32 v201, v222, v223
    v_mul_f32 v226, v226, v238
    v_accvgpr_read_b32 v212, a96
    v_exp_f32 v166, v166
    v_fmamk_f32 v168, v168, 0x3e0293ee, v232
    v_cvt_pk_bf16_f32 v84, v164, v165
    v_mul_f32 v227, v227, v238
    v_mfma_f32_16x16x32_bf16 v[132:135], a[252:255], a[188:191], 0
    ds_read_b64_tr_b16 a[230:231], v244 offset:12544
    v_mfma_f32_16x16x32_bf16 v[132:135], a[248:251], a[184:187], v[132:135]
    ds_read_b64_tr_b16 a[232:233], v244 offset:16640
    v_mfma_f32_16x16x32_bf16 v[132:135], a[244:247], a[180:183], v[132:135]
    ds_read_b64_tr_b16 a[234:235], v244 offset:20736
    v_mfma_f32_16x16x32_bf16 v[132:135], a[240:243], a[176:179], v[132:135]
    v_exp_f32 v167, v167
    v_accvgpr_read_b32 v213, a97
    v_fmamk_f32 v169, v169, 0x3e0293ee, v232
    v_cvt_pk_bf16_f32 v202, v224, v225
    v_exp_f32 v168, v168
    v_mul_f32 v212, v212, v240
    v_accvgpr_read_b32 v214, a98
    v_fmamk_f32 v170, v170, 0x3e0293ee, v232
    v_cvt_pk_bf16_f32 v85, v166, v167
    v_exp_f32 v169, v169
    v_mfma_f32_16x16x32_bf16 v[136:139], a[240:243], a[192:195], 0
    ds_read_b64_tr_b16 a[236:237], v244 offset:24832
    v_mfma_f32_16x16x32_bf16 v[136:139], a[244:247], a[196:199], v[136:139]
    ds_read_b64_tr_b16 a[238:239], v244 offset:28928
    v_mfma_f32_16x16x32_bf16 v[136:139], a[248:251], a[200:203], v[136:139]
    s_mov_b32 m0, s42
    v_exp_f32 v170, v170
    v_mfma_f32_16x16x32_bf16 v[136:139], a[252:255], a[204:207], v[136:139]
    buffer_load_dwordx4 v246, s[12:15], s82 offen offset:0 nt lds
    v_mul_f32 v213, v213, v240
    v_accvgpr_read_b32 v215, a99
    v_fmamk_f32 v171, v171, 0x3e0293ee, v232
    v_cvt_pk_bf16_f32 v203, v226, v227
    v_mul_f32 v214, v214, v240
    v_fmamk_f32 v172, v172, 0x3e0293ee, v234
    v_accvgpr_read_b32 v216, a100
    v_cvt_pk_bf16_f32 v88, v168, v169
    v_exp_f32 v171, v171
    v_mfma_f32_16x16x32_bf16 v[140:143], a[252:255], a[220:223], 0
    v_exp_f32 v172, v172
    v_mfma_f32_16x16x32_bf16 v[140:143], a[248:251], a[216:219], v[140:143]
    v_mfma_f32_16x16x32_bf16 v[140:143], a[244:247], a[212:215], v[140:143]
    v_fmamk_f32 v173, v173, 0x3e0293ee, v234
    v_mul_f32 v215, v215, v240
    v_mfma_f32_16x16x32_bf16 v[140:143], a[240:243], a[208:211], v[140:143]
    s_waitcnt lgkmcnt(0)
    v_exp_f32 v173, v173
    v_accvgpr_read_b32 v217, a101
    v_cvt_pk_bf16_f32 v188, v212, v213
    v_fmamk_f32 v174, v174, 0x3e0293ee, v234
    v_cvt_pk_bf16_f32 v89, v170, v171
    v_mul_f32 v216, v216, v240
    v_accvgpr_read_b32 v218, a102
    v_mfma_f32_16x16x32_bf16 a[4:7], a[224:227], v[0:3], 0
    ds_read_b128 a[240:243], v237 offset:49152
    v_mfma_f32_16x16x32_bf16 a[4:7], a[228:231], v[16:19], a[4:7]
    ds_read_b128 a[244:247], v237 offset:49408
    v_mfma_f32_16x16x32_bf16 a[4:7], a[232:235], v[32:35], a[4:7]
    v_exp_f32 v174, v174
    v_mfma_f32_16x16x32_bf16 a[4:7], a[236:239], v[48:51], a[4:7]
    v_fmamk_f32 v175, v175, 0x3e0293ee, v234
    v_mul_f32 v217, v217, v240
    v_accvgpr_read_b32 v219, a103
    v_fmamk_f32 v128, v128, 0x3e0293ee, v228
    v_cvt_pk_bf16_f32 v92, v172, v173
    v_cvt_pk_bf16_f32 v189, v214, v215
    v_mul_f32 v218, v218, v240
    v_exp_f32 v175, v175
    v_accvgpr_read_b32 v220, a104
    v_fmamk_f32 v129, v129, 0x3e0293ee, v228
    v_mfma_f32_16x16x32_bf16 a[20:23], a[236:239], v[52:55], 0
    ds_read_b128 a[248:251], v237 offset:49664
    v_mfma_f32_16x16x32_bf16 a[20:23], a[232:235], v[36:39], a[20:23]
    ds_read_b128 a[252:255], v237 offset:49920
    v_mfma_f32_16x16x32_bf16 a[20:23], a[228:231], v[20:23], a[20:23]
    s_mov_b32 m0, s42
    v_exp_f32 v128, v128
    v_mfma_f32_16x16x32_bf16 a[20:23], a[224:227], v[4:7], a[20:23]
    buffer_load_dwordx4 v247, s[12:15], s82 offen offset:1024 nt lds
    v_mul_f32 v219, v219, v240
    v_accvgpr_read_b32 v221, a105
    v_fmamk_f32 v130, v130, 0x3e0293ee, v228
    v_cvt_pk_bf16_f32 v93, v174, v175
    v_cvt_pk_bf16_f32 v190, v216, v217
    v_exp_f32 v129, v129
    v_mul_f32 v220, v220, v240
    v_accvgpr_read_b32 v222, a106
    v_fmamk_f32 v131, v131, 0x3e0293ee, v228
    v_mfma_f32_16x16x32_bf16 a[36:39], a[224:227], v[8:11], 0
    v_exp_f32 v130, v130
    v_mfma_f32_16x16x32_bf16 a[36:39], a[228:231], v[24:27], a[36:39]
    v_mfma_f32_16x16x32_bf16 a[36:39], a[232:235], v[40:43], a[36:39]
    v_exp_f32 v131, v131
    v_mfma_f32_16x16x32_bf16 a[36:39], a[236:239], v[56:59], a[36:39]
    v_mul_f32 v221, v221, v240
    v_fmamk_f32 v132, v132, 0x3e0293ee, v230
    v_accvgpr_read_b32 v223, a107
    v_cvt_pk_bf16_f32 v82, v128, v129
    v_cvt_pk_bf16_f32 v191, v218, v219
    v_fmamk_f32 v133, v133, 0x3e0293ee, v230
    v_mul_f32 v222, v222, v240
    v_accvgpr_read_b32 v224, a108
    v_mfma_f32_16x16x32_bf16 a[52:55], a[236:239], v[60:63], 0
    v_exp_f32 v132, v132
    v_mfma_f32_16x16x32_bf16 a[52:55], a[232:235], v[44:47], a[52:55]
    v_exp_f32 v133, v133
    v_mfma_f32_16x16x32_bf16 a[52:55], a[228:231], v[28:31], a[52:55]
    v_fmamk_f32 v134, v134, 0x3e0293ee, v230
    v_cvt_pk_bf16_f32 v83, v130, v131
    v_mfma_f32_16x16x32_bf16 a[52:55], a[224:227], v[12:15], a[52:55]
    s_waitcnt lgkmcnt(0)
    v_exp_f32 v134, v134
    v_mul_f32 v223, v223, v240
    v_accvgpr_read_b32 v225, a109
    v_fmamk_f32 v135, v135, 0x3e0293ee, v230
    v_cvt_pk_bf16_f32 v204, v220, v221
    v_mul_f32 v224, v224, v240
    v_mfma_f32_16x16x32_bf16 v[144:147], a[240:243], a[160:163], 0
    ds_read_b64_tr_b16 a[224:225], v245 offset:256
    v_mfma_f32_16x16x32_bf16 v[144:147], a[244:247], a[164:167], v[144:147]
    ds_read_b64_tr_b16 a[226:227], v245 offset:4352
    v_mfma_f32_16x16x32_bf16 v[144:147], a[248:251], a[168:171], v[144:147]
    ds_read_b64_tr_b16 a[228:229], v245 offset:8448
    s_mov_b32 m0, s42
    v_mfma_f32_16x16x32_bf16 v[144:147], a[252:255], a[172:175], v[144:147]
    buffer_load_dwordx4 v246, s[12:15], s82 offen offset:2048 nt lds
    v_accvgpr_read_b32 v226, a110
    v_fmamk_f32 v136, v136, 0x3e0293ee, v232
    v_cvt_pk_bf16_f32 v86, v132, v133
    v_mul_f32 v225, v225, v240
    v_exp_f32 v135, v135
    v_accvgpr_read_b32 v227, a111
    v_fmamk_f32 v137, v137, 0x3e0293ee, v232
    v_cvt_pk_bf16_f32 v205, v222, v223
    v_exp_f32 v136, v136
    v_mfma_f32_16x16x32_bf16 v[148:151], a[252:255], a[188:191], 0
    ds_read_b64_tr_b16 a[230:231], v245 offset:12544
    v_mfma_f32_16x16x32_bf16 v[148:151], a[248:251], a[184:187], v[148:151]
    ds_read_b64_tr_b16 a[232:233], v245 offset:16640
    v_mfma_f32_16x16x32_bf16 v[148:151], a[244:247], a[180:183], v[148:151]
    ds_read_b64_tr_b16 a[234:235], v245 offset:20736
    v_mfma_f32_16x16x32_bf16 v[148:151], a[240:243], a[176:179], v[148:151]
    v_exp_f32 v137, v137
    v_mul_f32 v226, v226, v240
    v_accvgpr_read_b32 v212, a112
    v_fmamk_f32 v138, v138, 0x3e0293ee, v232
    v_cvt_pk_bf16_f32 v87, v134, v135
    v_mul_f32 v227, v227, v240
    v_fmamk_f32 v139, v139, 0x3e0293ee, v232
    v_accvgpr_read_b32 v213, a113
    v_exp_f32 v138, v138
    v_mfma_f32_16x16x32_bf16 v[152:155], a[240:243], a[192:195], 0
    ds_read_b64_tr_b16 a[236:237], v245 offset:24832
    v_mfma_f32_16x16x32_bf16 v[152:155], a[244:247], a[196:199], v[152:155]
    ds_read_b64_tr_b16 a[238:239], v245 offset:28928
    v_mfma_f32_16x16x32_bf16 v[152:155], a[248:251], a[200:203], v[152:155]
    s_mov_b32 m0, s42
    v_exp_f32 v139, v139
    v_mfma_f32_16x16x32_bf16 v[152:155], a[252:255], a[204:207], v[152:155]
    buffer_load_dwordx4 v247, s[12:15], s82 offen offset:3072 nt lds
    v_cvt_pk_bf16_f32 v206, v224, v225
    v_fmamk_f32 v140, v140, 0x3e0293ee, v234
    v_mul_f32 v212, v212, v242
    v_accvgpr_read_b32 v214, a114
    v_cvt_pk_bf16_f32 v90, v136, v137
    v_fmamk_f32 v141, v141, 0x3e0293ee, v234
    v_mul_f32 v213, v213, v242
    v_accvgpr_read_b32 v215, a115
    v_exp_f32 v140, v140
    v_mfma_f32_16x16x32_bf16 v[156:159], a[252:255], a[220:223], 0
    v_mfma_f32_16x16x32_bf16 v[156:159], a[248:251], a[216:219], v[156:159]
    v_exp_f32 v141, v141
    v_mfma_f32_16x16x32_bf16 v[156:159], a[244:247], a[212:215], v[156:159]
    v_fmamk_f32 v142, v142, 0x3e0293ee, v234
    v_cvt_pk_bf16_f32 v207, v226, v227
    v_mfma_f32_16x16x32_bf16 v[156:159], a[240:243], a[208:211], v[156:159]
    s_waitcnt lgkmcnt(0)
    v_exp_f32 v142, v142
    v_cvt_pk_bf16_f32 v91, v138, v139
    v_mul_f32 v214, v214, v242
    v_accvgpr_read_b32 v216, a116
    v_fmamk_f32 v143, v143, 0x3e0293ee, v234
    v_mul_f32 v215, v215, v242
    v_accvgpr_read_b32 v217, a117
    v_fmamk_f32 v144, v144, 0x3e0293ee, v228
    v_mfma_f32_16x16x32_bf16 a[12:15], a[224:227], v[0:3], 0
    ds_read_b128 a[240:243], v237 offset:53248
    v_mfma_f32_16x16x32_bf16 a[12:15], a[228:231], v[16:19], a[12:15]
    ds_read_b128 a[244:247], v237 offset:53504
    v_mfma_f32_16x16x32_bf16 a[12:15], a[232:235], v[32:35], a[12:15]
    v_exp_f32 v143, v143
    v_mfma_f32_16x16x32_bf16 a[12:15], a[236:239], v[48:51], a[12:15]
    v_exp_f32 v144, v144
    v_cvt_pk_bf16_f32 v94, v140, v141
    v_cvt_pk_bf16_f32 v192, v212, v213
    v_mul_f32 v216, v216, v242
    v_accvgpr_read_b32 v218, a118
    v_fmamk_f32 v145, v145, 0x3e0293ee, v228
    v_mul_f32 v217, v217, v242
    v_accvgpr_read_b32 v219, a119
    v_fmamk_f32 v146, v146, 0x3e0293ee, v228
    v_mfma_f32_16x16x32_bf16 a[28:31], a[236:239], v[52:55], 0
    ds_read_b128 a[248:251], v237 offset:53760
    v_mfma_f32_16x16x32_bf16 a[28:31], a[232:235], v[36:39], a[28:31]
    ds_read_b128 a[252:255], v237 offset:54016
    v_mfma_f32_16x16x32_bf16 a[28:31], a[228:231], v[20:23], a[28:31]
    s_mov_b32 m0, s43
    v_exp_f32 v145, v145
    v_mfma_f32_16x16x32_bf16 a[28:31], a[224:227], v[4:7], a[28:31]
    buffer_load_dwordx4 v246, s[12:15], s83 offen offset:0 nt lds
    v_cvt_pk_bf16_f32 v95, v142, v143
    v_cvt_pk_bf16_f32 v193, v214, v215
    v_mul_f32 v218, v218, v242
    v_fmamk_f32 v147, v147, 0x3e0293ee, v228
    v_accvgpr_read_b32 v220, a120
    v_exp_f32 v146, v146
    v_fmamk_f32 v148, v148, 0x3e0293ee, v230
    v_mul_f32 v219, v219, v242
    v_cvt_pk_bf16_f32 v96, v144, v145
    v_accvgpr_read_b32 v221, a121
    v_mfma_f32_16x16x32_bf16 a[44:47], a[224:227], v[8:11], 0
    v_mfma_f32_16x16x32_bf16 a[44:47], a[228:231], v[24:27], a[44:47]
    v_exp_f32 v147, v147
    v_mfma_f32_16x16x32_bf16 a[44:47], a[232:235], v[40:43], a[44:47]
    v_exp_f32 v148, v148
    v_mfma_f32_16x16x32_bf16 a[44:47], a[236:239], v[56:59], a[44:47]
    v_cvt_pk_bf16_f32 v194, v216, v217
    v_fmamk_f32 v149, v149, 0x3e0293ee, v230
    v_mul_f32 v220, v220, v242
    v_accvgpr_read_b32 v222, a122
    v_fmamk_f32 v150, v150, 0x3e0293ee, v230
    v_cvt_pk_bf16_f32 v97, v146, v147
    v_mul_f32 v221, v221, v242
    v_mfma_f32_16x16x32_bf16 a[60:63], a[236:239], v[60:63], 0
    v_exp_f32 v149, v149
    v_mfma_f32_16x16x32_bf16 a[60:63], a[232:235], v[44:47], a[60:63]
    v_exp_f32 v150, v150
    v_mfma_f32_16x16x32_bf16 a[60:63], a[228:231], v[28:31], a[60:63]
    s_mov_b64 vcc, s[74:75]
    v_mfma_f32_16x16x32_bf16 a[60:63], a[224:227], v[12:15], a[60:63]
    s_waitcnt lgkmcnt(0)
    v_accvgpr_read_b32 v223, a123
    v_fmamk_f32 v151, v151, 0x3e0293ee, v230
    v_cvt_pk_bf16_f32 v195, v218, v219
    v_mul_f32 v222, v222, v242
    v_accvgpr_read_b32 v224, a124
    v_fmamk_f32 v152, v152, 0x3e0293ee, v232
    v_cvt_pk_bf16_f32 v100, v148, v149
    v_mfma_f32_16x16x32_bf16 v[160:163], a[240:243], a[160:163], 0
    ds_read_b64_tr_b16 a[224:225], v244 offset:512
    v_mfma_f32_16x16x32_bf16 v[160:163], a[244:247], a[164:167], v[160:163]
    ds_read_b64_tr_b16 a[226:227], v244 offset:4608
    v_mfma_f32_16x16x32_bf16 v[160:163], a[248:251], a[168:171], v[160:163]
    ds_read_b64_tr_b16 a[228:229], v244 offset:8704
    s_mov_b32 m0, s43
    v_mfma_f32_16x16x32_bf16 v[160:163], a[252:255], a[172:175], v[160:163]
    buffer_load_dwordx4 v247, s[12:15], s83 offen offset:1024 nt lds
    v_mul_f32 v223, v223, v242
    v_exp_f32 v151, v151
    v_accvgpr_read_b32 v225, a125
    v_fmamk_f32 v153, v153, 0x3e0293ee, v232
    v_cvt_pk_bf16_f32 v208, v220, v221
    v_exp_f32 v152, v152
    v_mul_f32 v224, v224, v242
    v_accvgpr_read_b32 v226, a126
    v_fmamk_f32 v154, v154, 0x3e0293ee, v232
    v_cvt_pk_bf16_f32 v101, v150, v151
    v_exp_f32 v153, v153
    v_mfma_f32_16x16x32_bf16 v[164:167], a[252:255], a[188:191], 0
    ds_read_b64_tr_b16 a[230:231], v244 offset:12800
    v_mfma_f32_16x16x32_bf16 v[164:167], a[248:251], a[184:187], v[164:167]
    ds_read_b64_tr_b16 a[232:233], v244 offset:16896
    v_mfma_f32_16x16x32_bf16 v[164:167], a[244:247], a[180:183], v[164:167]
    ds_read_b64_tr_b16 a[234:235], v244 offset:20992
    v_mfma_f32_16x16x32_bf16 v[164:167], a[240:243], a[176:179], v[164:167]
    v_exp_f32 v154, v154
    v_mul_f32 v225, v225, v242
    v_fmamk_f32 v155, v155, 0x3e0293ee, v232
    v_accvgpr_read_b32 v227, a127
    v_cvt_pk_bf16_f32 v209, v222, v223
    v_fmamk_f32 v156, v156, 0x3e0293ee, v234
    v_mul_f32 v226, v226, v242
    v_cvt_pk_bf16_f32 v104, v152, v153
    v_exp_f32 v155, v155
    v_mfma_f32_16x16x32_bf16 v[168:171], a[240:243], a[192:195], 0
    ds_read_b64_tr_b16 a[236:237], v244 offset:25088
    v_mfma_f32_16x16x32_bf16 v[168:171], a[244:247], a[196:199], v[168:171]
    ds_read_b64_tr_b16 a[238:239], v244 offset:29184
    v_mfma_f32_16x16x32_bf16 v[168:171], a[248:251], a[200:203], v[168:171]
    v_exp_f32 v156, v156
    v_mfma_f32_16x16x32_bf16 v[168:171], a[252:255], a[204:207], v[168:171]
    v_fmamk_f32 v157, v157, 0x3e0293ee, v234
    v_mul_f32 v227, v227, v242
    v_cndmask_b32_dpp v176, v196, v180, vcc quad_perm:[1,0,3,2] row_mask:0xf bank_mask:0xf
    v_fmamk_f32 v158, v158, 0x3e0293ee, v234
    v_cvt_pk_bf16_f32 v210, v224, v225
    v_cvt_pk_bf16_f32 v105, v154, v155
    v_cndmask_b32_dpp v177, v197, v181, vcc quad_perm:[1,0,3,2] row_mask:0xf bank_mask:0xf
    v_exp_f32 v157, v157
    v_mfma_f32_16x16x32_bf16 v[172:175], a[252:255], a[220:223], 0
    v_exp_f32 v158, v158
    v_mfma_f32_16x16x32_bf16 v[172:175], a[248:251], a[216:219], v[172:175]
    v_fmamk_f32 v159, v159, 0x3e0293ee, v234
    v_cndmask_b32_dpp v178, v198, v182, vcc quad_perm:[1,0,3,2] row_mask:0xf bank_mask:0xf
    v_mfma_f32_16x16x32_bf16 v[172:175], a[244:247], a[212:215], v[172:175]
    s_mov_b32 m0, s43
    v_exp_f32 v159, v159
    v_mfma_f32_16x16x32_bf16 v[172:175], a[240:243], a[208:211], v[172:175]
    s_waitcnt lgkmcnt(0)
    buffer_load_dwordx4 v246, s[12:15], s83 offen offset:2048 nt lds
    v_cndmask_b32_dpp v179, v199, v183, vcc quad_perm:[1,0,3,2] row_mask:0xf bank_mask:0xf
    v_fmamk_f32 v160, v160, 0x3e0293ee, v228
    v_cvt_pk_bf16_f32 v108, v156, v157
    s_mov_b64 vcc, s[76:77]
    v_cvt_pk_bf16_f32 v211, v226, v227
    v_fmamk_f32 v161, v161, 0x3e0293ee, v228
    v_cndmask_b32_dpp v196, v180, v196, vcc quad_perm:[1,0,3,2] row_mask:0xf bank_mask:0xf
    v_mfma_f32_16x16x32_bf16 a[64:67], a[224:227], v[0:3], 0
    ds_read_b128 a[240:243], v237 offset:57344
    v_mfma_f32_16x16x32_bf16 a[64:67], a[228:231], v[16:19], a[64:67]
    ds_read_b128 a[244:247], v237 offset:57600
    v_mfma_f32_16x16x32_bf16 a[64:67], a[232:235], v[32:35], a[64:67]
    v_exp_f32 v160, v160
    v_mfma_f32_16x16x32_bf16 a[64:67], a[236:239], v[48:51], a[64:67]
    v_exp_f32 v161, v161
    v_cndmask_b32_dpp v197, v181, v197, vcc quad_perm:[1,0,3,2] row_mask:0xf bank_mask:0xf
    v_fmamk_f32 v162, v162, 0x3e0293ee, v228
    v_cvt_pk_bf16_f32 v109, v158, v159
    v_cndmask_b32_dpp v198, v182, v198, vcc quad_perm:[1,0,3,2] row_mask:0xf bank_mask:0xf
    v_cndmask_b32_dpp v199, v183, v199, vcc quad_perm:[1,0,3,2] row_mask:0xf bank_mask:0xf
    v_fmamk_f32 v163, v163, 0x3e0293ee, v228
    v_mfma_f32_16x16x32_bf16 a[80:83], a[236:239], v[52:55], 0
    ds_read_b128 a[248:251], v237 offset:57856
    v_mfma_f32_16x16x32_bf16 a[80:83], a[232:235], v[36:39], a[80:83]
    ds_read_b128 a[252:255], v237 offset:58112
    v_mfma_f32_16x16x32_bf16 a[80:83], a[228:231], v[20:23], a[80:83]
    v_mfma_f32_16x16x32_bf16 a[80:83], a[224:227], v[4:7], a[80:83]
    v_permlane16_swap_b32 v176, v178
    v_exp_f32 v162, v162
    v_fmamk_f32 v164, v164, 0x3e0293ee, v230
    v_cvt_pk_bf16_f32 v98, v160, v161
    v_exp_f32 v163, v163
    v_permlane16_swap_b32 v177, v179
    v_fmamk_f32 v165, v165, 0x3e0293ee, v230
    v_mfma_f32_16x16x32_bf16 a[96:99], a[224:227], v[8:11], 0
    v_exp_f32 v164, v164
    v_mfma_f32_16x16x32_bf16 a[96:99], a[228:231], v[24:27], a[96:99]
    v_exp_f32 v165, v165
    v_mfma_f32_16x16x32_bf16 a[96:99], a[232:235], v[40:43], a[96:99]
    s_mov_b32 m0, s43
    v_permlane16_swap_b32 v196, v198
    v_mfma_f32_16x16x32_bf16 a[96:99], a[236:239], v[56:59], a[96:99]
    buffer_load_dwordx4 v247, s[12:15], s83 offen offset:3072 nt lds
    v_fmamk_f32 v166, v166, 0x3e0293ee, v230
    v_cvt_pk_bf16_f32 v99, v162, v163
    v_fmamk_f32 v167, v167, 0x3e0293ee, v230
    v_mfma_f32_16x16x32_bf16 a[112:115], a[236:239], v[60:63], 0
    v_exp_f32 v166, v166
    v_mfma_f32_16x16x32_bf16 a[112:115], a[232:235], v[44:47], a[112:115]
    v_mfma_f32_16x16x32_bf16 a[112:115], a[228:231], v[28:31], a[112:115]
    v_exp_f32 v167, v167
    v_mfma_f32_16x16x32_bf16 a[112:115], a[224:227], v[12:15], a[112:115]
    s_waitcnt lgkmcnt(0)
    buffer_store_dwordx4 v[176:179], v243, s[24:27], s52 offen offset:128 sc1
    v_permlane16_swap_b32 v197, v199
    v_fmamk_f32 v168, v168, 0x3e0293ee, v232
    v_cvt_pk_bf16_f32 v102, v164, v165
    v_fmamk_f32 v169, v169, 0x3e0293ee, v232
    v_exp_f32 v168, v168
    v_mfma_f32_16x16x32_bf16 v[128:131], a[240:243], a[160:163], 0
    ds_read_b64_tr_b16 a[224:225], v245 offset:512
    v_mfma_f32_16x16x32_bf16 v[128:131], a[244:247], a[164:167], v[128:131]
    ds_read_b64_tr_b16 a[226:227], v245 offset:4608
    v_mfma_f32_16x16x32_bf16 v[128:131], a[248:251], a[168:171], v[128:131]
    ds_read_b64_tr_b16 a[228:229], v245 offset:8704
    v_mfma_f32_16x16x32_bf16 v[128:131], a[252:255], a[172:175], v[128:131]
    s_mov_b64 vcc, s[74:75]
    buffer_store_dwordx4 v[196:199], v243, s[24:27], s52 offen offset:384 sc1
    v_exp_f32 v169, v169
    v_fmamk_f32 v170, v170, 0x3e0293ee, v232
    v_cvt_pk_bf16_f32 v103, v166, v167
    v_fmamk_f32 v171, v171, 0x3e0293ee, v232
    v_exp_f32 v170, v170
    v_mfma_f32_16x16x32_bf16 v[132:135], a[252:255], a[188:191], 0
    ds_read_b64_tr_b16 a[230:231], v245 offset:12800
    v_mfma_f32_16x16x32_bf16 v[132:135], a[248:251], a[184:187], v[132:135]
    ds_read_b64_tr_b16 a[232:233], v245 offset:16896
    v_mfma_f32_16x16x32_bf16 v[132:135], a[244:247], a[180:183], v[132:135]
    ds_read_b64_tr_b16 a[234:235], v245 offset:20992
    v_mfma_f32_16x16x32_bf16 v[132:135], a[240:243], a[176:179], v[132:135]
    v_exp_f32 v171, v171
    v_fmamk_f32 v172, v172, 0x3e0293ee, v234
    v_cvt_pk_bf16_f32 v106, v168, v169
    v_cndmask_b32_dpp v180, v200, v184, vcc quad_perm:[1,0,3,2] row_mask:0xf bank_mask:0xf
    v_fmamk_f32 v173, v173, 0x3e0293ee, v234
    v_cndmask_b32_dpp v181, v201, v185, vcc quad_perm:[1,0,3,2] row_mask:0xf bank_mask:0xf
    v_exp_f32 v172, v172
    v_cndmask_b32_dpp v182, v202, v186, vcc quad_perm:[1,0,3,2] row_mask:0xf bank_mask:0xf
    v_mfma_f32_16x16x32_bf16 v[136:139], a[240:243], a[192:195], 0
    ds_read_b64_tr_b16 a[236:237], v245 offset:25088
    v_mfma_f32_16x16x32_bf16 v[136:139], a[244:247], a[196:199], v[136:139]
    ds_read_b64_tr_b16 a[238:239], v245 offset:29184
    v_mfma_f32_16x16x32_bf16 v[136:139], a[248:251], a[200:203], v[136:139]
    v_exp_f32 v173, v173
    v_mfma_f32_16x16x32_bf16 v[136:139], a[252:255], a[204:207], v[136:139]
    v_fmamk_f32 v174, v174, 0x3e0293ee, v234
    v_cvt_pk_bf16_f32 v107, v170, v171
    v_cndmask_b32_dpp v183, v203, v187, vcc quad_perm:[1,0,3,2] row_mask:0xf bank_mask:0xf
    v_fmamk_f32 v175, v175, 0x3e0293ee, v234
    s_mov_b64 vcc, s[76:77]
    v_exp_f32 v174, v174
    v_cndmask_b32_dpp v200, v184, v200, vcc quad_perm:[1,0,3,2] row_mask:0xf bank_mask:0xf
    v_fmamk_f32 v128, v128, 0x3e0293ee, v228
    v_mfma_f32_16x16x32_bf16 v[140:143], a[252:255], a[220:223], 0
    v_exp_f32 v175, v175
    v_mfma_f32_16x16x32_bf16 v[140:143], a[248:251], a[216:219], v[140:143]
    v_exp_f32 v128, v128
    v_mfma_f32_16x16x32_bf16 v[140:143], a[244:247], a[212:215], v[140:143]
    v_mfma_f32_16x16x32_bf16 v[140:143], a[240:243], a[208:211], v[140:143]
    s_waitcnt lgkmcnt(0)
    v_cvt_pk_bf16_f32 v110, v172, v173
    v_cndmask_b32_dpp v201, v185, v201, vcc quad_perm:[1,0,3,2] row_mask:0xf bank_mask:0xf
    v_cndmask_b32_dpp v202, v186, v202, vcc quad_perm:[1,0,3,2] row_mask:0xf bank_mask:0xf
    v_fmamk_f32 v129, v129, 0x3e0293ee, v228
    v_cndmask_b32_dpp v203, v187, v203, vcc quad_perm:[1,0,3,2] row_mask:0xf bank_mask:0xf
    v_fmamk_f32 v130, v130, 0x3e0293ee, v228
    v_permlane16_swap_b32 v180, v182
    v_mfma_f32_16x16x32_bf16 a[72:75], a[224:227], v[0:3], 0
    ds_read_b128 a[240:243], v237 offset:61440
    v_mfma_f32_16x16x32_bf16 a[72:75], a[228:231], v[16:19], a[72:75]
    ds_read_b128 a[244:247], v237 offset:61696
    v_mfma_f32_16x16x32_bf16 a[72:75], a[232:235], v[32:35], a[72:75]
    s_mov_b32 s58, s57
    v_exp_f32 v129, v129
    v_mfma_f32_16x16x32_bf16 a[72:75], a[236:239], v[48:51], a[72:75]
    s_mov_b32 s57, s37
    v_permlane16_swap_b32 v181, v183
    v_cvt_pk_bf16_f32 v111, v174, v175
    v_fmamk_f32 v131, v131, 0x3e0293ee, v228
    v_exp_f32 v130, v130
    v_fmamk_f32 v132, v132, 0x3e0293ee, v230
    v_cvt_pk_bf16_f32 v112, v128, v129
    v_mfma_f32_16x16x32_bf16 a[88:91], a[236:239], v[52:55], 0
    ds_read_b128 a[248:251], v237 offset:61952
    v_mfma_f32_16x16x32_bf16 a[88:91], a[232:235], v[36:39], a[88:91]
    ds_read_b128 a[252:255], v237 offset:62208
    v_mfma_f32_16x16x32_bf16 a[88:91], a[228:231], v[20:23], a[88:91]
    s_add_u32 s37, s37, 8192
    v_exp_f32 v131, v131
    v_mfma_f32_16x16x32_bf16 a[88:91], a[224:227], v[4:7], a[88:91]
    s_xor_b32 s80, s37, s84
    buffer_store_dwordx4 v[180:183], v243, s[24:27], s53 offen offset:128 sc1
    v_exp_f32 v132, v132
    v_permlane16_swap_b32 v200, v202
    v_fmamk_f32 v133, v133, 0x3e0293ee, v230
    v_fmamk_f32 v134, v134, 0x3e0293ee, v230
    v_cvt_pk_bf16_f32 v113, v130, v131
    v_mfma_f32_16x16x32_bf16 a[104:107], a[224:227], v[8:11], 0
    s_xor_b32 s81, s80, 4096
    v_exp_f32 v133, v133
    v_mfma_f32_16x16x32_bf16 a[104:107], a[228:231], v[24:27], a[104:107]
    s_xor_b32 s82, s80, 16384
    v_exp_f32 v134, v134
    v_mfma_f32_16x16x32_bf16 a[104:107], a[232:235], v[40:43], a[104:107]
    s_xor_b32 s83, s80, 20480
    v_permlane16_swap_b32 v201, v203
    v_mfma_f32_16x16x32_bf16 a[104:107], a[236:239], v[56:59], a[104:107]
    s_cmp_eq_u32 s34, 6
    buffer_store_dwordx4 v[200:203], v243, s[24:27], s53 offen offset:384 sc1
    v_fmamk_f32 v135, v135, 0x3e0293ee, v230
    v_exp_f32 v135, v135
    v_fmamk_f32 v136, v136, 0x3e0293ee, v232
    v_cvt_pk_bf16_f32 v116, v132, v133
    v_mfma_f32_16x16x32_bf16 a[120:123], a[236:239], v[60:63], 0
    s_cselect_b32 s14, 0, s14
    v_mfma_f32_16x16x32_bf16 a[120:123], a[232:235], v[44:47], a[120:123]
    s_mov_b64 vcc, s[74:75]
    v_exp_f32 v136, v136
    v_mfma_f32_16x16x32_bf16 a[120:123], a[228:231], v[28:31], a[120:123]
    v_fmamk_f32 v137, v137, 0x3e0293ee, v232
    v_fmamk_f32 v138, v138, 0x3e0293ee, v232
    v_mfma_f32_16x16x32_bf16 a[120:123], a[224:227], v[12:15], a[120:123]
    s_waitcnt lgkmcnt(0)
    v_exp_f32 v137, v137
    v_cvt_pk_bf16_f32 v117, v134, v135
    v_mfma_f32_16x16x32_bf16 v[144:147], a[240:243], a[160:163], 0
    ds_read_b64_tr_b16 a[224:225], v244 offset:768
    v_mfma_f32_16x16x32_bf16 v[144:147], a[244:247], a[164:167], v[144:147]
    ds_read_b64_tr_b16 a[226:227], v244 offset:4864
    v_mfma_f32_16x16x32_bf16 v[144:147], a[248:251], a[168:171], v[144:147]
    ds_read_b64_tr_b16 a[228:229], v244 offset:8960
    v_mfma_f32_16x16x32_bf16 v[144:147], a[252:255], a[172:175], v[144:147]
    v_exp_f32 v138, v138
    v_fmamk_f32 v139, v139, 0x3e0293ee, v232
    v_cndmask_b32_dpp v184, v204, v188, vcc quad_perm:[1,0,3,2] row_mask:0xf bank_mask:0xf
    v_cndmask_b32_dpp v185, v205, v189, vcc quad_perm:[1,0,3,2] row_mask:0xf bank_mask:0xf
    v_fmamk_f32 v140, v140, 0x3e0293ee, v234
    v_cvt_pk_bf16_f32 v120, v136, v137
    v_cndmask_b32_dpp v186, v206, v190, vcc quad_perm:[1,0,3,2] row_mask:0xf bank_mask:0xf
    v_exp_f32 v139, v139
    v_mfma_f32_16x16x32_bf16 v[148:151], a[252:255], a[188:191], 0
    ds_read_b64_tr_b16 a[230:231], v244 offset:13056
    v_mfma_f32_16x16x32_bf16 v[148:151], a[248:251], a[184:187], v[148:151]
    ds_read_b64_tr_b16 a[232:233], v244 offset:17152
    v_mfma_f32_16x16x32_bf16 v[148:151], a[244:247], a[180:183], v[148:151]
    ds_read_b64_tr_b16 a[234:235], v244 offset:21248
    v_mfma_f32_16x16x32_bf16 v[148:151], a[240:243], a[176:179], v[148:151]
    v_exp_f32 v140, v140
    v_fmamk_f32 v141, v141, 0x3e0293ee, v234
    v_cndmask_b32_dpp v187, v207, v191, vcc quad_perm:[1,0,3,2] row_mask:0xf bank_mask:0xf
    s_mov_b64 vcc, s[76:77]
    v_fmamk_f32 v142, v142, 0x3e0293ee, v234
    v_cvt_pk_bf16_f32 v121, v138, v139
    v_cndmask_b32_dpp v204, v188, v204, vcc quad_perm:[1,0,3,2] row_mask:0xf bank_mask:0xf
    v_exp_f32 v141, v141
    v_mfma_f32_16x16x32_bf16 v[152:155], a[240:243], a[192:195], 0
    ds_read_b64_tr_b16 a[236:237], v244 offset:25344
    v_mfma_f32_16x16x32_bf16 v[152:155], a[244:247], a[196:199], v[152:155]
    ds_read_b64_tr_b16 a[238:239], v244 offset:29440
    v_mfma_f32_16x16x32_bf16 v[152:155], a[248:251], a[200:203], v[152:155]
    v_exp_f32 v142, v142
    v_mfma_f32_16x16x32_bf16 v[152:155], a[252:255], a[204:207], v[152:155]
    v_cndmask_b32_dpp v205, v189, v205, vcc quad_perm:[1,0,3,2] row_mask:0xf bank_mask:0xf
    v_fmamk_f32 v143, v143, 0x3e0293ee, v234
    v_cndmask_b32_dpp v206, v190, v206, vcc quad_perm:[1,0,3,2] row_mask:0xf bank_mask:0xf
    v_fmamk_f32 v144, v144, 0x3e0293ee, v228
    v_cndmask_b32_dpp v207, v191, v207, vcc quad_perm:[1,0,3,2] row_mask:0xf bank_mask:0xf
    v_cvt_pk_bf16_f32 v124, v140, v141
    v_exp_f32 v143, v143
    v_permlane16_swap_b32 v184, v186
    v_fmamk_f32 v145, v145, 0x3e0293ee, v228
    v_mfma_f32_16x16x32_bf16 v[156:159], a[252:255], a[220:223], 0
    v_exp_f32 v144, v144
    v_mfma_f32_16x16x32_bf16 v[156:159], a[248:251], a[216:219], v[156:159]
    v_mfma_f32_16x16x32_bf16 v[156:159], a[244:247], a[212:215], v[156:159]
    v_permlane16_swap_b32 v185, v187
    v_mfma_f32_16x16x32_bf16 v[156:159], a[240:243], a[208:211], v[156:159]
    s_waitcnt lgkmcnt(0)
    buffer_store_dwordx4 v[184:187], v243, s[24:27], s54 offen offset:128 sc1
    v_exp_f32 v145, v145
    v_permlane16_swap_b32 v204, v206
    v_fmamk_f32 v146, v146, 0x3e0293ee, v228
    v_cvt_pk_bf16_f32 v125, v142, v143
    v_fmamk_f32 v147, v147, 0x3e0293ee, v228
    v_mfma_f32_16x16x32_bf16 a[68:71], a[224:227], v[0:3], 0
    ds_read_b64_tr_b16 a[240:241], v245 offset:768
    v_mfma_f32_16x16x32_bf16 a[68:71], a[228:231], v[16:19], a[68:71]
    ds_read_b64_tr_b16 a[242:243], v245 offset:4864
    v_mfma_f32_16x16x32_bf16 a[68:71], a[232:235], v[32:35], a[68:71]
    ds_read_b64_tr_b16 a[244:245], v245 offset:8960
    v_mfma_f32_16x16x32_bf16 a[68:71], a[236:239], v[48:51], a[68:71]
    v_exp_f32 v146, v146
    v_fmamk_f32 v148, v148, 0x3e0293ee, v230
    v_cvt_pk_bf16_f32 v114, v144, v145
    v_exp_f32 v147, v147
    v_fmamk_f32 v149, v149, 0x3e0293ee, v230
    v_mfma_f32_16x16x32_bf16 a[84:87], a[236:239], v[52:55], 0
    ds_read_b64_tr_b16 a[246:247], v245 offset:13056
    v_mfma_f32_16x16x32_bf16 a[84:87], a[232:235], v[36:39], a[84:87]
    ds_read_b64_tr_b16 a[248:249], v245 offset:17152
    v_mfma_f32_16x16x32_bf16 a[84:87], a[228:231], v[20:23], a[84:87]
    ds_read_b64_tr_b16 a[250:251], v245 offset:21248
    v_mfma_f32_16x16x32_bf16 a[84:87], a[224:227], v[4:7], a[84:87]
    v_exp_f32 v148, v148
    v_fmamk_f32 v150, v150, 0x3e0293ee, v230
    v_cvt_pk_bf16_f32 v115, v146, v147
    v_permlane16_swap_b32 v205, v207
    v_exp_f32 v149, v149
    v_fmamk_f32 v151, v151, 0x3e0293ee, v230
    v_mfma_f32_16x16x32_bf16 a[100:103], a[224:227], v[8:11], 0
    ds_read_b64_tr_b16 a[252:253], v245 offset:25344
    v_mfma_f32_16x16x32_bf16 a[100:103], a[228:231], v[24:27], a[100:103]
    ds_read_b64_tr_b16 a[254:255], v245 offset:29440
    v_mfma_f32_16x16x32_bf16 a[100:103], a[232:235], v[40:43], a[100:103]
    s_mov_b64 vcc, s[74:75]
    v_exp_f32 v150, v150
    v_mfma_f32_16x16x32_bf16 a[100:103], a[236:239], v[56:59], a[100:103]
    buffer_store_dwordx4 v[204:207], v243, s[24:27], s54 offen offset:384 sc1
    v_exp_f32 v151, v151
    v_fmamk_f32 v152, v152, 0x3e0293ee, v232
    v_cvt_pk_bf16_f32 v118, v148, v149
    v_fmamk_f32 v153, v153, 0x3e0293ee, v232
    v_exp_f32 v152, v152
    v_mfma_f32_16x16x32_bf16 a[116:119], a[236:239], v[60:63], 0
    v_exp_f32 v153, v153
    v_mfma_f32_16x16x32_bf16 a[116:119], a[232:235], v[44:47], a[116:119]
    v_cndmask_b32_dpp v188, v208, v192, vcc quad_perm:[1,0,3,2] row_mask:0xf bank_mask:0xf
    v_fmamk_f32 v154, v154, 0x3e0293ee, v232
    v_mfma_f32_16x16x32_bf16 a[116:119], a[228:231], v[28:31], a[116:119]
    v_mfma_f32_16x16x32_bf16 a[116:119], a[224:227], v[12:15], a[116:119]
    s_waitcnt lgkmcnt(0)
    v_exp_f32 v154, v154
    v_cvt_pk_bf16_f32 v119, v150, v151
    v_cndmask_b32_dpp v189, v209, v193, vcc quad_perm:[1,0,3,2] row_mask:0xf bank_mask:0xf
    v_fmamk_f32 v155, v155, 0x3e0293ee, v232
    v_cndmask_b32_dpp v190, v210, v194, vcc quad_perm:[1,0,3,2] row_mask:0xf bank_mask:0xf
    v_mfma_f32_16x16x32_bf16 a[76:79], a[240:243], v[0:3], 0
    s_waitcnt vmcnt(6)
    v_exp_f32 v155, v155
    v_mfma_f32_16x16x32_bf16 a[76:79], a[244:247], v[16:19], a[76:79]
    ds_read_b128 a[192:195], v239 offset:0
    v_mfma_f32_16x16x32_bf16 a[76:79], a[248:251], v[32:35], a[76:79]
    ds_read_b128 a[196:199], v239 offset:256
    v_mfma_f32_16x16x32_bf16 a[76:79], a[252:255], v[48:51], a[76:79]
    v_cndmask_b32_dpp v191, v211, v195, vcc quad_perm:[1,0,3,2] row_mask:0xf bank_mask:0xf
    v_fmamk_f32 v156, v156, 0x3e0293ee, v234
    v_cvt_pk_bf16_f32 v122, v152, v153
    s_mov_b64 vcc, s[76:77]
    v_fmamk_f32 v157, v157, 0x3e0293ee, v234
    v_cndmask_b32_dpp v208, v192, v208, vcc quad_perm:[1,0,3,2] row_mask:0xf bank_mask:0xf
    v_exp_f32 v156, v156
    v_cndmask_b32_dpp v209, v193, v209, vcc quad_perm:[1,0,3,2] row_mask:0xf bank_mask:0xf
    v_mfma_f32_16x16x32_bf16 a[92:95], a[252:255], v[52:55], 0
    ds_read_b128 a[200:203], v239 offset:512
    v_mfma_f32_16x16x32_bf16 a[92:95], a[248:251], v[36:39], a[92:95]
    ds_read_b128 a[204:207], v239 offset:768
    v_mfma_f32_16x16x32_bf16 a[92:95], a[244:247], v[20:23], a[92:95]
    ds_read_b128 a[208:211], v239 offset:4096
    v_mfma_f32_16x16x32_bf16 a[92:95], a[240:243], v[4:7], a[92:95]
    v_exp_f32 v157, v157
    v_fmamk_f32 v158, v158, 0x3e0293ee, v234
    v_cvt_pk_bf16_f32 v123, v154, v155
    v_cndmask_b32_dpp v210, v194, v210, vcc quad_perm:[1,0,3,2] row_mask:0xf bank_mask:0xf
    v_cndmask_b32_dpp v211, v195, v211, vcc quad_perm:[1,0,3,2] row_mask:0xf bank_mask:0xf
    v_fmamk_f32 v159, v159, 0x3e0293ee, v234
    v_permlane16_swap_b32 v188, v190
    v_exp_f32 v158, v158
    v_mfma_f32_16x16x32_bf16 a[108:111], a[240:243], v[8:11], 0
    ds_read_b128 a[212:215], v239 offset:4352
    v_mfma_f32_16x16x32_bf16 a[108:111], a[244:247], v[24:27], a[108:111]
    ds_read_b128 a[216:219], v239 offset:4608
    v_mfma_f32_16x16x32_bf16 a[108:111], a[248:251], v[40:43], a[108:111]
    ds_read_b128 a[220:223], v239 offset:4864
    v_mfma_f32_16x16x32_bf16 a[108:111], a[252:255], v[56:59], a[108:111]
    v_exp_f32 v159, v159
    v_cvt_pk_bf16_f32 v126, v156, v157
    v_permlane16_swap_b32 v189, v191
    v_mfma_f32_16x16x32_bf16 a[124:127], a[252:255], v[60:63], 0
    v_permlane16_swap_b32 v208, v210
    v_mfma_f32_16x16x32_bf16 a[124:127], a[248:251], v[44:47], a[124:127]
    v_permlane16_swap_b32 v209, v211
    v_mfma_f32_16x16x32_bf16 a[124:127], a[244:247], v[28:31], a[124:127]
    v_cvt_pk_bf16_f32 v127, v158, v159
    v_mfma_f32_16x16x32_bf16 a[124:127], a[240:243], v[12:15], a[124:127]
    buffer_store_dwordx4 v[188:191], v243, s[24:27], s55 offen offset:128 sc1
    s_barrier
    v_mfma_f32_16x16x32_bf16 v[160:163], v[248:251], v[64:67], 0
    ds_read_b128 a[224:227], v237 offset:0
    v_mfma_f32_16x16x32_bf16 v[160:163], v[248:251], v[80:83], v[160:163]
    ds_read_b128 a[228:231], v237 offset:256
    v_mfma_f32_16x16x32_bf16 v[160:163], v[248:251], v[96:99], v[160:163]
    v_mfma_f32_16x16x32_bf16 v[160:163], v[248:251], v[112:115], v[160:163]
    buffer_store_dwordx4 v[208:211], v243, s[24:27], s55 offen offset:384 sc1
    v_mfma_f32_16x16x32_bf16 v[164:167], v[248:251], v[68:71], 0
    ds_read_b128 a[232:235], v237 offset:512
    v_mfma_f32_16x16x32_bf16 v[164:167], v[248:251], v[84:87], v[164:167]
    ds_read_b128 a[236:239], v237 offset:768
    v_mfma_f32_16x16x32_bf16 v[164:167], v[248:251], v[100:103], v[164:167]
    v_mfma_f32_16x16x32_bf16 v[164:167], v[248:251], v[116:119], v[164:167]
    v_mfma_f32_16x16x32_bf16 v[168:171], v[248:251], v[72:75], 0
    v_mfma_f32_16x16x32_bf16 v[168:171], v[248:251], v[88:91], v[168:171]
    v_mfma_f32_16x16x32_bf16 v[168:171], v[248:251], v[104:107], v[168:171]
    v_mfma_f32_16x16x32_bf16 v[168:171], v[248:251], v[120:123], v[168:171]
    v_mfma_f32_16x16x32_bf16 v[172:175], v[248:251], v[76:79], 0
    v_mfma_f32_16x16x32_bf16 v[172:175], v[248:251], v[92:95], v[172:175]
    v_mfma_f32_16x16x32_bf16 v[172:175], v[248:251], v[108:111], v[172:175]
    v_mfma_f32_16x16x32_bf16 v[172:175], v[248:251], v[124:127], v[172:175]
    s_waitcnt lgkmcnt(0)
    s_add_u32 s34, s34, 1
    s_cmp_eq_u32 s34, s56
    s_cbranch_scc1 L_ph4f
L_ph4s:
    s_cmp_lt_u32 s34, 2
    s_cbranch_scc0 L_nt62
    s_getpc_b64 s[72:73]
L_pc62:
    s_add_u32 s72, s72, L_ph1s-L_pc62
    s_addc_u32 s73, s73, (L_ph1s-L_pc62)>>32
    v_mbcnt_lo_u32_b32 v222, -1, 0
    v_mbcnt_hi_u32_b32 v222, -1, v222
    v_lshrrev_b32 v222, 2, v222
    v_lshl_add_u32 v222, s32, 4, v222
    v_lshlrev_b32 v222, 7, v222
    v_min_u32 v222, L_ph2s-L_ph1s, v222
    v_mov_b32 v223, s73
    v_add_co_u32 v222, vcc, s72, v222
    s_nop 1
    v_addc_co_u32 v223, vcc, 0, v223, vcc
    global_load_dword v254, v[222:223], off
L_nt62:
    v_mfma_f32_16x16x32_bf16 v[128:131], a[224:227], a[128:131], 0
    ds_read_b128 a[240:243], v237 offset:4096
    v_mfma_f32_16x16x32_bf16 v[128:131], a[228:231], a[132:135], v[128:131]
    ds_read_b128 a[244:247], v237 offset:4352
    s_xor_b32 s86, s85, 65536
    v_mfma_f32_16x16x32_bf16 v[128:131], a[232:235], a[136:139], v[128:131]
    s_xor_b32 m0, s35, 65536
    v_mfma_f32_16x16x32_bf16 v[128:131], a[236:239], a[140:143], v[128:131]
    buffer_load_dwordx4 v241, s[20:23], s86 offen nt lds
    v_max3_f32 v220, v160, v164, v168
    v_max_f32 v220, v220, v172
    v_mfma_f32_16x16x32_bf16 v[132:135], a[236:239], a[156:159], 0
    ds_read_b128 a[248:251], v237 offset:4608
    v_mfma_f32_16x16x32_bf16 v[132:135], a[232:235], a[152:155], v[132:135]
    ds_read_b128 a[252:255], v237 offset:4864
    v_mfma_f32_16x16x32_bf16 v[132:135], a[228:231], a[148:151], v[132:135]
    v_cmp_lt_f32 vcc, 0x5f800000, v220
    s_cbranch_vccnz L_chk63_redo
L_chk63:
    v_mfma_f32_16x16x32_bf16 v[132:135], a[224:227], a[144:147], v[132:135]
    v_add_f32 v236, v229, v160
    v_add_f32 v238, v231, v164
    v_add_f32 v240, v233, v168
    v_add_f32 v242, v235, v172
    v_rcp_f32 v236, v236
    v_mfma_f32_16x16x32_bf16 v[136:139], a[224:227], a[192:195], 0
    v_rcp_f32 v238, v238
    v_mfma_f32_16x16x32_bf16 v[136:139], a[228:231], a[196:199], v[136:139]
    s_xor_b32 s86, s85, 66560
    v_rcp_f32 v240, v240
    v_mfma_f32_16x16x32_bf16 v[136:139], a[232:235], a[200:203], v[136:139]
    s_xor_b32 m0, s35, 66560
    v_rcp_f32 v242, v242
    v_mfma_f32_16x16x32_bf16 v[136:139], a[236:239], a[204:207], v[136:139]
    buffer_load_dwordx4 v255, s[20:23], s86 offen nt lds
    v_max_f32 v220, v128, v129
    v_mfma_f32_16x16x32_bf16 v[140:143], a[236:239], a[220:223], 0
    v_mfma_f32_16x16x32_bf16 v[140:143], a[232:235], a[216:219], v[140:143]
    v_max3_f32 v220, v220, v130, v131
    v_max_f32 v221, v132, v133
    v_mfma_f32_16x16x32_bf16 v[140:143], a[228:231], a[212:215], v[140:143]
    v_max3_f32 v221, v221, v134, v135
    v_max_f32 v222, v136, v137
    v_mfma_f32_16x16x32_bf16 v[140:143], a[224:227], a[208:211], v[140:143]
    s_waitcnt lgkmcnt(0)
    v_max3_f32 v222, v222, v138, v139
    v_mfma_f32_16x16x32_bf16 v[144:147], a[240:243], a[128:131], 0
    ds_read_b64_tr_b16 a[224:225], v244 offset:32768
    v_mfma_f32_16x16x32_bf16 v[144:147], a[244:247], a[132:135], v[144:147]
    ds_read_b64_tr_b16 a[226:227], v244 offset:36864
    s_xor_b32 s86, s85, 73728
    v_mfma_f32_16x16x32_bf16 v[144:147], a[248:251], a[136:139], v[144:147]
    ds_read_b64_tr_b16 a[228:229], v244 offset:40960
    s_xor_b32 m0, s35, 69632
    v_mfma_f32_16x16x32_bf16 v[144:147], a[252:255], a[140:143], v[144:147]
    buffer_load_dwordx4 v241, s[20:23], s86 offen nt lds
    v_max_f32 v223, v140, v141
    v_max3_f32 v223, v223, v142, v143
    v_mfma_f32_16x16x32_bf16 v[148:151], a[252:255], a[156:159], 0
    ds_read_b64_tr_b16 a[230:231], v244 offset:45056
    v_mfma_f32_16x16x32_bf16 v[148:151], a[248:251], a[152:155], v[148:151]
    ds_read_b64_tr_b16 a[232:233], v244 offset:49152
    v_mfma_f32_16x16x32_bf16 v[148:151], a[244:247], a[148:151], v[148:151]
    ds_read_b64_tr_b16 a[234:235], v244 offset:53248
    v_mfma_f32_16x16x32_bf16 v[148:151], a[240:243], a[144:147], v[148:151]
    v_permlane32_swap_b32 v220, v221
    v_permlane32_swap_b32 v222, v223
    v_max_f32 v224, v220, v221
    v_max_f32 v226, v222, v223
    v_mov_b32 v225, v224
    v_mfma_f32_16x16x32_bf16 v[152:155], a[240:243], a[192:195], 0
    ds_read_b64_tr_b16 a[236:237], v244 offset:57344
    v_mfma_f32_16x16x32_bf16 v[152:155], a[244:247], a[196:199], v[152:155]
    ds_read_b64_tr_b16 a[238:239], v244 offset:61440
    s_xor_b32 s86, s85, 74752
    v_mfma_f32_16x16x32_bf16 v[152:155], a[248:251], a[200:203], v[152:155]
    s_xor_b32 m0, s35, 70656
    v_mov_b32 v227, v226
    v_mfma_f32_16x16x32_bf16 v[152:155], a[252:255], a[204:207], v[152:155]
    buffer_load_dwordx4 v255, s[20:23], s86 offen nt lds
    v_permlane16_swap_b32 v224, v225
    v_permlane16_swap_b32 v226, v227
    v_max_f32 v224, v224, v225
    v_max_f32 v226, v226, v227
    v_mul_f32 v228, 0xbe0293ee, v224
    v_mul_f32 v232, 0xbe0293ee, v226
    v_mfma_f32_16x16x32_bf16 v[156:159], a[252:255], a[220:223], 0
    v_mul_f32 v230, 0xbe0293ee, v224
    v_mul_f32 v234, 0xbe0293ee, v226
    v_mfma_f32_16x16x32_bf16 v[156:159], a[248:251], a[216:219], v[156:159]
    v_mfma_f32_16x16x32_bf16 v[156:159], a[244:247], a[212:215], v[156:159]
    v_permlane32_swap_b32 v228, v230
    v_mfma_f32_16x16x32_bf16 v[156:159], a[240:243], a[208:211], v[156:159]
    s_waitcnt lgkmcnt(0)
    v_permlane32_swap_b32 v232, v234
    v_fmamk_f32 v128, v128, 0x3e0293ee, v228
    s_xor_b32 s52, s58, s84
    v_fmamk_f32 v129, v129, 0x3e0293ee, v228
    v_mfma_f32_16x16x32_bf16 a[0:3], a[224:227], v[64:67], a[0:3]
    ds_read_b128 a[240:243], v237 offset:8192
    v_mfma_f32_16x16x32_bf16 a[0:3], a[228:231], v[80:83], a[0:3]
    ds_read_b128 a[244:247], v237 offset:8448
    v_mfma_f32_16x16x32_bf16 a[0:3], a[232:235], v[96:99], a[0:3]
    s_xor_b32 s53, s52, 4096
    v_exp_f32 v128, v128
    v_mfma_f32_16x16x32_bf16 a[0:3], a[236:239], v[112:115], a[0:3]
    s_xor_b32 s54, s52, 16384
    v_exp_f32 v129, v129
    v_fmamk_f32 v130, v130, 0x3e0293ee, v228
    s_xor_b32 s55, s52, 20480
    s_mov_b32 s26, 0x8000000
    v_fmamk_f32 v131, v131, 0x3e0293ee, v228
    v_mfma_f32_16x16x32_bf16 a[16:19], a[236:239], v[116:119], a[16:19]
    ds_read_b128 a[248:251], v237 offset:8704
    v_mfma_f32_16x16x32_bf16 a[16:19], a[232:235], v[100:103], a[16:19]
    ds_read_b128 a[252:255], v237 offset:8960
    s_xor_b32 s86, s85, 81920
    v_mfma_f32_16x16x32_bf16 a[16:19], a[228:231], v[84:87], a[16:19]
    s_xor_b32 m0, s35, 73728
    v_exp_f32 v130, v130
    v_mfma_f32_16x16x32_bf16 a[16:19], a[224:227], v[68:71], a[16:19]
    buffer_load_dwordx4 v241, s[20:23], s86 offen nt lds
    v_fmamk_f32 v132, v132, 0x3e0293ee, v230
    v_cvt_pk_bf16_f32 v0, v128, v129
    v_exp_f32 v131, v131
    v_fmamk_f32 v133, v133, 0x3e0293ee, v230
    v_exp_f32 v132, v132
    v_mfma_f32_16x16x32_bf16 a[32:35], a[224:227], v[72:75], a[32:35]
    v_exp_f32 v133, v133
    v_mfma_f32_16x16x32_bf16 a[32:35], a[228:231], v[88:91], a[32:35]
    v_mfma_f32_16x16x32_bf16 a[32:35], a[232:235], v[104:107], a[32:35]
    v_fmamk_f32 v134, v134, 0x3e0293ee, v230
    v_cvt_pk_bf16_f32 v1, v130, v131
    v_mfma_f32_16x16x32_bf16 a[32:35], a[236:239], v[120:123], a[32:35]
    v_exp_f32 v134, v134
    v_fmamk_f32 v135, v135, 0x3e0293ee, v230
    v_fmamk_f32 v136, v136, 0x3e0293ee, v232
    v_mfma_f32_16x16x32_bf16 a[48:51], a[236:239], v[124:127], a[48:51]
    v_exp_f32 v135, v135
    v_mfma_f32_16x16x32_bf16 a[48:51], a[232:235], v[108:111], a[48:51]
    s_xor_b32 s86, s85, 82944
    v_exp_f32 v136, v136
    v_mfma_f32_16x16x32_bf16 a[48:51], a[228:231], v[92:95], a[48:51]
    s_xor_b32 m0, s35, 74752
    v_cvt_pk_bf16_f32 v4, v132, v133
    v_fmamk_f32 v137, v137, 0x3e0293ee, v232
    v_mfma_f32_16x16x32_bf16 a[48:51], a[224:227], v[76:79], a[48:51]
    s_waitcnt lgkmcnt(0)
    buffer_load_dwordx4 v255, s[20:23], s86 offen nt lds
    v_fmamk_f32 v138, v138, 0x3e0293ee, v232
    v_cvt_pk_bf16_f32 v5, v134, v135
    v_mfma_f32_16x16x32_bf16 v[160:163], a[240:243], a[128:131], 0
    ds_read_b64_tr_b16 a[224:225], v245 offset:32768
    v_mfma_f32_16x16x32_bf16 v[160:163], a[244:247], a[132:135], v[160:163]
    ds_read_b64_tr_b16 a[226:227], v245 offset:36864
    v_mfma_f32_16x16x32_bf16 v[160:163], a[248:251], a[136:139], v[160:163]
    ds_read_b64_tr_b16 a[228:229], v245 offset:40960
    v_mfma_f32_16x16x32_bf16 v[160:163], a[252:255], a[140:143], v[160:163]
    v_exp_f32 v137, v137
    v_fmamk_f32 v139, v139, 0x3e0293ee, v232
    v_exp_f32 v138, v138
    v_fmamk_f32 v140, v140, 0x3e0293ee, v234
    v_cvt_pk_bf16_f32 v8, v136, v137
    v_exp_f32 v139, v139
    v_mfma_f32_16x16x32_bf16 v[164:167], a[252:255], a[156:159], 0
    ds_read_b64_tr_b16 a[230:231], v245 offset:45056
    v_mfma_f32_16x16x32_bf16 v[164:167], a[248:251], a[152:155], v[164:167]
    ds_read_b64_tr_b16 a[232:233], v245 offset:49152
    s_xor_b32 s86, s85, 90112
    v_mfma_f32_16x16x32_bf16 v[164:167], a[244:247], a[148:151], v[164:167]
    ds_read_b64_tr_b16 a[234:235], v245 offset:53248
    s_xor_b32 m0, s35, 77824
    v_mfma_f32_16x16x32_bf16 v[164:167], a[240:243], a[144:147], v[164:167]
    buffer_load_dwordx4 v241, s[20:23], s86 offen nt lds
    v_fmamk_f32 v141, v141, 0x3e0293ee, v234
    v_exp_f32 v140, v140
    v_fmamk_f32 v142, v142, 0x3e0293ee, v234
    v_cvt_pk_bf16_f32 v9, v138, v139
    v_exp_f32 v141, v141
    v_fmamk_f32 v143, v143, 0x3e0293ee, v234
    v_mfma_f32_16x16x32_bf16 v[168:171], a[240:243], a[192:195], 0
    ds_read_b64_tr_b16 a[236:237], v245 offset:57344
    v_mfma_f32_16x16x32_bf16 v[168:171], a[244:247], a[196:199], v[168:171]
    ds_read_b64_tr_b16 a[238:239], v245 offset:61440
    v_mfma_f32_16x16x32_bf16 v[168:171], a[248:251], a[200:203], v[168:171]
    v_exp_f32 v142, v142
    v_mfma_f32_16x16x32_bf16 v[168:171], a[252:255], a[204:207], v[168:171]
    v_exp_f32 v143, v143
    v_fmamk_f32 v144, v144, 0x3e0293ee, v228
    v_cvt_pk_bf16_f32 v12, v140, v141
    v_fmamk_f32 v145, v145, 0x3e0293ee, v228
    v_mfma_f32_16x16x32_bf16 v[172:175], a[252:255], a[220:223], 0
    v_mfma_f32_16x16x32_bf16 v[172:175], a[248:251], a[216:219], v[172:175]
    s_xor_b32 s86, s85, 91136
    v_exp_f32 v144, v144
    v_mfma_f32_16x16x32_bf16 v[172:175], a[244:247], a[212:215], v[172:175]
    s_xor_b32 m0, s35, 78848
    v_exp_f32 v145, v145
    v_mfma_f32_16x16x32_bf16 v[172:175], a[240:243], a[208:211], v[172:175]
    s_waitcnt lgkmcnt(0)
    buffer_load_dwordx4 v255, s[20:23], s86 offen nt lds
    v_fmamk_f32 v146, v146, 0x3e0293ee, v228
    v_cvt_pk_bf16_f32 v13, v142, v143
    v_fmamk_f32 v147, v147, 0x3e0293ee, v228
    v_exp_f32 v146, v146
    v_mfma_f32_16x16x32_bf16 a[8:11], a[224:227], v[64:67], a[8:11]
    ds_read_b128 a[240:243], v237 offset:12288
    v_mfma_f32_16x16x32_bf16 a[8:11], a[228:231], v[80:83], a[8:11]
    ds_read_b128 a[244:247], v237 offset:12544
    v_mfma_f32_16x16x32_bf16 a[8:11], a[232:235], v[96:99], a[8:11]
    v_exp_f32 v147, v147
    v_mfma_f32_16x16x32_bf16 a[8:11], a[236:239], v[112:115], a[8:11]
    v_fmamk_f32 v148, v148, 0x3e0293ee, v230
    v_cvt_pk_bf16_f32 v2, v144, v145
    v_fmamk_f32 v149, v149, 0x3e0293ee, v230
    v_exp_f32 v148, v148
    v_fmamk_f32 v150, v150, 0x3e0293ee, v230
    v_mfma_f32_16x16x32_bf16 a[24:27], a[236:239], v[116:119], a[24:27]
    ds_read_b128 a[248:251], v237 offset:12800
    v_mfma_f32_16x16x32_bf16 a[24:27], a[232:235], v[100:103], a[24:27]
    ds_read_b128 a[252:255], v237 offset:13056
    v_mfma_f32_16x16x32_bf16 a[24:27], a[228:231], v[84:87], a[24:27]
    v_exp_f32 v149, v149
    v_mfma_f32_16x16x32_bf16 a[24:27], a[224:227], v[68:71], a[24:27]
    v_exp_f32 v150, v150
    v_cvt_pk_bf16_f32 v3, v146, v147
    v_fmamk_f32 v151, v151, 0x3e0293ee, v230
    v_fmamk_f32 v152, v152, 0x3e0293ee, v232
    v_cvt_pk_bf16_f32 v6, v148, v149
    v_mfma_f32_16x16x32_bf16 a[40:43], a[224:227], v[72:75], a[40:43]
    v_mfma_f32_16x16x32_bf16 a[40:43], a[228:231], v[88:91], a[40:43]
    s_xor_b32 s86, s85, 4096
    v_exp_f32 v151, v151
    v_mfma_f32_16x16x32_bf16 a[40:43], a[232:235], v[104:107], a[40:43]
    s_xor_b32 m0, s35, 32768
    v_exp_f32 v152, v152
    v_mfma_f32_16x16x32_bf16 a[40:43], a[236:239], v[120:123], a[40:43]
    buffer_load_dwordx4 v241, s[16:19], s86 offen nt lds
    v_fmamk_f32 v153, v153, 0x3e0293ee, v232
    v_fmamk_f32 v154, v154, 0x3e0293ee, v232
    v_cvt_pk_bf16_f32 v7, v150, v151
    v_exp_f32 v153, v153
    v_fmamk_f32 v155, v155, 0x3e0293ee, v232
    v_mfma_f32_16x16x32_bf16 a[56:59], a[236:239], v[124:127], a[56:59]
    v_exp_f32 v154, v154
    v_mfma_f32_16x16x32_bf16 a[56:59], a[232:235], v[108:111], a[56:59]
    v_exp_f32 v155, v155
    v_mfma_f32_16x16x32_bf16 a[56:59], a[228:231], v[92:95], a[56:59]
    v_mfma_f32_16x16x32_bf16 a[56:59], a[224:227], v[76:79], a[56:59]
    s_waitcnt lgkmcnt(0)
    v_fmamk_f32 v156, v156, 0x3e0293ee, v234
    v_cvt_pk_bf16_f32 v10, v152, v153
    v_fmamk_f32 v157, v157, 0x3e0293ee, v234
    v_mfma_f32_16x16x32_bf16 v[128:131], a[240:243], a[128:131], 0
    ds_read_b64_tr_b16 a[224:225], v244 offset:33024
    v_mfma_f32_16x16x32_bf16 v[128:131], a[244:247], a[132:135], v[128:131]
    ds_read_b64_tr_b16 a[226:227], v244 offset:37120
    s_xor_b32 s86, s85, 5120
    v_mfma_f32_16x16x32_bf16 v[128:131], a[248:251], a[136:139], v[128:131]
    ds_read_b64_tr_b16 a[228:229], v244 offset:41216
    s_xor_b32 m0, s35, 33792
    v_mfma_f32_16x16x32_bf16 v[128:131], a[252:255], a[140:143], v[128:131]
    buffer_load_dwordx4 v255, s[16:19], s86 offen nt lds
    v_fmamk_f32 v158, v158, 0x3e0293ee, v234
    v_exp_f32 v156, v156
    v_cvt_pk_bf16_f32 v11, v154, v155
    v_exp_f32 v157, v157
    v_fmamk_f32 v159, v159, 0x3e0293ee, v234
    v_mfma_f32_16x16x32_bf16 v[132:135], a[252:255], a[156:159], 0
    ds_read_b64_tr_b16 a[230:231], v244 offset:45312
    v_mfma_f32_16x16x32_bf16 v[132:135], a[248:251], a[152:155], v[132:135]
    ds_read_b64_tr_b16 a[232:233], v244 offset:49408
    v_mfma_f32_16x16x32_bf16 v[132:135], a[244:247], a[148:151], v[132:135]
    ds_read_b64_tr_b16 a[234:235], v244 offset:53504
    v_mfma_f32_16x16x32_bf16 v[132:135], a[240:243], a[144:147], v[132:135]
    v_exp_f32 v158, v158
    v_fmamk_f32 v160, v160, 0x3e0293ee, v228
    v_cvt_pk_bf16_f32 v14, v156, v157
    v_exp_f32 v159, v159
    v_fmamk_f32 v161, v161, 0x3e0293ee, v228
    v_exp_f32 v160, v160
    v_fmamk_f32 v162, v162, 0x3e0293ee, v228
    v_mfma_f32_16x16x32_bf16 v[136:139], a[240:243], a[192:195], 0
    ds_read_b64_tr_b16 a[236:237], v244 offset:57600
    v_mfma_f32_16x16x32_bf16 v[136:139], a[244:247], a[196:199], v[136:139]
    ds_read_b64_tr_b16 a[238:239], v244 offset:61696
    s_xor_b32 s86, s85, 12288
    v_mfma_f32_16x16x32_bf16 v[136:139], a[248:251], a[200:203], v[136:139]
    s_xor_b32 m0, s35, 36864
    v_exp_f32 v161, v161
    v_mfma_f32_16x16x32_bf16 v[136:139], a[252:255], a[204:207], v[136:139]
    buffer_load_dwordx4 v241, s[16:19], s86 offen nt lds
    v_cvt_pk_bf16_f32 v15, v158, v159
    v_fmamk_f32 v163, v163, 0x3e0293ee, v228
    v_exp_f32 v162, v162
    v_fmamk_f32 v164, v164, 0x3e0293ee, v230
    v_mfma_f32_16x16x32_bf16 v[140:143], a[252:255], a[220:223], 0
    v_exp_f32 v163, v163
    v_mfma_f32_16x16x32_bf16 v[140:143], a[248:251], a[216:219], v[140:143]
    v_exp_f32 v164, v164
    v_mfma_f32_16x16x32_bf16 v[140:143], a[244:247], a[212:215], v[140:143]
    v_cvt_pk_bf16_f32 v16, v160, v161
    v_fmamk_f32 v165, v165, 0x3e0293ee, v230
    v_mfma_f32_16x16x32_bf16 v[140:143], a[240:243], a[208:211], v[140:143]
    s_waitcnt lgkmcnt(0)
    v_exp_f32 v165, v165
    v_fmamk_f32 v166, v166, 0x3e0293ee, v230
    v_cvt_pk_bf16_f32 v17, v162, v163
    v_mfma_f32_16x16x32_bf16 a[4:7], a[224:227], v[64:67], a[4:7]
    ds_read_b128 a[240:243], v237 offset:16384
    v_mfma_f32_16x16x32_bf16 a[4:7], a[228:231], v[80:83], a[4:7]
    ds_read_b128 a[244:247], v237 offset:16640
    s_xor_b32 s86, s85, 13312
    v_mfma_f32_16x16x32_bf16 a[4:7], a[232:235], v[96:99], a[4:7]
    s_xor_b32 m0, s35, 37888
    v_exp_f32 v166, v166
    v_mfma_f32_16x16x32_bf16 a[4:7], a[236:239], v[112:115], a[4:7]
    buffer_load_dwordx4 v255, s[16:19], s86 offen nt lds
    v_fmamk_f32 v167, v167, 0x3e0293ee, v230
    v_fmamk_f32 v168, v168, 0x3e0293ee, v232
    v_cvt_pk_bf16_f32 v20, v164, v165
    v_exp_f32 v167, v167
    v_fmamk_f32 v169, v169, 0x3e0293ee, v232
    v_mfma_f32_16x16x32_bf16 a[20:23], a[236:239], v[116:119], a[20:23]
    ds_read_b128 a[248:251], v237 offset:16896
    v_mfma_f32_16x16x32_bf16 a[20:23], a[232:235], v[100:103], a[20:23]
    ds_read_b128 a[252:255], v237 offset:17152
    v_mfma_f32_16x16x32_bf16 a[20:23], a[228:231], v[84:87], a[20:23]
    v_mfma_f32_16x16x32_bf16 a[20:23], a[224:227], v[68:71], a[20:23]
    v_exp_f32 v168, v168
    v_fmamk_f32 v170, v170, 0x3e0293ee, v232
    v_cvt_pk_bf16_f32 v21, v166, v167
    v_exp_f32 v169, v169
    v_fmamk_f32 v171, v171, 0x3e0293ee, v232
    v_mfma_f32_16x16x32_bf16 a[36:39], a[224:227], v[72:75], a[36:39]
    v_exp_f32 v170, v170
    v_mfma_f32_16x16x32_bf16 a[36:39], a[228:231], v[88:91], a[36:39]
    v_exp_f32 v171, v171
    v_mfma_f32_16x16x32_bf16 a[36:39], a[232:235], v[104:107], a[36:39]
    v_fmamk_f32 v172, v172, 0x3e0293ee, v234
    v_cvt_pk_bf16_f32 v24, v168, v169
    v_mfma_f32_16x16x32_bf16 a[36:39], a[236:239], v[120:123], a[36:39]
    v_exp_f32 v172, v172
    v_fmamk_f32 v173, v173, 0x3e0293ee, v234
    v_mfma_f32_16x16x32_bf16 a[52:55], a[236:239], v[124:127], a[52:55]
    v_exp_f32 v173, v173
    v_mfma_f32_16x16x32_bf16 a[52:55], a[232:235], v[108:111], a[52:55]
    s_xor_b32 s86, s85, 20480
    v_mfma_f32_16x16x32_bf16 a[52:55], a[228:231], v[92:95], a[52:55]
    s_xor_b32 m0, s35, 40960
    v_fmamk_f32 v174, v174, 0x3e0293ee, v234
    v_cvt_pk_bf16_f32 v25, v170, v171
    v_mfma_f32_16x16x32_bf16 a[52:55], a[224:227], v[76:79], a[52:55]
    s_waitcnt lgkmcnt(0)
    buffer_load_dwordx4 v241, s[16:19], s86 offen nt lds
    v_fmamk_f32 v175, v175, 0x3e0293ee, v234
    v_exp_f32 v174, v174
    v_fmamk_f32 v128, v128, 0x3e0293ee, v228
    v_mfma_f32_16x16x32_bf16 v[144:147], a[240:243], a[128:131], 0
    ds_read_b64_tr_b16 a[224:225], v245 offset:33024
    v_mfma_f32_16x16x32_bf16 v[144:147], a[244:247], a[132:135], v[144:147]
    ds_read_b64_tr_b16 a[226:227], v245 offset:37120
    v_mfma_f32_16x16x32_bf16 v[144:147], a[248:251], a[136:139], v[144:147]
    ds_read_b64_tr_b16 a[228:229], v245 offset:41216
    v_mfma_f32_16x16x32_bf16 v[144:147], a[252:255], a[140:143], v[144:147]
    v_exp_f32 v175, v175
    v_cvt_pk_bf16_f32 v28, v172, v173
    v_fmamk_f32 v129, v129, 0x3e0293ee, v228
    v_exp_f32 v128, v128
    v_fmamk_f32 v130, v130, 0x3e0293ee, v228
    v_mfma_f32_16x16x32_bf16 v[148:151], a[252:255], a[156:159], 0
    ds_read_b64_tr_b16 a[230:231], v245 offset:45312
    v_mfma_f32_16x16x32_bf16 v[148:151], a[248:251], a[152:155], v[148:151]
    ds_read_b64_tr_b16 a[232:233], v245 offset:49408
    s_xor_b32 s86, s85, 21504
    v_mfma_f32_16x16x32_bf16 v[148:151], a[244:247], a[148:151], v[148:151]
    ds_read_b64_tr_b16 a[234:235], v245 offset:53504
    s_xor_b32 m0, s35, 41984
    v_mfma_f32_16x16x32_bf16 v[148:151], a[240:243], a[144:147], v[148:151]
    buffer_load_dwordx4 v255, s[16:19], s86 offen nt lds
    v_cvt_pk_bf16_f32 v29, v174, v175
    v_exp_f32 v129, v129
    v_fmamk_f32 v131, v131, 0x3e0293ee, v228
    v_exp_f32 v130, v130
    v_fmamk_f32 v132, v132, 0x3e0293ee, v230
    v_cvt_pk_bf16_f32 v18, v128, v129
    v_exp_f32 v131, v131
    v_mfma_f32_16x16x32_bf16 v[152:155], a[240:243], a[192:195], 0
    ds_read_b64_tr_b16 a[236:237], v245 offset:57600
    v_mfma_f32_16x16x32_bf16 v[152:155], a[244:247], a[196:199], v[152:155]
    ds_read_b64_tr_b16 a[238:239], v245 offset:61696
    v_mfma_f32_16x16x32_bf16 v[152:155], a[248:251], a[200:203], v[152:155]
    v_exp_f32 v132, v132
    v_mfma_f32_16x16x32_bf16 v[152:155], a[252:255], a[204:207], v[152:155]
    v_fmamk_f32 v133, v133, 0x3e0293ee, v230
    v_fmamk_f32 v134, v134, 0x3e0293ee, v230
    v_cvt_pk_bf16_f32 v19, v130, v131
    v_exp_f32 v133, v133
    v_fmamk_f32 v135, v135, 0x3e0293ee, v230
    v_mfma_f32_16x16x32_bf16 v[156:159], a[252:255], a[220:223], 0
    v_exp_f32 v134, v134
    v_mfma_f32_16x16x32_bf16 v[156:159], a[248:251], a[216:219], v[156:159]
    s_xor_b32 s86, s85, 28672
    v_exp_f32 v135, v135
    v_mfma_f32_16x16x32_bf16 v[156:159], a[244:247], a[212:215], v[156:159]
    s_xor_b32 m0, s35, 45056
    v_mfma_f32_16x16x32_bf16 v[156:159], a[240:243], a[208:211], v[156:159]
    s_waitcnt lgkmcnt(0)
    buffer_load_dwordx4 v241, s[16:19], s86 offen nt lds
    v_fmamk_f32 v136, v136, 0x3e0293ee, v232
    v_cvt_pk_bf16_f32 v22, v132, v133
    v_fmamk_f32 v137, v137, 0x3e0293ee, v232
    v_mfma_f32_16x16x32_bf16 a[12:15], a[224:227], v[64:67], a[12:15]
    ds_read_b128 a[240:243], v237 offset:20480
    v_mfma_f32_16x16x32_bf16 a[12:15], a[228:231], v[80:83], a[12:15]
    ds_read_b128 a[244:247], v237 offset:20736
    v_mfma_f32_16x16x32_bf16 a[12:15], a[232:235], v[96:99], a[12:15]
    v_exp_f32 v136, v136
    v_mfma_f32_16x16x32_bf16 a[12:15], a[236:239], v[112:115], a[12:15]
    v_exp_f32 v137, v137
    v_fmamk_f32 v138, v138, 0x3e0293ee, v232
    v_cvt_pk_bf16_f32 v23, v134, v135
    v_fmamk_f32 v139, v139, 0x3e0293ee, v232
    v_exp_f32 v138, v138
    v_mfma_f32_16x16x32_bf16 a[28:31], a[236:239], v[116:119], a[28:31]
    ds_read_b128 a[248:251], v237 offset:20992
    v_mfma_f32_16x16x32_bf16 a[28:31], a[232:235], v[100:103], a[28:31]
    ds_read_b128 a[252:255], v237 offset:21248
    v_mfma_f32_16x16x32_bf16 a[28:31], a[228:231], v[84:87], a[28:31]
    v_exp_f32 v139, v139
    v_mfma_f32_16x16x32_bf16 a[28:31], a[224:227], v[68:71], a[28:31]
    v_fmamk_f32 v140, v140, 0x3e0293ee, v234
    v_cvt_pk_bf16_f32 v26, v136, v137
    v_fmamk_f32 v141, v141, 0x3e0293ee, v234
    v_exp_f32 v140, v140
    v_fmamk_f32 v142, v142, 0x3e0293ee, v234
    v_mfma_f32_16x16x32_bf16 a[44:47], a[224:227], v[72:75], a[44:47]
    v_exp_f32 v141, v141
    v_mfma_f32_16x16x32_bf16 a[44:47], a[228:231], v[88:91], a[44:47]
    s_xor_b32 s86, s85, 29696
    v_exp_f32 v142, v142
    v_mfma_f32_16x16x32_bf16 a[44:47], a[232:235], v[104:107], a[44:47]
    s_xor_b32 m0, s35, 46080
    v_cvt_pk_bf16_f32 v27, v138, v139
    v_fmamk_f32 v143, v143, 0x3e0293ee, v234
    v_mfma_f32_16x16x32_bf16 a[44:47], a[236:239], v[120:123], a[44:47]
    buffer_load_dwordx4 v255, s[16:19], s86 offen nt lds
    v_fmamk_f32 v144, v144, 0x3e0293ee, v228
    v_cvt_pk_bf16_f32 v30, v140, v141
    v_mfma_f32_16x16x32_bf16 a[60:63], a[236:239], v[124:127], a[60:63]
    v_mfma_f32_16x16x32_bf16 a[60:63], a[232:235], v[108:111], a[60:63]
    v_exp_f32 v143, v143
    v_mfma_f32_16x16x32_bf16 a[60:63], a[228:231], v[92:95], a[60:63]
    v_exp_f32 v144, v144
    v_mfma_f32_16x16x32_bf16 a[60:63], a[224:227], v[76:79], a[60:63]
    s_waitcnt lgkmcnt(0)
    v_fmamk_f32 v145, v145, 0x3e0293ee, v228
    v_fmamk_f32 v146, v146, 0x3e0293ee, v228
    v_cvt_pk_bf16_f32 v31, v142, v143
    v_exp_f32 v145, v145
    v_mfma_f32_16x16x32_bf16 v[160:163], a[240:243], a[128:131], 0
    ds_read_b64_tr_b16 a[224:225], v244 offset:33280
    v_mfma_f32_16x16x32_bf16 v[160:163], a[244:247], a[132:135], v[160:163]
    ds_read_b64_tr_b16 a[226:227], v244 offset:37376
    v_mfma_f32_16x16x32_bf16 v[160:163], a[248:251], a[136:139], v[160:163]
    ds_read_b64_tr_b16 a[228:229], v244 offset:41472
    s_mov_b32 m0, s42
    v_mfma_f32_16x16x32_bf16 v[160:163], a[252:255], a[140:143], v[160:163]
    buffer_load_dwordx4 v246, s[12:15], s80 offen offset:0 nt lds
    v_fmamk_f32 v147, v147, 0x3e0293ee, v228
    v_exp_f32 v146, v146
    v_fmamk_f32 v148, v148, 0x3e0293ee, v230
    v_cvt_pk_bf16_f32 v32, v144, v145
    v_exp_f32 v147, v147
    v_fmamk_f32 v149, v149, 0x3e0293ee, v230
    v_mfma_f32_16x16x32_bf16 v[164:167], a[252:255], a[156:159], 0
    ds_read_b64_tr_b16 a[230:231], v244 offset:45568
    v_mfma_f32_16x16x32_bf16 v[164:167], a[248:251], a[152:155], v[164:167]
    ds_read_b64_tr_b16 a[232:233], v244 offset:49664
    v_mfma_f32_16x16x32_bf16 v[164:167], a[244:247], a[148:151], v[164:167]
    ds_read_b64_tr_b16 a[234:235], v244 offset:53760
    v_mfma_f32_16x16x32_bf16 v[164:167], a[240:243], a[144:147], v[164:167]
    v_exp_f32 v148, v148
    v_fmamk_f32 v150, v150, 0x3e0293ee, v230
    v_cvt_pk_bf16_f32 v33, v146, v147
    v_exp_f32 v149, v149
    v_fmamk_f32 v151, v151, 0x3e0293ee, v230
    v_accvgpr_read_b32 v212, a0
    v_mfma_f32_16x16x32_bf16 v[168:171], a[240:243], a[192:195], 0
    ds_read_b64_tr_b16 a[236:237], v244 offset:57856
    v_mfma_f32_16x16x32_bf16 v[168:171], a[244:247], a[196:199], v[168:171]
    ds_read_b64_tr_b16 a[238:239], v244 offset:61952
    v_mfma_f32_16x16x32_bf16 v[168:171], a[248:251], a[200:203], v[168:171]
    s_mov_b32 m0, s42
    v_exp_f32 v150, v150
    v_mfma_f32_16x16x32_bf16 v[168:171], a[252:255], a[204:207], v[168:171]
    buffer_load_dwordx4 v247, s[12:15], s80 offen offset:1024 nt lds
    v_accvgpr_read_b32 v213, a1
    v_fmamk_f32 v152, v152, 0x3e0293ee, v232
    v_cvt_pk_bf16_f32 v36, v148, v149
    v_exp_f32 v151, v151
    v_accvgpr_read_b32 v214, a2
    v_fmamk_f32 v153, v153, 0x3e0293ee, v232
    v_mul_f32 v212, v212, v236
    v_accvgpr_read_b32 v215, a3
    v_exp_f32 v152, v152
    v_mfma_f32_16x16x32_bf16 v[172:175], a[252:255], a[220:223], 0
    v_exp_f32 v153, v153
    v_mfma_f32_16x16x32_bf16 v[172:175], a[248:251], a[216:219], v[172:175]
    v_mfma_f32_16x16x32_bf16 v[172:175], a[244:247], a[212:215], v[172:175]
    v_fmamk_f32 v154, v154, 0x3e0293ee, v232
    v_mul_f32 v213, v213, v236
    v_mfma_f32_16x16x32_bf16 v[172:175], a[240:243], a[208:211], v[172:175]
    s_waitcnt lgkmcnt(0)
    v_exp_f32 v154, v154
    v_cvt_pk_bf16_f32 v37, v150, v151
    v_accvgpr_read_b32 v216, a4
    v_fmamk_f32 v155, v155, 0x3e0293ee, v232
    v_mul_f32 v214, v214, v236
    v_accvgpr_read_b32 v217, a5
    v_fmamk_f32 v156, v156, 0x3e0293ee, v234
    v_mul_f32 v215, v215, v236
    v_mfma_f32_16x16x32_bf16 a[64:67], a[224:227], v[64:67], a[64:67]
    ds_read_b128 a[240:243], v237 offset:24576
    v_mfma_f32_16x16x32_bf16 a[64:67], a[228:231], v[80:83], a[64:67]
    ds_read_b128 a[244:247], v237 offset:24832
    v_mfma_f32_16x16x32_bf16 a[64:67], a[232:235], v[96:99], a[64:67]
    s_mov_b32 m0, s42
    v_exp_f32 v155, v155
    v_mfma_f32_16x16x32_bf16 a[64:67], a[236:239], v[112:115], a[64:67]
    buffer_load_dwordx4 v246, s[12:15], s80 offen offset:2048 nt lds
    v_accvgpr_read_b32 v218, a6
    v_cvt_pk_bf16_f32 v40, v152, v153
    v_mul_f32 v216, v216, v236
    v_fmamk_f32 v157, v157, 0x3e0293ee, v234
    v_accvgpr_read_b32 v219, a7
    v_exp_f32 v156, v156
    v_cvt_pk_bf16_f32 v180, v212, v213
    v_mul_f32 v217, v217, v236
    v_fmamk_f32 v158, v158, 0x3e0293ee, v234
    v_accvgpr_read_b32 v220, a8
    v_cvt_pk_bf16_f32 v41, v154, v155
    v_mfma_f32_16x16x32_bf16 a[80:83], a[236:239], v[116:119], a[80:83]
    ds_read_b128 a[248:251], v237 offset:25088
    v_mfma_f32_16x16x32_bf16 a[80:83], a[232:235], v[100:103], a[80:83]
    ds_read_b128 a[252:255], v237 offset:25344
    v_mfma_f32_16x16x32_bf16 a[80:83], a[228:231], v[84:87], a[80:83]
    v_exp_f32 v157, v157
    v_mfma_f32_16x16x32_bf16 a[80:83], a[224:227], v[68:71], a[80:83]
    v_exp_f32 v158, v158
    v_mul_f32 v218, v218, v236
    v_fmamk_f32 v159, v159, 0x3e0293ee, v234
    v_accvgpr_read_b32 v221, a9
    v_cvt_pk_bf16_f32 v181, v214, v215
    v_mul_f32 v219, v219, v236
    v_accvgpr_read_b32 v222, a10
    v_fmamk_f32 v160, v160, 0x3e0293ee, v228
    v_cvt_pk_bf16_f32 v44, v156, v157
    v_mul_f32 v220, v220, v236
    v_exp_f32 v159, v159
    v_accvgpr_read_b32 v223, a11
    v_fmamk_f32 v161, v161, 0x3e0293ee, v228
    v_mfma_f32_16x16x32_bf16 a[96:99], a[224:227], v[72:75], a[96:99]
    v_exp_f32 v160, v160
    v_mfma_f32_16x16x32_bf16 a[96:99], a[228:231], v[88:91], a[96:99]
    v_mfma_f32_16x16x32_bf16 a[96:99], a[232:235], v[104:107], a[96:99]
    v_exp_f32 v161, v161
    v_mfma_f32_16x16x32_bf16 a[96:99], a[236:239], v[120:123], a[96:99]
    v_cvt_pk_bf16_f32 v182, v216, v217
    v_mul_f32 v221, v221, v236
    v_accvgpr_read_b32 v224, a12
    v_fmamk_f32 v162, v162, 0x3e0293ee, v228
    v_mul_f32 v222, v222, v236
    v_cvt_pk_bf16_f32 v45, v158, v159
    v_accvgpr_read_b32 v225, a13
    v_fmamk_f32 v163, v163, 0x3e0293ee, v228
    v_cvt_pk_bf16_f32 v183, v218, v219
    v_mul_f32 v223, v223, v236
    v_mfma_f32_16x16x32_bf16 a[112:115], a[236:239], v[124:127], a[112:115]
    v_exp_f32 v162, v162
    v_mfma_f32_16x16x32_bf16 a[112:115], a[232:235], v[108:111], a[112:115]
    v_exp_f32 v163, v163
    v_mfma_f32_16x16x32_bf16 a[112:115], a[228:231], v[92:95], a[112:115]
    s_mov_b32 m0, s42
    v_accvgpr_read_b32 v226, a14
    v_fmamk_f32 v164, v164, 0x3e0293ee, v230
    v_mfma_f32_16x16x32_bf16 a[112:115], a[224:227], v[76:79], a[112:115]
    s_waitcnt lgkmcnt(0)
    buffer_load_dwordx4 v247, s[12:15], s80 offen offset:3072 nt lds
    v_mul_f32 v224, v224, v236
    v_accvgpr_read_b32 v227, a15
    v_cvt_pk_bf16_f32 v34, v160, v161
    v_cvt_pk_bf16_f32 v196, v220, v221
    v_fmamk_f32 v165, v165, 0x3e0293ee, v230
    v_mul_f32 v225, v225, v236
    v_accvgpr_read_b32 v212, a16
    v_mfma_f32_16x16x32_bf16 v[128:131], a[240:243], a[128:131], 0
    ds_read_b64_tr_b16 a[224:225], v245 offset:33280
    v_mfma_f32_16x16x32_bf16 v[128:131], a[244:247], a[132:135], v[128:131]
    ds_read_b64_tr_b16 a[226:227], v245 offset:37376
    v_mfma_f32_16x16x32_bf16 v[128:131], a[248:251], a[136:139], v[128:131]
    ds_read_b64_tr_b16 a[228:229], v245 offset:41472
    v_mfma_f32_16x16x32_bf16 v[128:131], a[252:255], a[140:143], v[128:131]
    s_mov_b64 vcc, s[74:75]
    v_exp_f32 v164, v164
    v_mul_f32 v226, v226, v236
    v_fmamk_f32 v166, v166, 0x3e0293ee, v230
    v_accvgpr_read_b32 v213, a17
    v_cvt_pk_bf16_f32 v35, v162, v163
    v_cvt_pk_bf16_f32 v197, v222, v223
    v_exp_f32 v165, v165
    v_mul_f32 v227, v227, v236
    v_fmamk_f32 v167, v167, 0x3e0293ee, v230
    v_accvgpr_read_b32 v214, a18
    v_mul_f32 v212, v212, v238
    v_exp_f32 v166, v166
    v_fmamk_f32 v168, v168, 0x3e0293ee, v232
    v_accvgpr_read_b32 v215, a19
    v_mfma_f32_16x16x32_bf16 v[132:135], a[252:255], a[156:159], 0
    ds_read_b64_tr_b16 a[230:231], v245 offset:45568
    v_mfma_f32_16x16x32_bf16 v[132:135], a[248:251], a[152:155], v[132:135]
    ds_read_b64_tr_b16 a[232:233], v245 offset:49664
    v_mfma_f32_16x16x32_bf16 v[132:135], a[244:247], a[148:151], v[132:135]
    ds_read_b64_tr_b16 a[234:235], v245 offset:53760
    s_mov_b32 m0, s43
    v_mfma_f32_16x16x32_bf16 v[132:135], a[240:243], a[144:147], v[132:135]
    buffer_load_dwordx4 v246, s[12:15], s81 offen offset:0 nt lds
    v_cvt_pk_bf16_f32 v38, v164, v165
    v_cvt_pk_bf16_f32 v198, v224, v225
    v_mul_f32 v213, v213, v238
    v_exp_f32 v167, v167
    v_accvgpr_read_b32 v216, a20
    v_fmamk_f32 v169, v169, 0x3e0293ee, v232
    v_mul_f32 v214, v214, v238
    v_exp_f32 v168, v168
    v_accvgpr_read_b32 v217, a21
    v_fmamk_f32 v170, v170, 0x3e0293ee, v232
    v_cvt_pk_bf16_f32 v199, v226, v227
    v_mul_f32 v215, v215, v238
    v_mfma_f32_16x16x32_bf16 v[136:139], a[240:243], a[192:195], 0
    ds_read_b64_tr_b16 a[236:237], v245 offset:57856
    v_mfma_f32_16x16x32_bf16 v[136:139], a[244:247], a[196:199], v[136:139]
    ds_read_b64_tr_b16 a[238:239], v245 offset:61952
    v_mfma_f32_16x16x32_bf16 v[136:139], a[248:251], a[200:203], v[136:139]
    v_exp_f32 v169, v169
    v_mfma_f32_16x16x32_bf16 v[136:139], a[252:255], a[204:207], v[136:139]
    v_exp_f32 v170, v170
    v_cvt_pk_bf16_f32 v39, v166, v167
    v_accvgpr_read_b32 v218, a22
    v_fmamk_f32 v171, v171, 0x3e0293ee, v232
    v_mul_f32 v216, v216, v238
    v_cndmask_b32_dpp v176, v196, v180, vcc quad_perm:[1,0,3,2] row_mask:0xf bank_mask:0xf
    v_accvgpr_read_b32 v219, a23
    v_cndmask_b32_dpp v177, v197, v181, vcc quad_perm:[1,0,3,2] row_mask:0xf bank_mask:0xf
    v_fmamk_f32 v172, v172, 0x3e0293ee, v234
    v_cvt_pk_bf16_f32 v184, v212, v213
    v_mul_f32 v217, v217, v238
    v_cndmask_b32_dpp v178, v198, v182, vcc quad_perm:[1,0,3,2] row_mask:0xf bank_mask:0xf
    v_accvgpr_read_b32 v220, a24
    v_cvt_pk_bf16_f32 v42, v168, v169
    v_cndmask_b32_dpp v179, v199, v183, vcc quad_perm:[1,0,3,2] row_mask:0xf bank_mask:0xf
    v_exp_f32 v171, v171
    v_mfma_f32_16x16x32_bf16 v[140:143], a[252:255], a[220:223], 0
    s_mov_b64 vcc, s[76:77]
    v_mfma_f32_16x16x32_bf16 v[140:143], a[248:251], a[216:219], v[140:143]
    v_exp_f32 v172, v172
    v_mfma_f32_16x16x32_bf16 v[140:143], a[244:247], a[212:215], v[140:143]
    s_mov_b32 m0, s43
    v_fmamk_f32 v173, v173, 0x3e0293ee, v234
    v_mul_f32 v218, v218, v238
    v_mfma_f32_16x16x32_bf16 v[140:143], a[240:243], a[208:211], v[140:143]
    s_waitcnt lgkmcnt(0)
    buffer_load_dwordx4 v247, s[12:15], s81 offen offset:1024 nt lds
    v_cndmask_b32_dpp v196, v180, v196, vcc quad_perm:[1,0,3,2] row_mask:0xf bank_mask:0xf
    v_accvgpr_read_b32 v221, a25
    v_cndmask_b32_dpp v197, v181, v197, vcc quad_perm:[1,0,3,2] row_mask:0xf bank_mask:0xf
    v_cvt_pk_bf16_f32 v185, v214, v215
    v_mul_f32 v219, v219, v238
    v_fmamk_f32 v174, v174, 0x3e0293ee, v234
    v_cndmask_b32_dpp v198, v182, v198, vcc quad_perm:[1,0,3,2] row_mask:0xf bank_mask:0xf
    v_accvgpr_read_b32 v222, a26
    v_cndmask_b32_dpp v199, v183, v199, vcc quad_perm:[1,0,3,2] row_mask:0xf bank_mask:0xf
    v_cvt_pk_bf16_f32 v43, v170, v171
    v_permlane16_swap_b32 v176, v178
    v_exp_f32 v173, v173
    v_mul_f32 v220, v220, v238
    v_fmamk_f32 v175, v175, 0x3e0293ee, v234
    v_mfma_f32_16x16x32_bf16 a[72:75], a[224:227], v[64:67], a[72:75]
    ds_read_b128 a[240:243], v237 offset:28672
    v_mfma_f32_16x16x32_bf16 a[72:75], a[228:231], v[80:83], a[72:75]
    ds_read_b128 a[244:247], v237 offset:28928
    v_mfma_f32_16x16x32_bf16 a[72:75], a[232:235], v[96:99], a[72:75]
    v_permlane16_swap_b32 v177, v179
    v_mfma_f32_16x16x32_bf16 a[72:75], a[236:239], v[112:115], a[72:75]
    buffer_store_dwordx4 v[176:179], v243, s[24:27], s52 offen offset:0 sc1
    v_exp_f32 v174, v174
    v_exp_f32 v175, v175
    v_accvgpr_read_b32 v223, a27
    v_cvt_pk_bf16_f32 v186, v216, v217
    v_mul_f32 v221, v221, v238
    v_fmamk_f32 v128, v128, 0x3e0293ee, v228
    v_accvgpr_read_b32 v224, a28
    v_cvt_pk_bf16_f32 v46, v172, v173
    v_mul_f32 v222, v222, v238
    v_accvgpr_read_b32 v225, a29
    v_fmamk_f32 v129, v129, 0x3e0293ee, v228
    v_permlane16_swap_b32 v196, v198
    v_cvt_pk_bf16_f32 v187, v218, v219
    v_mfma_f32_16x16x32_bf16 a[88:91], a[236:239], v[116:119], a[88:91]
    ds_read_b128 a[248:251], v237 offset:29184
    v_mfma_f32_16x16x32_bf16 a[88:91], a[232:235], v[100:103], a[88:91]
    ds_read_b128 a[252:255], v237 offset:29440
    v_mfma_f32_16x16x32_bf16 a[88:91], a[228:231], v[84:87], a[88:91]
    s_mov_b32 m0, s43
    v_exp_f32 v128, v128
    v_mfma_f32_16x16x32_bf16 a[88:91], a[224:227], v[68:71], a[88:91]
    buffer_load_dwordx4 v246, s[12:15], s81 offen offset:2048 nt lds
    v_mul_f32 v223, v223, v238
    v_accvgpr_read_b32 v226, a30
    v_permlane16_swap_b32 v197, v199
    v_fmamk_f32 v130, v130, 0x3e0293ee, v228
    v_mul_f32 v224, v224, v238
    v_cvt_pk_bf16_f32 v47, v174, v175
    v_accvgpr_read_b32 v227, a31
    v_exp_f32 v129, v129
    v_fmamk_f32 v131, v131, 0x3e0293ee, v228
    v_cvt_pk_bf16_f32 v200, v220, v221
    v_mul_f32 v225, v225, v238
    v_accvgpr_read_b32 v212, a32
    v_exp_f32 v130, v130
    v_mfma_f32_16x16x32_bf16 a[104:107], a[224:227], v[72:75], a[104:107]
    s_mov_b64 vcc, s[74:75]
    v_mfma_f32_16x16x32_bf16 a[104:107], a[228:231], v[88:91], a[104:107]
    v_exp_f32 v131, v131
    v_mfma_f32_16x16x32_bf16 a[104:107], a[232:235], v[104:107], a[104:107]
    v_fmamk_f32 v132, v132, 0x3e0293ee, v230
    v_mul_f32 v226, v226, v238
    v_mfma_f32_16x16x32_bf16 a[104:107], a[236:239], v[120:123], a[104:107]
    buffer_store_dwordx4 v[196:199], v243, s[24:27], s52 offen offset:256 sc1
    v_exp_f32 v132, v132
    v_cvt_pk_bf16_f32 v48, v128, v129
    v_accvgpr_read_b32 v213, a33
    v_fmamk_f32 v133, v133, 0x3e0293ee, v230
    v_cvt_pk_bf16_f32 v201, v222, v223
    v_mul_f32 v227, v227, v238
    v_accvgpr_read_b32 v214, a34
    v_mul_f32 v212, v212, v240
    v_fmamk_f32 v134, v134, 0x3e0293ee, v230
    v_mfma_f32_16x16x32_bf16 a[120:123], a[236:239], v[124:127], a[120:123]
    v_exp_f32 v133, v133
    v_mfma_f32_16x16x32_bf16 a[120:123], a[232:235], v[108:111], a[120:123]
    v_exp_f32 v134, v134
    v_mfma_f32_16x16x32_bf16 a[120:123], a[228:231], v[92:95], a[120:123]
    v_mfma_f32_16x16x32_bf16 a[120:123], a[224:227], v[76:79], a[120:123]
    s_waitcnt lgkmcnt(0)
    v_accvgpr_read_b32 v215, a35
    v_cvt_pk_bf16_f32 v49, v130, v131
    v_cvt_pk_bf16_f32 v202, v224, v225
    v_mul_f32 v213, v213, v240
    v_fmamk_f32 v135, v135, 0x3e0293ee, v230
    v_accvgpr_read_b32 v216, a36
    v_mul_f32 v214, v214, v240
    v_fmamk_f32 v136, v136, 0x3e0293ee, v232
    v_accvgpr_read_b32 v217, a37
    v_mfma_f32_16x16x32_bf16 v[144:147], a[240:243], a[128:131], 0
    ds_read_b64_tr_b16 a[224:225], v244 offset:33536
    v_mfma_f32_16x16x32_bf16 v[144:147], a[244:247], a[132:135], v[144:147]
    ds_read_b64_tr_b16 a[226:227], v244 offset:37632
    v_mfma_f32_16x16x32_bf16 v[144:147], a[248:251], a[136:139], v[144:147]
    ds_read_b64_tr_b16 a[228:229], v244 offset:41728
    s_mov_b32 m0, s43
    v_mfma_f32_16x16x32_bf16 v[144:147], a[252:255], a[140:143], v[144:147]
    buffer_load_dwordx4 v247, s[12:15], s81 offen offset:3072 nt lds
    v_cvt_pk_bf16_f32 v52, v132, v133
    v_cvt_pk_bf16_f32 v203, v226, v227
    v_mul_f32 v215, v215, v240
    v_exp_f32 v135, v135
    v_accvgpr_read_b32 v218, a38
    v_fmamk_f32 v137, v137, 0x3e0293ee, v232
    v_mul_f32 v216, v216, v240
    v_exp_f32 v136, v136
    v_cndmask_b32_dpp v180, v200, v184, vcc quad_perm:[1,0,3,2] row_mask:0xf bank_mask:0xf
    v_accvgpr_read_b32 v219, a39
    v_fmamk_f32 v138, v138, 0x3e0293ee, v232
    v_cndmask_b32_dpp v181, v201, v185, vcc quad_perm:[1,0,3,2] row_mask:0xf bank_mask:0xf
    v_cvt_pk_bf16_f32 v188, v212, v213
    v_mul_f32 v217, v217, v240
    v_cvt_pk_bf16_f32 v53, v134, v135
    v_cndmask_b32_dpp v182, v202, v186, vcc quad_perm:[1,0,3,2] row_mask:0xf bank_mask:0xf
    v_exp_f32 v137, v137
    v_accvgpr_read_b32 v220, a40
    v_mfma_f32_16x16x32_bf16 v[148:151], a[252:255], a[156:159], 0
    ds_read_b64_tr_b16 a[230:231], v244 offset:45824
    v_mfma_f32_16x16x32_bf16 v[148:151], a[248:251], a[152:155], v[148:151]
    ds_read_b64_tr_b16 a[232:233], v244 offset:49920
    v_mfma_f32_16x16x32_bf16 v[148:151], a[244:247], a[148:151], v[148:151]
    ds_read_b64_tr_b16 a[234:235], v244 offset:54016
    v_mfma_f32_16x16x32_bf16 v[148:151], a[240:243], a[144:147], v[148:151]
    v_exp_f32 v138, v138
    v_cndmask_b32_dpp v183, v203, v187, vcc quad_perm:[1,0,3,2] row_mask:0xf bank_mask:0xf
    v_fmamk_f32 v139, v139, 0x3e0293ee, v232
    s_mov_b64 vcc, s[76:77]
    v_mul_f32 v218, v218, v240
    v_cndmask_b32_dpp v200, v184, v200, vcc quad_perm:[1,0,3,2] row_mask:0xf bank_mask:0xf
    v_accvgpr_read_b32 v221, a41
    v_cndmask_b32_dpp v201, v185, v201, vcc quad_perm:[1,0,3,2] row_mask:0xf bank_mask:0xf
    v_fmamk_f32 v140, v140, 0x3e0293ee, v234
    v_cvt_pk_bf16_f32 v189, v214, v215
    v_mul_f32 v219, v219, v240
    v_cndmask_b32_dpp v202, v186, v202, vcc quad_perm:[1,0,3,2] row_mask:0xf bank_mask:0xf
    v_cvt_pk_bf16_f32 v56, v136, v137
    v_accvgpr_read_b32 v222, a42
    v_cndmask_b32_dpp v203, v187, v203, vcc quad_perm:[1,0,3,2] row_mask:0xf bank_mask:0xf
    v_exp_f32 v139, v139
    v_fmamk_f32 v141, v141, 0x3e0293ee, v234
    v_permlane16_swap_b32 v180, v182
    v_mul_f32 v220, v220, v240
    v_mfma_f32_16x16x32_bf16 v[152:155], a[240:243], a[192:195], 0
    ds_read_b64_tr_b16 a[236:237], v244 offset:58112
    v_mfma_f32_16x16x32_bf16 v[152:155], a[244:247], a[196:199], v[152:155]
    ds_read_b64_tr_b16 a[238:239], v244 offset:62208
    v_mfma_f32_16x16x32_bf16 v[152:155], a[248:251], a[200:203], v[152:155]
    s_cmp_eq_u32 s34, 5
    v_permlane16_swap_b32 v181, v183
    v_mfma_f32_16x16x32_bf16 v[152:155], a[252:255], a[204:207], v[152:155]
    s_cselect_b32 s41, 0, 16777216
    buffer_store_dwordx4 v[180:183], v243, s[24:27], s53 offen offset:0 sc1
    v_exp_f32 v140, v140
    v_exp_f32 v141, v141
    v_accvgpr_read_b32 v223, a43
    v_cvt_pk_bf16_f32 v190, v216, v217
    v_fmamk_f32 v142, v142, 0x3e0293ee, v234
    v_mul_f32 v221, v221, v240
    v_accvgpr_read_b32 v224, a44
    v_cvt_pk_bf16_f32 v57, v138, v139
    v_mul_f32 v222, v222, v240
    v_fmamk_f32 v143, v143, 0x3e0293ee, v234
    v_accvgpr_read_b32 v225, a45
    v_permlane16_swap_b32 v200, v202
    v_mfma_f32_16x16x32_bf16 v[156:159], a[252:255], a[220:223], 0
    s_add_u32 s59, s59, s41
    v_exp_f32 v142, v142
    v_mfma_f32_16x16x32_bf16 v[156:159], a[248:251], a[216:219], v[156:159]
    s_cmp_eq_u32 s34, 5
    v_permlane16_swap_b32 v201, v203
    v_mfma_f32_16x16x32_bf16 v[156:159], a[244:247], a[212:215], v[156:159]
    s_cselect_b32 s41, s66, s59
    v_exp_f32 v143, v143
    v_mfma_f32_16x16x32_bf16 v[156:159], a[240:243], a[208:211], v[156:159]
    s_waitcnt lgkmcnt(0)
    buffer_store_dwordx4 v[200:203], v243, s[24:27], s53 offen offset:256 sc1
    v_cvt_pk_bf16_f32 v191, v218, v219
    v_mul_f32 v223, v223, v240
    v_fmamk_f32 v144, v144, 0x3e0293ee, v228
    v_accvgpr_read_b32 v226, a46
    v_cvt_pk_bf16_f32 v60, v140, v141
    v_mul_f32 v224, v224, v240
    v_fmamk_f32 v145, v145, 0x3e0293ee, v228
    v_accvgpr_read_b32 v227, a47
    v_cvt_pk_bf16_f32 v204, v220, v221
    v_mul_f32 v225, v225, v240
    v_exp_f32 v144, v144
    v_mfma_f32_16x16x32_bf16 a[68:71], a[224:227], v[64:67], a[68:71]
    ds_read_b64_tr_b16 a[240:241], v245 offset:33536
    v_mfma_f32_16x16x32_bf16 a[68:71], a[228:231], v[80:83], a[68:71]
    ds_read_b64_tr_b16 a[242:243], v245 offset:37632
    v_mfma_f32_16x16x32_bf16 a[68:71], a[232:235], v[96:99], a[68:71]
    ds_read_b64_tr_b16 a[244:245], v245 offset:41728
    v_mfma_f32_16x16x32_bf16 a[68:71], a[236:239], v[112:115], a[68:71]
    s_mov_b64 vcc, s[74:75]
    v_exp_f32 v145, v145
    v_accvgpr_read_b32 v212, a48
    v_fmamk_f32 v146, v146, 0x3e0293ee, v228
    v_mul_f32 v226, v226, v240
    v_cvt_pk_bf16_f32 v61, v142, v143
    v_accvgpr_read_b32 v213, a49
    v_fmamk_f32 v147, v147, 0x3e0293ee, v228
    v_cvt_pk_bf16_f32 v205, v222, v223
    v_mul_f32 v227, v227, v240
    v_accvgpr_read_b32 v214, a50
    v_exp_f32 v146, v146
    v_fmamk_f32 v148, v148, 0x3e0293ee, v230
    v_mfma_f32_16x16x32_bf16 a[84:87], a[236:239], v[116:119], a[84:87]
    ds_read_b64_tr_b16 a[246:247], v245 offset:45824
    v_mfma_f32_16x16x32_bf16 a[84:87], a[232:235], v[100:103], a[84:87]
    ds_read_b64_tr_b16 a[248:249], v245 offset:49920
    v_mfma_f32_16x16x32_bf16 a[84:87], a[228:231], v[84:87], a[84:87]
    ds_read_b64_tr_b16 a[250:251], v245 offset:54016
    v_mfma_f32_16x16x32_bf16 a[84:87], a[224:227], v[68:71], a[84:87]
    v_exp_f32 v147, v147
    v_mul_f32 v212, v212, v242
    v_cvt_pk_bf16_f32 v50, v144, v145
    v_accvgpr_read_b32 v215, a51
    v_fmamk_f32 v149, v149, 0x3e0293ee, v230
    v_cvt_pk_bf16_f32 v206, v224, v225
    v_mul_f32 v213, v213, v242
    v_accvgpr_read_b32 v216, a52
    v_exp_f32 v148, v148
    v_fmamk_f32 v150, v150, 0x3e0293ee, v230
    v_mul_f32 v214, v214, v242
    v_accvgpr_read_b32 v217, a53
    v_cvt_pk_bf16_f32 v51, v146, v147
    v_mfma_f32_16x16x32_bf16 a[100:103], a[224:227], v[72:75], a[100:103]
    ds_read_b64_tr_b16 a[252:253], v245 offset:58112
    v_mfma_f32_16x16x32_bf16 a[100:103], a[228:231], v[88:91], a[100:103]
    ds_read_b64_tr_b16 a[254:255], v245 offset:62208
    v_mfma_f32_16x16x32_bf16 a[100:103], a[232:235], v[104:107], a[100:103]
    s_add_u32 s16, s62, s41
    v_exp_f32 v149, v149
    v_mfma_f32_16x16x32_bf16 a[100:103], a[236:239], v[120:123], a[100:103]
    s_addc_u32 s17, s63, 0
    v_exp_f32 v150, v150
    v_cvt_pk_bf16_f32 v207, v226, v227
    v_mul_f32 v215, v215, v242
    v_fmamk_f32 v151, v151, 0x3e0293ee, v230
    v_accvgpr_read_b32 v218, a54
    v_mul_f32 v216, v216, v242
    v_fmamk_f32 v152, v152, 0x3e0293ee, v232
    v_cndmask_b32_dpp v184, v204, v188, vcc quad_perm:[1,0,3,2] row_mask:0xf bank_mask:0xf
    v_accvgpr_read_b32 v219, a55
    v_cndmask_b32_dpp v185, v205, v189, vcc quad_perm:[1,0,3,2] row_mask:0xf bank_mask:0xf
    v_cvt_pk_bf16_f32 v54, v148, v149
    v_cvt_pk_bf16_f32 v192, v212, v213
    v_mul_f32 v217, v217, v242
    v_exp_f32 v151, v151
    v_cndmask_b32_dpp v186, v206, v190, vcc quad_perm:[1,0,3,2] row_mask:0xf bank_mask:0xf
    v_mfma_f32_16x16x32_bf16 a[116:119], a[236:239], v[124:127], a[116:119]
    v_mfma_f32_16x16x32_bf16 a[116:119], a[232:235], v[108:111], a[116:119]
    v_exp_f32 v152, v152
    v_mfma_f32_16x16x32_bf16 a[116:119], a[228:231], v[92:95], a[116:119]
    v_fmamk_f32 v153, v153, 0x3e0293ee, v232
    v_accvgpr_read_b32 v220, a56
    v_mfma_f32_16x16x32_bf16 a[116:119], a[224:227], v[76:79], a[116:119]
    s_waitcnt lgkmcnt(0)
    v_exp_f32 v153, v153
    v_cndmask_b32_dpp v187, v207, v191, vcc quad_perm:[1,0,3,2] row_mask:0xf bank_mask:0xf
    s_mov_b64 vcc, s[76:77]
    v_mul_f32 v218, v218, v242
    v_cndmask_b32_dpp v204, v188, v204, vcc quad_perm:[1,0,3,2] row_mask:0xf bank_mask:0xf
    v_accvgpr_read_b32 v221, a57
    v_fmamk_f32 v154, v154, 0x3e0293ee, v232
    v_cndmask_b32_dpp v205, v189, v205, vcc quad_perm:[1,0,3,2] row_mask:0xf bank_mask:0xf
    v_cvt_pk_bf16_f32 v193, v214, v215
    v_cvt_pk_bf16_f32 v55, v150, v151
    v_mul_f32 v219, v219, v242
    v_cndmask_b32_dpp v206, v190, v206, vcc quad_perm:[1,0,3,2] row_mask:0xf bank_mask:0xf
    v_accvgpr_read_b32 v222, a58
    v_cndmask_b32_dpp v207, v191, v207, vcc quad_perm:[1,0,3,2] row_mask:0xf bank_mask:0xf
    v_fmamk_f32 v155, v155, 0x3e0293ee, v232
    v_mfma_f32_16x16x32_bf16 a[76:79], a[240:243], v[64:67], a[76:79]
    v_permlane16_swap_b32 v184, v186
    v_mfma_f32_16x16x32_bf16 a[76:79], a[244:247], v[80:83], a[76:79]
    v_exp_f32 v154, v154
    v_mfma_f32_16x16x32_bf16 a[76:79], a[248:251], v[96:99], a[76:79]
    v_mfma_f32_16x16x32_bf16 a[76:79], a[252:255], v[112:115], a[76:79]
    v_permlane16_swap_b32 v185, v187
    v_mul_f32 v220, v220, v242
    v_accvgpr_read_b32 v223, a59
    v_fmamk_f32 v156, v156, 0x3e0293ee, v234
    v_cvt_pk_bf16_f32 v194, v216, v217
    v_mul_f32 v221, v221, v242
    v_cvt_pk_bf16_f32 v58, v152, v153
    v_accvgpr_read_b32 v224, a60
    v_exp_f32 v155, v155
    v_fmamk_f32 v157, v157, 0x3e0293ee, v234
    v_mul_f32 v222, v222, v242
    v_accvgpr_read_b32 v225, a61
    v_mfma_f32_16x16x32_bf16 a[92:95], a[252:255], v[116:119], a[92:95]
    v_exp_f32 v156, v156
    v_mfma_f32_16x16x32_bf16 a[92:95], a[248:251], v[100:103], a[92:95]
    v_permlane16_swap_b32 v204, v206
    v_mfma_f32_16x16x32_bf16 a[92:95], a[244:247], v[84:87], a[92:95]
    v_permlane16_swap_b32 v205, v207
    v_mfma_f32_16x16x32_bf16 a[92:95], a[240:243], v[68:71], a[92:95]
    buffer_store_dwordx4 v[184:187], v243, s[24:27], s54 offen offset:0 sc1
    v_exp_f32 v157, v157
    v_fmamk_f32 v158, v158, 0x3e0293ee, v234
    v_cvt_pk_bf16_f32 v195, v218, v219
    v_mul_f32 v223, v223, v242
    v_accvgpr_read_b32 v226, a62
    v_cvt_pk_bf16_f32 v59, v154, v155
    v_fmamk_f32 v159, v159, 0x3e0293ee, v234
    v_mul_f32 v224, v224, v242
    v_accvgpr_read_b32 v227, a63
    v_exp_f32 v158, v158
    v_cvt_pk_bf16_f32 v208, v220, v221
    v_mul_f32 v225, v225, v242
    v_mfma_f32_16x16x32_bf16 a[108:111], a[240:243], v[72:75], a[108:111]
    s_mov_b64 vcc, s[74:75]
    v_exp_f32 v159, v159
    v_mfma_f32_16x16x32_bf16 a[108:111], a[244:247], v[88:91], a[108:111]
    v_mfma_f32_16x16x32_bf16 a[108:111], a[248:251], v[104:107], a[108:111]
    v_cvt_pk_bf16_f32 v62, v156, v157
    v_mul_f32 v226, v226, v242
    v_mfma_f32_16x16x32_bf16 a[108:111], a[252:255], v[120:123], a[108:111]
    buffer_store_dwordx4 v[204:207], v243, s[24:27], s54 offen offset:256 sc1
    v_cvt_pk_bf16_f32 v209, v222, v223
    v_mul_f32 v227, v227, v242
    v_cvt_pk_bf16_f32 v63, v158, v159
    v_cvt_pk_bf16_f32 v210, v224, v225
    v_mfma_f32_16x16x32_bf16 a[124:127], a[252:255], v[124:127], a[124:127]
    v_cvt_pk_bf16_f32 v211, v226, v227
    v_mfma_f32_16x16x32_bf16 a[124:127], a[248:251], v[108:111], a[124:127]
    v_mfma_f32_16x16x32_bf16 a[124:127], a[244:247], v[92:95], a[124:127]
    v_cndmask_b32_dpp v188, v208, v192, vcc quad_perm:[1,0,3,2] row_mask:0xf bank_mask:0xf
    v_cndmask_b32_dpp v189, v209, v193, vcc quad_perm:[1,0,3,2] row_mask:0xf bank_mask:0xf
    v_mfma_f32_16x16x32_bf16 a[124:127], a[240:243], v[76:79], a[124:127]
    v_cndmask_b32_dpp v190, v210, v194, vcc quad_perm:[1,0,3,2] row_mask:0xf bank_mask:0xf
    v_cndmask_b32_dpp v191, v211, v195, vcc quad_perm:[1,0,3,2] row_mask:0xf bank_mask:0xf
    s_waitcnt vmcnt(14)
    s_barrier
    v_mfma_f32_16x16x32_bf16 v[160:163], v[248:251], v[0:3], 0
    ds_read_b128 a[224:227], v237 offset:32768
    v_mfma_f32_16x16x32_bf16 v[160:163], v[248:251], v[16:19], v[160:163]
    ds_read_b128 a[228:231], v237 offset:33024
    v_mfma_f32_16x16x32_bf16 v[160:163], v[248:251], v[32:35], v[160:163]
    s_mov_b64 vcc, s[76:77]
    v_cndmask_b32_dpp v208, v192, v208, vcc quad_perm:[1,0,3,2] row_mask:0xf bank_mask:0xf
    v_cndmask_b32_dpp v209, v193, v209, vcc quad_perm:[1,0,3,2] row_mask:0xf bank_mask:0xf
    v_mfma_f32_16x16x32_bf16 v[160:163], v[248:251], v[48:51], v[160:163]
    v_cndmask_b32_dpp v210, v194, v210, vcc quad_perm:[1,0,3,2] row_mask:0xf bank_mask:0xf
    v_cndmask_b32_dpp v211, v195, v211, vcc quad_perm:[1,0,3,2] row_mask:0xf bank_mask:0xf
    v_mfma_f32_16x16x32_bf16 v[164:167], v[248:251], v[4:7], 0
    ds_read_b128 a[232:235], v237 offset:33280
    v_mfma_f32_16x16x32_bf16 v[164:167], v[248:251], v[20:23], v[164:167]
    ds_read_b128 a[236:239], v237 offset:33536
    v_mfma_f32_16x16x32_bf16 v[164:167], v[248:251], v[36:39], v[164:167]
    v_mfma_f32_16x16x32_bf16 v[164:167], v[248:251], v[52:55], v[164:167]
    v_permlane16_swap_b32 v188, v190
    v_permlane16_swap_b32 v189, v191
    v_permlane16_swap_b32 v208, v210
    v_permlane16_swap_b32 v209, v211
    v_mfma_f32_16x16x32_bf16 v[168:171], v[248:251], v[8:11], 0
    v_mfma_f32_16x16x32_bf16 v[168:171], v[248:251], v[24:27], v[168:171]
    v_mfma_f32_16x16x32_bf16 v[168:171], v[248:251], v[40:43], v[168:171]
    v_mfma_f32_16x16x32_bf16 v[168:171], v[248:251], v[56:59], v[168:171]
    buffer_store_dwordx4 v[188:191], v243, s[24:27], s55 offen offset:0 sc1
    v_mfma_f32_16x16x32_bf16 v[172:175], v[248:251], v[12:15], 0
    v_mfma_f32_16x16x32_bf16 v[172:175], v[248:251], v[28:31], v[172:175]
    v_mfma_f32_16x16x32_bf16 v[172:175], v[248:251], v[44:47], v[172:175]
    v_mfma_f32_16x16x32_bf16 v[172:175], v[248:251], v[60:63], v[172:175]
    s_waitcnt lgkmcnt(0)
    buffer_store_dwordx4 v[208:211], v243, s[24:27], s55 offen offset:256 sc1
    s_branch L_ph1s
L_ph5s:
L_ph1f:
    s_cmp_eq_u32 s34, 7
    s_cbranch_scc0 L_nt64
    s_getpc_b64 s[72:73]
L_pc64:
    s_add_u32 s72, s72, L_last-L_pc64
    s_addc_u32 s73, s73, (L_last-L_pc64)>>32
    v_mbcnt_lo_u32_b32 v222, -1, 0
    v_mbcnt_hi_u32_b32 v222, -1, v222
    v_lshrrev_b32 v222, 2, v222
    v_lshl_add_u32 v222, s32, 4, v222
    v_lshlrev_b32 v222, 7, v222
    v_min_u32 v222, L_end-L_last, v222
    v_mov_b32 v223, s73
    v_add_co_u32 v222, vcc, s72, v222
    s_nop 1
    v_addc_co_u32 v223, vcc, 0, v223, vcc
    global_load_dword v254, v[222:223], off
L_nt64:
    s_cmp_lt_u32 s34, s38
    s_cbranch_scc0 L_nt65
    s_getpc_b64 s[72:73]
L_pc65:
    s_add_u32 s72, s72, L_ph2f-L_pc65
    s_addc_u32 s73, s73, (L_ph2f-L_pc65)>>32
    v_mbcnt_lo_u32_b32 v222, -1, 0
    v_mbcnt_hi_u32_b32 v222, -1, v222
    v_lshrrev_b32 v222, 2, v222
    v_lshl_add_u32 v222, s32, 4, v222
    v_lshlrev_b32 v222, 7, v222
    v_min_u32 v222, L_ph3f-L_ph2f, v222
    v_mov_b32 v223, s73
    v_add_co_u32 v222, vcc, s72, v222
    s_nop 1
    v_addc_co_u32 v223, vcc, 0, v223, vcc
    global_load_dword v254, v[222:223], off
L_nt65:
    v_mfma_f32_16x16x32_bf16 v[128:131], a[224:227], a[128:131], 0
    ds_read_b128 a[240:243], v237 offset:36864
    v_mfma_f32_16x16x32_bf16 v[128:131], a[228:231], a[132:135], v[128:131]
    ds_read_b128 a[244:247], v237 offset:37120
    s_xor_b32 s86, s85, 69632
    v_mfma_f32_16x16x32_bf16 v[128:131], a[232:235], a[136:139], v[128:131]
    s_xor_b32 m0, s35, 98304
    v_mfma_f32_16x16x32_bf16 v[128:131], a[236:239], a[140:143], v[128:131]
    s_cmp_eq_u32 s34, 7
    s_cbranch_scc1 L_sh67
    buffer_load_dwordx4 v241, s[20:23], s86 offen nt lds
L_shr67:
    v_max3_f32 v220, v160, v164, v168
    v_mfma_f32_16x16x32_bf16 v[132:135], a[236:239], a[156:159], 0
    ds_read_b128 a[248:251], v237 offset:37376
    v_max_f32 v220, v220, v172
    v_mfma_f32_16x16x32_bf16 v[132:135], a[232:235], a[152:155], v[132:135]
    ds_read_b128 a[252:255], v237 offset:37632
    v_cmp_lt_f32 vcc, 0x5f800000, v220
    v_mfma_f32_16x16x32_bf16 v[132:135], a[228:231], a[148:151], v[132:135]
    s_cbranch_vccnz L_chk66_redo
L_chk66:
    v_mov_b32 v229, v160
    v_mfma_f32_16x16x32_bf16 v[132:135], a[224:227], a[144:147], v[132:135]
    v_mov_b32 v231, v164
    v_mov_b32 v233, v168
    v_mov_b32 v235, v172
    v_accvgpr_read_b32 v212, a64
    v_accvgpr_read_b32 v213, a65
    v_pk_fma_f32 v[128:129], v[128:129], s[88:89], v[228:229] op_sel_hi:[1,1,0]
    v_pk_fma_f32 v[130:131], v[130:131], s[88:89], v[228:229] op_sel_hi:[1,1,0]
    v_mfma_f32_16x16x32_bf16 v[136:139], a[224:227], a[192:195], 0
    v_exp_f32 v128, v128
    v_mfma_f32_16x16x32_bf16 v[136:139], a[228:231], a[196:199], v[136:139]
    s_xor_b32 s86, s85, 70656
    v_exp_f32 v129, v129
    v_mfma_f32_16x16x32_bf16 v[136:139], a[232:235], a[200:203], v[136:139]
    s_xor_b32 m0, s35, 99328
    v_exp_f32 v130, v130
    v_mfma_f32_16x16x32_bf16 v[136:139], a[236:239], a[204:207], v[136:139]
    s_cmp_eq_u32 s34, 7
    s_cbranch_scc1 L_sh68
    buffer_load_dwordx4 v255, s[20:23], s86 offen nt lds
L_shr68:
    v_cvt_pk_bf16_f32 v64, v128, v129
    v_mfma_f32_16x16x32_bf16 v[140:143], a[236:239], a[220:223], 0
    v_exp_f32 v131, v131
    v_mfma_f32_16x16x32_bf16 v[140:143], a[232:235], a[216:219], v[140:143]
    v_accvgpr_read_b32 v214, a66
    v_accvgpr_read_b32 v215, a67
    v_mfma_f32_16x16x32_bf16 v[140:143], a[228:231], a[212:215], v[140:143]
    v_cvt_pk_bf16_f32 v65, v130, v131
    v_accvgpr_read_b32 v216, a68
    v_mfma_f32_16x16x32_bf16 v[140:143], a[224:227], a[208:211], v[140:143]
    s_waitcnt lgkmcnt(0)
    v_accvgpr_read_b32 v217, a69
    v_accvgpr_read_b32 v218, a70
    v_fmamk_f32 v132, v132, 0x3e0293ee, v230
    v_mfma_f32_16x16x32_bf16 v[144:147], a[240:243], a[128:131], 0
    ds_read_b64_tr_b16 a[224:225], v244 offset:0
    v_fmamk_f32 v133, v133, 0x3e0293ee, v230
    v_mfma_f32_16x16x32_bf16 v[144:147], a[244:247], a[132:135], v[144:147]
    ds_read_b64_tr_b16 a[226:227], v244 offset:4096
    v_accvgpr_read_b32 v219, a71
    v_mfma_f32_16x16x32_bf16 v[144:147], a[248:251], a[136:139], v[144:147]
    ds_read_b64_tr_b16 a[228:229], v244 offset:8192
    v_accvgpr_read_b32 v220, a72
    v_mfma_f32_16x16x32_bf16 v[144:147], a[252:255], a[140:143], v[144:147]
    v_exp_f32 v132, v132
    v_exp_f32 v133, v133
    v_mul_f32 v212, v212, v236
    v_pk_fma_f32 v[134:135], v[134:135], s[88:89], v[230:231] op_sel_hi:[1,1,0]
    v_pk_fma_f32 v[136:137], v[136:137], s[88:89], v[232:233] op_sel_hi:[1,1,0]
    v_mul_f32 v213, v213, v236
    v_pk_mul_f32 v[214:215], v[214:215], v[236:237] op_sel_hi:[1,0]
    v_pk_mul_f32 v[216:217], v[216:217], v[236:237] op_sel_hi:[1,0]
    v_mfma_f32_16x16x32_bf16 v[148:151], a[252:255], a[156:159], 0
    ds_read_b64_tr_b16 a[230:231], v244 offset:12288
    v_cvt_pk_bf16_f32 v68, v132, v133
    v_mfma_f32_16x16x32_bf16 v[148:151], a[248:251], a[152:155], v[148:151]
    ds_read_b64_tr_b16 a[232:233], v244 offset:16384
    s_xor_b32 s86, s85, 77824
    v_mfma_f32_16x16x32_bf16 v[148:151], a[244:247], a[148:151], v[148:151]
    ds_read_b64_tr_b16 a[234:235], v244 offset:20480
    s_xor_b32 m0, s35, 102400
    v_mfma_f32_16x16x32_bf16 v[148:151], a[240:243], a[144:147], v[148:151]
    s_cmp_eq_u32 s34, 7
    s_cbranch_scc1 L_sh69
    buffer_load_dwordx4 v241, s[20:23], s86 offen nt lds
L_shr69:
    v_cvt_pk_bf16_f32 v180, v212, v213
    v_exp_f32 v134, v134
    v_mfma_f32_16x16x32_bf16 v[152:155], a[240:243], a[192:195], 0
    ds_read_b64_tr_b16 a[236:237], v244 offset:24576
    v_cvt_pk_bf16_f32 v181, v214, v215
    v_mfma_f32_16x16x32_bf16 v[152:155], a[244:247], a[196:199], v[152:155]
    ds_read_b64_tr_b16 a[238:239], v244 offset:28672
    v_accvgpr_read_b32 v221, a73
    v_mfma_f32_16x16x32_bf16 v[152:155], a[248:251], a[200:203], v[152:155]
    v_exp_f32 v135, v135
    v_mfma_f32_16x16x32_bf16 v[152:155], a[252:255], a[204:207], v[152:155]
    v_exp_f32 v136, v136
    v_cvt_pk_bf16_f32 v69, v134, v135
    v_exp_f32 v137, v137
    v_pk_fma_f32 v[138:139], v[138:139], s[88:89], v[232:233] op_sel_hi:[1,1,0]
    v_pk_mul_f32 v[218:219], v[218:219], v[236:237] op_sel_hi:[1,0]
    v_pk_fma_f32 v[140:141], v[140:141], s[88:89], v[234:235] op_sel_hi:[1,1,0]
    v_mfma_f32_16x16x32_bf16 v[156:159], a[252:255], a[220:223], 0
    v_exp_f32 v138, v138
    v_mfma_f32_16x16x32_bf16 v[156:159], a[248:251], a[216:219], v[156:159]
    v_exp_f32 v139, v139
    v_mfma_f32_16x16x32_bf16 v[156:159], a[244:247], a[212:215], v[156:159]
    v_exp_f32 v140, v140
    v_mfma_f32_16x16x32_bf16 v[156:159], a[240:243], a[208:211], v[156:159]
    s_waitcnt lgkmcnt(0)
    v_exp_f32 v141, v141
    v_cvt_pk_bf16_f32 v72, v136, v137
    v_mfma_f32_16x16x32_bf16 a[0:3], a[224:227], v[0:3], 0
    ds_read_b128 a[240:243], v237 offset:40960
    v_cvt_pk_bf16_f32 v182, v216, v217
    v_mfma_f32_16x16x32_bf16 a[0:3], a[228:231], v[16:19], a[0:3]
    ds_read_b128 a[244:247], v237 offset:41216
    s_waitcnt vmcnt(9)
    s_xor_b32 s86, s85, 78848
    v_mfma_f32_16x16x32_bf16 a[0:3], a[232:235], v[32:35], a[0:3]
    ds_read_b128 a[160:163], v239 offset:0
    s_xor_b32 m0, s35, 103424
    v_mfma_f32_16x16x32_bf16 a[0:3], a[236:239], v[48:51], a[0:3]
    s_cmp_eq_u32 s34, 7
    s_cbranch_scc1 L_sh70
    buffer_load_dwordx4 v255, s[20:23], s86 offen nt lds
L_shr70:
    v_accvgpr_read_b32 v222, a74
    v_cvt_pk_bf16_f32 v73, v138, v139
    v_accvgpr_read_b32 v223, a75
    v_cvt_pk_bf16_f32 v183, v218, v219
    v_pk_fma_f32 v[142:143], v[142:143], s[88:89], v[234:235] op_sel_hi:[1,1,0]
    v_pk_mul_f32 v[220:221], v[220:221], v[236:237] op_sel_hi:[1,0]
    v_pk_fma_f32 v[144:145], v[144:145], s[88:89], v[228:229] op_sel_hi:[1,1,0]
    v_pk_mul_f32 v[222:223], v[222:223], v[236:237] op_sel_hi:[1,0]
    v_pk_fma_f32 v[146:147], v[146:147], s[88:89], v[228:229] op_sel_hi:[1,1,0]
    v_mfma_f32_16x16x32_bf16 a[16:19], a[236:239], v[52:55], 0
    ds_read_b128 a[248:251], v237 offset:41472
    v_cvt_pk_bf16_f32 v76, v140, v141
    v_mfma_f32_16x16x32_bf16 a[16:19], a[232:235], v[36:39], a[16:19]
    ds_read_b128 a[252:255], v237 offset:41728
    v_accvgpr_read_b32 v224, a76
    v_mfma_f32_16x16x32_bf16 a[16:19], a[228:231], v[20:23], a[16:19]
    ds_read_b128 a[164:167], v239 offset:256
    v_accvgpr_read_b32 v225, a77
    v_mfma_f32_16x16x32_bf16 a[16:19], a[224:227], v[4:7], a[16:19]
    v_exp_f32 v142, v142
    v_exp_f32 v143, v143
    v_mfma_f32_16x16x32_bf16 a[32:35], a[224:227], v[8:11], 0
    ds_read_b128 a[168:171], v239 offset:512
    v_cvt_pk_bf16_f32 v77, v142, v143
    v_mfma_f32_16x16x32_bf16 a[32:35], a[228:231], v[24:27], a[32:35]
    ds_read_b128 a[172:175], v239 offset:768
    v_cvt_pk_bf16_f32 v196, v220, v221
    v_mfma_f32_16x16x32_bf16 a[32:35], a[232:235], v[40:43], a[32:35]
    ds_read_b128 a[176:179], v239 offset:4096
    v_accvgpr_read_b32 v226, a78
    v_mfma_f32_16x16x32_bf16 a[32:35], a[236:239], v[56:59], a[32:35]
    v_exp_f32 v144, v144
    v_exp_f32 v145, v145
    v_exp_f32 v146, v146
    v_pk_mul_f32 v[224:225], v[224:225], v[236:237] op_sel_hi:[1,0]
    v_pk_fma_f32 v[148:149], v[148:149], s[88:89], v[230:231] op_sel_hi:[1,1,0]
    v_pk_fma_f32 v[150:151], v[150:151], s[88:89], v[230:231] op_sel_hi:[1,1,0]
    v_mfma_f32_16x16x32_bf16 a[48:51], a[236:239], v[60:63], 0
    ds_read_b128 a[180:183], v239 offset:4352
    v_accvgpr_read_b32 v227, a79
    v_mfma_f32_16x16x32_bf16 a[48:51], a[232:235], v[44:47], a[48:51]
    ds_read_b128 a[184:187], v239 offset:4608
    s_xor_b32 s86, s85, 86016
    v_mfma_f32_16x16x32_bf16 a[48:51], a[228:231], v[28:31], a[48:51]
    ds_read_b128 a[188:191], v239 offset:4864
    s_xor_b32 m0, s35, 106496
    v_mfma_f32_16x16x32_bf16 a[48:51], a[224:227], v[12:15], a[48:51]
    s_waitcnt lgkmcnt(7)
    s_cmp_eq_u32 s34, 7
    s_cbranch_scc1 L_sh71
    buffer_load_dwordx4 v241, s[20:23], s86 offen nt lds
L_shr71:
    v_cvt_pk_bf16_f32 v66, v144, v145
    v_exp_f32 v147, v147
    v_pk_mul_f32 v[226:227], v[226:227], v[236:237] op_sel_hi:[1,0]
    v_pk_fma_f32 v[152:153], v[152:153], s[88:89], v[232:233] op_sel_hi:[1,1,0]
    v_cvt_pk_bf16_f32 v197, v222, v223
    v_accvgpr_read_b32 v212, a80
    v_mfma_f32_16x16x32_bf16 v[160:163], a[240:243], a[128:131], 0
    ds_read_b64_tr_b16 a[224:225], v245 offset:0
    v_cvt_pk_bf16_f32 v67, v146, v147
    v_mfma_f32_16x16x32_bf16 v[160:163], a[244:247], a[132:135], v[160:163]
    ds_read_b64_tr_b16 a[226:227], v245 offset:4096
    v_accvgpr_read_b32 v213, a81
    v_mfma_f32_16x16x32_bf16 v[160:163], a[248:251], a[136:139], v[160:163]
    ds_read_b64_tr_b16 a[228:229], v245 offset:8192
    v_cvt_pk_bf16_f32 v198, v224, v225
    v_mfma_f32_16x16x32_bf16 v[160:163], a[252:255], a[140:143], v[160:163]
    v_exp_f32 v148, v148
    v_exp_f32 v149, v149
    v_accvgpr_read_b32 v214, a82
    v_pk_mul_f32 v[212:213], v[212:213], v[238:239] op_sel_hi:[1,0]
    v_pk_fma_f32 v[154:155], v[154:155], s[88:89], v[232:233] op_sel_hi:[1,1,0]
    v_mfma_f32_16x16x32_bf16 v[164:167], a[252:255], a[156:159], 0
    ds_read_b64_tr_b16 a[230:231], v245 offset:12288
    v_cvt_pk_bf16_f32 v70, v148, v149
    v_mfma_f32_16x16x32_bf16 v[164:167], a[248:251], a[152:155], v[164:167]
    ds_read_b64_tr_b16 a[232:233], v245 offset:16384
    v_accvgpr_read_b32 v215, a83
    v_mfma_f32_16x16x32_bf16 v[164:167], a[244:247], a[148:151], v[164:167]
    ds_read_b64_tr_b16 a[234:235], v245 offset:20480
    v_cvt_pk_bf16_f32 v199, v226, v227
    v_mfma_f32_16x16x32_bf16 v[164:167], a[240:243], a[144:147], v[164:167]
    v_exp_f32 v150, v150
    v_exp_f32 v151, v151
    v_exp_f32 v152, v152
    v_pk_mul_f32 v[214:215], v[214:215], v[238:239] op_sel_hi:[1,0]
    v_pk_fma_f32 v[156:157], v[156:157], s[88:89], v[234:235] op_sel_hi:[1,1,0]
    v_mfma_f32_16x16x32_bf16 v[168:171], a[240:243], a[192:195], 0
    ds_read_b64_tr_b16 a[236:237], v245 offset:24576
    v_accvgpr_read_b32 v216, a84
    v_mfma_f32_16x16x32_bf16 v[168:171], a[244:247], a[196:199], v[168:171]
    ds_read_b64_tr_b16 a[238:239], v245 offset:28672
    s_xor_b32 s86, s85, 87040
    v_mfma_f32_16x16x32_bf16 v[168:171], a[248:251], a[200:203], v[168:171]
    s_xor_b32 m0, s35, 107520
    v_exp_f32 v153, v153
    v_mfma_f32_16x16x32_bf16 v[168:171], a[252:255], a[204:207], v[168:171]
    s_cmp_eq_u32 s34, 7
    s_cbranch_scc1 L_sh72
    buffer_load_dwordx4 v255, s[20:23], s86 offen nt lds
L_shr72:
    v_cvt_pk_bf16_f32 v71, v150, v151
    v_accvgpr_read_b32 v217, a85
    v_cvt_pk_bf16_f32 v184, v212, v213
    v_exp_f32 v154, v154
    v_pk_mul_f32 v[216:217], v[216:217], v[238:239] op_sel_hi:[1,0]
    v_pk_fma_f32 v[158:159], v[158:159], s[88:89], v[234:235] op_sel_hi:[1,1,0]
    v_mfma_f32_16x16x32_bf16 v[172:175], a[252:255], a[220:223], 0
    v_exp_f32 v155, v155
    v_mfma_f32_16x16x32_bf16 v[172:175], a[248:251], a[216:219], v[172:175]
    v_exp_f32 v156, v156
    v_mfma_f32_16x16x32_bf16 v[172:175], a[244:247], a[212:215], v[172:175]
    v_exp_f32 v157, v157
    v_mfma_f32_16x16x32_bf16 v[172:175], a[240:243], a[208:211], v[172:175]
    s_waitcnt lgkmcnt(0)
    v_exp_f32 v158, v158
    v_accvgpr_read_b32 v218, a86
    v_cvt_pk_bf16_f32 v74, v152, v153
    v_accvgpr_read_b32 v219, a87
    v_pk_mul_f32 v[218:219], v[218:219], v[238:239] op_sel_hi:[1,0]
    v_pk_fma_f32 v[160:161], v[160:161], s[88:89], v[228:229] op_sel_hi:[1,1,0]
    v_cvt_pk_bf16_f32 v185, v214, v215
    v_mfma_f32_16x16x32_bf16 a[8:11], a[224:227], v[0:3], 0
    ds_read_b128 a[240:243], v237 offset:45056
    v_cvt_pk_bf16_f32 v75, v154, v155
    v_mfma_f32_16x16x32_bf16 a[8:11], a[228:231], v[16:19], a[8:11]
    ds_read_b128 a[244:247], v237 offset:45312
    s_xor_b32 s86, s85, 94208
    v_mfma_f32_16x16x32_bf16 a[8:11], a[232:235], v[32:35], a[8:11]
    s_xor_b32 m0, s35, 110592
    v_exp_f32 v159, v159
    v_mfma_f32_16x16x32_bf16 a[8:11], a[236:239], v[48:51], a[8:11]
    s_cmp_eq_u32 s34, 7
    s_cbranch_scc1 L_sh73
    buffer_load_dwordx4 v241, s[20:23], s86 offen nt lds
L_shr73:
    v_accvgpr_read_b32 v220, a88
    v_accvgpr_read_b32 v221, a89
    v_mfma_f32_16x16x32_bf16 a[24:27], a[236:239], v[52:55], 0
    ds_read_b128 a[248:251], v237 offset:45568
    v_cvt_pk_bf16_f32 v186, v216, v217
    v_mfma_f32_16x16x32_bf16 a[24:27], a[232:235], v[36:39], a[24:27]
    ds_read_b128 a[252:255], v237 offset:45824
    v_cvt_pk_bf16_f32 v78, v156, v157
    v_mfma_f32_16x16x32_bf16 a[24:27], a[228:231], v[20:23], a[24:27]
    v_exp_f32 v160, v160
    v_mfma_f32_16x16x32_bf16 a[24:27], a[224:227], v[4:7], a[24:27]
    v_exp_f32 v161, v161
    v_accvgpr_read_b32 v222, a90
    v_accvgpr_read_b32 v223, a91
    v_cvt_pk_bf16_f32 v79, v158, v159
    v_pk_mul_f32 v[220:221], v[220:221], v[238:239] op_sel_hi:[1,0]
    v_pk_fma_f32 v[162:163], v[162:163], s[88:89], v[228:229] op_sel_hi:[1,1,0]
    v_pk_mul_f32 v[222:223], v[222:223], v[238:239] op_sel_hi:[1,0]
    v_pk_fma_f32 v[164:165], v[164:165], s[88:89], v[230:231] op_sel_hi:[1,1,0]
    v_mfma_f32_16x16x32_bf16 a[40:43], a[224:227], v[8:11], 0
    v_exp_f32 v162, v162
    v_mfma_f32_16x16x32_bf16 a[40:43], a[228:231], v[24:27], a[40:43]
    v_exp_f32 v163, v163
    v_mfma_f32_16x16x32_bf16 a[40:43], a[232:235], v[40:43], a[40:43]
    v_exp_f32 v164, v164
    v_mfma_f32_16x16x32_bf16 a[40:43], a[236:239], v[56:59], a[40:43]
    v_exp_f32 v165, v165
    v_cvt_pk_bf16_f32 v187, v218, v219
    v_accvgpr_read_b32 v224, a92
    v_accvgpr_read_b32 v225, a93
    v_pk_mul_f32 v[224:225], v[224:225], v[238:239] op_sel_hi:[1,0]
    v_pk_fma_f32 v[166:167], v[166:167], s[88:89], v[230:231] op_sel_hi:[1,1,0]
    v_cvt_pk_bf16_f32 v80, v160, v161
    v_mfma_f32_16x16x32_bf16 a[56:59], a[236:239], v[60:63], 0
    v_exp_f32 v166, v166
    v_mfma_f32_16x16x32_bf16 a[56:59], a[232:235], v[44:47], a[56:59]
    s_xor_b32 s86, s85, 95232
    v_exp_f32 v167, v167
    v_mfma_f32_16x16x32_bf16 a[56:59], a[228:231], v[28:31], a[56:59]
    s_xor_b32 m0, s35, 111616
    v_cvt_pk_bf16_f32 v200, v220, v221
    v_accvgpr_read_b32 v226, a94
    v_mfma_f32_16x16x32_bf16 a[56:59], a[224:227], v[12:15], a[56:59]
    s_waitcnt lgkmcnt(0)
    s_cmp_eq_u32 s34, 7
    s_cbranch_scc1 L_sh74
    buffer_load_dwordx4 v255, s[20:23], s86 offen nt lds
L_shr74:
    v_cvt_pk_bf16_f32 v81, v162, v163
    v_accvgpr_read_b32 v227, a95
    v_mfma_f32_16x16x32_bf16 v[128:131], a[240:243], a[128:131], 0
    ds_read_b64_tr_b16 a[224:225], v244 offset:256
    v_cvt_pk_bf16_f32 v201, v222, v223
    v_mfma_f32_16x16x32_bf16 v[128:131], a[244:247], a[132:135], v[128:131]
    ds_read_b64_tr_b16 a[226:227], v244 offset:4352
    v_accvgpr_read_b32 v212, a96
    v_mfma_f32_16x16x32_bf16 v[128:131], a[248:251], a[136:139], v[128:131]
    ds_read_b64_tr_b16 a[228:229], v244 offset:8448
    v_cvt_pk_bf16_f32 v84, v164, v165
    v_mfma_f32_16x16x32_bf16 v[128:131], a[252:255], a[140:143], v[128:131]
    v_accvgpr_read_b32 v213, a97
    v_cvt_pk_bf16_f32 v202, v224, v225
    v_accvgpr_read_b32 v214, a98
    v_cvt_pk_bf16_f32 v85, v166, v167
    v_accvgpr_read_b32 v215, a99
    v_pk_mul_f32 v[226:227], v[226:227], v[238:239] op_sel_hi:[1,0]
    v_pk_fma_f32 v[168:169], v[168:169], s[88:89], v[232:233] op_sel_hi:[1,1,0]
    v_pk_mul_f32 v[212:213], v[212:213], v[240:241] op_sel_hi:[1,0]
    v_pk_fma_f32 v[170:171], v[170:171], s[88:89], v[232:233] op_sel_hi:[1,1,0]
    v_mfma_f32_16x16x32_bf16 v[132:135], a[252:255], a[156:159], 0
    ds_read_b64_tr_b16 a[230:231], v244 offset:12544
    v_cvt_pk_bf16_f32 v203, v226, v227
    v_mfma_f32_16x16x32_bf16 v[132:135], a[248:251], a[152:155], v[132:135]
    ds_read_b64_tr_b16 a[232:233], v244 offset:16640
    v_accvgpr_read_b32 v216, a100
    v_mfma_f32_16x16x32_bf16 v[132:135], a[244:247], a[148:151], v[132:135]
    ds_read_b64_tr_b16 a[234:235], v244 offset:20736
    v_accvgpr_read_b32 v217, a101
    v_mfma_f32_16x16x32_bf16 v[132:135], a[240:243], a[144:147], v[132:135]
    v_exp_f32 v168, v168
    v_exp_f32 v169, v169
    v_mfma_f32_16x16x32_bf16 v[136:139], a[240:243], a[192:195], 0
    ds_read_b64_tr_b16 a[236:237], v244 offset:24832
    v_cvt_pk_bf16_f32 v88, v168, v169
    v_mfma_f32_16x16x32_bf16 v[136:139], a[244:247], a[196:199], v[136:139]
    ds_read_b64_tr_b16 a[238:239], v244 offset:28928
    v_cvt_pk_bf16_f32 v188, v212, v213
    v_mfma_f32_16x16x32_bf16 v[136:139], a[248:251], a[200:203], v[136:139]
    s_mov_b32 m0, s42
    v_exp_f32 v170, v170
    v_mfma_f32_16x16x32_bf16 v[136:139], a[252:255], a[204:207], v[136:139]
    buffer_load_dwordx4 v246, s[12:15], s82 offen offset:0 nt lds
    v_accvgpr_read_b32 v218, a102
    v_exp_f32 v171, v171
    v_accvgpr_read_b32 v219, a103
    v_pk_mul_f32 v[214:215], v[214:215], v[240:241] op_sel_hi:[1,0]
    v_pk_fma_f32 v[172:173], v[172:173], s[88:89], v[234:235] op_sel_hi:[1,1,0]
    v_pk_fma_f32 v[174:175], v[174:175], s[88:89], v[234:235] op_sel_hi:[1,1,0]
    v_pk_mul_f32 v[216:217], v[216:217], v[240:241] op_sel_hi:[1,0]
    v_pk_fma_f32 v[128:129], v[128:129], s[88:89], v[228:229] op_sel_hi:[1,1,0]
    v_mfma_f32_16x16x32_bf16 v[140:143], a[252:255], a[220:223], 0
    v_exp_f32 v172, v172
    v_mfma_f32_16x16x32_bf16 v[140:143], a[248:251], a[216:219], v[140:143]
    v_exp_f32 v173, v173
    v_mfma_f32_16x16x32_bf16 v[140:143], a[244:247], a[212:215], v[140:143]
    v_exp_f32 v174, v174
    v_mfma_f32_16x16x32_bf16 v[140:143], a[240:243], a[208:211], v[140:143]
    s_waitcnt lgkmcnt(0)
    v_exp_f32 v175, v175
    v_cvt_pk_bf16_f32 v89, v170, v171
    v_mfma_f32_16x16x32_bf16 a[4:7], a[224:227], v[0:3], 0
    ds_read_b128 a[240:243], v237 offset:49152
    v_cvt_pk_bf16_f32 v92, v172, v173
    v_mfma_f32_16x16x32_bf16 a[4:7], a[228:231], v[16:19], a[4:7]
    ds_read_b128 a[244:247], v237 offset:49408
    v_cvt_pk_bf16_f32 v189, v214, v215
    v_mfma_f32_16x16x32_bf16 a[4:7], a[232:235], v[32:35], a[4:7]
    v_exp_f32 v128, v128
    v_mfma_f32_16x16x32_bf16 a[4:7], a[236:239], v[48:51], a[4:7]
    v_exp_f32 v129, v129
    v_accvgpr_read_b32 v220, a104
    v_accvgpr_read_b32 v221, a105
    v_cvt_pk_bf16_f32 v93, v174, v175
    v_pk_mul_f32 v[218:219], v[218:219], v[240:241] op_sel_hi:[1,0]
    v_pk_fma_f32 v[130:131], v[130:131], s[88:89], v[228:229] op_sel_hi:[1,1,0]
    v_pk_mul_f32 v[220:221], v[220:221], v[240:241] op_sel_hi:[1,0]
    v_pk_fma_f32 v[132:133], v[132:133], s[88:89], v[230:231] op_sel_hi:[1,1,0]
    v_mfma_f32_16x16x32_bf16 a[20:23], a[236:239], v[52:55], 0
    ds_read_b128 a[248:251], v237 offset:49664
    v_cvt_pk_bf16_f32 v190, v216, v217
    v_mfma_f32_16x16x32_bf16 a[20:23], a[232:235], v[36:39], a[20:23]
    ds_read_b128 a[252:255], v237 offset:49920
    v_accvgpr_read_b32 v222, a106
    v_mfma_f32_16x16x32_bf16 a[20:23], a[228:231], v[20:23], a[20:23]
    s_mov_b32 m0, s42
    v_exp_f32 v130, v130
    v_mfma_f32_16x16x32_bf16 a[20:23], a[224:227], v[4:7], a[20:23]
    buffer_load_dwordx4 v247, s[12:15], s82 offen offset:1024 nt lds
    v_accvgpr_read_b32 v223, a107
    v_mfma_f32_16x16x32_bf16 a[36:39], a[224:227], v[8:11], 0
    v_exp_f32 v131, v131
    v_mfma_f32_16x16x32_bf16 a[36:39], a[228:231], v[24:27], a[36:39]
    v_exp_f32 v132, v132
    v_mfma_f32_16x16x32_bf16 a[36:39], a[232:235], v[40:43], a[36:39]
    v_exp_f32 v133, v133
    v_mfma_f32_16x16x32_bf16 a[36:39], a[236:239], v[56:59], a[36:39]
    v_cvt_pk_bf16_f32 v82, v128, v129
    v_cvt_pk_bf16_f32 v191, v218, v219
    v_accvgpr_read_b32 v224, a108
    v_cvt_pk_bf16_f32 v83, v130, v131
    v_accvgpr_read_b32 v225, a109
    v_pk_mul_f32 v[222:223], v[222:223], v[240:241] op_sel_hi:[1,0]
    v_pk_fma_f32 v[134:135], v[134:135], s[88:89], v[230:231] op_sel_hi:[1,1,0]
    v_pk_mul_f32 v[224:225], v[224:225], v[240:241] op_sel_hi:[1,0]
    v_pk_fma_f32 v[136:137], v[136:137], s[88:89], v[232:233] op_sel_hi:[1,1,0]
    v_mfma_f32_16x16x32_bf16 a[52:55], a[236:239], v[60:63], 0
    v_exp_f32 v134, v134
    v_mfma_f32_16x16x32_bf16 a[52:55], a[232:235], v[44:47], a[52:55]
    v_exp_f32 v135, v135
    v_mfma_f32_16x16x32_bf16 a[52:55], a[228:231], v[28:31], a[52:55]
    v_exp_f32 v136, v136
    v_mfma_f32_16x16x32_bf16 a[52:55], a[224:227], v[12:15], a[52:55]
    s_waitcnt lgkmcnt(0)
    v_exp_f32 v137, v137
    v_cvt_pk_bf16_f32 v204, v220, v221
    v_mfma_f32_16x16x32_bf16 v[144:147], a[240:243], a[128:131], 0
    ds_read_b64_tr_b16 a[224:225], v245 offset:256
    v_accvgpr_read_b32 v226, a110
    v_mfma_f32_16x16x32_bf16 v[144:147], a[244:247], a[132:135], v[144:147]
    ds_read_b64_tr_b16 a[226:227], v245 offset:4352
    v_cvt_pk_bf16_f32 v86, v132, v133
    v_mfma_f32_16x16x32_bf16 v[144:147], a[248:251], a[136:139], v[144:147]
    ds_read_b64_tr_b16 a[228:229], v245 offset:8448
    s_mov_b32 m0, s42
    v_mfma_f32_16x16x32_bf16 v[144:147], a[252:255], a[140:143], v[144:147]
    buffer_load_dwordx4 v246, s[12:15], s82 offen offset:2048 nt lds
    v_accvgpr_read_b32 v227, a111
    v_cvt_pk_bf16_f32 v205, v222, v223
    v_mfma_f32_16x16x32_bf16 v[148:151], a[252:255], a[156:159], 0
    ds_read_b64_tr_b16 a[230:231], v245 offset:12544
    v_accvgpr_read_b32 v212, a112
    v_mfma_f32_16x16x32_bf16 v[148:151], a[248:251], a[152:155], v[148:151]
    ds_read_b64_tr_b16 a[232:233], v245 offset:16640
    v_cvt_pk_bf16_f32 v87, v134, v135
    v_mfma_f32_16x16x32_bf16 v[148:151], a[244:247], a[148:151], v[148:151]
    ds_read_b64_tr_b16 a[234:235], v245 offset:20736
    v_accvgpr_read_b32 v213, a113
    v_mfma_f32_16x16x32_bf16 v[148:151], a[240:243], a[144:147], v[148:151]
    v_cvt_pk_bf16_f32 v206, v224, v225
    v_accvgpr_read_b32 v214, a114
    v_cvt_pk_bf16_f32 v90, v136, v137
    v_accvgpr_read_b32 v215, a115
    v_accvgpr_read_b32 v216, a116
    v_pk_mul_f32 v[226:227], v[226:227], v[240:241] op_sel_hi:[1,0]
    v_pk_fma_f32 v[138:139], v[138:139], s[88:89], v[232:233] op_sel_hi:[1,1,0]
    v_pk_fma_f32 v[140:141], v[140:141], s[88:89], v[234:235] op_sel_hi:[1,1,0]
    v_pk_mul_f32 v[212:213], v[212:213], v[242:243] op_sel_hi:[1,0]
    v_pk_fma_f32 v[142:143], v[142:143], s[88:89], v[234:235] op_sel_hi:[1,1,0]
    v_pk_mul_f32 v[214:215], v[214:215], v[242:243] op_sel_hi:[1,0]
    v_exp_f32 v138, v138
    v_mfma_f32_16x16x32_bf16 v[152:155], a[240:243], a[192:195], 0
    ds_read_b64_tr_b16 a[236:237], v245 offset:24832
    v_cvt_pk_bf16_f32 v207, v226, v227
    v_mfma_f32_16x16x32_bf16 v[152:155], a[244:247], a[196:199], v[152:155]
    ds_read_b64_tr_b16 a[238:239], v245 offset:28928
    v_accvgpr_read_b32 v217, a117
    v_mfma_f32_16x16x32_bf16 v[152:155], a[248:251], a[200:203], v[152:155]
    s_mov_b32 m0, s42
    v_exp_f32 v139, v139
    v_mfma_f32_16x16x32_bf16 v[152:155], a[252:255], a[204:207], v[152:155]
    buffer_load_dwordx4 v247, s[12:15], s82 offen offset:3072 nt lds
    v_cvt_pk_bf16_f32 v91, v138, v139
    v_exp_f32 v140, v140
    v_mfma_f32_16x16x32_bf16 v[156:159], a[252:255], a[220:223], 0
    v_exp_f32 v141, v141
    v_mfma_f32_16x16x32_bf16 v[156:159], a[248:251], a[216:219], v[156:159]
    v_exp_f32 v142, v142
    v_mfma_f32_16x16x32_bf16 v[156:159], a[244:247], a[212:215], v[156:159]
    v_exp_f32 v143, v143
    v_mfma_f32_16x16x32_bf16 v[156:159], a[240:243], a[208:211], v[156:159]
    s_waitcnt lgkmcnt(0)
    v_cvt_pk_bf16_f32 v94, v140, v141
    v_cvt_pk_bf16_f32 v192, v212, v213
    v_accvgpr_read_b32 v218, a118
    v_accvgpr_read_b32 v219, a119
    v_cvt_pk_bf16_f32 v95, v142, v143
    v_pk_fma_f32 v[144:145], v[144:145], s[88:89], v[228:229] op_sel_hi:[1,1,0]
    v_pk_mul_f32 v[216:217], v[216:217], v[242:243] op_sel_hi:[1,0]
    v_pk_fma_f32 v[146:147], v[146:147], s[88:89], v[228:229] op_sel_hi:[1,1,0]
    v_pk_mul_f32 v[218:219], v[218:219], v[242:243] op_sel_hi:[1,0]
    v_mfma_f32_16x16x32_bf16 a[12:15], a[224:227], v[0:3], 0
    ds_read_b128 a[240:243], v237 offset:53248
    v_cvt_pk_bf16_f32 v193, v214, v215
    v_mfma_f32_16x16x32_bf16 a[12:15], a[228:231], v[16:19], a[12:15]
    ds_read_b128 a[244:247], v237 offset:53504
    v_accvgpr_read_b32 v220, a120
    v_mfma_f32_16x16x32_bf16 a[12:15], a[232:235], v[32:35], a[12:15]
    v_exp_f32 v144, v144
    v_mfma_f32_16x16x32_bf16 a[12:15], a[236:239], v[48:51], a[12:15]
    v_exp_f32 v145, v145
    v_mfma_f32_16x16x32_bf16 a[28:31], a[236:239], v[52:55], 0
    ds_read_b128 a[248:251], v237 offset:53760
    v_cvt_pk_bf16_f32 v96, v144, v145
    v_mfma_f32_16x16x32_bf16 a[28:31], a[232:235], v[36:39], a[28:31]
    ds_read_b128 a[252:255], v237 offset:54016
    v_accvgpr_read_b32 v221, a121
    v_mfma_f32_16x16x32_bf16 a[28:31], a[228:231], v[20:23], a[28:31]
    s_mov_b32 m0, s43
    v_exp_f32 v146, v146
    v_mfma_f32_16x16x32_bf16 a[28:31], a[224:227], v[4:7], a[28:31]
    buffer_load_dwordx4 v246, s[12:15], s83 offen offset:0 nt lds
    v_cvt_pk_bf16_f32 v194, v216, v217
    v_exp_f32 v147, v147
    v_accvgpr_read_b32 v222, a122
    v_pk_fma_f32 v[148:149], v[148:149], s[88:89], v[230:231] op_sel_hi:[1,1,0]
    v_pk_mul_f32 v[220:221], v[220:221], v[242:243] op_sel_hi:[1,0]
    v_pk_fma_f32 v[150:151], v[150:151], s[88:89], v[230:231] op_sel_hi:[1,1,0]
    v_mfma_f32_16x16x32_bf16 a[44:47], a[224:227], v[8:11], 0
    v_exp_f32 v148, v148
    v_mfma_f32_16x16x32_bf16 a[44:47], a[228:231], v[24:27], a[44:47]
    v_exp_f32 v149, v149
    v_mfma_f32_16x16x32_bf16 a[44:47], a[232:235], v[40:43], a[44:47]
    v_exp_f32 v150, v150
    v_mfma_f32_16x16x32_bf16 a[44:47], a[236:239], v[56:59], a[44:47]
    v_exp_f32 v151, v151
    v_cvt_pk_bf16_f32 v97, v146, v147
    v_mfma_f32_16x16x32_bf16 a[60:63], a[236:239], v[60:63], 0
    v_accvgpr_read_b32 v223, a123
    v_cvt_pk_bf16_f32 v195, v218, v219
    v_mfma_f32_16x16x32_bf16 a[60:63], a[232:235], v[44:47], a[60:63]
    v_accvgpr_read_b32 v224, a124
    v_cvt_pk_bf16_f32 v100, v148, v149
    v_mfma_f32_16x16x32_bf16 a[60:63], a[228:231], v[28:31], a[60:63]
    s_mov_b64 vcc, s[74:75]
    v_accvgpr_read_b32 v225, a125
    v_cvt_pk_bf16_f32 v208, v220, v221
    v_mfma_f32_16x16x32_bf16 a[60:63], a[224:227], v[12:15], a[60:63]
    s_waitcnt lgkmcnt(0)
    v_accvgpr_read_b32 v226, a126
    v_cvt_pk_bf16_f32 v101, v150, v151
    v_accvgpr_read_b32 v227, a127
    v_cndmask_b32_dpp v176, v196, v180, vcc quad_perm:[1,0,3,2] row_mask:0xf bank_mask:0xf
    v_cndmask_b32_dpp v177, v197, v181, vcc quad_perm:[1,0,3,2] row_mask:0xf bank_mask:0xf
    v_pk_mul_f32 v[222:223], v[222:223], v[242:243] op_sel_hi:[1,0]
    v_pk_fma_f32 v[152:153], v[152:153], s[88:89], v[232:233] op_sel_hi:[1,1,0]
    v_pk_mul_f32 v[224:225], v[224:225], v[242:243] op_sel_hi:[1,0]
    v_pk_fma_f32 v[154:155], v[154:155], s[88:89], v[232:233] op_sel_hi:[1,1,0]
    v_mfma_f32_16x16x32_bf16 v[160:163], a[240:243], a[128:131], 0
    ds_read_b64_tr_b16 a[224:225], v244 offset:512
    v_cvt_pk_bf16_f32 v209, v222, v223
    v_mfma_f32_16x16x32_bf16 v[160:163], a[244:247], a[132:135], v[160:163]
    ds_read_b64_tr_b16 a[226:227], v244 offset:4608
    v_cvt_pk_bf16_f32 v210, v224, v225
    v_mfma_f32_16x16x32_bf16 v[160:163], a[248:251], a[136:139], v[160:163]
    ds_read_b64_tr_b16 a[228:229], v244 offset:8704
    s_mov_b32 m0, s43
    v_mfma_f32_16x16x32_bf16 v[160:163], a[252:255], a[140:143], v[160:163]
    buffer_load_dwordx4 v247, s[12:15], s83 offen offset:1024 nt lds
    v_cndmask_b32_dpp v178, v198, v182, vcc quad_perm:[1,0,3,2] row_mask:0xf bank_mask:0xf
    v_exp_f32 v152, v152
    v_exp_f32 v153, v153
    v_pk_fma_f32 v[156:157], v[156:157], s[88:89], v[234:235] op_sel_hi:[1,1,0]
    v_pk_mul_f32 v[226:227], v[226:227], v[242:243] op_sel_hi:[1,0]
    v_mfma_f32_16x16x32_bf16 v[164:167], a[252:255], a[156:159], 0
    ds_read_b64_tr_b16 a[230:231], v244 offset:12800
    v_cvt_pk_bf16_f32 v104, v152, v153
    v_mfma_f32_16x16x32_bf16 v[164:167], a[248:251], a[152:155], v[164:167]
    ds_read_b64_tr_b16 a[232:233], v244 offset:16896
    v_cndmask_b32_dpp v179, v199, v183, vcc quad_perm:[1,0,3,2] row_mask:0xf bank_mask:0xf
    v_mfma_f32_16x16x32_bf16 v[164:167], a[244:247], a[148:151], v[164:167]
    ds_read_b64_tr_b16 a[234:235], v244 offset:20992
    s_mov_b64 vcc, s[76:77]
    v_mfma_f32_16x16x32_bf16 v[164:167], a[240:243], a[144:147], v[164:167]
    v_exp_f32 v154, v154
    v_exp_f32 v155, v155
    v_mfma_f32_16x16x32_bf16 v[168:171], a[240:243], a[192:195], 0
    ds_read_b64_tr_b16 a[236:237], v244 offset:25088
    v_cvt_pk_bf16_f32 v105, v154, v155
    v_mfma_f32_16x16x32_bf16 v[168:171], a[244:247], a[196:199], v[168:171]
    ds_read_b64_tr_b16 a[238:239], v244 offset:29184
    v_cvt_pk_bf16_f32 v211, v226, v227
    v_mfma_f32_16x16x32_bf16 v[168:171], a[248:251], a[200:203], v[168:171]
    v_exp_f32 v156, v156
    v_mfma_f32_16x16x32_bf16 v[168:171], a[252:255], a[204:207], v[168:171]
    v_exp_f32 v157, v157
    v_cndmask_b32_dpp v196, v180, v196, vcc quad_perm:[1,0,3,2] row_mask:0xf bank_mask:0xf
    v_cvt_pk_bf16_f32 v108, v156, v157
    v_cndmask_b32_dpp v197, v181, v197, vcc quad_perm:[1,0,3,2] row_mask:0xf bank_mask:0xf
    v_pk_fma_f32 v[158:159], v[158:159], s[88:89], v[234:235] op_sel_hi:[1,1,0]
    v_pk_fma_f32 v[160:161], v[160:161], s[88:89], v[228:229] op_sel_hi:[1,1,0]
    v_pk_fma_f32 v[162:163], v[162:163], s[88:89], v[228:229] op_sel_hi:[1,1,0]
    v_mfma_f32_16x16x32_bf16 v[172:175], a[252:255], a[220:223], 0
    v_exp_f32 v158, v158
    v_mfma_f32_16x16x32_bf16 v[172:175], a[248:251], a[216:219], v[172:175]
    v_exp_f32 v159, v159
    v_mfma_f32_16x16x32_bf16 v[172:175], a[244:247], a[212:215], v[172:175]
    s_mov_b32 m0, s43
    v_exp_f32 v160, v160
    v_mfma_f32_16x16x32_bf16 v[172:175], a[240:243], a[208:211], v[172:175]
    s_waitcnt lgkmcnt(0)
    buffer_load_dwordx4 v246, s[12:15], s83 offen offset:2048 nt lds
    v_mfma_f32_16x16x32_bf16 a[64:67], a[224:227], v[0:3], 0
    ds_read_b128 a[240:243], v237 offset:57344
    v_cvt_pk_bf16_f32 v109, v158, v159
    v_mfma_f32_16x16x32_bf16 a[64:67], a[228:231], v[16:19], a[64:67]
    ds_read_b128 a[244:247], v237 offset:57600
    v_cndmask_b32_dpp v198, v182, v198, vcc quad_perm:[1,0,3,2] row_mask:0xf bank_mask:0xf
    v_mfma_f32_16x16x32_bf16 a[64:67], a[232:235], v[32:35], a[64:67]
    v_exp_f32 v161, v161
    v_mfma_f32_16x16x32_bf16 a[64:67], a[236:239], v[48:51], a[64:67]
    v_exp_f32 v162, v162
    v_cndmask_b32_dpp v199, v183, v199, vcc quad_perm:[1,0,3,2] row_mask:0xf bank_mask:0xf
    v_mfma_f32_16x16x32_bf16 a[80:83], a[236:239], v[52:55], 0
    ds_read_b128 a[248:251], v237 offset:57856
    v_cvt_pk_bf16_f32 v98, v160, v161
    v_mfma_f32_16x16x32_bf16 a[80:83], a[232:235], v[36:39], a[80:83]
    ds_read_b128 a[252:255], v237 offset:58112
    v_fmamk_f32 v164, v164, 0x3e0293ee, v230
    v_mfma_f32_16x16x32_bf16 a[80:83], a[228:231], v[20:23], a[80:83]
    v_permlane16_swap_b32 v176, v178
    v_mfma_f32_16x16x32_bf16 a[80:83], a[224:227], v[4:7], a[80:83]
    v_exp_f32 v163, v163
    v_permlane16_swap_b32 v177, v179
    v_fmamk_f32 v165, v165, 0x3e0293ee, v230
    v_pk_fma_f32 v[166:167], v[166:167], s[88:89], v[230:231] op_sel_hi:[1,1,0]
    v_pk_fma_f32 v[168:169], v[168:169], s[88:89], v[232:233] op_sel_hi:[1,1,0]
    v_mfma_f32_16x16x32_bf16 a[96:99], a[224:227], v[8:11], 0
    v_exp_f32 v164, v164
    v_mfma_f32_16x16x32_bf16 a[96:99], a[228:231], v[24:27], a[96:99]
    v_exp_f32 v165, v165
    v_mfma_f32_16x16x32_bf16 a[96:99], a[232:235], v[40:43], a[96:99]
    s_mov_b32 m0, s43
    v_exp_f32 v166, v166
    v_mfma_f32_16x16x32_bf16 a[96:99], a[236:239], v[56:59], a[96:99]
    buffer_load_dwordx4 v247, s[12:15], s83 offen offset:3072 nt lds
    v_cvt_pk_bf16_f32 v99, v162, v163
    v_mfma_f32_16x16x32_bf16 a[112:115], a[236:239], v[60:63], 0
    v_permlane16_swap_b32 v196, v198
    v_mfma_f32_16x16x32_bf16 a[112:115], a[232:235], v[44:47], a[112:115]
    v_exp_f32 v167, v167
    v_mfma_f32_16x16x32_bf16 a[112:115], a[228:231], v[28:31], a[112:115]
    v_permlane16_swap_b32 v197, v199
    v_mfma_f32_16x16x32_bf16 a[112:115], a[224:227], v[12:15], a[112:115]
    s_waitcnt lgkmcnt(0)
    buffer_store_dwordx4 v[176:179], v243, s[24:27], s52 offen offset:128 sc1
    v_exp_f32 v168, v168
    v_exp_f32 v169, v169
    v_pk_fma_f32 v[170:171], v[170:171], s[88:89], v[232:233] op_sel_hi:[1,1,0]
    v_pk_fma_f32 v[172:173], v[172:173], s[88:89], v[234:235] op_sel_hi:[1,1,0]
    v_cvt_pk_bf16_f32 v102, v164, v165
    v_mfma_f32_16x16x32_bf16 v[128:131], a[240:243], a[128:131], 0
    ds_read_b64_tr_b16 a[224:225], v245 offset:512
    v_cvt_pk_bf16_f32 v103, v166, v167
    v_mfma_f32_16x16x32_bf16 v[128:131], a[244:247], a[132:135], v[128:131]
    ds_read_b64_tr_b16 a[226:227], v245 offset:4608
    s_mov_b64 vcc, s[74:75]
    v_mfma_f32_16x16x32_bf16 v[128:131], a[248:251], a[136:139], v[128:131]
    ds_read_b64_tr_b16 a[228:229], v245 offset:8704
    v_cvt_pk_bf16_f32 v106, v168, v169
    v_mfma_f32_16x16x32_bf16 v[128:131], a[252:255], a[140:143], v[128:131]
    buffer_store_dwordx4 v[196:199], v243, s[24:27], s52 offen offset:384 sc1
    v_exp_f32 v170, v170
    v_exp_f32 v171, v171
    v_pk_fma_f32 v[174:175], v[174:175], s[88:89], v[234:235] op_sel_hi:[1,1,0]
    v_mfma_f32_16x16x32_bf16 v[132:135], a[252:255], a[156:159], 0
    ds_read_b64_tr_b16 a[230:231], v245 offset:12800
    v_cndmask_b32_dpp v180, v200, v184, vcc quad_perm:[1,0,3,2] row_mask:0xf bank_mask:0xf
    v_mfma_f32_16x16x32_bf16 v[132:135], a[248:251], a[152:155], v[132:135]
    ds_read_b64_tr_b16 a[232:233], v245 offset:16896
    v_cndmask_b32_dpp v181, v201, v185, vcc quad_perm:[1,0,3,2] row_mask:0xf bank_mask:0xf
    v_mfma_f32_16x16x32_bf16 v[132:135], a[244:247], a[148:151], v[132:135]
    ds_read_b64_tr_b16 a[234:235], v245 offset:20992
    v_cndmask_b32_dpp v182, v202, v186, vcc quad_perm:[1,0,3,2] row_mask:0xf bank_mask:0xf
    v_mfma_f32_16x16x32_bf16 v[132:135], a[240:243], a[144:147], v[132:135]
    v_exp_f32 v172, v172
    v_mfma_f32_16x16x32_bf16 v[136:139], a[240:243], a[192:195], 0
    ds_read_b64_tr_b16 a[236:237], v245 offset:25088
    v_cvt_pk_bf16_f32 v107, v170, v171
    v_mfma_f32_16x16x32_bf16 v[136:139], a[244:247], a[196:199], v[136:139]
    ds_read_b64_tr_b16 a[238:239], v245 offset:29184
    v_cndmask_b32_dpp v183, v203, v187, vcc quad_perm:[1,0,3,2] row_mask:0xf bank_mask:0xf
    v_mfma_f32_16x16x32_bf16 v[136:139], a[248:251], a[200:203], v[136:139]
    s_mov_b64 vcc, s[76:77]
    v_exp_f32 v173, v173
    v_mfma_f32_16x16x32_bf16 v[136:139], a[252:255], a[204:207], v[136:139]
    v_exp_f32 v174, v174
    v_cndmask_b32_dpp v200, v184, v200, vcc quad_perm:[1,0,3,2] row_mask:0xf bank_mask:0xf
    v_cvt_pk_bf16_f32 v110, v172, v173
    v_cndmask_b32_dpp v201, v185, v201, vcc quad_perm:[1,0,3,2] row_mask:0xf bank_mask:0xf
    v_pk_fma_f32 v[128:129], v[128:129], s[88:89], v[228:229] op_sel_hi:[1,1,0]
    v_pk_fma_f32 v[130:131], v[130:131], s[88:89], v[228:229] op_sel_hi:[1,1,0]
    v_mfma_f32_16x16x32_bf16 v[140:143], a[252:255], a[220:223], 0
    v_exp_f32 v175, v175
    v_mfma_f32_16x16x32_bf16 v[140:143], a[248:251], a[216:219], v[140:143]
    v_exp_f32 v128, v128
    v_mfma_f32_16x16x32_bf16 v[140:143], a[244:247], a[212:215], v[140:143]
    v_exp_f32 v129, v129
    v_mfma_f32_16x16x32_bf16 v[140:143], a[240:243], a[208:211], v[140:143]
    s_waitcnt lgkmcnt(0)
    v_exp_f32 v130, v130
    v_cndmask_b32_dpp v202, v186, v202, vcc quad_perm:[1,0,3,2] row_mask:0xf bank_mask:0xf
    v_cndmask_b32_dpp v203, v187, v203, vcc quad_perm:[1,0,3,2] row_mask:0xf bank_mask:0xf
    v_permlane16_swap_b32 v180, v182
    v_pk_fma_f32 v[132:133], v[132:133], s[88:89], v[230:231] op_sel_hi:[1,1,0]
    v_mfma_f32_16x16x32_bf16 a[72:75], a[224:227], v[0:3], 0
    ds_read_b128 a[240:243], v237 offset:61440
    v_cvt_pk_bf16_f32 v111, v174, v175
    v_mfma_f32_16x16x32_bf16 a[72:75], a[228:231], v[16:19], a[72:75]
    ds_read_b128 a[244:247], v237 offset:61696
    v_cvt_pk_bf16_f32 v112, v128, v129
    v_mfma_f32_16x16x32_bf16 a[72:75], a[232:235], v[32:35], a[72:75]
    s_mov_b32 s58, s57
    v_permlane16_swap_b32 v181, v183
    v_mfma_f32_16x16x32_bf16 a[72:75], a[236:239], v[48:51], a[72:75]
    s_mov_b32 s57, s37
    buffer_store_dwordx4 v[180:183], v243, s[24:27], s53 offen offset:128 sc1
    v_exp_f32 v131, v131
    v_exp_f32 v132, v132
    v_pk_fma_f32 v[134:135], v[134:135], s[88:89], v[230:231] op_sel_hi:[1,1,0]
    v_mfma_f32_16x16x32_bf16 a[88:91], a[236:239], v[52:55], 0
    ds_read_b128 a[248:251], v237 offset:61952
    v_cvt_pk_bf16_f32 v113, v130, v131
    v_mfma_f32_16x16x32_bf16 a[88:91], a[232:235], v[36:39], a[88:91]
    ds_read_b128 a[252:255], v237 offset:62208
    v_fmamk_f32 v136, v136, 0x3e0293ee, v232
    v_mfma_f32_16x16x32_bf16 a[88:91], a[228:231], v[20:23], a[88:91]
    s_add_u32 s37, s37, 33546240
    v_permlane16_swap_b32 v200, v202
    v_mfma_f32_16x16x32_bf16 a[88:91], a[224:227], v[4:7], a[88:91]
    s_cmp_eq_u32 s34, 5
    v_exp_f32 v133, v133
    v_mfma_f32_16x16x32_bf16 a[104:107], a[224:227], v[8:11], 0
    s_cselect_b32 s37, s67, s37
    v_exp_f32 v134, v134
    v_mfma_f32_16x16x32_bf16 a[104:107], a[228:231], v[24:27], a[104:107]
    s_cmp_eq_u32 s34, 5
    v_permlane16_swap_b32 v201, v203
    v_mfma_f32_16x16x32_bf16 a[104:107], a[232:235], v[40:43], a[104:107]
    s_cselect_b32 s41, 0, 16777216
    v_exp_f32 v135, v135
    v_mfma_f32_16x16x32_bf16 a[104:107], a[236:239], v[56:59], a[104:107]
    s_add_u32 s60, s60, s41
    buffer_store_dwordx4 v[200:203], v243, s[24:27], s53 offen offset:384 sc1
    v_exp_f32 v136, v136
    v_cvt_pk_bf16_f32 v116, v132, v133
    v_fmamk_f32 v137, v137, 0x3e0293ee, v232
    v_pk_fma_f32 v[138:139], v[138:139], s[88:89], v[232:233] op_sel_hi:[1,1,0]
    v_mfma_f32_16x16x32_bf16 a[120:123], a[236:239], v[60:63], 0
    s_cmp_eq_u32 s34, 5
    v_exp_f32 v137, v137
    v_mfma_f32_16x16x32_bf16 a[120:123], a[232:235], v[44:47], a[120:123]
    s_cselect_b32 s41, s66, s60
    v_exp_f32 v138, v138
    v_mfma_f32_16x16x32_bf16 a[120:123], a[228:231], v[28:31], a[120:123]
    s_mov_b64 vcc, s[74:75]
    v_exp_f32 v139, v139
    v_mfma_f32_16x16x32_bf16 a[120:123], a[224:227], v[12:15], a[120:123]
    s_waitcnt lgkmcnt(0)
    v_cvt_pk_bf16_f32 v117, v134, v135
    v_cndmask_b32_dpp v184, v204, v188, vcc quad_perm:[1,0,3,2] row_mask:0xf bank_mask:0xf
    v_mfma_f32_16x16x32_bf16 v[144:147], a[240:243], a[128:131], 0
    ds_read_b64_tr_b16 a[224:225], v244 offset:768
    v_cndmask_b32_dpp v185, v205, v189, vcc quad_perm:[1,0,3,2] row_mask:0xf bank_mask:0xf
    v_mfma_f32_16x16x32_bf16 v[144:147], a[244:247], a[132:135], v[144:147]
    ds_read_b64_tr_b16 a[226:227], v244 offset:4864
    v_cvt_pk_bf16_f32 v120, v136, v137
    v_mfma_f32_16x16x32_bf16 v[144:147], a[248:251], a[136:139], v[144:147]
    ds_read_b64_tr_b16 a[228:229], v244 offset:8960
    v_cndmask_b32_dpp v186, v206, v190, vcc quad_perm:[1,0,3,2] row_mask:0xf bank_mask:0xf
    v_mfma_f32_16x16x32_bf16 v[144:147], a[252:255], a[140:143], v[144:147]
    v_cndmask_b32_dpp v187, v207, v191, vcc quad_perm:[1,0,3,2] row_mask:0xf bank_mask:0xf
    s_mov_b64 vcc, s[76:77]
    v_cvt_pk_bf16_f32 v121, v138, v139
    v_cndmask_b32_dpp v204, v188, v204, vcc quad_perm:[1,0,3,2] row_mask:0xf bank_mask:0xf
    v_cndmask_b32_dpp v205, v189, v205, vcc quad_perm:[1,0,3,2] row_mask:0xf bank_mask:0xf
    v_pk_fma_f32 v[140:141], v[140:141], s[88:89], v[234:235] op_sel_hi:[1,1,0]
    v_pk_fma_f32 v[142:143], v[142:143], s[88:89], v[234:235] op_sel_hi:[1,1,0]
    v_mfma_f32_16x16x32_bf16 v[148:151], a[252:255], a[156:159], 0
    ds_read_b64_tr_b16 a[230:231], v244 offset:13056
    v_cndmask_b32_dpp v206, v190, v206, vcc quad_perm:[1,0,3,2] row_mask:0xf bank_mask:0xf
    v_mfma_f32_16x16x32_bf16 v[148:151], a[248:251], a[152:155], v[148:151]
    ds_read_b64_tr_b16 a[232:233], v244 offset:17152
    v_cndmask_b32_dpp v207, v191, v207, vcc quad_perm:[1,0,3,2] row_mask:0xf bank_mask:0xf
    v_mfma_f32_16x16x32_bf16 v[148:151], a[244:247], a[148:151], v[148:151]
    ds_read_b64_tr_b16 a[234:235], v244 offset:21248
    v_fmamk_f32 v144, v144, 0x3e0293ee, v228
    v_mfma_f32_16x16x32_bf16 v[148:151], a[240:243], a[144:147], v[148:151]
    v_exp_f32 v140, v140
    v_exp_f32 v141, v141
    v_mfma_f32_16x16x32_bf16 v[152:155], a[240:243], a[192:195], 0
    ds_read_b64_tr_b16 a[236:237], v244 offset:25344
    v_cvt_pk_bf16_f32 v124, v140, v141
    v_mfma_f32_16x16x32_bf16 v[152:155], a[244:247], a[196:199], v[152:155]
    ds_read_b64_tr_b16 a[238:239], v244 offset:29440
    v_fmamk_f32 v145, v145, 0x3e0293ee, v228
    v_mfma_f32_16x16x32_bf16 v[152:155], a[248:251], a[200:203], v[152:155]
    s_add_u32 s20, s64, s41
    v_exp_f32 v142, v142
    v_mfma_f32_16x16x32_bf16 v[152:155], a[252:255], a[204:207], v[152:155]
    s_addc_u32 s21, s65, 0
    v_exp_f32 v143, v143
    v_permlane16_swap_b32 v184, v186
    v_mfma_f32_16x16x32_bf16 v[156:159], a[252:255], a[220:223], 0
    s_xor_b32 s80, s37, s84
    v_exp_f32 v144, v144
    v_mfma_f32_16x16x32_bf16 v[156:159], a[248:251], a[216:219], v[156:159]
    s_xor_b32 s81, s80, 4096
    v_permlane16_swap_b32 v185, v187
    v_mfma_f32_16x16x32_bf16 v[156:159], a[244:247], a[212:215], v[156:159]
    s_xor_b32 s82, s80, 16384
    v_exp_f32 v145, v145
    v_mfma_f32_16x16x32_bf16 v[156:159], a[240:243], a[208:211], v[156:159]
    s_waitcnt lgkmcnt(0)
    buffer_store_dwordx4 v[184:187], v243, s[24:27], s54 offen offset:128 sc1
    v_permlane16_swap_b32 v204, v206
    v_cvt_pk_bf16_f32 v125, v142, v143
    v_cvt_pk_bf16_f32 v114, v144, v145
    v_pk_fma_f32 v[146:147], v[146:147], s[88:89], v[228:229] op_sel_hi:[1,1,0]
    v_pk_fma_f32 v[148:149], v[148:149], s[88:89], v[230:231] op_sel_hi:[1,1,0]
    v_pk_fma_f32 v[150:151], v[150:151], s[88:89], v[230:231] op_sel_hi:[1,1,0]
    v_mfma_f32_16x16x32_bf16 a[68:71], a[224:227], v[0:3], 0
    ds_read_b64_tr_b16 a[240:241], v245 offset:768
    v_fmamk_f32 v152, v152, 0x3e0293ee, v232
    v_mfma_f32_16x16x32_bf16 a[68:71], a[228:231], v[16:19], a[68:71]
    ds_read_b64_tr_b16 a[242:243], v245 offset:4864
    v_fmamk_f32 v153, v153, 0x3e0293ee, v232
    v_mfma_f32_16x16x32_bf16 a[68:71], a[232:235], v[32:35], a[68:71]
    ds_read_b64_tr_b16 a[244:245], v245 offset:8960
    v_fmamk_f32 v154, v154, 0x3e0293ee, v232
    v_mfma_f32_16x16x32_bf16 a[68:71], a[236:239], v[48:51], a[68:71]
    s_xor_b32 s83, s80, 20480
    v_exp_f32 v146, v146
    v_exp_f32 v147, v147
    v_mfma_f32_16x16x32_bf16 a[84:87], a[236:239], v[52:55], 0
    ds_read_b64_tr_b16 a[246:247], v245 offset:13056
    v_cvt_pk_bf16_f32 v115, v146, v147
    v_mfma_f32_16x16x32_bf16 a[84:87], a[232:235], v[36:39], a[84:87]
    ds_read_b64_tr_b16 a[248:249], v245 offset:17152
    v_fmamk_f32 v155, v155, 0x3e0293ee, v232
    v_mfma_f32_16x16x32_bf16 a[84:87], a[228:231], v[20:23], a[84:87]
    ds_read_b64_tr_b16 a[250:251], v245 offset:21248
    v_fmamk_f32 v156, v156, 0x3e0293ee, v234
    v_mfma_f32_16x16x32_bf16 a[84:87], a[224:227], v[4:7], a[84:87]
    v_exp_f32 v148, v148
    v_permlane16_swap_b32 v205, v207
    v_exp_f32 v149, v149
    v_mfma_f32_16x16x32_bf16 a[100:103], a[224:227], v[8:11], 0
    ds_read_b64_tr_b16 a[252:253], v245 offset:25344
    v_cvt_pk_bf16_f32 v118, v148, v149
    v_mfma_f32_16x16x32_bf16 a[100:103], a[228:231], v[24:27], a[100:103]
    ds_read_b64_tr_b16 a[254:255], v245 offset:29440
    s_mov_b64 vcc, s[74:75]
    v_mfma_f32_16x16x32_bf16 a[100:103], a[232:235], v[40:43], a[100:103]
    s_cmp_eq_u32 s34, 6
    v_exp_f32 v150, v150
    v_mfma_f32_16x16x32_bf16 a[100:103], a[236:239], v[56:59], a[100:103]
    s_cselect_b32 s14, 0, s14
    buffer_store_dwordx4 v[204:207], v243, s[24:27], s54 offen offset:384 sc1
    v_exp_f32 v151, v151
    v_exp_f32 v152, v152
    v_mfma_f32_16x16x32_bf16 a[116:119], a[236:239], v[60:63], 0
    s_cmp_eq_u32 s34, 6
    v_exp_f32 v153, v153
    v_mfma_f32_16x16x32_bf16 a[116:119], a[232:235], v[44:47], a[116:119]
    s_cselect_b32 s18, 0, s18
    v_exp_f32 v154, v154
    v_mfma_f32_16x16x32_bf16 a[116:119], a[228:231], v[28:31], a[116:119]
    v_exp_f32 v155, v155
    v_mfma_f32_16x16x32_bf16 a[116:119], a[224:227], v[12:15], a[116:119]
    s_waitcnt lgkmcnt(0)
    v_exp_f32 v156, v156
    v_cndmask_b32_dpp v188, v208, v192, vcc quad_perm:[1,0,3,2] row_mask:0xf bank_mask:0xf
    v_cvt_pk_bf16_f32 v119, v150, v151
    v_cndmask_b32_dpp v189, v209, v193, vcc quad_perm:[1,0,3,2] row_mask:0xf bank_mask:0xf
    v_cndmask_b32_dpp v190, v210, v194, vcc quad_perm:[1,0,3,2] row_mask:0xf bank_mask:0xf
    v_mfma_f32_16x16x32_bf16 a[76:79], a[240:243], v[0:3], 0
    s_waitcnt vmcnt(6)
    v_cndmask_b32_dpp v191, v211, v195, vcc quad_perm:[1,0,3,2] row_mask:0xf bank_mask:0xf
    v_cvt_pk_bf16_f32 v122, v152, v153
    v_mfma_f32_16x16x32_bf16 a[76:79], a[244:247], v[16:19], a[76:79]
    ds_read_b128 a[192:195], v239 offset:0
    s_mov_b64 vcc, s[76:77]
    v_mfma_f32_16x16x32_bf16 a[76:79], a[248:251], v[32:35], a[76:79]
    ds_read_b128 a[196:199], v239 offset:256
    v_fmamk_f32 v157, v157, 0x3e0293ee, v234
    v_mfma_f32_16x16x32_bf16 a[76:79], a[252:255], v[48:51], a[76:79]
    v_exp_f32 v157, v157
    v_cndmask_b32_dpp v208, v192, v208, vcc quad_perm:[1,0,3,2] row_mask:0xf bank_mask:0xf
    v_cndmask_b32_dpp v209, v193, v209, vcc quad_perm:[1,0,3,2] row_mask:0xf bank_mask:0xf
    v_mfma_f32_16x16x32_bf16 a[92:95], a[252:255], v[52:55], 0
    ds_read_b128 a[200:203], v239 offset:512
    v_cvt_pk_bf16_f32 v123, v154, v155
    v_mfma_f32_16x16x32_bf16 a[92:95], a[248:251], v[36:39], a[92:95]
    ds_read_b128 a[204:207], v239 offset:768
    v_cndmask_b32_dpp v210, v194, v210, vcc quad_perm:[1,0,3,2] row_mask:0xf bank_mask:0xf
    v_mfma_f32_16x16x32_bf16 a[92:95], a[244:247], v[20:23], a[92:95]
    ds_read_b128 a[208:211], v239 offset:4096
    v_cndmask_b32_dpp v211, v195, v211, vcc quad_perm:[1,0,3,2] row_mask:0xf bank_mask:0xf
    v_mfma_f32_16x16x32_bf16 a[92:95], a[240:243], v[4:7], a[92:95]
    v_permlane16_swap_b32 v188, v190
    v_cvt_pk_bf16_f32 v126, v156, v157
    v_permlane16_swap_b32 v189, v191
    v_pk_fma_f32 v[158:159], v[158:159], s[88:89], v[234:235] op_sel_hi:[1,1,0]
    v_exp_f32 v158, v158
    v_mfma_f32_16x16x32_bf16 a[108:111], a[240:243], v[8:11], 0
    ds_read_b128 a[212:215], v239 offset:4352
    v_mfma_f32_16x16x32_bf16 a[108:111], a[244:247], v[24:27], a[108:111]
    ds_read_b128 a[216:219], v239 offset:4608
    v_mfma_f32_16x16x32_bf16 a[108:111], a[248:251], v[40:43], a[108:111]
    ds_read_b128 a[220:223], v239 offset:4864
    v_mfma_f32_16x16x32_bf16 a[108:111], a[252:255], v[56:59], a[108:111]
    buffer_store_dwordx4 v[188:191], v243, s[24:27], s55 offen offset:128 sc1
    v_exp_f32 v159, v159
    v_permlane16_swap_b32 v208, v210
    v_mfma_f32_16x16x32_bf16 a[124:127], a[252:255], v[60:63], 0
    v_permlane16_swap_b32 v209, v211
    v_mfma_f32_16x16x32_bf16 a[124:127], a[248:251], v[44:47], a[124:127]
    v_cvt_pk_bf16_f32 v127, v158, v159
    v_mfma_f32_16x16x32_bf16 a[124:127], a[244:247], v[28:31], a[124:127]
    v_mfma_f32_16x16x32_bf16 a[124:127], a[240:243], v[12:15], a[124:127]
    s_barrier
    v_mfma_f32_16x16x32_bf16 v[160:163], v[248:251], v[64:67], 0
    ds_read_b128 a[224:227], v237 offset:0
    v_mfma_f32_16x16x32_bf16 v[160:163], v[248:251], v[80:83], v[160:163]
    ds_read_b128 a[228:231], v237 offset:256
    v_mfma_f32_16x16x32_bf16 v[160:163], v[248:251], v[96:99], v[160:163]
    v_mfma_f32_16x16x32_bf16 v[160:163], v[248:251], v[112:115], v[160:163]
    buffer_store_dwordx4 v[208:211], v243, s[24:27], s55 offen offset:384 sc1
    v_mfma_f32_16x16x32_bf16 v[164:167], v[248:251], v[68:71], 0
    ds_read_b128 a[232:235], v237 offset:512
    v_mfma_f32_16x16x32_bf16 v[164:167], v[248:251], v[84:87], v[164:167]
    ds_read_b128 a[236:239], v237 offset:768
    v_mfma_f32_16x16x32_bf16 v[164:167], v[248:251], v[100:103], v[164:167]
    v_mfma_f32_16x16x32_bf16 v[164:167], v[248:251], v[116:119], v[164:167]
    v_mfma_f32_16x16x32_bf16 v[168:171], v[248:251], v[72:75], 0
    v_mfma_f32_16x16x32_bf16 v[168:171], v[248:251], v[88:91], v[168:171]
    v_mfma_f32_16x16x32_bf16 v[168:171], v[248:251], v[104:107], v[168:171]
    v_mfma_f32_16x16x32_bf16 v[168:171], v[248:251], v[120:123], v[168:171]
    v_mfma_f32_16x16x32_bf16 v[172:175], v[248:251], v[76:79], 0
    v_mfma_f32_16x16x32_bf16 v[172:175], v[248:251], v[92:95], v[172:175]
    v_mfma_f32_16x16x32_bf16 v[172:175], v[248:251], v[108:111], v[172:175]
    v_mfma_f32_16x16x32_bf16 v[172:175], v[248:251], v[124:127], v[172:175]
    s_waitcnt lgkmcnt(0)
    s_add_u32 s34, s34, 1
    s_cmp_eq_u32 s34, 8
    s_cbranch_scc1 L_last
L_ph2f:
    s_cmp_lt_u32 s34, s38
    s_cbranch_scc0 L_nt75
    s_getpc_b64 s[72:73]
L_pc75:
    s_add_u32 s72, s72, L_ph3f-L_pc75
    s_addc_u32 s73, s73, (L_ph3f-L_pc75)>>32
    v_mbcnt_lo_u32_b32 v222, -1, 0
    v_mbcnt_hi_u32_b32 v222, -1, v222
    v_lshrrev_b32 v222, 2, v222
    v_lshl_add_u32 v222, s32, 4, v222
    v_lshlrev_b32 v222, 7, v222
    v_min_u32 v222, L_ph4f-L_ph3f, v222
    v_mov_b32 v223, s73
    v_add_co_u32 v222, vcc, s72, v222
    s_nop 1
    v_addc_co_u32 v223, vcc, 0, v223, vcc
    global_load_dword v254, v[222:223], off
L_nt75:
    v_mfma_f32_16x16x32_bf16 v[128:131], a[224:227], a[160:163], 0
    ds_read_b128 a[240:243], v237 offset:4096
    v_mfma_f32_16x16x32_bf16 v[128:131], a[228:231], a[164:167], v[128:131]
    ds_read_b128 a[244:247], v237 offset:4352
    v_mfma_f32_16x16x32_bf16 v[128:131], a[232:235], a[168:171], v[128:131]
    s_mov_b32 m0, s42
    v_mfma_f32_16x16x32_bf16 v[128:131], a[236:239], a[172:175], v[128:131]
    buffer_load_dwordx4 v246, s[12:15], s80 offen offset:0 nt lds
    v_max3_f32 v220, v160, v164, v168
    v_max_f32 v220, v220, v172
    v_mfma_f32_16x16x32_bf16 v[132:135], a[236:239], a[188:191], 0
    ds_read_b128 a[248:251], v237 offset:4608
    v_cmp_lt_f32 vcc, 0x5f800000, v220
    v_mfma_f32_16x16x32_bf16 v[132:135], a[232:235], a[184:187], v[132:135]
    ds_read_b128 a[252:255], v237 offset:4864
    s_cbranch_vccnz L_chk76_redo
L_chk76:
    v_mfma_f32_16x16x32_bf16 v[132:135], a[228:231], a[180:183], v[132:135]
    v_add_f32 v236, v229, v160
    v_add_f32 v238, v231, v164
    v_mfma_f32_16x16x32_bf16 v[132:135], a[224:227], a[176:179], v[132:135]
    v_add_f32 v240, v233, v168
    v_add_f32 v242, v235, v172
    v_rcp_f32 v236, v236
    v_mfma_f32_16x16x32_bf16 v[136:139], a[224:227], a[192:195], 0
    v_rcp_f32 v238, v238
    v_mfma_f32_16x16x32_bf16 v[136:139], a[228:231], a[196:199], v[136:139]
    v_rcp_f32 v240, v240
    v_mfma_f32_16x16x32_bf16 v[136:139], a[232:235], a[200:203], v[136:139]
    v_rcp_f32 v242, v242
    v_mfma_f32_16x16x32_bf16 v[136:139], a[236:239], a[204:207], v[136:139]
    v_max_f32 v220, v128, v129
    v_max3_f32 v220, v220, v130, v131
    v_mfma_f32_16x16x32_bf16 v[140:143], a[236:239], a[220:223], 0
    v_max_f32 v221, v132, v133
    v_max3_f32 v221, v221, v134, v135
    v_mfma_f32_16x16x32_bf16 v[140:143], a[232:235], a[216:219], v[140:143]
    v_mfma_f32_16x16x32_bf16 v[140:143], a[228:231], a[212:215], v[140:143]
    v_mfma_f32_16x16x32_bf16 v[140:143], a[224:227], a[208:211], v[140:143]
    s_waitcnt lgkmcnt(0)
    v_max_f32 v222, v136, v137
    v_max3_f32 v222, v222, v138, v139
    v_mfma_f32_16x16x32_bf16 v[144:147], a[240:243], a[160:163], 0
    ds_read_b64_tr_b16 a[224:225], v244 offset:32768
    v_mfma_f32_16x16x32_bf16 v[144:147], a[244:247], a[164:167], v[144:147]
    ds_read_b64_tr_b16 a[226:227], v244 offset:36864
    v_mfma_f32_16x16x32_bf16 v[144:147], a[248:251], a[168:171], v[144:147]
    ds_read_b64_tr_b16 a[228:229], v244 offset:40960
    v_max_f32 v223, v140, v141
    v_mfma_f32_16x16x32_bf16 v[144:147], a[252:255], a[172:175], v[144:147]
    v_max3_f32 v223, v223, v142, v143
    v_mfma_f32_16x16x32_bf16 v[148:151], a[252:255], a[188:191], 0
    ds_read_b64_tr_b16 a[230:231], v244 offset:45056
    v_mfma_f32_16x16x32_bf16 v[148:151], a[248:251], a[184:187], v[148:151]
    ds_read_b64_tr_b16 a[232:233], v244 offset:49152
    v_mfma_f32_16x16x32_bf16 v[148:151], a[244:247], a[180:183], v[148:151]
    ds_read_b64_tr_b16 a[234:235], v244 offset:53248
    s_mov_b32 m0, s42
    v_mfma_f32_16x16x32_bf16 v[148:151], a[240:243], a[176:179], v[148:151]
    buffer_load_dwordx4 v247, s[12:15], s80 offen offset:1024 nt lds
    v_permlane32_swap_b32 v220, v221
    v_permlane32_swap_b32 v222, v223
    v_max_f32 v224, v220, v221
    v_max_f32 v226, v222, v223
    v_mov_b32 v225, v224
    v_mfma_f32_16x16x32_bf16 v[152:155], a[240:243], a[192:195], 0
    ds_read_b64_tr_b16 a[236:237], v244 offset:57344
    v_mov_b32 v227, v226
    v_mfma_f32_16x16x32_bf16 v[152:155], a[244:247], a[196:199], v[152:155]
    ds_read_b64_tr_b16 a[238:239], v244 offset:61440
    v_mfma_f32_16x16x32_bf16 v[152:155], a[248:251], a[200:203], v[152:155]
    v_permlane16_swap_b32 v224, v225
    v_mfma_f32_16x16x32_bf16 v[152:155], a[252:255], a[204:207], v[152:155]
    v_permlane16_swap_b32 v226, v227
    v_max_f32 v224, v224, v225
    v_max_f32 v226, v226, v227
    v_mul_f32 v228, 0xbe0293ee, v224
    v_mul_f32 v232, 0xbe0293ee, v226
    v_mfma_f32_16x16x32_bf16 v[156:159], a[252:255], a[220:223], 0
    v_mul_f32 v230, 0xbe0293ee, v224
    v_mul_f32 v234, 0xbe0293ee, v226
    v_mfma_f32_16x16x32_bf16 v[156:159], a[248:251], a[216:219], v[156:159]
    v_permlane32_swap_b32 v228, v230
    v_mfma_f32_16x16x32_bf16 v[156:159], a[244:247], a[212:215], v[156:159]
    v_permlane32_swap_b32 v232, v234
    v_mfma_f32_16x16x32_bf16 v[156:159], a[240:243], a[208:211], v[156:159]
    s_waitcnt lgkmcnt(0)
    s_xor_b32 s52, s58, s84
    s_xor_b32 s53, s52, 4096
    s_xor_b32 s54, s52, 16384
    s_xor_b32 s55, s52, 20480
    s_mov_b32 s26, 0x8000000
    v_pk_fma_f32 v[128:129], v[128:129], s[88:89], v[228:229] op_sel_hi:[1,1,0]
    v_pk_fma_f32 v[130:131], v[130:131], s[88:89], v[228:229] op_sel_hi:[1,1,0]
    v_pk_fma_f32 v[132:133], v[132:133], s[88:89], v[230:231] op_sel_hi:[1,1,0]
    v_mfma_f32_16x16x32_bf16 a[0:3], a[224:227], v[64:67], a[0:3]
    ds_read_b128 a[240:243], v237 offset:8192
    v_fmamk_f32 v134, v134, 0x3e0293ee, v230
    v_mfma_f32_16x16x32_bf16 a[0:3], a[228:231], v[80:83], a[0:3]
    ds_read_b128 a[244:247], v237 offset:8448
    v_fmamk_f32 v135, v135, 0x3e0293ee, v230
    v_mfma_f32_16x16x32_bf16 a[0:3], a[232:235], v[96:99], a[0:3]
    v_exp_f32 v128, v128
    v_mfma_f32_16x16x32_bf16 a[0:3], a[236:239], v[112:115], a[0:3]
    v_exp_f32 v129, v129
    v_mfma_f32_16x16x32_bf16 a[16:19], a[236:239], v[116:119], a[16:19]
    ds_read_b128 a[248:251], v237 offset:8704
    v_cvt_pk_bf16_f32 v0, v128, v129
    v_mfma_f32_16x16x32_bf16 a[16:19], a[232:235], v[100:103], a[16:19]
    ds_read_b128 a[252:255], v237 offset:8960
    v_fmamk_f32 v136, v136, 0x3e0293ee, v232
    v_mfma_f32_16x16x32_bf16 a[16:19], a[228:231], v[84:87], a[16:19]
    v_exp_f32 v130, v130
    v_mfma_f32_16x16x32_bf16 a[16:19], a[224:227], v[68:71], a[16:19]
    v_exp_f32 v131, v131
    v_exp_f32 v132, v132
    v_mfma_f32_16x16x32_bf16 a[32:35], a[224:227], v[72:75], a[32:35]
    v_exp_f32 v133, v133
    v_mfma_f32_16x16x32_bf16 a[32:35], a[228:231], v[88:91], a[32:35]
    v_exp_f32 v134, v134
    v_mfma_f32_16x16x32_bf16 a[32:35], a[232:235], v[104:107], a[32:35]
    s_mov_b32 m0, s42
    v_exp_f32 v135, v135
    v_mfma_f32_16x16x32_bf16 a[32:35], a[236:239], v[120:123], a[32:35]
    buffer_load_dwordx4 v246, s[12:15], s80 offen offset:2048 nt lds
    v_cvt_pk_bf16_f32 v1, v130, v131
    v_mfma_f32_16x16x32_bf16 a[48:51], a[236:239], v[124:127], a[48:51]
    v_exp_f32 v136, v136
    v_mfma_f32_16x16x32_bf16 a[48:51], a[232:235], v[108:111], a[48:51]
    v_cvt_pk_bf16_f32 v4, v132, v133
    v_fmamk_f32 v137, v137, 0x3e0293ee, v232
    v_mfma_f32_16x16x32_bf16 a[48:51], a[228:231], v[92:95], a[48:51]
    v_exp_f32 v137, v137
    v_mfma_f32_16x16x32_bf16 a[48:51], a[224:227], v[76:79], a[48:51]
    s_waitcnt lgkmcnt(0)
    v_cvt_pk_bf16_f32 v5, v134, v135
    v_cvt_pk_bf16_f32 v8, v136, v137
    v_fmamk_f32 v138, v138, 0x3e0293ee, v232
    v_mfma_f32_16x16x32_bf16 v[160:163], a[240:243], a[160:163], 0
    ds_read_b64_tr_b16 a[224:225], v245 offset:32768
    v_fmamk_f32 v139, v139, 0x3e0293ee, v232
    v_mfma_f32_16x16x32_bf16 v[160:163], a[244:247], a[164:167], v[160:163]
    ds_read_b64_tr_b16 a[226:227], v245 offset:36864
    v_fmamk_f32 v140, v140, 0x3e0293ee, v234
    v_mfma_f32_16x16x32_bf16 v[160:163], a[248:251], a[168:171], v[160:163]
    ds_read_b64_tr_b16 a[228:229], v245 offset:40960
    v_fmamk_f32 v141, v141, 0x3e0293ee, v234
    v_mfma_f32_16x16x32_bf16 v[160:163], a[252:255], a[172:175], v[160:163]
    v_exp_f32 v138, v138
    v_exp_f32 v139, v139
    v_mfma_f32_16x16x32_bf16 v[164:167], a[252:255], a[188:191], 0
    ds_read_b64_tr_b16 a[230:231], v245 offset:45056
    v_cvt_pk_bf16_f32 v9, v138, v139
    v_mfma_f32_16x16x32_bf16 v[164:167], a[248:251], a[184:187], v[164:167]
    ds_read_b64_tr_b16 a[232:233], v245 offset:49152
    v_fmamk_f32 v142, v142, 0x3e0293ee, v234
    v_mfma_f32_16x16x32_bf16 v[164:167], a[244:247], a[180:183], v[164:167]
    ds_read_b64_tr_b16 a[234:235], v245 offset:53248
    v_fmamk_f32 v143, v143, 0x3e0293ee, v234
    v_mfma_f32_16x16x32_bf16 v[164:167], a[240:243], a[176:179], v[164:167]
    v_exp_f32 v140, v140
    v_exp_f32 v141, v141
    v_mfma_f32_16x16x32_bf16 v[168:171], a[240:243], a[192:195], 0
    ds_read_b64_tr_b16 a[236:237], v245 offset:57344
    v_cvt_pk_bf16_f32 v12, v140, v141
    v_mfma_f32_16x16x32_bf16 v[168:171], a[244:247], a[196:199], v[168:171]
    ds_read_b64_tr_b16 a[238:239], v245 offset:61440
    v_fmamk_f32 v144, v144, 0x3e0293ee, v228
    v_mfma_f32_16x16x32_bf16 v[168:171], a[248:251], a[200:203], v[168:171]
    v_exp_f32 v142, v142
    v_mfma_f32_16x16x32_bf16 v[168:171], a[252:255], a[204:207], v[168:171]
    v_exp_f32 v143, v143
    v_fmamk_f32 v145, v145, 0x3e0293ee, v228
    v_mfma_f32_16x16x32_bf16 v[172:175], a[252:255], a[220:223], 0
    v_exp_f32 v144, v144
    v_mfma_f32_16x16x32_bf16 v[172:175], a[248:251], a[216:219], v[172:175]
    v_exp_f32 v145, v145
    v_mfma_f32_16x16x32_bf16 v[172:175], a[244:247], a[212:215], v[172:175]
    s_mov_b32 m0, s42
    v_cvt_pk_bf16_f32 v13, v142, v143
    v_cvt_pk_bf16_f32 v2, v144, v145
    v_mfma_f32_16x16x32_bf16 v[172:175], a[240:243], a[208:211], v[172:175]
    s_waitcnt lgkmcnt(0)
    buffer_load_dwordx4 v247, s[12:15], s80 offen offset:3072 nt lds
    v_fmamk_f32 v146, v146, 0x3e0293ee, v228
    v_fmamk_f32 v147, v147, 0x3e0293ee, v228
    v_exp_f32 v146, v146
    v_pk_fma_f32 v[148:149], v[148:149], s[88:89], v[230:231] op_sel_hi:[1,1,0]
    v_pk_fma_f32 v[150:151], v[150:151], s[88:89], v[230:231] op_sel_hi:[1,1,0]
    v_mfma_f32_16x16x32_bf16 a[8:11], a[224:227], v[64:67], a[8:11]
    ds_read_b128 a[240:243], v237 offset:12288
    v_fmamk_f32 v152, v152, 0x3e0293ee, v232
    v_mfma_f32_16x16x32_bf16 a[8:11], a[228:231], v[80:83], a[8:11]
    ds_read_b128 a[244:247], v237 offset:12544
    v_fmamk_f32 v153, v153, 0x3e0293ee, v232
    v_mfma_f32_16x16x32_bf16 a[8:11], a[232:235], v[96:99], a[8:11]
    v_exp_f32 v147, v147
    v_mfma_f32_16x16x32_bf16 a[8:11], a[236:239], v[112:115], a[8:11]
    v_exp_f32 v148, v148
    v_mfma_f32_16x16x32_bf16 a[24:27], a[236:239], v[116:119], a[24:27]
    ds_read_b128 a[248:251], v237 offset:12800
    v_cvt_pk_bf16_f32 v3, v146, v147
    v_mfma_f32_16x16x32_bf16 a[24:27], a[232:235], v[100:103], a[24:27]
    ds_read_b128 a[252:255], v237 offset:13056
    v_fmamk_f32 v154, v154, 0x3e0293ee, v232
    v_mfma_f32_16x16x32_bf16 a[24:27], a[228:231], v[84:87], a[24:27]
    v_exp_f32 v149, v149
    v_mfma_f32_16x16x32_bf16 a[24:27], a[224:227], v[68:71], a[24:27]
    v_exp_f32 v150, v150
    v_cvt_pk_bf16_f32 v6, v148, v149
    v_mfma_f32_16x16x32_bf16 a[40:43], a[224:227], v[72:75], a[40:43]
    v_exp_f32 v151, v151
    v_mfma_f32_16x16x32_bf16 a[40:43], a[228:231], v[88:91], a[40:43]
    v_exp_f32 v152, v152
    v_mfma_f32_16x16x32_bf16 a[40:43], a[232:235], v[104:107], a[40:43]
    v_exp_f32 v153, v153
    v_mfma_f32_16x16x32_bf16 a[40:43], a[236:239], v[120:123], a[40:43]
    v_exp_f32 v154, v154
    v_cvt_pk_bf16_f32 v7, v150, v151
    v_fmamk_f32 v155, v155, 0x3e0293ee, v232
    v_mfma_f32_16x16x32_bf16 a[56:59], a[236:239], v[124:127], a[56:59]
    v_exp_f32 v155, v155
    v_mfma_f32_16x16x32_bf16 a[56:59], a[232:235], v[108:111], a[56:59]
    v_cvt_pk_bf16_f32 v10, v152, v153
    v_cvt_pk_bf16_f32 v11, v154, v155
    v_mfma_f32_16x16x32_bf16 a[56:59], a[228:231], v[92:95], a[56:59]
    v_fmamk_f32 v156, v156, 0x3e0293ee, v234
    v_fmamk_f32 v157, v157, 0x3e0293ee, v234
    v_mfma_f32_16x16x32_bf16 a[56:59], a[224:227], v[76:79], a[56:59]
    s_waitcnt lgkmcnt(0)
    v_exp_f32 v156, v156
    v_mfma_f32_16x16x32_bf16 v[128:131], a[240:243], a[160:163], 0
    ds_read_b64_tr_b16 a[224:225], v244 offset:33024
    v_fmamk_f32 v158, v158, 0x3e0293ee, v234
    v_mfma_f32_16x16x32_bf16 v[128:131], a[244:247], a[164:167], v[128:131]
    ds_read_b64_tr_b16 a[226:227], v244 offset:37120
    v_fmamk_f32 v159, v159, 0x3e0293ee, v234
    v_mfma_f32_16x16x32_bf16 v[128:131], a[248:251], a[168:171], v[128:131]
    ds_read_b64_tr_b16 a[228:229], v244 offset:41216
    s_mov_b32 m0, s43
    v_mfma_f32_16x16x32_bf16 v[128:131], a[252:255], a[172:175], v[128:131]
    buffer_load_dwordx4 v246, s[12:15], s81 offen offset:0 nt lds
    v_fmamk_f32 v160, v160, 0x3e0293ee, v228
    v_exp_f32 v157, v157
    v_mfma_f32_16x16x32_bf16 v[132:135], a[252:255], a[188:191], 0
    ds_read_b64_tr_b16 a[230:231], v244 offset:45312
    v_cvt_pk_bf16_f32 v14, v156, v157
    v_mfma_f32_16x16x32_bf16 v[132:135], a[248:251], a[184:187], v[132:135]
    ds_read_b64_tr_b16 a[232:233], v244 offset:49408
    v_fmamk_f32 v161, v161, 0x3e0293ee, v228
    v_mfma_f32_16x16x32_bf16 v[132:135], a[244:247], a[180:183], v[132:135]
    ds_read_b64_tr_b16 a[234:235], v244 offset:53504
    v_fmamk_f32 v162, v162, 0x3e0293ee, v228
    v_mfma_f32_16x16x32_bf16 v[132:135], a[240:243], a[176:179], v[132:135]
    v_exp_f32 v158, v158
    v_exp_f32 v159, v159
    v_exp_f32 v160, v160
    v_mfma_f32_16x16x32_bf16 v[136:139], a[240:243], a[192:195], 0
    ds_read_b64_tr_b16 a[236:237], v244 offset:57600
    v_cvt_pk_bf16_f32 v15, v158, v159
    v_mfma_f32_16x16x32_bf16 v[136:139], a[244:247], a[196:199], v[136:139]
    ds_read_b64_tr_b16 a[238:239], v244 offset:61696
    v_fmamk_f32 v163, v163, 0x3e0293ee, v228
    v_mfma_f32_16x16x32_bf16 v[136:139], a[248:251], a[200:203], v[136:139]
    v_exp_f32 v161, v161
    v_mfma_f32_16x16x32_bf16 v[136:139], a[252:255], a[204:207], v[136:139]
    v_exp_f32 v162, v162
    v_cvt_pk_bf16_f32 v16, v160, v161
    v_exp_f32 v163, v163
    v_pk_fma_f32 v[164:165], v[164:165], s[88:89], v[230:231] op_sel_hi:[1,1,0]
    v_pk_fma_f32 v[166:167], v[166:167], s[88:89], v[230:231] op_sel_hi:[1,1,0]
    v_mfma_f32_16x16x32_bf16 v[140:143], a[252:255], a[220:223], 0
    v_exp_f32 v164, v164
    v_mfma_f32_16x16x32_bf16 v[140:143], a[248:251], a[216:219], v[140:143]
    v_exp_f32 v165, v165
    v_mfma_f32_16x16x32_bf16 v[140:143], a[244:247], a[212:215], v[140:143]
    v_exp_f32 v166, v166
    v_mfma_f32_16x16x32_bf16 v[140:143], a[240:243], a[208:211], v[140:143]
    s_waitcnt lgkmcnt(0)
    v_exp_f32 v167, v167
    v_cvt_pk_bf16_f32 v17, v162, v163
    v_mfma_f32_16x16x32_bf16 a[4:7], a[224:227], v[64:67], a[4:7]
    ds_read_b128 a[240:243], v237 offset:16384
    v_cvt_pk_bf16_f32 v20, v164, v165
    v_mfma_f32_16x16x32_bf16 a[4:7], a[228:231], v[80:83], a[4:7]
    ds_read_b128 a[244:247], v237 offset:16640
    v_cvt_pk_bf16_f32 v21, v166, v167
    v_mfma_f32_16x16x32_bf16 a[4:7], a[232:235], v[96:99], a[4:7]
    v_fmamk_f32 v168, v168, 0x3e0293ee, v232
    v_fmamk_f32 v169, v169, 0x3e0293ee, v232
    v_mfma_f32_16x16x32_bf16 a[4:7], a[236:239], v[112:115], a[4:7]
    v_exp_f32 v168, v168
    v_mfma_f32_16x16x32_bf16 a[20:23], a[236:239], v[116:119], a[20:23]
    ds_read_b128 a[248:251], v237 offset:16896
    v_fmamk_f32 v170, v170, 0x3e0293ee, v232
    v_mfma_f32_16x16x32_bf16 a[20:23], a[232:235], v[100:103], a[20:23]
    ds_read_b128 a[252:255], v237 offset:17152
    v_fmamk_f32 v171, v171, 0x3e0293ee, v232
    v_mfma_f32_16x16x32_bf16 a[20:23], a[228:231], v[84:87], a[20:23]
    s_mov_b32 m0, s43
    v_exp_f32 v169, v169
    v_mfma_f32_16x16x32_bf16 a[20:23], a[224:227], v[68:71], a[20:23]
    buffer_load_dwordx4 v247, s[12:15], s81 offen offset:1024 nt lds
    v_cvt_pk_bf16_f32 v24, v168, v169
    v_mfma_f32_16x16x32_bf16 a[36:39], a[224:227], v[72:75], a[36:39]
    v_exp_f32 v170, v170
    v_mfma_f32_16x16x32_bf16 a[36:39], a[228:231], v[88:91], a[36:39]
    v_exp_f32 v171, v171
    v_mfma_f32_16x16x32_bf16 a[36:39], a[232:235], v[104:107], a[36:39]
    v_cvt_pk_bf16_f32 v25, v170, v171
    v_fmamk_f32 v172, v172, 0x3e0293ee, v234
    v_mfma_f32_16x16x32_bf16 a[36:39], a[236:239], v[120:123], a[36:39]
    v_exp_f32 v172, v172
    v_fmamk_f32 v173, v173, 0x3e0293ee, v234
    v_mfma_f32_16x16x32_bf16 a[52:55], a[236:239], v[124:127], a[52:55]
    v_exp_f32 v173, v173
    v_mfma_f32_16x16x32_bf16 a[52:55], a[232:235], v[108:111], a[52:55]
    v_cvt_pk_bf16_f32 v28, v172, v173
    v_fmamk_f32 v174, v174, 0x3e0293ee, v234
    v_mfma_f32_16x16x32_bf16 a[52:55], a[228:231], v[92:95], a[52:55]
    v_exp_f32 v174, v174
    v_mfma_f32_16x16x32_bf16 a[52:55], a[224:227], v[76:79], a[52:55]
    s_waitcnt lgkmcnt(0)
    v_fmamk_f32 v175, v175, 0x3e0293ee, v234
    v_fmamk_f32 v128, v128, 0x3e0293ee, v228
    v_mfma_f32_16x16x32_bf16 v[144:147], a[240:243], a[160:163], 0
    ds_read_b64_tr_b16 a[224:225], v245 offset:33024
    v_fmamk_f32 v129, v129, 0x3e0293ee, v228
    v_mfma_f32_16x16x32_bf16 v[144:147], a[244:247], a[164:167], v[144:147]
    ds_read_b64_tr_b16 a[226:227], v245 offset:37120
    v_fmamk_f32 v130, v130, 0x3e0293ee, v228
    v_mfma_f32_16x16x32_bf16 v[144:147], a[248:251], a[168:171], v[144:147]
    ds_read_b64_tr_b16 a[228:229], v245 offset:41216
    v_fmamk_f32 v131, v131, 0x3e0293ee, v228
    v_mfma_f32_16x16x32_bf16 v[144:147], a[252:255], a[172:175], v[144:147]
    v_exp_f32 v175, v175
    v_exp_f32 v128, v128
    v_mfma_f32_16x16x32_bf16 v[148:151], a[252:255], a[188:191], 0
    ds_read_b64_tr_b16 a[230:231], v245 offset:45312
    v_cvt_pk_bf16_f32 v29, v174, v175
    v_mfma_f32_16x16x32_bf16 v[148:151], a[248:251], a[184:187], v[148:151]
    ds_read_b64_tr_b16 a[232:233], v245 offset:49408
    v_fmamk_f32 v132, v132, 0x3e0293ee, v230
    v_mfma_f32_16x16x32_bf16 v[148:151], a[244:247], a[180:183], v[148:151]
    ds_read_b64_tr_b16 a[234:235], v245 offset:53504
    v_fmamk_f32 v133, v133, 0x3e0293ee, v230
    v_mfma_f32_16x16x32_bf16 v[148:151], a[240:243], a[176:179], v[148:151]
    v_exp_f32 v129, v129
    v_exp_f32 v130, v130
    v_cvt_pk_bf16_f32 v18, v128, v129
    v_pk_fma_f32 v[134:135], v[134:135], s[88:89], v[230:231] op_sel_hi:[1,1,0]
    v_pk_fma_f32 v[136:137], v[136:137], s[88:89], v[232:233] op_sel_hi:[1,1,0]
    v_exp_f32 v131, v131
    v_mfma_f32_16x16x32_bf16 v[152:155], a[240:243], a[192:195], 0
    ds_read_b64_tr_b16 a[236:237], v245 offset:57600
    v_cvt_pk_bf16_f32 v19, v130, v131
    v_mfma_f32_16x16x32_bf16 v[152:155], a[244:247], a[196:199], v[152:155]
    ds_read_b64_tr_b16 a[238:239], v245 offset:61696
    v_fmamk_f32 v138, v138, 0x3e0293ee, v232
    v_mfma_f32_16x16x32_bf16 v[152:155], a[248:251], a[200:203], v[152:155]
    s_mov_b32 m0, s43
    v_exp_f32 v132, v132
    v_mfma_f32_16x16x32_bf16 v[152:155], a[252:255], a[204:207], v[152:155]
    buffer_load_dwordx4 v246, s[12:15], s81 offen offset:2048 nt lds
    v_fmamk_f32 v139, v139, 0x3e0293ee, v232
    v_exp_f32 v133, v133
    v_mfma_f32_16x16x32_bf16 v[156:159], a[252:255], a[220:223], 0
    v_exp_f32 v134, v134
    v_mfma_f32_16x16x32_bf16 v[156:159], a[248:251], a[216:219], v[156:159]
    v_exp_f32 v135, v135
    v_mfma_f32_16x16x32_bf16 v[156:159], a[244:247], a[212:215], v[156:159]
    v_exp_f32 v136, v136
    v_mfma_f32_16x16x32_bf16 v[156:159], a[240:243], a[208:211], v[156:159]
    s_waitcnt lgkmcnt(0)
    v_exp_f32 v137, v137
    v_cvt_pk_bf16_f32 v22, v132, v133
    v_mfma_f32_16x16x32_bf16 a[12:15], a[224:227], v[64:67], a[12:15]
    ds_read_b128 a[240:243], v237 offset:20480
    v_cvt_pk_bf16_f32 v23, v134, v135
    v_mfma_f32_16x16x32_bf16 a[12:15], a[228:231], v[80:83], a[12:15]
    ds_read_b128 a[244:247], v237 offset:20736
    v_cvt_pk_bf16_f32 v26, v136, v137
    v_mfma_f32_16x16x32_bf16 a[12:15], a[232:235], v[96:99], a[12:15]
    v_exp_f32 v138, v138
    v_mfma_f32_16x16x32_bf16 a[12:15], a[236:239], v[112:115], a[12:15]
    v_exp_f32 v139, v139
    v_mfma_f32_16x16x32_bf16 a[28:31], a[236:239], v[116:119], a[28:31]
    ds_read_b128 a[248:251], v237 offset:20992
    v_cvt_pk_bf16_f32 v27, v138, v139
    v_mfma_f32_16x16x32_bf16 a[28:31], a[232:235], v[100:103], a[28:31]
    ds_read_b128 a[252:255], v237 offset:21248
    v_fmamk_f32 v140, v140, 0x3e0293ee, v234
    v_mfma_f32_16x16x32_bf16 a[28:31], a[228:231], v[84:87], a[28:31]
    v_exp_f32 v140, v140
    v_mfma_f32_16x16x32_bf16 a[28:31], a[224:227], v[68:71], a[28:31]
    v_fmamk_f32 v141, v141, 0x3e0293ee, v234
    v_fmamk_f32 v142, v142, 0x3e0293ee, v234
    v_mfma_f32_16x16x32_bf16 a[44:47], a[224:227], v[72:75], a[44:47]
    v_exp_f32 v141, v141
    v_mfma_f32_16x16x32_bf16 a[44:47], a[228:231], v[88:91], a[44:47]
    v_exp_f32 v142, v142
    v_mfma_f32_16x16x32_bf16 a[44:47], a[232:235], v[104:107], a[44:47]
    v_fmamk_f32 v143, v143, 0x3e0293ee, v234
    v_cvt_pk_bf16_f32 v30, v140, v141
    v_mfma_f32_16x16x32_bf16 a[44:47], a[236:239], v[120:123], a[44:47]
    v_exp_f32 v143, v143
    v_accvgpr_read_b32 v212, a0
    v_cvt_pk_bf16_f32 v31, v142, v143
    v_fmamk_f32 v144, v144, 0x3e0293ee, v228
    v_mfma_f32_16x16x32_bf16 a[60:63], a[236:239], v[124:127], a[60:63]
    v_exp_f32 v144, v144
    v_mfma_f32_16x16x32_bf16 a[60:63], a[232:235], v[108:111], a[60:63]
    v_fmamk_f32 v145, v145, 0x3e0293ee, v228
    v_accvgpr_read_b32 v213, a1
    v_mfma_f32_16x16x32_bf16 a[60:63], a[228:231], v[92:95], a[60:63]
    s_mov_b32 m0, s43
    v_exp_f32 v145, v145
    v_mfma_f32_16x16x32_bf16 a[60:63], a[224:227], v[76:79], a[60:63]
    s_waitcnt lgkmcnt(0)
    buffer_load_dwordx4 v247, s[12:15], s81 offen offset:3072 nt lds
    v_cvt_pk_bf16_f32 v32, v144, v145
    v_accvgpr_read_b32 v214, a2
    v_accvgpr_read_b32 v215, a3
    v_pk_fma_f32 v[146:147], v[146:147], s[88:89], v[228:229] op_sel_hi:[1,1,0]
    v_pk_fma_f32 v[148:149], v[148:149], s[88:89], v[230:231] op_sel_hi:[1,1,0]
    v_pk_fma_f32 v[150:151], v[150:151], s[88:89], v[230:231] op_sel_hi:[1,1,0]
    v_mfma_f32_16x16x32_bf16 v[160:163], a[240:243], a[160:163], 0
    ds_read_b64_tr_b16 a[224:225], v244 offset:33280
    v_fmamk_f32 v152, v152, 0x3e0293ee, v232
    v_mfma_f32_16x16x32_bf16 v[160:163], a[244:247], a[164:167], v[160:163]
    ds_read_b64_tr_b16 a[226:227], v244 offset:37376
    v_fmamk_f32 v153, v153, 0x3e0293ee, v232
    v_mfma_f32_16x16x32_bf16 v[160:163], a[248:251], a[168:171], v[160:163]
    ds_read_b64_tr_b16 a[228:229], v244 offset:41472
    v_accvgpr_read_b32 v216, a4
    v_mfma_f32_16x16x32_bf16 v[160:163], a[252:255], a[172:175], v[160:163]
    v_exp_f32 v146, v146
    v_exp_f32 v147, v147
    v_mfma_f32_16x16x32_bf16 v[164:167], a[252:255], a[188:191], 0
    ds_read_b64_tr_b16 a[230:231], v244 offset:45568
    v_cvt_pk_bf16_f32 v33, v146, v147
    v_mfma_f32_16x16x32_bf16 v[164:167], a[248:251], a[184:187], v[164:167]
    ds_read_b64_tr_b16 a[232:233], v244 offset:49664
    v_accvgpr_read_b32 v217, a5
    v_mfma_f32_16x16x32_bf16 v[164:167], a[244:247], a[180:183], v[164:167]
    ds_read_b64_tr_b16 a[234:235], v244 offset:53760
    v_accvgpr_read_b32 v218, a6
    v_mfma_f32_16x16x32_bf16 v[164:167], a[240:243], a[176:179], v[164:167]
    v_exp_f32 v148, v148
    v_exp_f32 v149, v149
    v_mfma_f32_16x16x32_bf16 v[168:171], a[240:243], a[192:195], 0
    ds_read_b64_tr_b16 a[236:237], v244 offset:57856
    v_cvt_pk_bf16_f32 v36, v148, v149
    v_mfma_f32_16x16x32_bf16 v[168:171], a[244:247], a[196:199], v[168:171]
    ds_read_b64_tr_b16 a[238:239], v244 offset:61952
    v_accvgpr_read_b32 v219, a7
    v_mfma_f32_16x16x32_bf16 v[168:171], a[248:251], a[200:203], v[168:171]
    v_exp_f32 v150, v150
    v_mfma_f32_16x16x32_bf16 v[168:171], a[252:255], a[204:207], v[168:171]
    v_exp_f32 v151, v151
    v_exp_f32 v152, v152
    v_cvt_pk_bf16_f32 v37, v150, v151
    v_pk_mul_f32 v[212:213], v[212:213], v[236:237] op_sel_hi:[1,0]
    v_pk_fma_f32 v[154:155], v[154:155], s[88:89], v[232:233] op_sel_hi:[1,1,0]
    v_pk_mul_f32 v[214:215], v[214:215], v[236:237] op_sel_hi:[1,0]
    v_pk_fma_f32 v[156:157], v[156:157], s[88:89], v[234:235] op_sel_hi:[1,1,0]
    v_pk_mul_f32 v[216:217], v[216:217], v[236:237] op_sel_hi:[1,0]
    v_mfma_f32_16x16x32_bf16 v[172:175], a[252:255], a[220:223], 0
    v_exp_f32 v153, v153
    v_mfma_f32_16x16x32_bf16 v[172:175], a[248:251], a[216:219], v[172:175]
    v_exp_f32 v154, v154
    v_mfma_f32_16x16x32_bf16 v[172:175], a[244:247], a[212:215], v[172:175]
    v_exp_f32 v155, v155
    v_mfma_f32_16x16x32_bf16 v[172:175], a[240:243], a[208:211], v[172:175]
    s_waitcnt lgkmcnt(0)
    v_exp_f32 v156, v156
    v_mfma_f32_16x16x32_bf16 a[64:67], a[224:227], v[64:67], a[64:67]
    ds_read_b128 a[240:243], v237 offset:24576
    v_cvt_pk_bf16_f32 v40, v152, v153
    v_mfma_f32_16x16x32_bf16 a[64:67], a[228:231], v[80:83], a[64:67]
    ds_read_b128 a[244:247], v237 offset:24832
    v_cvt_pk_bf16_f32 v180, v212, v213
    v_mfma_f32_16x16x32_bf16 a[64:67], a[232:235], v[96:99], a[64:67]
    v_exp_f32 v157, v157
    v_mfma_f32_16x16x32_bf16 a[64:67], a[236:239], v[112:115], a[64:67]
    v_accvgpr_read_b32 v220, a8
    v_cvt_pk_bf16_f32 v41, v154, v155
    v_accvgpr_read_b32 v221, a9
    v_cvt_pk_bf16_f32 v181, v214, v215
    v_accvgpr_read_b32 v222, a10
    v_pk_fma_f32 v[158:159], v[158:159], s[88:89], v[234:235] op_sel_hi:[1,1,0]
    v_pk_mul_f32 v[218:219], v[218:219], v[236:237] op_sel_hi:[1,0]
    v_pk_fma_f32 v[160:161], v[160:161], s[88:89], v[228:229] op_sel_hi:[1,1,0]
    v_pk_mul_f32 v[220:221], v[220:221], v[236:237] op_sel_hi:[1,0]
    v_pk_fma_f32 v[162:163], v[162:163], s[88:89], v[228:229] op_sel_hi:[1,1,0]
    v_mfma_f32_16x16x32_bf16 a[80:83], a[236:239], v[116:119], a[80:83]
    ds_read_b128 a[248:251], v237 offset:25088
    v_cvt_pk_bf16_f32 v44, v156, v157
    v_mfma_f32_16x16x32_bf16 a[80:83], a[232:235], v[100:103], a[80:83]
    ds_read_b128 a[252:255], v237 offset:25344
    v_accvgpr_read_b32 v223, a11
    v_mfma_f32_16x16x32_bf16 a[80:83], a[228:231], v[84:87], a[80:83]
    v_exp_f32 v158, v158
    v_mfma_f32_16x16x32_bf16 a[80:83], a[224:227], v[68:71], a[80:83]
    v_exp_f32 v159, v159
    v_mfma_f32_16x16x32_bf16 a[96:99], a[224:227], v[72:75], a[96:99]
    v_exp_f32 v160, v160
    v_mfma_f32_16x16x32_bf16 a[96:99], a[228:231], v[88:91], a[96:99]
    v_exp_f32 v161, v161
    v_mfma_f32_16x16x32_bf16 a[96:99], a[232:235], v[104:107], a[96:99]
    v_exp_f32 v162, v162
    v_mfma_f32_16x16x32_bf16 a[96:99], a[236:239], v[120:123], a[96:99]
    v_exp_f32 v163, v163
    v_cvt_pk_bf16_f32 v182, v216, v217
    v_accvgpr_read_b32 v224, a12
    v_cvt_pk_bf16_f32 v45, v158, v159
    v_pk_mul_f32 v[222:223], v[222:223], v[236:237] op_sel_hi:[1,0]
    v_pk_fma_f32 v[164:165], v[164:165], s[88:89], v[230:231] op_sel_hi:[1,1,0]
    v_pk_fma_f32 v[166:167], v[166:167], s[88:89], v[230:231] op_sel_hi:[1,1,0]
    v_accvgpr_read_b32 v225, a13
    v_pk_mul_f32 v[224:225], v[224:225], v[236:237] op_sel_hi:[1,0]
    v_cvt_pk_bf16_f32 v183, v218, v219
    v_mfma_f32_16x16x32_bf16 a[112:115], a[236:239], v[124:127], a[112:115]
    v_exp_f32 v164, v164
    v_mfma_f32_16x16x32_bf16 a[112:115], a[232:235], v[108:111], a[112:115]
    v_exp_f32 v165, v165
    v_mfma_f32_16x16x32_bf16 a[112:115], a[228:231], v[92:95], a[112:115]
    v_exp_f32 v166, v166
    v_mfma_f32_16x16x32_bf16 a[112:115], a[224:227], v[76:79], a[112:115]
    s_waitcnt lgkmcnt(0)
    v_accvgpr_read_b32 v226, a14
    v_accvgpr_read_b32 v227, a15
    v_cvt_pk_bf16_f32 v34, v160, v161
    v_cvt_pk_bf16_f32 v196, v220, v221
    v_accvgpr_read_b32 v212, a16
    v_pk_mul_f32 v[226:227], v[226:227], v[236:237] op_sel_hi:[1,0]
    v_pk_fma_f32 v[168:169], v[168:169], s[88:89], v[232:233] op_sel_hi:[1,1,0]
    v_mfma_f32_16x16x32_bf16 v[128:131], a[240:243], a[160:163], 0
    ds_read_b64_tr_b16 a[224:225], v245 offset:33280
    v_accvgpr_read_b32 v213, a17
    v_mfma_f32_16x16x32_bf16 v[128:131], a[244:247], a[164:167], v[128:131]
    ds_read_b64_tr_b16 a[226:227], v245 offset:37376
    v_cvt_pk_bf16_f32 v35, v162, v163
    v_mfma_f32_16x16x32_bf16 v[128:131], a[248:251], a[168:171], v[128:131]
    ds_read_b64_tr_b16 a[228:229], v245 offset:41472
    v_cvt_pk_bf16_f32 v197, v222, v223
    v_mfma_f32_16x16x32_bf16 v[128:131], a[252:255], a[172:175], v[128:131]
    s_mov_b64 vcc, s[74:75]
    v_exp_f32 v167, v167
    v_accvgpr_read_b32 v214, a18
    v_accvgpr_read_b32 v215, a19
    v_cvt_pk_bf16_f32 v38, v164, v165
    v_pk_mul_f32 v[212:213], v[212:213], v[238:239] op_sel_hi:[1,0]
    v_pk_mul_f32 v[214:215], v[214:215], v[238:239] op_sel_hi:[1,0]
    v_pk_fma_f32 v[170:171], v[170:171], s[88:89], v[232:233] op_sel_hi:[1,1,0]
    v_mfma_f32_16x16x32_bf16 v[132:135], a[252:255], a[188:191], 0
    ds_read_b64_tr_b16 a[230:231], v245 offset:45568
    v_cvt_pk_bf16_f32 v198, v224, v225
    v_mfma_f32_16x16x32_bf16 v[132:135], a[248:251], a[184:187], v[132:135]
    ds_read_b64_tr_b16 a[232:233], v245 offset:49664
    v_accvgpr_read_b32 v216, a20
    v_mfma_f32_16x16x32_bf16 v[132:135], a[244:247], a[180:183], v[132:135]
    ds_read_b64_tr_b16 a[234:235], v245 offset:53760
    v_accvgpr_read_b32 v217, a21
    v_mfma_f32_16x16x32_bf16 v[132:135], a[240:243], a[176:179], v[132:135]
    v_exp_f32 v168, v168
    v_cvt_pk_bf16_f32 v199, v226, v227
    v_mfma_f32_16x16x32_bf16 v[136:139], a[240:243], a[192:195], 0
    ds_read_b64_tr_b16 a[236:237], v245 offset:57856
    v_cvt_pk_bf16_f32 v39, v166, v167
    v_mfma_f32_16x16x32_bf16 v[136:139], a[244:247], a[196:199], v[136:139]
    ds_read_b64_tr_b16 a[238:239], v245 offset:61952
    v_accvgpr_read_b32 v218, a22
    v_mfma_f32_16x16x32_bf16 v[136:139], a[248:251], a[200:203], v[136:139]
    v_exp_f32 v169, v169
    v_mfma_f32_16x16x32_bf16 v[136:139], a[252:255], a[204:207], v[136:139]
    v_exp_f32 v170, v170
    v_cndmask_b32_dpp v176, v196, v180, vcc quad_perm:[1,0,3,2] row_mask:0xf bank_mask:0xf
    v_accvgpr_read_b32 v219, a23
    v_cndmask_b32_dpp v177, v197, v181, vcc quad_perm:[1,0,3,2] row_mask:0xf bank_mask:0xf
    v_pk_mul_f32 v[216:217], v[216:217], v[238:239] op_sel_hi:[1,0]
    v_pk_fma_f32 v[172:173], v[172:173], s[88:89], v[234:235] op_sel_hi:[1,1,0]
    v_pk_mul_f32 v[218:219], v[218:219], v[238:239] op_sel_hi:[1,0]
    v_pk_fma_f32 v[174:175], v[174:175], s[88:89], v[234:235] op_sel_hi:[1,1,0]
    v_pk_fma_f32 v[128:129], v[128:129], s[88:89], v[228:229] op_sel_hi:[1,1,0]
    v_cvt_pk_bf16_f32 v184, v212, v213
    v_cndmask_b32_dpp v178, v198, v182, vcc quad_perm:[1,0,3,2] row_mask:0xf bank_mask:0xf
    v_accvgpr_read_b32 v220, a24
    v_cvt_pk_bf16_f32 v42, v168, v169
    v_cndmask_b32_dpp v179, v199, v183, vcc quad_perm:[1,0,3,2] row_mask:0xf bank_mask:0xf
    v_exp_f32 v171, v171
    v_mfma_f32_16x16x32_bf16 v[140:143], a[252:255], a[220:223], 0
    s_mov_b64 vcc, s[76:77]
    v_exp_f32 v172, v172
    v_mfma_f32_16x16x32_bf16 v[140:143], a[248:251], a[216:219], v[140:143]
    v_exp_f32 v173, v173
    v_mfma_f32_16x16x32_bf16 v[140:143], a[244:247], a[212:215], v[140:143]
    v_exp_f32 v174, v174
    v_mfma_f32_16x16x32_bf16 v[140:143], a[240:243], a[208:211], v[140:143]
    s_waitcnt lgkmcnt(0)
    v_exp_f32 v175, v175
    v_cndmask_b32_dpp v196, v180, v196, vcc quad_perm:[1,0,3,2] row_mask:0xf bank_mask:0xf
    v_accvgpr_read_b32 v221, a25
    v_cndmask_b32_dpp v197, v181, v197, vcc quad_perm:[1,0,3,2] row_mask:0xf bank_mask:0xf
    v_pk_mul_f32 v[220:221], v[220:221], v[238:239] op_sel_hi:[1,0]
    v_pk_fma_f32 v[130:131], v[130:131], s[88:89], v[228:229] op_sel_hi:[1,1,0]
    v_cvt_pk_bf16_f32 v185, v214, v215
    v_cndmask_b32_dpp v198, v182, v198, vcc quad_perm:[1,0,3,2] row_mask:0xf bank_mask:0xf
    v_accvgpr_read_b32 v222, a26
    v_cndmask_b32_dpp v199, v183, v199, vcc quad_perm:[1,0,3,2] row_mask:0xf bank_mask:0xf
    v_cvt_pk_bf16_f32 v43, v170, v171
    v_permlane16_swap_b32 v176, v178
    v_mfma_f32_16x16x32_bf16 a[72:75], a[224:227], v[64:67], a[72:75]
    ds_read_b128 a[240:243], v237 offset:28672
    v_accvgpr_read_b32 v223, a27
    v_mfma_f32_16x16x32_bf16 a[72:75], a[228:231], v[80:83], a[72:75]
    ds_read_b128 a[244:247], v237 offset:28928
    v_cvt_pk_bf16_f32 v186, v216, v217
    v_mfma_f32_16x16x32_bf16 a[72:75], a[232:235], v[96:99], a[72:75]
    v_permlane16_swap_b32 v177, v179
    v_mfma_f32_16x16x32_bf16 a[72:75], a[236:239], v[112:115], a[72:75]
    buffer_store_dwordx4 v[176:179], v243, s[24:27], s52 offen offset:0 sc1
    v_permlane16_swap_b32 v196, v198
    v_exp_f32 v128, v128
    v_pk_mul_f32 v[222:223], v[222:223], v[238:239] op_sel_hi:[1,0]
    v_pk_fma_f32 v[132:133], v[132:133], s[88:89], v[230:231] op_sel_hi:[1,1,0]
    v_accvgpr_read_b32 v224, a28
    v_cvt_pk_bf16_f32 v46, v172, v173
    v_accvgpr_read_b32 v225, a29
    v_pk_mul_f32 v[224:225], v[224:225], v[238:239] op_sel_hi:[1,0]
    v_cvt_pk_bf16_f32 v187, v218, v219
    v_mfma_f32_16x16x32_bf16 a[88:91], a[236:239], v[116:119], a[88:91]
    ds_read_b128 a[248:251], v237 offset:29184
    v_accvgpr_read_b32 v226, a30
    v_mfma_f32_16x16x32_bf16 a[88:91], a[232:235], v[100:103], a[88:91]
    ds_read_b128 a[252:255], v237 offset:29440
    v_cvt_pk_bf16_f32 v47, v174, v175
    v_mfma_f32_16x16x32_bf16 a[88:91], a[228:231], v[84:87], a[88:91]
    v_permlane16_swap_b32 v197, v199
    v_mfma_f32_16x16x32_bf16 a[88:91], a[224:227], v[68:71], a[88:91]
    s_mov_b64 vcc, s[74:75]
    buffer_store_dwordx4 v[196:199], v243, s[24:27], s52 offen offset:256 sc1
    v_exp_f32 v129, v129
    v_exp_f32 v130, v130
    v_pk_fma_f32 v[134:135], v[134:135], s[88:89], v[230:231] op_sel_hi:[1,1,0]
    v_accvgpr_read_b32 v227, a31
    v_pk_mul_f32 v[226:227], v[226:227], v[238:239] op_sel_hi:[1,0]
    v_cvt_pk_bf16_f32 v200, v220, v221
    v_accvgpr_read_b32 v212, a32
    v_mfma_f32_16x16x32_bf16 a[104:107], a[224:227], v[72:75], a[104:107]
    v_exp_f32 v131, v131
    v_mfma_f32_16x16x32_bf16 a[104:107], a[228:231], v[88:91], a[104:107]
    v_exp_f32 v132, v132
    v_mfma_f32_16x16x32_bf16 a[104:107], a[232:235], v[104:107], a[104:107]
    v_exp_f32 v133, v133
    v_mfma_f32_16x16x32_bf16 a[104:107], a[236:239], v[120:123], a[104:107]
    v_exp_f32 v134, v134
    v_cvt_pk_bf16_f32 v48, v128, v129
    v_accvgpr_read_b32 v213, a33
    v_cvt_pk_bf16_f32 v201, v222, v223
    v_pk_mul_f32 v[212:213], v[212:213], v[240:241] op_sel_hi:[1,0]
    v_pk_fma_f32 v[136:137], v[136:137], s[88:89], v[232:233] op_sel_hi:[1,1,0]
    v_accvgpr_read_b32 v214, a34
    v_mfma_f32_16x16x32_bf16 a[120:123], a[236:239], v[124:127], a[120:123]
    v_exp_f32 v135, v135
    v_mfma_f32_16x16x32_bf16 a[120:123], a[232:235], v[108:111], a[120:123]
    v_exp_f32 v136, v136
    v_mfma_f32_16x16x32_bf16 a[120:123], a[228:231], v[92:95], a[120:123]
    v_exp_f32 v137, v137
    v_mfma_f32_16x16x32_bf16 a[120:123], a[224:227], v[76:79], a[120:123]
    s_waitcnt lgkmcnt(0)
    v_accvgpr_read_b32 v215, a35
    v_cvt_pk_bf16_f32 v49, v130, v131
    v_cvt_pk_bf16_f32 v202, v224, v225
    v_accvgpr_read_b32 v216, a36
    v_accvgpr_read_b32 v217, a37
    v_pk_mul_f32 v[214:215], v[214:215], v[240:241] op_sel_hi:[1,0]
    v_pk_mul_f32 v[216:217], v[216:217], v[240:241] op_sel_hi:[1,0]
    v_pk_fma_f32 v[138:139], v[138:139], s[88:89], v[232:233] op_sel_hi:[1,1,0]
    v_pk_fma_f32 v[140:141], v[140:141], s[88:89], v[234:235] op_sel_hi:[1,1,0]
    v_mfma_f32_16x16x32_bf16 v[144:147], a[240:243], a[160:163], 0
    ds_read_b64_tr_b16 a[224:225], v244 offset:33536
    v_cvt_pk_bf16_f32 v52, v132, v133
    v_mfma_f32_16x16x32_bf16 v[144:147], a[244:247], a[164:167], v[144:147]
    ds_read_b64_tr_b16 a[226:227], v244 offset:37632
    v_cvt_pk_bf16_f32 v203, v226, v227
    v_mfma_f32_16x16x32_bf16 v[144:147], a[248:251], a[168:171], v[144:147]
    ds_read_b64_tr_b16 a[228:229], v244 offset:41728
    v_accvgpr_read_b32 v218, a38
    v_mfma_f32_16x16x32_bf16 v[144:147], a[252:255], a[172:175], v[144:147]
    v_exp_f32 v138, v138
    v_cndmask_b32_dpp v180, v200, v184, vcc quad_perm:[1,0,3,2] row_mask:0xf bank_mask:0xf
    v_accvgpr_read_b32 v219, a39
    v_cndmask_b32_dpp v181, v201, v185, vcc quad_perm:[1,0,3,2] row_mask:0xf bank_mask:0xf
    v_pk_mul_f32 v[218:219], v[218:219], v[240:241] op_sel_hi:[1,0]
    v_pk_fma_f32 v[142:143], v[142:143], s[88:89], v[234:235] op_sel_hi:[1,1,0]
    v_cvt_pk_bf16_f32 v188, v212, v213
    v_cvt_pk_bf16_f32 v53, v134, v135
    v_cndmask_b32_dpp v182, v202, v186, vcc quad_perm:[1,0,3,2] row_mask:0xf bank_mask:0xf
    v_accvgpr_read_b32 v220, a40
    v_mfma_f32_16x16x32_bf16 v[148:151], a[252:255], a[188:191], 0
    ds_read_b64_tr_b16 a[230:231], v244 offset:45824
    v_cndmask_b32_dpp v183, v203, v187, vcc quad_perm:[1,0,3,2] row_mask:0xf bank_mask:0xf
    v_mfma_f32_16x16x32_bf16 v[148:151], a[248:251], a[184:187], v[148:151]
    ds_read_b64_tr_b16 a[232:233], v244 offset:49920
    s_mov_b64 vcc, s[76:77]
    v_mfma_f32_16x16x32_bf16 v[148:151], a[244:247], a[180:183], v[148:151]
    ds_read_b64_tr_b16 a[234:235], v244 offset:54016
    v_cndmask_b32_dpp v200, v184, v200, vcc quad_perm:[1,0,3,2] row_mask:0xf bank_mask:0xf
    v_mfma_f32_16x16x32_bf16 v[148:151], a[240:243], a[176:179], v[148:151]
    v_exp_f32 v139, v139
    v_accvgpr_read_b32 v221, a41
    v_cndmask_b32_dpp v201, v185, v201, vcc quad_perm:[1,0,3,2] row_mask:0xf bank_mask:0xf
    v_cvt_pk_bf16_f32 v189, v214, v215
    v_pk_mul_f32 v[220:221], v[220:221], v[240:241] op_sel_hi:[1,0]
    v_pk_fma_f32 v[144:145], v[144:145], s[88:89], v[228:229] op_sel_hi:[1,1,0]
    v_cndmask_b32_dpp v202, v186, v202, vcc quad_perm:[1,0,3,2] row_mask:0xf bank_mask:0xf
    v_cvt_pk_bf16_f32 v56, v136, v137
    v_accvgpr_read_b32 v222, a42
    v_cndmask_b32_dpp v203, v187, v203, vcc quad_perm:[1,0,3,2] row_mask:0xf bank_mask:0xf
    v_permlane16_swap_b32 v180, v182
    v_mfma_f32_16x16x32_bf16 v[152:155], a[240:243], a[192:195], 0
    ds_read_b64_tr_b16 a[236:237], v244 offset:58112
    v_accvgpr_read_b32 v223, a43
    v_mfma_f32_16x16x32_bf16 v[152:155], a[244:247], a[196:199], v[152:155]
    ds_read_b64_tr_b16 a[238:239], v244 offset:62208
    v_cvt_pk_bf16_f32 v190, v216, v217
    v_mfma_f32_16x16x32_bf16 v[152:155], a[248:251], a[200:203], v[152:155]
    v_permlane16_swap_b32 v181, v183
    v_mfma_f32_16x16x32_bf16 v[152:155], a[252:255], a[204:207], v[152:155]
    buffer_store_dwordx4 v[180:183], v243, s[24:27], s53 offen offset:0 sc1
    v_exp_f32 v140, v140
    v_exp_f32 v141, v141
    v_pk_mul_f32 v[222:223], v[222:223], v[240:241] op_sel_hi:[1,0]
    v_pk_fma_f32 v[146:147], v[146:147], s[88:89], v[228:229] op_sel_hi:[1,1,0]
    v_accvgpr_read_b32 v224, a44
    v_cvt_pk_bf16_f32 v57, v138, v139
    v_accvgpr_read_b32 v225, a45
    v_pk_mul_f32 v[224:225], v[224:225], v[240:241] op_sel_hi:[1,0]
    v_permlane16_swap_b32 v200, v202
    v_mfma_f32_16x16x32_bf16 v[156:159], a[252:255], a[220:223], 0
    v_exp_f32 v142, v142
    v_mfma_f32_16x16x32_bf16 v[156:159], a[248:251], a[216:219], v[156:159]
    v_permlane16_swap_b32 v201, v203
    v_mfma_f32_16x16x32_bf16 v[156:159], a[244:247], a[212:215], v[156:159]
    v_exp_f32 v143, v143
    v_mfma_f32_16x16x32_bf16 v[156:159], a[240:243], a[208:211], v[156:159]
    s_waitcnt lgkmcnt(0)
    buffer_store_dwordx4 v[200:203], v243, s[24:27], s53 offen offset:256 sc1
    v_exp_f32 v144, v144
    v_exp_f32 v145, v145
    v_pk_fma_f32 v[148:149], v[148:149], s[88:89], v[230:231] op_sel_hi:[1,1,0]
    v_cvt_pk_bf16_f32 v191, v218, v219
    v_accvgpr_read_b32 v226, a46
    v_cvt_pk_bf16_f32 v60, v140, v141
    v_accvgpr_read_b32 v227, a47
    v_pk_mul_f32 v[226:227], v[226:227], v[240:241] op_sel_hi:[1,0]
    v_cvt_pk_bf16_f32 v204, v220, v221
    v_mfma_f32_16x16x32_bf16 a[68:71], a[224:227], v[64:67], a[68:71]
    ds_read_b64_tr_b16 a[240:241], v245 offset:33536
    v_accvgpr_read_b32 v212, a48
    v_mfma_f32_16x16x32_bf16 a[68:71], a[228:231], v[80:83], a[68:71]
    ds_read_b64_tr_b16 a[242:243], v245 offset:37632
    v_cvt_pk_bf16_f32 v61, v142, v143
    v_mfma_f32_16x16x32_bf16 a[68:71], a[232:235], v[96:99], a[68:71]
    ds_read_b64_tr_b16 a[244:245], v245 offset:41728
    v_accvgpr_read_b32 v213, a49
    v_mfma_f32_16x16x32_bf16 a[68:71], a[236:239], v[112:115], a[68:71]
    s_mov_b64 vcc, s[74:75]
    v_exp_f32 v146, v146
    v_cvt_pk_bf16_f32 v205, v222, v223
    v_accvgpr_read_b32 v214, a50
    v_mfma_f32_16x16x32_bf16 a[84:87], a[236:239], v[116:119], a[84:87]
    ds_read_b64_tr_b16 a[246:247], v245 offset:45824
    v_cvt_pk_bf16_f32 v50, v144, v145
    v_mfma_f32_16x16x32_bf16 a[84:87], a[232:235], v[100:103], a[84:87]
    ds_read_b64_tr_b16 a[248:249], v245 offset:49920
    v_accvgpr_read_b32 v215, a51
    v_mfma_f32_16x16x32_bf16 a[84:87], a[228:231], v[84:87], a[84:87]
    ds_read_b64_tr_b16 a[250:251], v245 offset:54016
    v_cvt_pk_bf16_f32 v206, v224, v225
    v_mfma_f32_16x16x32_bf16 a[84:87], a[224:227], v[68:71], a[84:87]
    v_exp_f32 v147, v147
    v_accvgpr_read_b32 v216, a52
    v_exp_f32 v148, v148
    v_pk_mul_f32 v[212:213], v[212:213], v[242:243] op_sel_hi:[1,0]
    v_pk_fma_f32 v[150:151], v[150:151], s[88:89], v[230:231] op_sel_hi:[1,1,0]
    v_pk_mul_f32 v[214:215], v[214:215], v[242:243] op_sel_hi:[1,0]
    v_pk_fma_f32 v[152:153], v[152:153], s[88:89], v[232:233] op_sel_hi:[1,1,0]
    v_pk_fma_f32 v[154:155], v[154:155], s[88:89], v[232:233] op_sel_hi:[1,1,0]
    v_accvgpr_read_b32 v217, a53
    v_pk_mul_f32 v[216:217], v[216:217], v[242:243] op_sel_hi:[1,0]
    v_cvt_pk_bf16_f32 v51, v146, v147
    v_mfma_f32_16x16x32_bf16 a[100:103], a[224:227], v[72:75], a[100:103]
    ds_read_b64_tr_b16 a[252:253], v245 offset:58112
    v_cvt_pk_bf16_f32 v207, v226, v227
    v_mfma_f32_16x16x32_bf16 a[100:103], a[228:231], v[88:91], a[100:103]
    ds_read_b64_tr_b16 a[254:255], v245 offset:62208
    v_accvgpr_read_b32 v218, a54
    v_mfma_f32_16x16x32_bf16 a[100:103], a[232:235], v[104:107], a[100:103]
    v_exp_f32 v149, v149
    v_mfma_f32_16x16x32_bf16 a[100:103], a[236:239], v[120:123], a[100:103]
    v_exp_f32 v150, v150
    v_cndmask_b32_dpp v184, v204, v188, vcc quad_perm:[1,0,3,2] row_mask:0xf bank_mask:0xf
    v_accvgpr_read_b32 v219, a55
    v_cndmask_b32_dpp v185, v205, v189, vcc quad_perm:[1,0,3,2] row_mask:0xf bank_mask:0xf
    v_pk_mul_f32 v[218:219], v[218:219], v[242:243] op_sel_hi:[1,0]
    v_pk_fma_f32 v[156:157], v[156:157], s[88:89], v[234:235] op_sel_hi:[1,1,0]
    v_cvt_pk_bf16_f32 v54, v148, v149
    v_cvt_pk_bf16_f32 v192, v212, v213
    v_exp_f32 v151, v151
    v_cndmask_b32_dpp v186, v206, v190, vcc quad_perm:[1,0,3,2] row_mask:0xf bank_mask:0xf
    v_mfma_f32_16x16x32_bf16 a[116:119], a[236:239], v[124:127], a[116:119]
    v_exp_f32 v152, v152
    v_mfma_f32_16x16x32_bf16 a[116:119], a[232:235], v[108:111], a[116:119]
    v_exp_f32 v153, v153
    v_mfma_f32_16x16x32_bf16 a[116:119], a[228:231], v[92:95], a[116:119]
    v_exp_f32 v154, v154
    v_mfma_f32_16x16x32_bf16 a[116:119], a[224:227], v[76:79], a[116:119]
    s_waitcnt lgkmcnt(0)
    v_exp_f32 v155, v155
    v_accvgpr_read_b32 v220, a56
    v_cndmask_b32_dpp v187, v207, v191, vcc quad_perm:[1,0,3,2] row_mask:0xf bank_mask:0xf
    s_mov_b64 vcc, s[76:77]
    v_pk_fma_f32 v[158:159], v[158:159], s[88:89], v[234:235] op_sel_hi:[1,1,0]
    v_cndmask_b32_dpp v204, v188, v204, vcc quad_perm:[1,0,3,2] row_mask:0xf bank_mask:0xf
    v_accvgpr_read_b32 v221, a57
    v_pk_mul_f32 v[220:221], v[220:221], v[242:243] op_sel_hi:[1,0]
    v_cndmask_b32_dpp v205, v189, v205, vcc quad_perm:[1,0,3,2] row_mask:0xf bank_mask:0xf
    v_cvt_pk_bf16_f32 v193, v214, v215
    v_cvt_pk_bf16_f32 v55, v150, v151
    v_cndmask_b32_dpp v206, v190, v206, vcc quad_perm:[1,0,3,2] row_mask:0xf bank_mask:0xf
    v_accvgpr_read_b32 v222, a58
    v_cndmask_b32_dpp v207, v191, v207, vcc quad_perm:[1,0,3,2] row_mask:0xf bank_mask:0xf
    v_mfma_f32_16x16x32_bf16 a[76:79], a[240:243], v[64:67], a[76:79]
    v_permlane16_swap_b32 v184, v186
    v_mfma_f32_16x16x32_bf16 a[76:79], a[244:247], v[80:83], a[76:79]
    v_permlane16_swap_b32 v185, v187
    v_mfma_f32_16x16x32_bf16 a[76:79], a[248:251], v[96:99], a[76:79]
    v_exp_f32 v156, v156
    v_mfma_f32_16x16x32_bf16 a[76:79], a[252:255], v[112:115], a[76:79]
    buffer_store_dwordx4 v[184:187], v243, s[24:27], s54 offen offset:0 sc1
    v_permlane16_swap_b32 v204, v206
    v_permlane16_swap_b32 v205, v207
    v_accvgpr_read_b32 v223, a59
    v_pk_mul_f32 v[222:223], v[222:223], v[242:243] op_sel_hi:[1,0]
    v_cvt_pk_bf16_f32 v194, v216, v217
    v_cvt_pk_bf16_f32 v58, v152, v153
    v_accvgpr_read_b32 v224, a60
    v_accvgpr_read_b32 v225, a61
    v_pk_mul_f32 v[224:225], v[224:225], v[242:243] op_sel_hi:[1,0]
    v_mfma_f32_16x16x32_bf16 a[92:95], a[252:255], v[116:119], a[92:95]
    v_exp_f32 v157, v157
    v_mfma_f32_16x16x32_bf16 a[92:95], a[248:251], v[100:103], a[92:95]
    v_exp_f32 v158, v158
    v_mfma_f32_16x16x32_bf16 a[92:95], a[244:247], v[84:87], a[92:95]
    v_exp_f32 v159, v159
    v_mfma_f32_16x16x32_bf16 a[92:95], a[240:243], v[68:71], a[92:95]
    buffer_store_dwordx4 v[204:207], v243, s[24:27], s54 offen offset:256 sc1
    v_cvt_pk_bf16_f32 v195, v218, v219
    v_accvgpr_read_b32 v226, a62
    v_cvt_pk_bf16_f32 v59, v154, v155
    v_accvgpr_read_b32 v227, a63
    v_pk_mul_f32 v[226:227], v[226:227], v[242:243] op_sel_hi:[1,0]
    v_cvt_pk_bf16_f32 v208, v220, v221
    v_mfma_f32_16x16x32_bf16 a[108:111], a[240:243], v[72:75], a[108:111]
    s_mov_b64 vcc, s[74:75]
    v_cvt_pk_bf16_f32 v62, v156, v157
    v_cvt_pk_bf16_f32 v209, v222, v223
    v_mfma_f32_16x16x32_bf16 a[108:111], a[244:247], v[88:91], a[108:111]
    v_cvt_pk_bf16_f32 v63, v158, v159
    v_cvt_pk_bf16_f32 v210, v224, v225
    v_mfma_f32_16x16x32_bf16 a[108:111], a[248:251], v[104:107], a[108:111]
    v_cvt_pk_bf16_f32 v211, v226, v227
    v_mfma_f32_16x16x32_bf16 a[108:111], a[252:255], v[120:123], a[108:111]
    v_mfma_f32_16x16x32_bf16 a[124:127], a[252:255], v[124:127], a[124:127]
    v_cndmask_b32_dpp v188, v208, v192, vcc quad_perm:[1,0,3,2] row_mask:0xf bank_mask:0xf
    v_cndmask_b32_dpp v189, v209, v193, vcc quad_perm:[1,0,3,2] row_mask:0xf bank_mask:0xf
    v_mfma_f32_16x16x32_bf16 a[124:127], a[248:251], v[108:111], a[124:127]
    v_cndmask_b32_dpp v190, v210, v194, vcc quad_perm:[1,0,3,2] row_mask:0xf bank_mask:0xf
    v_cndmask_b32_dpp v191, v211, v195, vcc quad_perm:[1,0,3,2] row_mask:0xf bank_mask:0xf
    v_mfma_f32_16x16x32_bf16 a[124:127], a[244:247], v[92:95], a[124:127]
    s_mov_b64 vcc, s[76:77]
    v_cndmask_b32_dpp v208, v192, v208, vcc quad_perm:[1,0,3,2] row_mask:0xf bank_mask:0xf
    v_cndmask_b32_dpp v209, v193, v209, vcc quad_perm:[1,0,3,2] row_mask:0xf bank_mask:0xf
    v_mfma_f32_16x16x32_bf16 a[124:127], a[240:243], v[76:79], a[124:127]
    v_cndmask_b32_dpp v210, v194, v210, vcc quad_perm:[1,0,3,2] row_mask:0xf bank_mask:0xf
    v_cndmask_b32_dpp v211, v195, v211, vcc quad_perm:[1,0,3,2] row_mask:0xf bank_mask:0xf
    s_barrier
    v_mfma_f32_16x16x32_bf16 v[160:163], v[248:251], v[0:3], 0
    ds_read_b128 a[224:227], v237 offset:32768
    v_mfma_f32_16x16x32_bf16 v[160:163], v[248:251], v[16:19], v[160:163]
    ds_read_b128 a[228:231], v237 offset:33024
    v_mfma_f32_16x16x32_bf16 v[160:163], v[248:251], v[32:35], v[160:163]
    v_permlane16_swap_b32 v188, v190
    v_mfma_f32_16x16x32_bf16 v[160:163], v[248:251], v[48:51], v[160:163]
    v_permlane16_swap_b32 v189, v191
    v_mfma_f32_16x16x32_bf16 v[164:167], v[248:251], v[4:7], 0
    ds_read_b128 a[232:235], v237 offset:33280
    v_mfma_f32_16x16x32_bf16 v[164:167], v[248:251], v[20:23], v[164:167]
    ds_read_b128 a[236:239], v237 offset:33536
    v_mfma_f32_16x16x32_bf16 v[164:167], v[248:251], v[36:39], v[164:167]
    v_permlane16_swap_b32 v208, v210
    v_mfma_f32_16x16x32_bf16 v[164:167], v[248:251], v[52:55], v[164:167]
    buffer_store_dwordx4 v[188:191], v243, s[24:27], s55 offen offset:0 sc1
    v_permlane16_swap_b32 v209, v211
    v_mfma_f32_16x16x32_bf16 v[168:171], v[248:251], v[8:11], 0
    v_mfma_f32_16x16x32_bf16 v[168:171], v[248:251], v[24:27], v[168:171]
    v_mfma_f32_16x16x32_bf16 v[168:171], v[248:251], v[40:43], v[168:171]
    v_mfma_f32_16x16x32_bf16 v[168:171], v[248:251], v[56:59], v[168:171]
    buffer_store_dwordx4 v[208:211], v243, s[24:27], s55 offen offset:256 sc1
    v_mfma_f32_16x16x32_bf16 v[172:175], v[248:251], v[12:15], 0
    v_mfma_f32_16x16x32_bf16 v[172:175], v[248:251], v[28:31], v[172:175]
    v_mfma_f32_16x16x32_bf16 v[172:175], v[248:251], v[44:47], v[172:175]
    v_mfma_f32_16x16x32_bf16 v[172:175], v[248:251], v[60:63], v[172:175]
    s_waitcnt lgkmcnt(0)
L_ph3f:
    s_cmp_eq_u32 s34, 7
    s_cbranch_scc0 L_nt77
    s_getpc_b64 s[72:73]
L_pc77:
    s_add_u32 s72, s72, L_last-L_pc77
    s_addc_u32 s73, s73, (L_last-L_pc77)>>32
    v_mbcnt_lo_u32_b32 v222, -1, 0
    v_mbcnt_hi_u32_b32 v222, -1, v222
    v_lshrrev_b32 v222, 2, v222
    v_lshl_add_u32 v222, s32, 4, v222
    v_lshlrev_b32 v222, 7, v222
    v_min_u32 v222, L_end-L_last, v222
    v_mov_b32 v223, s73
    v_add_co_u32 v222, vcc, s72, v222
    s_nop 1
    v_addc_co_u32 v223, vcc, 0, v223, vcc
    global_load_dword v254, v[222:223], off
L_nt77:
    s_cmp_lt_u32 s34, s38
    s_cbranch_scc0 L_nt78
    s_getpc_b64 s[72:73]
L_pc78:
    s_add_u32 s72, s72, L_ph4f-L_pc78
    s_addc_u32 s73, s73, (L_ph4f-L_pc78)>>32
    v_mbcnt_lo_u32_b32 v222, -1, 0
    v_mbcnt_hi_u32_b32 v222, -1, v222
    v_lshrrev_b32 v222, 2, v222
    v_lshl_add_u32 v222, s32, 4, v222
    v_lshlrev_b32 v222, 7, v222
    v_min_u32 v222, L_ph5f-L_ph4f, v222
    v_mov_b32 v223, s73
    v_add_co_u32 v222, vcc, s72, v222
    s_nop 1
    v_addc_co_u32 v223, vcc, 0, v223, vcc
    global_load_dword v254, v[222:223], off
L_nt78:
    v_mfma_f32_16x16x32_bf16 v[128:131], a[224:227], a[160:163], 0
    ds_read_b128 a[240:243], v237 offset:36864
    v_mfma_f32_16x16x32_bf16 v[128:131], a[228:231], a[164:167], v[128:131]
    ds_read_b128 a[244:247], v237 offset:37120
    s_xor_b32 s86, s85, 0
    v_mfma_f32_16x16x32_bf16 v[128:131], a[232:235], a[168:171], v[128:131]
    s_xor_b32 m0, s35, 0
    v_mfma_f32_16x16x32_bf16 v[128:131], a[236:239], a[172:175], v[128:131]
    s_cmp_eq_u32 s34, 6
    s_cbranch_scc1 L_sh80
    buffer_load_dwordx4 v241, s[16:19], s86 offen nt lds
L_shr80:
    v_max3_f32 v220, v160, v164, v168
    v_mfma_f32_16x16x32_bf16 v[132:135], a[236:239], a[188:191], 0
    ds_read_b128 a[248:251], v237 offset:37376
    v_max_f32 v220, v220, v172
    v_mfma_f32_16x16x32_bf16 v[132:135], a[232:235], a[184:187], v[132:135]
    ds_read_b128 a[252:255], v237 offset:37632
    v_cmp_lt_f32 vcc, 0x5f800000, v220
    v_mfma_f32_16x16x32_bf16 v[132:135], a[228:231], a[180:183], v[132:135]
    s_cbranch_vccnz L_chk79_redo
L_chk79:
    v_mov_b32 v229, v160
    v_mfma_f32_16x16x32_bf16 v[132:135], a[224:227], a[176:179], v[132:135]
    v_mov_b32 v231, v164
    v_mov_b32 v233, v168
    v_mov_b32 v235, v172
    v_accvgpr_read_b32 v212, a64
    v_accvgpr_read_b32 v213, a65
    v_pk_fma_f32 v[128:129], v[128:129], s[88:89], v[228:229] op_sel_hi:[1,1,0]
    v_pk_fma_f32 v[130:131], v[130:131], s[88:89], v[228:229] op_sel_hi:[1,1,0]
    v_mfma_f32_16x16x32_bf16 v[136:139], a[224:227], a[192:195], 0
    v_exp_f32 v128, v128
    v_mfma_f32_16x16x32_bf16 v[136:139], a[228:231], a[196:199], v[136:139]
    s_xor_b32 s86, s85, 1024
    v_exp_f32 v129, v129
    v_mfma_f32_16x16x32_bf16 v[136:139], a[232:235], a[200:203], v[136:139]
    s_xor_b32 m0, s35, 1024
    v_exp_f32 v130, v130
    v_mfma_f32_16x16x32_bf16 v[136:139], a[236:239], a[204:207], v[136:139]
    s_cmp_eq_u32 s34, 6
    s_cbranch_scc1 L_sh81
    buffer_load_dwordx4 v255, s[16:19], s86 offen nt lds
L_shr81:
    v_cvt_pk_bf16_f32 v64, v128, v129
    v_mfma_f32_16x16x32_bf16 v[140:143], a[236:239], a[220:223], 0
    v_exp_f32 v131, v131
    v_mfma_f32_16x16x32_bf16 v[140:143], a[232:235], a[216:219], v[140:143]
    v_accvgpr_read_b32 v214, a66
    v_accvgpr_read_b32 v215, a67
    v_mfma_f32_16x16x32_bf16 v[140:143], a[228:231], a[212:215], v[140:143]
    v_cvt_pk_bf16_f32 v65, v130, v131
    v_accvgpr_read_b32 v216, a68
    v_mfma_f32_16x16x32_bf16 v[140:143], a[224:227], a[208:211], v[140:143]
    s_waitcnt lgkmcnt(0)
    v_accvgpr_read_b32 v217, a69
    v_accvgpr_read_b32 v218, a70
    v_fmamk_f32 v132, v132, 0x3e0293ee, v230
    v_mfma_f32_16x16x32_bf16 v[144:147], a[240:243], a[160:163], 0
    ds_read_b64_tr_b16 a[224:225], v244 offset:0
    v_fmamk_f32 v133, v133, 0x3e0293ee, v230
    v_mfma_f32_16x16x32_bf16 v[144:147], a[244:247], a[164:167], v[144:147]
    ds_read_b64_tr_b16 a[226:227], v244 offset:4096
    v_accvgpr_read_b32 v219, a71
    v_mfma_f32_16x16x32_bf16 v[144:147], a[248:251], a[168:171], v[144:147]
    ds_read_b64_tr_b16 a[228:229], v244 offset:8192
    v_accvgpr_read_b32 v220, a72
    v_mfma_f32_16x16x32_bf16 v[144:147], a[252:255], a[172:175], v[144:147]
    v_exp_f32 v132, v132
    v_exp_f32 v133, v133
    v_mul_f32 v212, v212, v236
    v_pk_fma_f32 v[134:135], v[134:135], s[88:89], v[230:231] op_sel_hi:[1,1,0]
    v_pk_fma_f32 v[136:137], v[136:137], s[88:89], v[232:233] op_sel_hi:[1,1,0]
    v_mul_f32 v213, v213, v236
    v_pk_mul_f32 v[214:215], v[214:215], v[236:237] op_sel_hi:[1,0]
    v_pk_mul_f32 v[216:217], v[216:217], v[236:237] op_sel_hi:[1,0]
    v_mfma_f32_16x16x32_bf16 v[148:151], a[252:255], a[188:191], 0
    ds_read_b64_tr_b16 a[230:231], v244 offset:12288
    v_cvt_pk_bf16_f32 v68, v132, v133
    v_mfma_f32_16x16x32_bf16 v[148:151], a[248:251], a[184:187], v[148:151]
    ds_read_b64_tr_b16 a[232:233], v244 offset:16384
    s_xor_b32 s86, s85, 8192
    v_mfma_f32_16x16x32_bf16 v[148:151], a[244:247], a[180:183], v[148:151]
    ds_read_b64_tr_b16 a[234:235], v244 offset:20480
    s_xor_b32 m0, s35, 4096
    v_mfma_f32_16x16x32_bf16 v[148:151], a[240:243], a[176:179], v[148:151]
    s_cmp_eq_u32 s34, 6
    s_cbranch_scc1 L_sh82
    buffer_load_dwordx4 v241, s[16:19], s86 offen nt lds
L_shr82:
    v_cvt_pk_bf16_f32 v180, v212, v213
    v_exp_f32 v134, v134
    v_mfma_f32_16x16x32_bf16 v[152:155], a[240:243], a[192:195], 0
    ds_read_b64_tr_b16 a[236:237], v244 offset:24576
    v_cvt_pk_bf16_f32 v181, v214, v215
    v_mfma_f32_16x16x32_bf16 v[152:155], a[244:247], a[196:199], v[152:155]
    ds_read_b64_tr_b16 a[238:239], v244 offset:28672
    v_accvgpr_read_b32 v221, a73
    v_mfma_f32_16x16x32_bf16 v[152:155], a[248:251], a[200:203], v[152:155]
    v_exp_f32 v135, v135
    v_mfma_f32_16x16x32_bf16 v[152:155], a[252:255], a[204:207], v[152:155]
    v_exp_f32 v136, v136
    v_cvt_pk_bf16_f32 v69, v134, v135
    v_exp_f32 v137, v137
    v_pk_fma_f32 v[138:139], v[138:139], s[88:89], v[232:233] op_sel_hi:[1,1,0]
    v_pk_mul_f32 v[218:219], v[218:219], v[236:237] op_sel_hi:[1,0]
    v_pk_fma_f32 v[140:141], v[140:141], s[88:89], v[234:235] op_sel_hi:[1,1,0]
    v_mfma_f32_16x16x32_bf16 v[156:159], a[252:255], a[220:223], 0
    v_exp_f32 v138, v138
    v_mfma_f32_16x16x32_bf16 v[156:159], a[248:251], a[216:219], v[156:159]
    v_exp_f32 v139, v139
    v_mfma_f32_16x16x32_bf16 v[156:159], a[244:247], a[212:215], v[156:159]
    v_exp_f32 v140, v140
    v_mfma_f32_16x16x32_bf16 v[156:159], a[240:243], a[208:211], v[156:159]
    s_waitcnt lgkmcnt(0)
    v_exp_f32 v141, v141
    v_cvt_pk_bf16_f32 v72, v136, v137
    v_mfma_f32_16x16x32_bf16 a[0:3], a[224:227], v[0:3], 0
    ds_read_b128 a[240:243], v237 offset:40960
    v_cvt_pk_bf16_f32 v182, v216, v217
    v_mfma_f32_16x16x32_bf16 a[0:3], a[228:231], v[16:19], a[0:3]
    ds_read_b128 a[244:247], v237 offset:41216
    s_waitcnt vmcnt(11)
    s_xor_b32 s86, s85, 9216
    v_mfma_f32_16x16x32_bf16 a[0:3], a[232:235], v[32:35], a[0:3]
    ds_read_b128 a[128:131], v239 offset:0
    s_xor_b32 m0, s35, 5120
    v_mfma_f32_16x16x32_bf16 a[0:3], a[236:239], v[48:51], a[0:3]
    s_cmp_eq_u32 s34, 6
    s_cbranch_scc1 L_sh83
    buffer_load_dwordx4 v255, s[16:19], s86 offen nt lds
L_shr83:
    v_accvgpr_read_b32 v222, a74
    v_cvt_pk_bf16_f32 v73, v138, v139
    v_accvgpr_read_b32 v223, a75
    v_cvt_pk_bf16_f32 v183, v218, v219
    v_pk_fma_f32 v[142:143], v[142:143], s[88:89], v[234:235] op_sel_hi:[1,1,0]
    v_pk_mul_f32 v[220:221], v[220:221], v[236:237] op_sel_hi:[1,0]
    v_pk_fma_f32 v[144:145], v[144:145], s[88:89], v[228:229] op_sel_hi:[1,1,0]
    v_pk_mul_f32 v[222:223], v[222:223], v[236:237] op_sel_hi:[1,0]
    v_pk_fma_f32 v[146:147], v[146:147], s[88:89], v[228:229] op_sel_hi:[1,1,0]
    v_mfma_f32_16x16x32_bf16 a[16:19], a[236:239], v[52:55], 0
    ds_read_b128 a[248:251], v237 offset:41472
    v_cvt_pk_bf16_f32 v76, v140, v141
    v_mfma_f32_16x16x32_bf16 a[16:19], a[232:235], v[36:39], a[16:19]
    ds_read_b128 a[252:255], v237 offset:41728
    v_accvgpr_read_b32 v224, a76
    v_mfma_f32_16x16x32_bf16 a[16:19], a[228:231], v[20:23], a[16:19]
    ds_read_b128 a[132:135], v239 offset:256
    v_accvgpr_read_b32 v225, a77
    v_mfma_f32_16x16x32_bf16 a[16:19], a[224:227], v[4:7], a[16:19]
    v_exp_f32 v142, v142
    v_exp_f32 v143, v143
    v_mfma_f32_16x16x32_bf16 a[32:35], a[224:227], v[8:11], 0
    ds_read_b128 a[136:139], v239 offset:512
    v_cvt_pk_bf16_f32 v77, v142, v143
    v_mfma_f32_16x16x32_bf16 a[32:35], a[228:231], v[24:27], a[32:35]
    ds_read_b128 a[140:143], v239 offset:768
    v_cvt_pk_bf16_f32 v196, v220, v221
    v_mfma_f32_16x16x32_bf16 a[32:35], a[232:235], v[40:43], a[32:35]
    ds_read_b128 a[144:147], v239 offset:4096
    v_accvgpr_read_b32 v226, a78
    v_mfma_f32_16x16x32_bf16 a[32:35], a[236:239], v[56:59], a[32:35]
    v_exp_f32 v144, v144
    v_exp_f32 v145, v145
    v_exp_f32 v146, v146
    v_pk_mul_f32 v[224:225], v[224:225], v[236:237] op_sel_hi:[1,0]
    v_pk_fma_f32 v[148:149], v[148:149], s[88:89], v[230:231] op_sel_hi:[1,1,0]
    v_pk_fma_f32 v[150:151], v[150:151], s[88:89], v[230:231] op_sel_hi:[1,1,0]
    v_mfma_f32_16x16x32_bf16 a[48:51], a[236:239], v[60:63], 0
    ds_read_b128 a[148:151], v239 offset:4352
    v_accvgpr_read_b32 v227, a79
    v_mfma_f32_16x16x32_bf16 a[48:51], a[232:235], v[44:47], a[48:51]
    ds_read_b128 a[152:155], v239 offset:4608
    s_xor_b32 s86, s85, 16384
    v_mfma_f32_16x16x32_bf16 a[48:51], a[228:231], v[28:31], a[48:51]
    ds_read_b128 a[156:159], v239 offset:4864
    s_xor_b32 m0, s35, 8192
    v_mfma_f32_16x16x32_bf16 a[48:51], a[224:227], v[12:15], a[48:51]
    s_waitcnt lgkmcnt(7)
    s_cmp_eq_u32 s34, 6
    s_cbranch_scc1 L_sh84
    buffer_load_dwordx4 v241, s[16:19], s86 offen nt lds
L_shr84:
    v_cvt_pk_bf16_f32 v66, v144, v145
    v_exp_f32 v147, v147
    v_pk_mul_f32 v[226:227], v[226:227], v[236:237] op_sel_hi:[1,0]
    v_pk_fma_f32 v[152:153], v[152:153], s[88:89], v[232:233] op_sel_hi:[1,1,0]
    v_cvt_pk_bf16_f32 v197, v222, v223
    v_accvgpr_read_b32 v212, a80
    v_mfma_f32_16x16x32_bf16 v[160:163], a[240:243], a[160:163], 0
    ds_read_b64_tr_b16 a[224:225], v245 offset:0
    v_cvt_pk_bf16_f32 v67, v146, v147
    v_mfma_f32_16x16x32_bf16 v[160:163], a[244:247], a[164:167], v[160:163]
    ds_read_b64_tr_b16 a[226:227], v245 offset:4096
    v_accvgpr_read_b32 v213, a81
    v_mfma_f32_16x16x32_bf16 v[160:163], a[248:251], a[168:171], v[160:163]
    ds_read_b64_tr_b16 a[228:229], v245 offset:8192
    v_cvt_pk_bf16_f32 v198, v224, v225
    v_mfma_f32_16x16x32_bf16 v[160:163], a[252:255], a[172:175], v[160:163]
    v_exp_f32 v148, v148
    v_exp_f32 v149, v149
    v_accvgpr_read_b32 v214, a82
    v_pk_mul_f32 v[212:213], v[212:213], v[238:239] op_sel_hi:[1,0]
    v_pk_fma_f32 v[154:155], v[154:155], s[88:89], v[232:233] op_sel_hi:[1,1,0]
    v_mfma_f32_16x16x32_bf16 v[164:167], a[252:255], a[188:191], 0
    ds_read_b64_tr_b16 a[230:231], v245 offset:12288
    v_cvt_pk_bf16_f32 v70, v148, v149
    v_mfma_f32_16x16x32_bf16 v[164:167], a[248:251], a[184:187], v[164:167]
    ds_read_b64_tr_b16 a[232:233], v245 offset:16384
    v_accvgpr_read_b32 v215, a83
    v_mfma_f32_16x16x32_bf16 v[164:167], a[244:247], a[180:183], v[164:167]
    ds_read_b64_tr_b16 a[234:235], v245 offset:20480
    v_cvt_pk_bf16_f32 v199, v226, v227
    v_mfma_f32_16x16x32_bf16 v[164:167], a[240:243], a[176:179], v[164:167]
    v_exp_f32 v150, v150
    v_exp_f32 v151, v151
    v_exp_f32 v152, v152
    v_pk_mul_f32 v[214:215], v[214:215], v[238:239] op_sel_hi:[1,0]
    v_pk_fma_f32 v[156:157], v[156:157], s[88:89], v[234:235] op_sel_hi:[1,1,0]
    v_mfma_f32_16x16x32_bf16 v[168:171], a[240:243], a[192:195], 0
    ds_read_b64_tr_b16 a[236:237], v245 offset:24576
    v_accvgpr_read_b32 v216, a84
    v_mfma_f32_16x16x32_bf16 v[168:171], a[244:247], a[196:199], v[168:171]
    ds_read_b64_tr_b16 a[238:239], v245 offset:28672
    s_xor_b32 s86, s85, 17408
    v_mfma_f32_16x16x32_bf16 v[168:171], a[248:251], a[200:203], v[168:171]
    s_xor_b32 m0, s35, 9216
    v_exp_f32 v153, v153
    v_mfma_f32_16x16x32_bf16 v[168:171], a[252:255], a[204:207], v[168:171]
    s_cmp_eq_u32 s34, 6
    s_cbranch_scc1 L_sh85
    buffer_load_dwordx4 v255, s[16:19], s86 offen nt lds
L_shr85:
    v_cvt_pk_bf16_f32 v71, v150, v151
    v_accvgpr_read_b32 v217, a85
    v_cvt_pk_bf16_f32 v184, v212, v213
    v_exp_f32 v154, v154
    v_pk_mul_f32 v[216:217], v[216:217], v[238:239] op_sel_hi:[1,0]
    v_pk_fma_f32 v[158:159], v[158:159], s[88:89], v[234:235] op_sel_hi:[1,1,0]
    v_mfma_f32_16x16x32_bf16 v[172:175], a[252:255], a[220:223], 0
    v_exp_f32 v155, v155
    v_mfma_f32_16x16x32_bf16 v[172:175], a[248:251], a[216:219], v[172:175]
    v_exp_f32 v156, v156
    v_mfma_f32_16x16x32_bf16 v[172:175], a[244:247], a[212:215], v[172:175]
    v_exp_f32 v157, v157
    v_mfma_f32_16x16x32_bf16 v[172:175], a[240:243], a[208:211], v[172:175]
    s_waitcnt lgkmcnt(0)
    v_exp_f32 v158, v158
    v_accvgpr_read_b32 v218, a86
    v_cvt_pk_bf16_f32 v74, v152, v153
    v_accvgpr_read_b32 v219, a87
    v_pk_mul_f32 v[218:219], v[218:219], v[238:239] op_sel_hi:[1,0]
    v_pk_fma_f32 v[160:161], v[160:161], s[88:89], v[228:229] op_sel_hi:[1,1,0]
    v_cvt_pk_bf16_f32 v185, v214, v215
    v_mfma_f32_16x16x32_bf16 a[8:11], a[224:227], v[0:3], 0
    ds_read_b128 a[240:243], v237 offset:45056
    v_cvt_pk_bf16_f32 v75, v154, v155
    v_mfma_f32_16x16x32_bf16 a[8:11], a[228:231], v[16:19], a[8:11]
    ds_read_b128 a[244:247], v237 offset:45312
    s_xor_b32 s86, s85, 24576
    v_mfma_f32_16x16x32_bf16 a[8:11], a[232:235], v[32:35], a[8:11]
    s_xor_b32 m0, s35, 12288
    v_exp_f32 v159, v159
    v_mfma_f32_16x16x32_bf16 a[8:11], a[236:239], v[48:51], a[8:11]
    s_cmp_eq_u32 s34, 6
    s_cbranch_scc1 L_sh86
    buffer_load_dwordx4 v241, s[16:19], s86 offen nt lds
L_shr86:
    v_accvgpr_read_b32 v220, a88
    v_accvgpr_read_b32 v221, a89
    v_mfma_f32_16x16x32_bf16 a[24:27], a[236:239], v[52:55], 0
    ds_read_b128 a[248:251], v237 offset:45568
    v_cvt_pk_bf16_f32 v186, v216, v217
    v_mfma_f32_16x16x32_bf16 a[24:27], a[232:235], v[36:39], a[24:27]
    ds_read_b128 a[252:255], v237 offset:45824
    v_cvt_pk_bf16_f32 v78, v156, v157
    v_mfma_f32_16x16x32_bf16 a[24:27], a[228:231], v[20:23], a[24:27]
    v_exp_f32 v160, v160
    v_mfma_f32_16x16x32_bf16 a[24:27], a[224:227], v[4:7], a[24:27]
    v_exp_f32 v161, v161
    v_accvgpr_read_b32 v222, a90
    v_accvgpr_read_b32 v223, a91
    v_cvt_pk_bf16_f32 v79, v158, v159
    v_pk_mul_f32 v[220:221], v[220:221], v[238:239] op_sel_hi:[1,0]
    v_pk_fma_f32 v[162:163], v[162:163], s[88:89], v[228:229] op_sel_hi:[1,1,0]
    v_pk_mul_f32 v[222:223], v[222:223], v[238:239] op_sel_hi:[1,0]
    v_pk_fma_f32 v[164:165], v[164:165], s[88:89], v[230:231] op_sel_hi:[1,1,0]
    v_mfma_f32_16x16x32_bf16 a[40:43], a[224:227], v[8:11], 0
    v_exp_f32 v162, v162
    v_mfma_f32_16x16x32_bf16 a[40:43], a[228:231], v[24:27], a[40:43]
    v_exp_f32 v163, v163
    v_mfma_f32_16x16x32_bf16 a[40:43], a[232:235], v[40:43], a[40:43]
    v_exp_f32 v164, v164
    v_mfma_f32_16x16x32_bf16 a[40:43], a[236:239], v[56:59], a[40:43]
    v_exp_f32 v165, v165
    v_cvt_pk_bf16_f32 v187, v218, v219
    v_accvgpr_read_b32 v224, a92
    v_accvgpr_read_b32 v225, a93
    v_pk_mul_f32 v[224:225], v[224:225], v[238:239] op_sel_hi:[1,0]
    v_pk_fma_f32 v[166:167], v[166:167], s[88:89], v[230:231] op_sel_hi:[1,1,0]
    v_cvt_pk_bf16_f32 v80, v160, v161
    v_mfma_f32_16x16x32_bf16 a[56:59], a[236:239], v[60:63], 0
    v_exp_f32 v166, v166
    v_mfma_f32_16x16x32_bf16 a[56:59], a[232:235], v[44:47], a[56:59]
    s_xor_b32 s86, s85, 25600
    v_exp_f32 v167, v167
    v_mfma_f32_16x16x32_bf16 a[56:59], a[228:231], v[28:31], a[56:59]
    s_xor_b32 m0, s35, 13312
    v_cvt_pk_bf16_f32 v200, v220, v221
    v_accvgpr_read_b32 v226, a94
    v_mfma_f32_16x16x32_bf16 a[56:59], a[224:227], v[12:15], a[56:59]
    s_waitcnt lgkmcnt(0)
    s_cmp_eq_u32 s34, 6
    s_cbranch_scc1 L_sh87
    buffer_load_dwordx4 v255, s[16:19], s86 offen nt lds
L_shr87:
    v_cvt_pk_bf16_f32 v81, v162, v163
    v_accvgpr_read_b32 v227, a95
    v_mfma_f32_16x16x32_bf16 v[128:131], a[240:243], a[160:163], 0
    ds_read_b64_tr_b16 a[224:225], v244 offset:256
    v_cvt_pk_bf16_f32 v201, v222, v223
    v_mfma_f32_16x16x32_bf16 v[128:131], a[244:247], a[164:167], v[128:131]
    ds_read_b64_tr_b16 a[226:227], v244 offset:4352
    v_accvgpr_read_b32 v212, a96
    v_mfma_f32_16x16x32_bf16 v[128:131], a[248:251], a[168:171], v[128:131]
    ds_read_b64_tr_b16 a[228:229], v244 offset:8448
    v_cvt_pk_bf16_f32 v84, v164, v165
    v_mfma_f32_16x16x32_bf16 v[128:131], a[252:255], a[172:175], v[128:131]
    v_accvgpr_read_b32 v213, a97
    v_cvt_pk_bf16_f32 v202, v224, v225
    v_accvgpr_read_b32 v214, a98
    v_cvt_pk_bf16_f32 v85, v166, v167
    v_accvgpr_read_b32 v215, a99
    v_pk_mul_f32 v[226:227], v[226:227], v[238:239] op_sel_hi:[1,0]
    v_pk_fma_f32 v[168:169], v[168:169], s[88:89], v[232:233] op_sel_hi:[1,1,0]
    v_pk_mul_f32 v[212:213], v[212:213], v[240:241] op_sel_hi:[1,0]
    v_pk_fma_f32 v[170:171], v[170:171], s[88:89], v[232:233] op_sel_hi:[1,1,0]
    v_mfma_f32_16x16x32_bf16 v[132:135], a[252:255], a[188:191], 0
    ds_read_b64_tr_b16 a[230:231], v244 offset:12544
    v_cvt_pk_bf16_f32 v203, v226, v227
    v_mfma_f32_16x16x32_bf16 v[132:135], a[248:251], a[184:187], v[132:135]
    ds_read_b64_tr_b16 a[232:233], v244 offset:16640
    v_accvgpr_read_b32 v216, a100
    v_mfma_f32_16x16x32_bf16 v[132:135], a[244:247], a[180:183], v[132:135]
    ds_read_b64_tr_b16 a[234:235], v244 offset:20736
    v_accvgpr_read_b32 v217, a101
    v_mfma_f32_16x16x32_bf16 v[132:135], a[240:243], a[176:179], v[132:135]
    v_exp_f32 v168, v168
    v_exp_f32 v169, v169
    v_mfma_f32_16x16x32_bf16 v[136:139], a[240:243], a[192:195], 0
    ds_read_b64_tr_b16 a[236:237], v244 offset:24832
    v_cvt_pk_bf16_f32 v88, v168, v169
    v_mfma_f32_16x16x32_bf16 v[136:139], a[244:247], a[196:199], v[136:139]
    ds_read_b64_tr_b16 a[238:239], v244 offset:28928
    v_cvt_pk_bf16_f32 v188, v212, v213
    v_mfma_f32_16x16x32_bf16 v[136:139], a[248:251], a[200:203], v[136:139]
    s_mov_b32 m0, s42
    v_exp_f32 v170, v170
    v_mfma_f32_16x16x32_bf16 v[136:139], a[252:255], a[204:207], v[136:139]
    buffer_load_dwordx4 v246, s[12:15], s82 offen offset:0 nt lds
    v_accvgpr_read_b32 v218, a102
    v_exp_f32 v171, v171
    v_accvgpr_read_b32 v219, a103
    v_pk_mul_f32 v[214:215], v[214:215], v[240:241] op_sel_hi:[1,0]
    v_pk_fma_f32 v[172:173], v[172:173], s[88:89], v[234:235] op_sel_hi:[1,1,0]
    v_pk_fma_f32 v[174:175], v[174:175], s[88:89], v[234:235] op_sel_hi:[1,1,0]
    v_pk_mul_f32 v[216:217], v[216:217], v[240:241] op_sel_hi:[1,0]
    v_pk_fma_f32 v[128:129], v[128:129], s[88:89], v[228:229] op_sel_hi:[1,1,0]
    v_mfma_f32_16x16x32_bf16 v[140:143], a[252:255], a[220:223], 0
    v_exp_f32 v172, v172
    v_mfma_f32_16x16x32_bf16 v[140:143], a[248:251], a[216:219], v[140:143]
    v_exp_f32 v173, v173
    v_mfma_f32_16x16x32_bf16 v[140:143], a[244:247], a[212:215], v[140:143]
    v_exp_f32 v174, v174
    v_mfma_f32_16x16x32_bf16 v[140:143], a[240:243], a[208:211], v[140:143]
    s_waitcnt lgkmcnt(0)
    v_exp_f32 v175, v175
    v_cvt_pk_bf16_f32 v89, v170, v171
    v_mfma_f32_16x16x32_bf16 a[4:7], a[224:227], v[0:3], 0
    ds_read_b128 a[240:243], v237 offset:49152
    v_cvt_pk_bf16_f32 v92, v172, v173
    v_mfma_f32_16x16x32_bf16 a[4:7], a[228:231], v[16:19], a[4:7]
    ds_read_b128 a[244:247], v237 offset:49408
    v_cvt_pk_bf16_f32 v189, v214, v215
    v_mfma_f32_16x16x32_bf16 a[4:7], a[232:235], v[32:35], a[4:7]
    v_exp_f32 v128, v128
    v_mfma_f32_16x16x32_bf16 a[4:7], a[236:239], v[48:51], a[4:7]
    v_exp_f32 v129, v129
    v_accvgpr_read_b32 v220, a104
    v_accvgpr_read_b32 v221, a105
    v_cvt_pk_bf16_f32 v93, v174, v175
    v_pk_mul_f32 v[218:219], v[218:219], v[240:241] op_sel_hi:[1,0]
    v_pk_fma_f32 v[130:131], v[130:131], s[88:89], v[228:229] op_sel_hi:[1,1,0]
    v_pk_mul_f32 v[220:221], v[220:221], v[240:241] op_sel_hi:[1,0]
    v_pk_fma_f32 v[132:133], v[132:133], s[88:89], v[230:231] op_sel_hi:[1,1,0]
    v_mfma_f32_16x16x32_bf16 a[20:23], a[236:239], v[52:55], 0
    ds_read_b128 a[248:251], v237 offset:49664
    v_cvt_pk_bf16_f32 v190, v216, v217
    v_mfma_f32_16x16x32_bf16 a[20:23], a[232:235], v[36:39], a[20:23]
    ds_read_b128 a[252:255], v237 offset:49920
    v_accvgpr_read_b32 v222, a106
    v_mfma_f32_16x16x32_bf16 a[20:23], a[228:231], v[20:23], a[20:23]
    s_mov_b32 m0, s42
    v_exp_f32 v130, v130
    v_mfma_f32_16x16x32_bf16 a[20:23], a[224:227], v[4:7], a[20:23]
    buffer_load_dwordx4 v247, s[12:15], s82 offen offset:1024 nt lds
    v_accvgpr_read_b32 v223, a107
    v_mfma_f32_16x16x32_bf16 a[36:39], a[224:227], v[8:11], 0
    v_exp_f32 v131, v131
    v_mfma_f32_16x16x32_bf16 a[36:39], a[228:231], v[24:27], a[36:39]
    v_exp_f32 v132, v132
    v_mfma_f32_16x16x32_bf16 a[36:39], a[232:235], v[40:43], a[36:39]
    v_exp_f32 v133, v133
    v_mfma_f32_16x16x32_bf16 a[36:39], a[236:239], v[56:59], a[36:39]
    v_cvt_pk_bf16_f32 v82, v128, v129
    v_cvt_pk_bf16_f32 v191, v218, v219
    v_accvgpr_read_b32 v224, a108
    v_cvt_pk_bf16_f32 v83, v130, v131
    v_accvgpr_read_b32 v225, a109
    v_pk_mul_f32 v[222:223], v[222:223], v[240:241] op_sel_hi:[1,0]
    v_pk_fma_f32 v[134:135], v[134:135], s[88:89], v[230:231] op_sel_hi:[1,1,0]
    v_pk_mul_f32 v[224:225], v[224:225], v[240:241] op_sel_hi:[1,0]
    v_pk_fma_f32 v[136:137], v[136:137], s[88:89], v[232:233] op_sel_hi:[1,1,0]
    v_mfma_f32_16x16x32_bf16 a[52:55], a[236:239], v[60:63], 0
    v_exp_f32 v134, v134
    v_mfma_f32_16x16x32_bf16 a[52:55], a[232:235], v[44:47], a[52:55]
    v_exp_f32 v135, v135
    v_mfma_f32_16x16x32_bf16 a[52:55], a[228:231], v[28:31], a[52:55]
    v_exp_f32 v136, v136
    v_mfma_f32_16x16x32_bf16 a[52:55], a[224:227], v[12:15], a[52:55]
    s_waitcnt lgkmcnt(0)
    v_exp_f32 v137, v137
    v_cvt_pk_bf16_f32 v204, v220, v221
    v_mfma_f32_16x16x32_bf16 v[144:147], a[240:243], a[160:163], 0
    ds_read_b64_tr_b16 a[224:225], v245 offset:256
    v_accvgpr_read_b32 v226, a110
    v_mfma_f32_16x16x32_bf16 v[144:147], a[244:247], a[164:167], v[144:147]
    ds_read_b64_tr_b16 a[226:227], v245 offset:4352
    v_cvt_pk_bf16_f32 v86, v132, v133
    v_mfma_f32_16x16x32_bf16 v[144:147], a[248:251], a[168:171], v[144:147]
    ds_read_b64_tr_b16 a[228:229], v245 offset:8448
    s_mov_b32 m0, s42
    v_mfma_f32_16x16x32_bf16 v[144:147], a[252:255], a[172:175], v[144:147]
    buffer_load_dwordx4 v246, s[12:15], s82 offen offset:2048 nt lds
    v_accvgpr_read_b32 v227, a111
    v_cvt_pk_bf16_f32 v205, v222, v223
    v_mfma_f32_16x16x32_bf16 v[148:151], a[252:255], a[188:191], 0
    ds_read_b64_tr_b16 a[230:231], v245 offset:12544
    v_accvgpr_read_b32 v212, a112
    v_mfma_f32_16x16x32_bf16 v[148:151], a[248:251], a[184:187], v[148:151]
    ds_read_b64_tr_b16 a[232:233], v245 offset:16640
    v_cvt_pk_bf16_f32 v87, v134, v135
    v_mfma_f32_16x16x32_bf16 v[148:151], a[244:247], a[180:183], v[148:151]
    ds_read_b64_tr_b16 a[234:235], v245 offset:20736
    v_accvgpr_read_b32 v213, a113
    v_mfma_f32_16x16x32_bf16 v[148:151], a[240:243], a[176:179], v[148:151]
    v_cvt_pk_bf16_f32 v206, v224, v225
    v_accvgpr_read_b32 v214, a114
    v_cvt_pk_bf16_f32 v90, v136, v137
    v_accvgpr_read_b32 v215, a115
    v_accvgpr_read_b32 v216, a116
    v_pk_mul_f32 v[226:227], v[226:227], v[240:241] op_sel_hi:[1,0]
    v_pk_fma_f32 v[138:139], v[138:139], s[88:89], v[232:233] op_sel_hi:[1,1,0]
    v_pk_fma_f32 v[140:141], v[140:141], s[88:89], v[234:235] op_sel_hi:[1,1,0]
    v_pk_mul_f32 v[212:213], v[212:213], v[242:243] op_sel_hi:[1,0]
    v_pk_fma_f32 v[142:143], v[142:143], s[88:89], v[234:235] op_sel_hi:[1,1,0]
    v_pk_mul_f32 v[214:215], v[214:215], v[242:243] op_sel_hi:[1,0]
    v_exp_f32 v138, v138
    v_mfma_f32_16x16x32_bf16 v[152:155], a[240:243], a[192:195], 0
    ds_read_b64_tr_b16 a[236:237], v245 offset:24832
    v_cvt_pk_bf16_f32 v207, v226, v227
    v_mfma_f32_16x16x32_bf16 v[152:155], a[244:247], a[196:199], v[152:155]
    ds_read_b64_tr_b16 a[238:239], v245 offset:28928
    v_accvgpr_read_b32 v217, a117
    v_mfma_f32_16x16x32_bf16 v[152:155], a[248:251], a[200:203], v[152:155]
    s_mov_b32 m0, s42
    v_exp_f32 v139, v139
    v_mfma_f32_16x16x32_bf16 v[152:155], a[252:255], a[204:207], v[152:155]
    buffer_load_dwordx4 v247, s[12:15], s82 offen offset:3072 nt lds
    v_cvt_pk_bf16_f32 v91, v138, v139
    v_exp_f32 v140, v140
    v_mfma_f32_16x16x32_bf16 v[156:159], a[252:255], a[220:223], 0
    v_exp_f32 v141, v141
    v_mfma_f32_16x16x32_bf16 v[156:159], a[248:251], a[216:219], v[156:159]
    v_exp_f32 v142, v142
    v_mfma_f32_16x16x32_bf16 v[156:159], a[244:247], a[212:215], v[156:159]
    v_exp_f32 v143, v143
    v_mfma_f32_16x16x32_bf16 v[156:159], a[240:243], a[208:211], v[156:159]
    s_waitcnt lgkmcnt(0)
    v_cvt_pk_bf16_f32 v94, v140, v141
    v_cvt_pk_bf16_f32 v192, v212, v213
    v_accvgpr_read_b32 v218, a118
    v_accvgpr_read_b32 v219, a119
    v_cvt_pk_bf16_f32 v95, v142, v143
    v_pk_fma_f32 v[144:145], v[144:145], s[88:89], v[228:229] op_sel_hi:[1,1,0]
    v_pk_mul_f32 v[216:217], v[216:217], v[242:243] op_sel_hi:[1,0]
    v_pk_fma_f32 v[146:147], v[146:147], s[88:89], v[228:229] op_sel_hi:[1,1,0]
    v_pk_mul_f32 v[218:219], v[218:219], v[242:243] op_sel_hi:[1,0]
    v_mfma_f32_16x16x32_bf16 a[12:15], a[224:227], v[0:3], 0
    ds_read_b128 a[240:243], v237 offset:53248
    v_cvt_pk_bf16_f32 v193, v214, v215
    v_mfma_f32_16x16x32_bf16 a[12:15], a[228:231], v[16:19], a[12:15]
    ds_read_b128 a[244:247], v237 offset:53504
    v_accvgpr_read_b32 v220, a120
    v_mfma_f32_16x16x32_bf16 a[12:15], a[232:235], v[32:35], a[12:15]
    v_exp_f32 v144, v144
    v_mfma_f32_16x16x32_bf16 a[12:15], a[236:239], v[48:51], a[12:15]
    v_exp_f32 v145, v145
    v_mfma_f32_16x16x32_bf16 a[28:31], a[236:239], v[52:55], 0
    ds_read_b128 a[248:251], v237 offset:53760
    v_cvt_pk_bf16_f32 v96, v144, v145
    v_mfma_f32_16x16x32_bf16 a[28:31], a[232:235], v[36:39], a[28:31]
    ds_read_b128 a[252:255], v237 offset:54016
    v_accvgpr_read_b32 v221, a121
    v_mfma_f32_16x16x32_bf16 a[28:31], a[228:231], v[20:23], a[28:31]
    s_mov_b32 m0, s43
    v_exp_f32 v146, v146
    v_mfma_f32_16x16x32_bf16 a[28:31], a[224:227], v[4:7], a[28:31]
    buffer_load_dwordx4 v246, s[12:15], s83 offen offset:0 nt lds
    v_cvt_pk_bf16_f32 v194, v216, v217
    v_exp_f32 v147, v147
    v_accvgpr_read_b32 v222, a122
    v_pk_fma_f32 v[148:149], v[148:149], s[88:89], v[230:231] op_sel_hi:[1,1,0]
    v_pk_mul_f32 v[220:221], v[220:221], v[242:243] op_sel_hi:[1,0]
    v_pk_fma_f32 v[150:151], v[150:151], s[88:89], v[230:231] op_sel_hi:[1,1,0]
    v_mfma_f32_16x16x32_bf16 a[44:47], a[224:227], v[8:11], 0
    v_exp_f32 v148, v148
    v_mfma_f32_16x16x32_bf16 a[44:47], a[228:231], v[24:27], a[44:47]
    v_exp_f32 v149, v149
    v_mfma_f32_16x16x32_bf16 a[44:47], a[232:235], v[40:43], a[44:47]
    v_exp_f32 v150, v150
    v_mfma_f32_16x16x32_bf16 a[44:47], a[236:239], v[56:59], a[44:47]
    v_exp_f32 v151, v151
    v_cvt_pk_bf16_f32 v97, v146, v147
    v_mfma_f32_16x16x32_bf16 a[60:63], a[236:239], v[60:63], 0
    v_accvgpr_read_b32 v223, a123
    v_cvt_pk_bf16_f32 v195, v218, v219
    v_mfma_f32_16x16x32_bf16 a[60:63], a[232:235], v[44:47], a[60:63]
    v_accvgpr_read_b32 v224, a124
    v_cvt_pk_bf16_f32 v100, v148, v149
    v_mfma_f32_16x16x32_bf16 a[60:63], a[228:231], v[28:31], a[60:63]
    s_mov_b64 vcc, s[74:75]
    v_accvgpr_read_b32 v225, a125
    v_cvt_pk_bf16_f32 v208, v220, v221
    v_mfma_f32_16x16x32_bf16 a[60:63], a[224:227], v[12:15], a[60:63]
    s_waitcnt lgkmcnt(0)
    v_accvgpr_read_b32 v226, a126
    v_cvt_pk_bf16_f32 v101, v150, v151
    v_accvgpr_read_b32 v227, a127
    v_cndmask_b32_dpp v176, v196, v180, vcc quad_perm:[1,0,3,2] row_mask:0xf bank_mask:0xf
    v_cndmask_b32_dpp v177, v197, v181, vcc quad_perm:[1,0,3,2] row_mask:0xf bank_mask:0xf
    v_pk_mul_f32 v[222:223], v[222:223], v[242:243] op_sel_hi:[1,0]
    v_pk_fma_f32 v[152:153], v[152:153], s[88:89], v[232:233] op_sel_hi:[1,1,0]
    v_pk_mul_f32 v[224:225], v[224:225], v[242:243] op_sel_hi:[1,0]
    v_pk_fma_f32 v[154:155], v[154:155], s[88:89], v[232:233] op_sel_hi:[1,1,0]
    v_mfma_f32_16x16x32_bf16 v[160:163], a[240:243], a[160:163], 0
    ds_read_b64_tr_b16 a[224:225], v244 offset:512
    v_cvt_pk_bf16_f32 v209, v222, v223
    v_mfma_f32_16x16x32_bf16 v[160:163], a[244:247], a[164:167], v[160:163]
    ds_read_b64_tr_b16 a[226:227], v244 offset:4608
    v_cvt_pk_bf16_f32 v210, v224, v225
    v_mfma_f32_16x16x32_bf16 v[160:163], a[248:251], a[168:171], v[160:163]
    ds_read_b64_tr_b16 a[228:229], v244 offset:8704
    s_mov_b32 m0, s43
    v_mfma_f32_16x16x32_bf16 v[160:163], a[252:255], a[172:175], v[160:163]
    buffer_load_dwordx4 v247, s[12:15], s83 offen offset:1024 nt lds
    v_cndmask_b32_dpp v178, v198, v182, vcc quad_perm:[1,0,3,2] row_mask:0xf bank_mask:0xf
    v_exp_f32 v152, v152
    v_exp_f32 v153, v153
    v_pk_fma_f32 v[156:157], v[156:157], s[88:89], v[234:235] op_sel_hi:[1,1,0]
    v_pk_mul_f32 v[226:227], v[226:227], v[242:243] op_sel_hi:[1,0]
    v_mfma_f32_16x16x32_bf16 v[164:167], a[252:255], a[188:191], 0
    ds_read_b64_tr_b16 a[230:231], v244 offset:12800
    v_cvt_pk_bf16_f32 v104, v152, v153
    v_mfma_f32_16x16x32_bf16 v[164:167], a[248:251], a[184:187], v[164:167]
    ds_read_b64_tr_b16 a[232:233], v244 offset:16896
    v_cndmask_b32_dpp v179, v199, v183, vcc quad_perm:[1,0,3,2] row_mask:0xf bank_mask:0xf
    v_mfma_f32_16x16x32_bf16 v[164:167], a[244:247], a[180:183], v[164:167]
    ds_read_b64_tr_b16 a[234:235], v244 offset:20992
    s_mov_b64 vcc, s[76:77]
    v_mfma_f32_16x16x32_bf16 v[164:167], a[240:243], a[176:179], v[164:167]
    v_exp_f32 v154, v154
    v_exp_f32 v155, v155
    v_mfma_f32_16x16x32_bf16 v[168:171], a[240:243], a[192:195], 0
    ds_read_b64_tr_b16 a[236:237], v244 offset:25088
    v_cvt_pk_bf16_f32 v105, v154, v155
    v_mfma_f32_16x16x32_bf16 v[168:171], a[244:247], a[196:199], v[168:171]
    ds_read_b64_tr_b16 a[238:239], v244 offset:29184
    v_cvt_pk_bf16_f32 v211, v226, v227
    v_mfma_f32_16x16x32_bf16 v[168:171], a[248:251], a[200:203], v[168:171]
    v_exp_f32 v156, v156
    v_mfma_f32_16x16x32_bf16 v[168:171], a[252:255], a[204:207], v[168:171]
    v_exp_f32 v157, v157
    v_cndmask_b32_dpp v196, v180, v196, vcc quad_perm:[1,0,3,2] row_mask:0xf bank_mask:0xf
    v_cvt_pk_bf16_f32 v108, v156, v157
    v_cndmask_b32_dpp v197, v181, v197, vcc quad_perm:[1,0,3,2] row_mask:0xf bank_mask:0xf
    v_pk_fma_f32 v[158:159], v[158:159], s[88:89], v[234:235] op_sel_hi:[1,1,0]
    v_pk_fma_f32 v[160:161], v[160:161], s[88:89], v[228:229] op_sel_hi:[1,1,0]
    v_pk_fma_f32 v[162:163], v[162:163], s[88:89], v[228:229] op_sel_hi:[1,1,0]
    v_mfma_f32_16x16x32_bf16 v[172:175], a[252:255], a[220:223], 0
    v_exp_f32 v158, v158
    v_mfma_f32_16x16x32_bf16 v[172:175], a[248:251], a[216:219], v[172:175]
    v_exp_f32 v159, v159
    v_mfma_f32_16x16x32_bf16 v[172:175], a[244:247], a[212:215], v[172:175]
    s_mov_b32 m0, s43
    v_exp_f32 v160, v160
    v_mfma_f32_16x16x32_bf16 v[172:175], a[240:243], a[208:211], v[172:175]
    s_waitcnt lgkmcnt(0)
    buffer_load_dwordx4 v246, s[12:15], s83 offen offset:2048 nt lds
    v_mfma_f32_16x16x32_bf16 a[64:67], a[224:227], v[0:3], 0
    ds_read_b128 a[240:243], v237 offset:57344
    v_cvt_pk_bf16_f32 v109, v158, v159
    v_mfma_f32_16x16x32_bf16 a[64:67], a[228:231], v[16:19], a[64:67]
    ds_read_b128 a[244:247], v237 offset:57600
    v_cndmask_b32_dpp v198, v182, v198, vcc quad_perm:[1,0,3,2] row_mask:0xf bank_mask:0xf
    v_mfma_f32_16x16x32_bf16 a[64:67], a[232:235], v[32:35], a[64:67]
    v_exp_f32 v161, v161
    v_mfma_f32_16x16x32_bf16 a[64:67], a[236:239], v[48:51], a[64:67]
    v_exp_f32 v162, v162
    v_cndmask_b32_dpp v199, v183, v199, vcc quad_perm:[1,0,3,2] row_mask:0xf bank_mask:0xf
    v_mfma_f32_16x16x32_bf16 a[80:83], a[236:239], v[52:55], 0
    ds_read_b128 a[248:251], v237 offset:57856
    v_cvt_pk_bf16_f32 v98, v160, v161
    v_mfma_f32_16x16x32_bf16 a[80:83], a[232:235], v[36:39], a[80:83]
    ds_read_b128 a[252:255], v237 offset:58112
    v_fmamk_f32 v164, v164, 0x3e0293ee, v230
    v_mfma_f32_16x16x32_bf16 a[80:83], a[228:231], v[20:23], a[80:83]
    v_permlane16_swap_b32 v176, v178
    v_mfma_f32_16x16x32_bf16 a[80:83], a[224:227], v[4:7], a[80:83]
    v_exp_f32 v163, v163
    v_permlane16_swap_b32 v177, v179
    v_fmamk_f32 v165, v165, 0x3e0293ee, v230
    v_pk_fma_f32 v[166:167], v[166:167], s[88:89], v[230:231] op_sel_hi:[1,1,0]
    v_pk_fma_f32 v[168:169], v[168:169], s[88:89], v[232:233] op_sel_hi:[1,1,0]
    v_mfma_f32_16x16x32_bf16 a[96:99], a[224:227], v[8:11], 0
    v_exp_f32 v164, v164
    v_mfma_f32_16x16x32_bf16 a[96:99], a[228:231], v[24:27], a[96:99]
    v_exp_f32 v165, v165
    v_mfma_f32_16x16x32_bf16 a[96:99], a[232:235], v[40:43], a[96:99]
    s_mov_b32 m0, s43
    v_exp_f32 v166, v166
    v_mfma_f32_16x16x32_bf16 a[96:99], a[236:239], v[56:59], a[96:99]
    buffer_load_dwordx4 v247, s[12:15], s83 offen offset:3072 nt lds
    v_cvt_pk_bf16_f32 v99, v162, v163
    v_mfma_f32_16x16x32_bf16 a[112:115], a[236:239], v[60:63], 0
    v_permlane16_swap_b32 v196, v198
    v_mfma_f32_16x16x32_bf16 a[112:115], a[232:235], v[44:47], a[112:115]
    v_exp_f32 v167, v167
    v_mfma_f32_16x16x32_bf16 a[112:115], a[228:231], v[28:31], a[112:115]
    v_permlane16_swap_b32 v197, v199
    v_mfma_f32_16x16x32_bf16 a[112:115], a[224:227], v[12:15], a[112:115]
    s_waitcnt lgkmcnt(0)
    buffer_store_dwordx4 v[176:179], v243, s[24:27], s52 offen offset:128 sc1
    v_exp_f32 v168, v168
    v_exp_f32 v169, v169
    v_pk_fma_f32 v[170:171], v[170:171], s[88:89], v[232:233] op_sel_hi:[1,1,0]
    v_pk_fma_f32 v[172:173], v[172:173], s[88:89], v[234:235] op_sel_hi:[1,1,0]
    v_cvt_pk_bf16_f32 v102, v164, v165
    v_mfma_f32_16x16x32_bf16 v[128:131], a[240:243], a[160:163], 0
    ds_read_b64_tr_b16 a[224:225], v245 offset:512
    v_cvt_pk_bf16_f32 v103, v166, v167
    v_mfma_f32_16x16x32_bf16 v[128:131], a[244:247], a[164:167], v[128:131]
    ds_read_b64_tr_b16 a[226:227], v245 offset:4608
    s_mov_b64 vcc, s[74:75]
    v_mfma_f32_16x16x32_bf16 v[128:131], a[248:251], a[168:171], v[128:131]
    ds_read_b64_tr_b16 a[228:229], v245 offset:8704
    v_cvt_pk_bf16_f32 v106, v168, v169
    v_mfma_f32_16x16x32_bf16 v[128:131], a[252:255], a[172:175], v[128:131]
    buffer_store_dwordx4 v[196:199], v243, s[24:27], s52 offen offset:384 sc1
    v_exp_f32 v170, v170
    v_exp_f32 v171, v171
    v_pk_fma_f32 v[174:175], v[174:175], s[88:89], v[234:235] op_sel_hi:[1,1,0]
    v_mfma_f32_16x16x32_bf16 v[132:135], a[252:255], a[188:191], 0
    ds_read_b64_tr_b16 a[230:231], v245 offset:12800
    v_cndmask_b32_dpp v180, v200, v184, vcc quad_perm:[1,0,3,2] row_mask:0xf bank_mask:0xf
    v_mfma_f32_16x16x32_bf16 v[132:135], a[248:251], a[184:187], v[132:135]
    ds_read_b64_tr_b16 a[232:233], v245 offset:16896
    v_cndmask_b32_dpp v181, v201, v185, vcc quad_perm:[1,0,3,2] row_mask:0xf bank_mask:0xf
    v_mfma_f32_16x16x32_bf16 v[132:135], a[244:247], a[180:183], v[132:135]
    ds_read_b64_tr_b16 a[234:235], v245 offset:20992
    v_cndmask_b32_dpp v182, v202, v186, vcc quad_perm:[1,0,3,2] row_mask:0xf bank_mask:0xf
    v_mfma_f32_16x16x32_bf16 v[132:135], a[240:243], a[176:179], v[132:135]
    v_exp_f32 v172, v172
    v_mfma_f32_16x16x32_bf16 v[136:139], a[240:243], a[192:195], 0
    ds_read_b64_tr_b16 a[236:237], v245 offset:25088
    v_cvt_pk_bf16_f32 v107, v170, v171
    v_mfma_f32_16x16x32_bf16 v[136:139], a[244:247], a[196:199], v[136:139]
    ds_read_b64_tr_b16 a[238:239], v245 offset:29184
    v_cndmask_b32_dpp v183, v203, v187, vcc quad_perm:[1,0,3,2] row_mask:0xf bank_mask:0xf
    v_mfma_f32_16x16x32_bf16 v[136:139], a[248:251], a[200:203], v[136:139]
    s_mov_b64 vcc, s[76:77]
    v_exp_f32 v173, v173
    v_mfma_f32_16x16x32_bf16 v[136:139], a[252:255], a[204:207], v[136:139]
    v_exp_f32 v174, v174
    v_cndmask_b32_dpp v200, v184, v200, vcc quad_perm:[1,0,3,2] row_mask:0xf bank_mask:0xf
    v_cvt_pk_bf16_f32 v110, v172, v173
    v_cndmask_b32_dpp v201, v185, v201, vcc quad_perm:[1,0,3,2] row_mask:0xf bank_mask:0xf
    v_pk_fma_f32 v[128:129], v[128:129], s[88:89], v[228:229] op_sel_hi:[1,1,0]
    v_pk_fma_f32 v[130:131], v[130:131], s[88:89], v[228:229] op_sel_hi:[1,1,0]
    v_mfma_f32_16x16x32_bf16 v[140:143], a[252:255], a[220:223], 0
    v_exp_f32 v175, v175
    v_mfma_f32_16x16x32_bf16 v[140:143], a[248:251], a[216:219], v[140:143]
    v_exp_f32 v128, v128
    v_mfma_f32_16x16x32_bf16 v[140:143], a[244:247], a[212:215], v[140:143]
    v_exp_f32 v129, v129
    v_mfma_f32_16x16x32_bf16 v[140:143], a[240:243], a[208:211], v[140:143]
    s_waitcnt lgkmcnt(0)
    v_exp_f32 v130, v130
    v_cndmask_b32_dpp v202, v186, v202, vcc quad_perm:[1,0,3,2] row_mask:0xf bank_mask:0xf
    v_cndmask_b32_dpp v203, v187, v203, vcc quad_perm:[1,0,3,2] row_mask:0xf bank_mask:0xf
    v_permlane16_swap_b32 v180, v182
    v_pk_fma_f32 v[132:133], v[132:133], s[88:89], v[230:231] op_sel_hi:[1,1,0]
    v_mfma_f32_16x16x32_bf16 a[72:75], a[224:227], v[0:3], 0
    ds_read_b128 a[240:243], v237 offset:61440
    v_cvt_pk_bf16_f32 v111, v174, v175
    v_mfma_f32_16x16x32_bf16 a[72:75], a[228:231], v[16:19], a[72:75]
    ds_read_b128 a[244:247], v237 offset:61696
    v_cvt_pk_bf16_f32 v112, v128, v129
    v_mfma_f32_16x16x32_bf16 a[72:75], a[232:235], v[32:35], a[72:75]
    s_mov_b32 s58, s57
    v_permlane16_swap_b32 v181, v183
    v_mfma_f32_16x16x32_bf16 a[72:75], a[236:239], v[48:51], a[72:75]
    s_mov_b32 s57, s37
    buffer_store_dwordx4 v[180:183], v243, s[24:27], s53 offen offset:128 sc1
    v_exp_f32 v131, v131
    v_exp_f32 v132, v132
    v_pk_fma_f32 v[134:135], v[134:135], s[88:89], v[230:231] op_sel_hi:[1,1,0]
    v_mfma_f32_16x16x32_bf16 a[88:91], a[236:239], v[52:55], 0
    ds_read_b128 a[248:251], v237 offset:61952
    v_cvt_pk_bf16_f32 v113, v130, v131
    v_mfma_f32_16x16x32_bf16 a[88:91], a[232:235], v[36:39], a[88:91]
    ds_read_b128 a[252:255], v237 offset:62208
    v_fmamk_f32 v136, v136, 0x3e0293ee, v232
    v_mfma_f32_16x16x32_bf16 a[88:91], a[228:231], v[20:23], a[88:91]
    s_add_u32 s37, s37, 8192
    v_permlane16_swap_b32 v200, v202
    v_mfma_f32_16x16x32_bf16 a[88:91], a[224:227], v[4:7], a[88:91]
    s_xor_b32 s80, s37, s84
    v_exp_f32 v133, v133
    v_mfma_f32_16x16x32_bf16 a[104:107], a[224:227], v[8:11], 0
    s_xor_b32 s81, s80, 4096
    v_exp_f32 v134, v134
    v_mfma_f32_16x16x32_bf16 a[104:107], a[228:231], v[24:27], a[104:107]
    s_xor_b32 s82, s80, 16384
    v_permlane16_swap_b32 v201, v203
    v_mfma_f32_16x16x32_bf16 a[104:107], a[232:235], v[40:43], a[104:107]
    s_xor_b32 s83, s80, 20480
    v_exp_f32 v135, v135
    v_mfma_f32_16x16x32_bf16 a[104:107], a[236:239], v[56:59], a[104:107]
    s_cmp_eq_u32 s34, 6
    buffer_store_dwordx4 v[200:203], v243, s[24:27], s53 offen offset:384 sc1
    v_exp_f32 v136, v136
    v_cvt_pk_bf16_f32 v116, v132, v133
    v_fmamk_f32 v137, v137, 0x3e0293ee, v232
    v_pk_fma_f32 v[138:139], v[138:139], s[88:89], v[232:233] op_sel_hi:[1,1,0]
    v_mfma_f32_16x16x32_bf16 a[120:123], a[236:239], v[60:63], 0
    s_cselect_b32 s14, 0, s14
    v_exp_f32 v137, v137
    v_mfma_f32_16x16x32_bf16 a[120:123], a[232:235], v[44:47], a[120:123]
    s_mov_b64 vcc, s[74:75]
    v_exp_f32 v138, v138
    v_mfma_f32_16x16x32_bf16 a[120:123], a[228:231], v[28:31], a[120:123]
    v_exp_f32 v139, v139
    v_mfma_f32_16x16x32_bf16 a[120:123], a[224:227], v[12:15], a[120:123]
    s_waitcnt lgkmcnt(0)
    v_cvt_pk_bf16_f32 v117, v134, v135
    v_cndmask_b32_dpp v184, v204, v188, vcc quad_perm:[1,0,3,2] row_mask:0xf bank_mask:0xf
    v_mfma_f32_16x16x32_bf16 v[144:147], a[240:243], a[160:163], 0
    ds_read_b64_tr_b16 a[224:225], v244 offset:768
    v_cndmask_b32_dpp v185, v205, v189, vcc quad_perm:[1,0,3,2] row_mask:0xf bank_mask:0xf
    v_mfma_f32_16x16x32_bf16 v[144:147], a[244:247], a[164:167], v[144:147]
    ds_read_b64_tr_b16 a[226:227], v244 offset:4864
    v_cvt_pk_bf16_f32 v120, v136, v137
    v_mfma_f32_16x16x32_bf16 v[144:147], a[248:251], a[168:171], v[144:147]
    ds_read_b64_tr_b16 a[228:229], v244 offset:8960
    v_cndmask_b32_dpp v186, v206, v190, vcc quad_perm:[1,0,3,2] row_mask:0xf bank_mask:0xf
    v_mfma_f32_16x16x32_bf16 v[144:147], a[252:255], a[172:175], v[144:147]
    v_cndmask_b32_dpp v187, v207, v191, vcc quad_perm:[1,0,3,2] row_mask:0xf bank_mask:0xf
    s_mov_b64 vcc, s[76:77]
    v_cvt_pk_bf16_f32 v121, v138, v139
    v_cndmask_b32_dpp v204, v188, v204, vcc quad_perm:[1,0,3,2] row_mask:0xf bank_mask:0xf
    v_cndmask_b32_dpp v205, v189, v205, vcc quad_perm:[1,0,3,2] row_mask:0xf bank_mask:0xf
    v_pk_fma_f32 v[140:141], v[140:141], s[88:89], v[234:235] op_sel_hi:[1,1,0]
    v_pk_fma_f32 v[142:143], v[142:143], s[88:89], v[234:235] op_sel_hi:[1,1,0]
    v_mfma_f32_16x16x32_bf16 v[148:151], a[252:255], a[188:191], 0
    ds_read_b64_tr_b16 a[230:231], v244 offset:13056
    v_cndmask_b32_dpp v206, v190, v206, vcc quad_perm:[1,0,3,2] row_mask:0xf bank_mask:0xf
    v_mfma_f32_16x16x32_bf16 v[148:151], a[248:251], a[184:187], v[148:151]
    ds_read_b64_tr_b16 a[232:233], v244 offset:17152
    v_cndmask_b32_dpp v207, v191, v207, vcc quad_perm:[1,0,3,2] row_mask:0xf bank_mask:0xf
    v_mfma_f32_16x16x32_bf16 v[148:151], a[244:247], a[180:183], v[148:151]
    ds_read_b64_tr_b16 a[234:235], v244 offset:21248
    v_fmamk_f32 v144, v144, 0x3e0293ee, v228
    v_mfma_f32_16x16x32_bf16 v[148:151], a[240:243], a[176:179], v[148:151]
    v_exp_f32 v140, v140
    v_exp_f32 v141, v141
    v_mfma_f32_16x16x32_bf16 v[152:155], a[240:243], a[192:195], 0
    ds_read_b64_tr_b16 a[236:237], v244 offset:25344
    v_cvt_pk_bf16_f32 v124, v140, v141
    v_mfma_f32_16x16x32_bf16 v[152:155], a[244:247], a[196:199], v[152:155]
    ds_read_b64_tr_b16 a[238:239], v244 offset:29440
    v_fmamk_f32 v145, v145, 0x3e0293ee, v228
    v_mfma_f32_16x16x32_bf16 v[152:155], a[248:251], a[200:203], v[152:155]
    v_exp_f32 v142, v142
    v_mfma_f32_16x16x32_bf16 v[152:155], a[252:255], a[204:207], v[152:155]
    v_exp_f32 v143, v143
    v_permlane16_swap_b32 v184, v186
    v_mfma_f32_16x16x32_bf16 v[156:159], a[252:255], a[220:223], 0
    v_exp_f32 v144, v144
    v_mfma_f32_16x16x32_bf16 v[156:159], a[248:251], a[216:219], v[156:159]
    v_permlane16_swap_b32 v185, v187
    v_mfma_f32_16x16x32_bf16 v[156:159], a[244:247], a[212:215], v[156:159]
    v_exp_f32 v145, v145
    v_mfma_f32_16x16x32_bf16 v[156:159], a[240:243], a[208:211], v[156:159]
    s_waitcnt lgkmcnt(0)
    buffer_store_dwordx4 v[184:187], v243, s[24:27], s54 offen offset:128 sc1
    v_permlane16_swap_b32 v204, v206
    v_cvt_pk_bf16_f32 v125, v142, v143
    v_cvt_pk_bf16_f32 v114, v144, v145
    v_pk_fma_f32 v[146:147], v[146:147], s[88:89], v[228:229] op_sel_hi:[1,1,0]
    v_pk_fma_f32 v[148:149], v[148:149], s[88:89], v[230:231] op_sel_hi:[1,1,0]
    v_pk_fma_f32 v[150:151], v[150:151], s[88:89], v[230:231] op_sel_hi:[1,1,0]
    v_mfma_f32_16x16x32_bf16 a[68:71], a[224:227], v[0:3], 0
    ds_read_b64_tr_b16 a[240:241], v245 offset:768
    v_fmamk_f32 v152, v152, 0x3e0293ee, v232
    v_mfma_f32_16x16x32_bf16 a[68:71], a[228:231], v[16:19], a[68:71]
    ds_read_b64_tr_b16 a[242:243], v245 offset:4864
    v_fmamk_f32 v153, v153, 0x3e0293ee, v232
    v_mfma_f32_16x16x32_bf16 a[68:71], a[232:235], v[32:35], a[68:71]
    ds_read_b64_tr_b16 a[244:245], v245 offset:8960
    v_fmamk_f32 v154, v154, 0x3e0293ee, v232
    v_mfma_f32_16x16x32_bf16 a[68:71], a[236:239], v[48:51], a[68:71]
    v_exp_f32 v146, v146
    v_exp_f32 v147, v147
    v_mfma_f32_16x16x32_bf16 a[84:87], a[236:239], v[52:55], 0
    ds_read_b64_tr_b16 a[246:247], v245 offset:13056
    v_cvt_pk_bf16_f32 v115, v146, v147
    v_mfma_f32_16x16x32_bf16 a[84:87], a[232:235], v[36:39], a[84:87]
    ds_read_b64_tr_b16 a[248:249], v245 offset:17152
    v_fmamk_f32 v155, v155, 0x3e0293ee, v232
    v_mfma_f32_16x16x32_bf16 a[84:87], a[228:231], v[20:23], a[84:87]
    ds_read_b64_tr_b16 a[250:251], v245 offset:21248
    v_fmamk_f32 v156, v156, 0x3e0293ee, v234
    v_mfma_f32_16x16x32_bf16 a[84:87], a[224:227], v[4:7], a[84:87]
    v_exp_f32 v148, v148
    v_permlane16_swap_b32 v205, v207
    v_exp_f32 v149, v149
    v_mfma_f32_16x16x32_bf16 a[100:103], a[224:227], v[8:11], 0
    ds_read_b64_tr_b16 a[252:253], v245 offset:25344
    v_cvt_pk_bf16_f32 v118, v148, v149
    v_mfma_f32_16x16x32_bf16 a[100:103], a[228:231], v[24:27], a[100:103]
    ds_read_b64_tr_b16 a[254:255], v245 offset:29440
    s_mov_b64 vcc, s[74:75]
    v_mfma_f32_16x16x32_bf16 a[100:103], a[232:235], v[40:43], a[100:103]
    v_exp_f32 v150, v150
    v_mfma_f32_16x16x32_bf16 a[100:103], a[236:239], v[56:59], a[100:103]
    buffer_store_dwordx4 v[204:207], v243, s[24:27], s54 offen offset:384 sc1
    v_exp_f32 v151, v151
    v_exp_f32 v152, v152
    v_mfma_f32_16x16x32_bf16 a[116:119], a[236:239], v[60:63], 0
    v_exp_f32 v153, v153
    v_mfma_f32_16x16x32_bf16 a[116:119], a[232:235], v[44:47], a[116:119]
    v_exp_f32 v154, v154
    v_mfma_f32_16x16x32_bf16 a[116:119], a[228:231], v[28:31], a[116:119]
    v_exp_f32 v155, v155
    v_mfma_f32_16x16x32_bf16 a[116:119], a[224:227], v[12:15], a[116:119]
    s_waitcnt lgkmcnt(0)
    v_exp_f32 v156, v156
    v_cndmask_b32_dpp v188, v208, v192, vcc quad_perm:[1,0,3,2] row_mask:0xf bank_mask:0xf
    v_cvt_pk_bf16_f32 v119, v150, v151
    v_cndmask_b32_dpp v189, v209, v193, vcc quad_perm:[1,0,3,2] row_mask:0xf bank_mask:0xf
    v_cndmask_b32_dpp v190, v210, v194, vcc quad_perm:[1,0,3,2] row_mask:0xf bank_mask:0xf
    v_mfma_f32_16x16x32_bf16 a[76:79], a[240:243], v[0:3], 0
    s_waitcnt vmcnt(6)
    v_cndmask_b32_dpp v191, v211, v195, vcc quad_perm:[1,0,3,2] row_mask:0xf bank_mask:0xf
    v_cvt_pk_bf16_f32 v122, v152, v153
    v_mfma_f32_16x16x32_bf16 a[76:79], a[244:247], v[16:19], a[76:79]
    ds_read_b128 a[192:195], v239 offset:0
    s_mov_b64 vcc, s[76:77]
    v_mfma_f32_16x16x32_bf16 a[76:79], a[248:251], v[32:35], a[76:79]
    ds_read_b128 a[196:199], v239 offset:256
    v_fmamk_f32 v157, v157, 0x3e0293ee, v234
    v_mfma_f32_16x16x32_bf16 a[76:79], a[252:255], v[48:51], a[76:79]
    v_exp_f32 v157, v157
    v_cndmask_b32_dpp v208, v192, v208, vcc quad_perm:[1,0,3,2] row_mask:0xf bank_mask:0xf
    v_cndmask_b32_dpp v209, v193, v209, vcc quad_perm:[1,0,3,2] row_mask:0xf bank_mask:0xf
    v_mfma_f32_16x16x32_bf16 a[92:95], a[252:255], v[52:55], 0
    ds_read_b128 a[200:203], v239 offset:512
    v_cvt_pk_bf16_f32 v123, v154, v155
    v_mfma_f32_16x16x32_bf16 a[92:95], a[248:251], v[36:39], a[92:95]
    ds_read_b128 a[204:207], v239 offset:768
    v_cndmask_b32_dpp v210, v194, v210, vcc quad_perm:[1,0,3,2] row_mask:0xf bank_mask:0xf
    v_mfma_f32_16x16x32_bf16 a[92:95], a[244:247], v[20:23], a[92:95]
    ds_read_b128 a[208:211], v239 offset:4096
    v_cndmask_b32_dpp v211, v195, v211, vcc quad_perm:[1,0,3,2] row_mask:0xf bank_mask:0xf
    v_mfma_f32_16x16x32_bf16 a[92:95], a[240:243], v[4:7], a[92:95]
    v_permlane16_swap_b32 v188, v190
    v_cvt_pk_bf16_f32 v126, v156, v157
    v_permlane16_swap_b32 v189, v191
    v_pk_fma_f32 v[158:159], v[158:159], s[88:89], v[234:235] op_sel_hi:[1,1,0]
    v_exp_f32 v158, v158
    v_mfma_f32_16x16x32_bf16 a[108:111], a[240:243], v[8:11], 0
    ds_read_b128 a[212:215], v239 offset:4352
    v_mfma_f32_16x16x32_bf16 a[108:111], a[244:247], v[24:27], a[108:111]
    ds_read_b128 a[216:219], v239 offset:4608
    v_mfma_f32_16x16x32_bf16 a[108:111], a[248:251], v[40:43], a[108:111]
    ds_read_b128 a[220:223], v239 offset:4864
    v_mfma_f32_16x16x32_bf16 a[108:111], a[252:255], v[56:59], a[108:111]
    buffer_store_dwordx4 v[188:191], v243, s[24:27], s55 offen offset:128 sc1
    v_exp_f32 v159, v159
    v_permlane16_swap_b32 v208, v210
    v_mfma_f32_16x16x32_bf16 a[124:127], a[252:255], v[60:63], 0
    v_permlane16_swap_b32 v209, v211
    v_mfma_f32_16x16x32_bf16 a[124:127], a[248:251], v[44:47], a[124:127]
    v_cvt_pk_bf16_f32 v127, v158, v159
    v_mfma_f32_16x16x32_bf16 a[124:127], a[244:247], v[28:31], a[124:127]
    v_mfma_f32_16x16x32_bf16 a[124:127], a[240:243], v[12:15], a[124:127]
    s_barrier
    v_mfma_f32_16x16x32_bf16 v[160:163], v[248:251], v[64:67], 0
    ds_read_b128 a[224:227], v237 offset:0
    v_mfma_f32_16x16x32_bf16 v[160:163], v[248:251], v[80:83], v[160:163]
    ds_read_b128 a[228:231], v237 offset:256
    v_mfma_f32_16x16x32_bf16 v[160:163], v[248:251], v[96:99], v[160:163]
    v_mfma_f32_16x16x32_bf16 v[160:163], v[248:251], v[112:115], v[160:163]
    buffer_store_dwordx4 v[208:211], v243, s[24:27], s55 offen offset:384 sc1
    v_mfma_f32_16x16x32_bf16 v[164:167], v[248:251], v[68:71], 0
    ds_read_b128 a[232:235], v237 offset:512
    v_mfma_f32_16x16x32_bf16 v[164:167], v[248:251], v[84:87], v[164:167]
    ds_read_b128 a[236:239], v237 offset:768
    v_mfma_f32_16x16x32_bf16 v[164:167], v[248:251], v[100:103], v[164:167]
    v_mfma_f32_16x16x32_bf16 v[164:167], v[248:251], v[116:119], v[164:167]
    v_mfma_f32_16x16x32_bf16 v[168:171], v[248:251], v[72:75], 0
    v_mfma_f32_16x16x32_bf16 v[168:171], v[248:251], v[88:91], v[168:171]
    v_mfma_f32_16x16x32_bf16 v[168:171], v[248:251], v[104:107], v[168:171]
    v_mfma_f32_16x16x32_bf16 v[168:171], v[248:251], v[120:123], v[168:171]
    v_mfma_f32_16x16x32_bf16 v[172:175], v[248:251], v[76:79], 0
    v_mfma_f32_16x16x32_bf16 v[172:175], v[248:251], v[92:95], v[172:175]
    v_mfma_f32_16x16x32_bf16 v[172:175], v[248:251], v[108:111], v[172:175]
    v_mfma_f32_16x16x32_bf16 v[172:175], v[248:251], v[124:127], v[172:175]
    s_waitcnt lgkmcnt(0)
    s_add_u32 s34, s34, 1
    s_cmp_eq_u32 s34, 8
    s_cbranch_scc1 L_last
L_ph4f:
    s_cmp_lt_u32 s34, s38
    s_cbranch_scc0 L_nt88
    s_getpc_b64 s[72:73]
L_pc88:
    s_add_u32 s72, s72, L_ph1f-L_pc88
    s_addc_u32 s73, s73, (L_ph1f-L_pc88)>>32
    v_mbcnt_lo_u32_b32 v222, -1, 0
    v_mbcnt_hi_u32_b32 v222, -1, v222
    v_lshrrev_b32 v222, 2, v222
    v_lshl_add_u32 v222, s32, 4, v222
    v_lshlrev_b32 v222, 7, v222
    v_min_u32 v222, L_ph2f-L_ph1f, v222
    v_mov_b32 v223, s73
    v_add_co_u32 v222, vcc, s72, v222
    s_nop 1
    v_addc_co_u32 v223, vcc, 0, v223, vcc
    global_load_dword v254, v[222:223], off
L_nt88:
    v_mfma_f32_16x16x32_bf16 v[128:131], a[224:227], a[128:131], 0
    ds_read_b128 a[240:243], v237 offset:4096
    v_mfma_f32_16x16x32_bf16 v[128:131], a[228:231], a[132:135], v[128:131]
    ds_read_b128 a[244:247], v237 offset:4352
    s_xor_b32 s86, s85, 65536
    v_mfma_f32_16x16x32_bf16 v[128:131], a[232:235], a[136:139], v[128:131]
    s_xor_b32 m0, s35, 65536
    v_mfma_f32_16x16x32_bf16 v[128:131], a[236:239], a[140:143], v[128:131]
    s_cmp_eq_u32 s34, 7
    s_cbranch_scc1 L_sh90
    buffer_load_dwordx4 v241, s[20:23], s86 offen nt lds
L_shr90:
    v_max3_f32 v220, v160, v164, v168
    v_max_f32 v220, v220, v172
    v_mfma_f32_16x16x32_bf16 v[132:135], a[236:239], a[156:159], 0
    ds_read_b128 a[248:251], v237 offset:4608
    v_cmp_lt_f32 vcc, 0x5f800000, v220
    v_mfma_f32_16x16x32_bf16 v[132:135], a[232:235], a[152:155], v[132:135]
    ds_read_b128 a[252:255], v237 offset:4864
    s_cbranch_vccnz L_chk89_redo
L_chk89:
    v_mfma_f32_16x16x32_bf16 v[132:135], a[228:231], a[148:151], v[132:135]
    v_add_f32 v236, v229, v160
    v_add_f32 v238, v231, v164
    v_mfma_f32_16x16x32_bf16 v[132:135], a[224:227], a[144:147], v[132:135]
    v_add_f32 v240, v233, v168
    v_add_f32 v242, v235, v172
    v_rcp_f32 v236, v236
    v_mfma_f32_16x16x32_bf16 v[136:139], a[224:227], a[192:195], 0
    v_rcp_f32 v238, v238
    v_mfma_f32_16x16x32_bf16 v[136:139], a[228:231], a[196:199], v[136:139]
    s_xor_b32 s86, s85, 66560
    v_rcp_f32 v240, v240
    v_mfma_f32_16x16x32_bf16 v[136:139], a[232:235], a[200:203], v[136:139]
    s_xor_b32 m0, s35, 66560
    v_rcp_f32 v242, v242
    v_mfma_f32_16x16x32_bf16 v[136:139], a[236:239], a[204:207], v[136:139]
    s_cmp_eq_u32 s34, 7
    s_cbranch_scc1 L_sh91
    buffer_load_dwordx4 v255, s[20:23], s86 offen nt lds
L_shr91:
    v_max_f32 v220, v128, v129
    v_mfma_f32_16x16x32_bf16 v[140:143], a[236:239], a[220:223], 0
    v_max3_f32 v220, v220, v130, v131
    v_max_f32 v221, v132, v133
    v_mfma_f32_16x16x32_bf16 v[140:143], a[232:235], a[216:219], v[140:143]
    v_max3_f32 v221, v221, v134, v135
    v_max_f32 v222, v136, v137
    v_mfma_f32_16x16x32_bf16 v[140:143], a[228:231], a[212:215], v[140:143]
    v_max3_f32 v222, v222, v138, v139
    v_mfma_f32_16x16x32_bf16 v[140:143], a[224:227], a[208:211], v[140:143]
    s_waitcnt lgkmcnt(0)
    v_mfma_f32_16x16x32_bf16 v[144:147], a[240:243], a[128:131], 0
    ds_read_b64_tr_b16 a[224:225], v244 offset:32768
    v_mfma_f32_16x16x32_bf16 v[144:147], a[244:247], a[132:135], v[144:147]
    ds_read_b64_tr_b16 a[226:227], v244 offset:36864
    s_xor_b32 s86, s85, 73728
    v_mfma_f32_16x16x32_bf16 v[144:147], a[248:251], a[136:139], v[144:147]
    ds_read_b64_tr_b16 a[228:229], v244 offset:40960
    s_xor_b32 m0, s35, 69632
    v_mfma_f32_16x16x32_bf16 v[144:147], a[252:255], a[140:143], v[144:147]
    s_cmp_eq_u32 s34, 7
    s_cbranch_scc1 L_sh92
    buffer_load_dwordx4 v241, s[20:23], s86 offen nt lds
L_shr92:
    v_max_f32 v223, v140, v141
    v_max3_f32 v223, v223, v142, v143
    v_mfma_f32_16x16x32_bf16 v[148:151], a[252:255], a[156:159], 0
    ds_read_b64_tr_b16 a[230:231], v244 offset:45056
    v_mfma_f32_16x16x32_bf16 v[148:151], a[248:251], a[152:155], v[148:151]
    ds_read_b64_tr_b16 a[232:233], v244 offset:49152
    v_mfma_f32_16x16x32_bf16 v[148:151], a[244:247], a[148:151], v[148:151]
    ds_read_b64_tr_b16 a[234:235], v244 offset:53248
    v_mfma_f32_16x16x32_bf16 v[148:151], a[240:243], a[144:147], v[148:151]
    v_permlane32_swap_b32 v220, v221
    v_permlane32_swap_b32 v222, v223
    v_max_f32 v224, v220, v221
    v_max_f32 v226, v222, v223
    v_mov_b32 v225, v224
    v_mfma_f32_16x16x32_bf16 v[152:155], a[240:243], a[192:195], 0
    ds_read_b64_tr_b16 a[236:237], v244 offset:57344
    v_mov_b32 v227, v226
    v_mfma_f32_16x16x32_bf16 v[152:155], a[244:247], a[196:199], v[152:155]
    ds_read_b64_tr_b16 a[238:239], v244 offset:61440
    s_xor_b32 s86, s85, 74752
    v_mfma_f32_16x16x32_bf16 v[152:155], a[248:251], a[200:203], v[152:155]
    s_xor_b32 m0, s35, 70656
    v_permlane16_swap_b32 v224, v225
    v_mfma_f32_16x16x32_bf16 v[152:155], a[252:255], a[204:207], v[152:155]
    s_cmp_eq_u32 s34, 7
    s_cbranch_scc1 L_sh93
    buffer_load_dwordx4 v255, s[20:23], s86 offen nt lds
L_shr93:
    v_permlane16_swap_b32 v226, v227
    v_max_f32 v224, v224, v225
    v_max_f32 v226, v226, v227
    v_mul_f32 v228, 0xbe0293ee, v224
    v_mul_f32 v232, 0xbe0293ee, v226
    v_mfma_f32_16x16x32_bf16 v[156:159], a[252:255], a[220:223], 0
    v_mul_f32 v230, 0xbe0293ee, v224
    v_mul_f32 v234, 0xbe0293ee, v226
    v_mfma_f32_16x16x32_bf16 v[156:159], a[248:251], a[216:219], v[156:159]
    v_permlane32_swap_b32 v228, v230
    v_mfma_f32_16x16x32_bf16 v[156:159], a[244:247], a[212:215], v[156:159]
    v_permlane32_swap_b32 v232, v234
    v_mfma_f32_16x16x32_bf16 v[156:159], a[240:243], a[208:211], v[156:159]
    s_waitcnt lgkmcnt(0)
    s_xor_b32 s52, s58, s84
    s_xor_b32 s53, s52, 4096
    s_xor_b32 s54, s52, 16384
    s_xor_b32 s55, s52, 20480
    s_mov_b32 s26, 0x8000000
    v_pk_fma_f32 v[128:129], v[128:129], s[88:89], v[228:229] op_sel_hi:[1,1,0]
    v_pk_fma_f32 v[130:131], v[130:131], s[88:89], v[228:229] op_sel_hi:[1,1,0]
    v_pk_fma_f32 v[132:133], v[132:133], s[88:89], v[230:231] op_sel_hi:[1,1,0]
    v_mfma_f32_16x16x32_bf16 a[0:3], a[224:227], v[64:67], a[0:3]
    ds_read_b128 a[240:243], v237 offset:8192
    v_fmamk_f32 v134, v134, 0x3e0293ee, v230
    v_mfma_f32_16x16x32_bf16 a[0:3], a[228:231], v[80:83], a[0:3]
    ds_read_b128 a[244:247], v237 offset:8448
    v_fmamk_f32 v135, v135, 0x3e0293ee, v230
    v_mfma_f32_16x16x32_bf16 a[0:3], a[232:235], v[96:99], a[0:3]
    v_exp_f32 v128, v128
    v_mfma_f32_16x16x32_bf16 a[0:3], a[236:239], v[112:115], a[0:3]
    v_exp_f32 v129, v129
    v_mfma_f32_16x16x32_bf16 a[16:19], a[236:239], v[116:119], a[16:19]
    ds_read_b128 a[248:251], v237 offset:8704
    v_cvt_pk_bf16_f32 v0, v128, v129
    v_mfma_f32_16x16x32_bf16 a[16:19], a[232:235], v[100:103], a[16:19]
    ds_read_b128 a[252:255], v237 offset:8960
    s_xor_b32 s86, s85, 81920
    v_mfma_f32_16x16x32_bf16 a[16:19], a[228:231], v[84:87], a[16:19]
    s_xor_b32 m0, s35, 73728
    v_exp_f32 v130, v130
    v_mfma_f32_16x16x32_bf16 a[16:19], a[224:227], v[68:71], a[16:19]
    s_cmp_eq_u32 s34, 7
    s_cbranch_scc1 L_sh94
    buffer_load_dwordx4 v241, s[20:23], s86 offen nt lds
L_shr94:
    v_fmamk_f32 v136, v136, 0x3e0293ee, v232
    v_exp_f32 v131, v131
    v_exp_f32 v132, v132
    v_mfma_f32_16x16x32_bf16 a[32:35], a[224:227], v[72:75], a[32:35]
    v_exp_f32 v133, v133
    v_mfma_f32_16x16x32_bf16 a[32:35], a[228:231], v[88:91], a[32:35]
    v_exp_f32 v134, v134
    v_mfma_f32_16x16x32_bf16 a[32:35], a[232:235], v[104:107], a[32:35]
    v_exp_f32 v135, v135
    v_mfma_f32_16x16x32_bf16 a[32:35], a[236:239], v[120:123], a[32:35]
    v_exp_f32 v136, v136
    v_cvt_pk_bf16_f32 v1, v130, v131
    v_mfma_f32_16x16x32_bf16 a[48:51], a[236:239], v[124:127], a[48:51]
    v_cvt_pk_bf16_f32 v4, v132, v133
    v_fmamk_f32 v137, v137, 0x3e0293ee, v232
    v_mfma_f32_16x16x32_bf16 a[48:51], a[232:235], v[108:111], a[48:51]
    s_xor_b32 s86, s85, 82944
    v_exp_f32 v137, v137
    v_mfma_f32_16x16x32_bf16 a[48:51], a[228:231], v[92:95], a[48:51]
    s_xor_b32 m0, s35, 74752
    v_cvt_pk_bf16_f32 v5, v134, v135
    v_cvt_pk_bf16_f32 v8, v136, v137
    v_mfma_f32_16x16x32_bf16 a[48:51], a[224:227], v[76:79], a[48:51]
    s_waitcnt lgkmcnt(0)
    s_cmp_eq_u32 s34, 7
    s_cbranch_scc1 L_sh95
    buffer_load_dwordx4 v255, s[20:23], s86 offen nt lds
L_shr95:
    v_fmamk_f32 v138, v138, 0x3e0293ee, v232
    v_mfma_f32_16x16x32_bf16 v[160:163], a[240:243], a[128:131], 0
    ds_read_b64_tr_b16 a[224:225], v245 offset:32768
    v_fmamk_f32 v139, v139, 0x3e0293ee, v232
    v_mfma_f32_16x16x32_bf16 v[160:163], a[244:247], a[132:135], v[160:163]
    ds_read_b64_tr_b16 a[226:227], v245 offset:36864
    v_fmamk_f32 v140, v140, 0x3e0293ee, v234
    v_mfma_f32_16x16x32_bf16 v[160:163], a[248:251], a[136:139], v[160:163]
    ds_read_b64_tr_b16 a[228:229], v245 offset:40960
    v_fmamk_f32 v141, v141, 0x3e0293ee, v234
    v_mfma_f32_16x16x32_bf16 v[160:163], a[252:255], a[140:143], v[160:163]
    v_exp_f32 v138, v138
    v_exp_f32 v139, v139
    v_mfma_f32_16x16x32_bf16 v[164:167], a[252:255], a[156:159], 0
    ds_read_b64_tr_b16 a[230:231], v245 offset:45056
    v_cvt_pk_bf16_f32 v9, v138, v139
    v_mfma_f32_16x16x32_bf16 v[164:167], a[248:251], a[152:155], v[164:167]
    ds_read_b64_tr_b16 a[232:233], v245 offset:49152
    s_xor_b32 s86, s85, 90112
    v_mfma_f32_16x16x32_bf16 v[164:167], a[244:247], a[148:151], v[164:167]
    ds_read_b64_tr_b16 a[234:235], v245 offset:53248
    s_xor_b32 m0, s35, 77824
    v_mfma_f32_16x16x32_bf16 v[164:167], a[240:243], a[144:147], v[164:167]
    s_cmp_eq_u32 s34, 7
    s_cbranch_scc1 L_sh96
    buffer_load_dwordx4 v241, s[20:23], s86 offen nt lds
L_shr96:
    v_fmamk_f32 v142, v142, 0x3e0293ee, v234
    v_exp_f32 v140, v140
    v_exp_f32 v141, v141
    v_fmamk_f32 v143, v143, 0x3e0293ee, v234
    v_pk_fma_f32 v[144:145], v[144:145], s[88:89], v[228:229] op_sel_hi:[1,1,0]
    v_pk_fma_f32 v[146:147], v[146:147], s[88:89], v[228:229] op_sel_hi:[1,1,0]
    v_mfma_f32_16x16x32_bf16 v[168:171], a[240:243], a[192:195], 0
    ds_read_b64_tr_b16 a[236:237], v245 offset:57344
    v_cvt_pk_bf16_f32 v12, v140, v141
    v_mfma_f32_16x16x32_bf16 v[168:171], a[244:247], a[196:199], v[168:171]
    ds_read_b64_tr_b16 a[238:239], v245 offset:61440
    v_fmamk_f32 v148, v148, 0x3e0293ee, v230
    v_mfma_f32_16x16x32_bf16 v[168:171], a[248:251], a[200:203], v[168:171]
    v_exp_f32 v142, v142
    v_mfma_f32_16x16x32_bf16 v[168:171], a[252:255], a[204:207], v[168:171]
    v_exp_f32 v143, v143
    v_mfma_f32_16x16x32_bf16 v[172:175], a[252:255], a[220:223], 0
    v_exp_f32 v144, v144
    v_mfma_f32_16x16x32_bf16 v[172:175], a[248:251], a[216:219], v[172:175]
    s_xor_b32 s86, s85, 91136
    v_exp_f32 v145, v145
    v_mfma_f32_16x16x32_bf16 v[172:175], a[244:247], a[212:215], v[172:175]
    s_xor_b32 m0, s35, 78848
    v_exp_f32 v146, v146
    v_mfma_f32_16x16x32_bf16 v[172:175], a[240:243], a[208:211], v[172:175]
    s_waitcnt lgkmcnt(0)
    s_cmp_eq_u32 s34, 7
    s_cbranch_scc1 L_sh97
    buffer_load_dwordx4 v255, s[20:23], s86 offen nt lds
L_shr97:
    v_cvt_pk_bf16_f32 v13, v142, v143
    v_mfma_f32_16x16x32_bf16 a[8:11], a[224:227], v[64:67], a[8:11]
    ds_read_b128 a[240:243], v237 offset:12288
    v_cvt_pk_bf16_f32 v2, v144, v145
    v_mfma_f32_16x16x32_bf16 a[8:11], a[228:231], v[80:83], a[8:11]
    ds_read_b128 a[244:247], v237 offset:12544
    v_fmamk_f32 v149, v149, 0x3e0293ee, v230
    v_mfma_f32_16x16x32_bf16 a[8:11], a[232:235], v[96:99], a[8:11]
    v_exp_f32 v147, v147
    v_mfma_f32_16x16x32_bf16 a[8:11], a[236:239], v[112:115], a[8:11]
    v_exp_f32 v148, v148
    v_cvt_pk_bf16_f32 v3, v146, v147
    v_exp_f32 v149, v149
    v_pk_fma_f32 v[150:151], v[150:151], s[88:89], v[230:231] op_sel_hi:[1,1,0]
    v_pk_fma_f32 v[152:153], v[152:153], s[88:89], v[232:233] op_sel_hi:[1,1,0]
    v_mfma_f32_16x16x32_bf16 a[24:27], a[236:239], v[116:119], a[24:27]
    ds_read_b128 a[248:251], v237 offset:12800
    v_cvt_pk_bf16_f32 v6, v148, v149
    v_mfma_f32_16x16x32_bf16 a[24:27], a[232:235], v[100:103], a[24:27]
    ds_read_b128 a[252:255], v237 offset:13056
    v_fmamk_f32 v154, v154, 0x3e0293ee, v232
    v_mfma_f32_16x16x32_bf16 a[24:27], a[228:231], v[84:87], a[24:27]
    v_exp_f32 v150, v150
    v_mfma_f32_16x16x32_bf16 a[24:27], a[224:227], v[68:71], a[24:27]
    v_exp_f32 v151, v151
    v_mfma_f32_16x16x32_bf16 a[40:43], a[224:227], v[72:75], a[40:43]
    v_exp_f32 v152, v152
    v_mfma_f32_16x16x32_bf16 a[40:43], a[228:231], v[88:91], a[40:43]
    s_xor_b32 s86, s85, 4096
    v_exp_f32 v153, v153
    v_mfma_f32_16x16x32_bf16 a[40:43], a[232:235], v[104:107], a[40:43]
    s_xor_b32 m0, s35, 32768
    v_exp_f32 v154, v154
    v_mfma_f32_16x16x32_bf16 a[40:43], a[236:239], v[120:123], a[40:43]
    s_cmp_eq_u32 s34, 7
    s_cbranch_scc1 L_sh98
    buffer_load_dwordx4 v241, s[16:19], s86 offen nt lds
L_shr98:
    v_cvt_pk_bf16_f32 v7, v150, v151
    v_fmamk_f32 v155, v155, 0x3e0293ee, v232
    v_mfma_f32_16x16x32_bf16 a[56:59], a[236:239], v[124:127], a[56:59]
    v_exp_f32 v155, v155
    v_mfma_f32_16x16x32_bf16 a[56:59], a[232:235], v[108:111], a[56:59]
    v_cvt_pk_bf16_f32 v10, v152, v153
    v_cvt_pk_bf16_f32 v11, v154, v155
    v_mfma_f32_16x16x32_bf16 a[56:59], a[228:231], v[92:95], a[56:59]
    v_fmamk_f32 v156, v156, 0x3e0293ee, v234
    v_fmamk_f32 v157, v157, 0x3e0293ee, v234
    v_mfma_f32_16x16x32_bf16 a[56:59], a[224:227], v[76:79], a[56:59]
    s_waitcnt lgkmcnt(0)
    v_exp_f32 v156, v156
    v_mfma_f32_16x16x32_bf16 v[128:131], a[240:243], a[128:131], 0
    ds_read_b64_tr_b16 a[224:225], v244 offset:33024
    v_fmamk_f32 v158, v158, 0x3e0293ee, v234
    v_mfma_f32_16x16x32_bf16 v[128:131], a[244:247], a[132:135], v[128:131]
    ds_read_b64_tr_b16 a[226:227], v244 offset:37120
    s_xor_b32 s86, s85, 5120
    v_mfma_f32_16x16x32_bf16 v[128:131], a[248:251], a[136:139], v[128:131]
    ds_read_b64_tr_b16 a[228:229], v244 offset:41216
    s_xor_b32 m0, s35, 33792
    v_mfma_f32_16x16x32_bf16 v[128:131], a[252:255], a[140:143], v[128:131]
    s_cmp_eq_u32 s34, 7
    s_cbranch_scc1 L_sh99
    buffer_load_dwordx4 v255, s[16:19], s86 offen nt lds
L_shr99:
    v_fmamk_f32 v159, v159, 0x3e0293ee, v234
    v_exp_f32 v157, v157
    v_mfma_f32_16x16x32_bf16 v[132:135], a[252:255], a[156:159], 0
    ds_read_b64_tr_b16 a[230:231], v244 offset:45312
    v_cvt_pk_bf16_f32 v14, v156, v157
    v_mfma_f32_16x16x32_bf16 v[132:135], a[248:251], a[152:155], v[132:135]
    ds_read_b64_tr_b16 a[232:233], v244 offset:49408
    v_fmamk_f32 v160, v160, 0x3e0293ee, v228
    v_mfma_f32_16x16x32_bf16 v[132:135], a[244:247], a[148:151], v[132:135]
    ds_read_b64_tr_b16 a[234:235], v244 offset:53504
    v_fmamk_f32 v161, v161, 0x3e0293ee, v228
    v_mfma_f32_16x16x32_bf16 v[132:135], a[240:243], a[144:147], v[132:135]
    v_exp_f32 v158, v158
    v_exp_f32 v159, v159
    v_exp_f32 v160, v160
    v_pk_fma_f32 v[162:163], v[162:163], s[88:89], v[228:229] op_sel_hi:[1,1,0]
    v_pk_fma_f32 v[164:165], v[164:165], s[88:89], v[230:231] op_sel_hi:[1,1,0]
    v_mfma_f32_16x16x32_bf16 v[136:139], a[240:243], a[192:195], 0
    ds_read_b64_tr_b16 a[236:237], v244 offset:57600
    v_cvt_pk_bf16_f32 v15, v158, v159
    v_mfma_f32_16x16x32_bf16 v[136:139], a[244:247], a[196:199], v[136:139]
    ds_read_b64_tr_b16 a[238:239], v244 offset:61696
    s_xor_b32 s86, s85, 12288
    v_mfma_f32_16x16x32_bf16 v[136:139], a[248:251], a[200:203], v[136:139]
    s_xor_b32 m0, s35, 36864
    v_exp_f32 v161, v161
    v_mfma_f32_16x16x32_bf16 v[136:139], a[252:255], a[204:207], v[136:139]
    s_cmp_eq_u32 s34, 7
    s_cbranch_scc1 L_sh100
    buffer_load_dwordx4 v241, s[16:19], s86 offen nt lds
L_shr100:
    v_cvt_pk_bf16_f32 v16, v160, v161
    v_exp_f32 v162, v162
    v_mfma_f32_16x16x32_bf16 v[140:143], a[252:255], a[220:223], 0
    v_exp_f32 v163, v163
    v_mfma_f32_16x16x32_bf16 v[140:143], a[248:251], a[216:219], v[140:143]
    v_exp_f32 v164, v164
    v_mfma_f32_16x16x32_bf16 v[140:143], a[244:247], a[212:215], v[140:143]
    v_exp_f32 v165, v165
    v_mfma_f32_16x16x32_bf16 v[140:143], a[240:243], a[208:211], v[140:143]
    s_waitcnt lgkmcnt(0)
    v_cvt_pk_bf16_f32 v17, v162, v163
    v_cvt_pk_bf16_f32 v20, v164, v165
    v_fmamk_f32 v166, v166, 0x3e0293ee, v230
    v_mfma_f32_16x16x32_bf16 a[4:7], a[224:227], v[64:67], a[4:7]
    ds_read_b128 a[240:243], v237 offset:16384
    v_fmamk_f32 v167, v167, 0x3e0293ee, v230
    v_mfma_f32_16x16x32_bf16 a[4:7], a[228:231], v[80:83], a[4:7]
    ds_read_b128 a[244:247], v237 offset:16640
    s_xor_b32 s86, s85, 13312
    v_mfma_f32_16x16x32_bf16 a[4:7], a[232:235], v[96:99], a[4:7]
    s_xor_b32 m0, s35, 37888
    v_exp_f32 v166, v166
    v_mfma_f32_16x16x32_bf16 a[4:7], a[236:239], v[112:115], a[4:7]
    s_cmp_eq_u32 s34, 7
    s_cbranch_scc1 L_sh101
    buffer_load_dwordx4 v255, s[16:19], s86 offen nt lds
L_shr101:
    v_fmamk_f32 v168, v168, 0x3e0293ee, v232
    v_exp_f32 v167, v167
    v_fmamk_f32 v169, v169, 0x3e0293ee, v232
    v_pk_fma_f32 v[170:171], v[170:171], s[88:89], v[232:233] op_sel_hi:[1,1,0]
    v_pk_fma_f32 v[172:173], v[172:173], s[88:89], v[234:235] op_sel_hi:[1,1,0]
    v_mfma_f32_16x16x32_bf16 a[20:23], a[236:239], v[116:119], a[20:23]
    ds_read_b128 a[248:251], v237 offset:16896
    v_cvt_pk_bf16_f32 v21, v166, v167
    v_mfma_f32_16x16x32_bf16 a[20:23], a[232:235], v[100:103], a[20:23]
    ds_read_b128 a[252:255], v237 offset:17152
    v_fmamk_f32 v174, v174, 0x3e0293ee, v234
    v_mfma_f32_16x16x32_bf16 a[20:23], a[228:231], v[84:87], a[20:23]
    v_exp_f32 v168, v168
    v_mfma_f32_16x16x32_bf16 a[20:23], a[224:227], v[68:71], a[20:23]
    v_exp_f32 v169, v169
    v_mfma_f32_16x16x32_bf16 a[36:39], a[224:227], v[72:75], a[36:39]
    v_exp_f32 v170, v170
    v_mfma_f32_16x16x32_bf16 a[36:39], a[228:231], v[88:91], a[36:39]
    v_exp_f32 v171, v171
    v_mfma_f32_16x16x32_bf16 a[36:39], a[232:235], v[104:107], a[36:39]
    v_exp_f32 v172, v172
    v_mfma_f32_16x16x32_bf16 a[36:39], a[236:239], v[120:123], a[36:39]
    v_exp_f32 v173, v173
    v_cvt_pk_bf16_f32 v24, v168, v169
    v_mfma_f32_16x16x32_bf16 a[52:55], a[236:239], v[124:127], a[52:55]
    v_exp_f32 v174, v174
    v_mfma_f32_16x16x32_bf16 a[52:55], a[232:235], v[108:111], a[52:55]
    s_xor_b32 s86, s85, 20480
    v_cvt_pk_bf16_f32 v25, v170, v171
    v_fmamk_f32 v175, v175, 0x3e0293ee, v234
    v_mfma_f32_16x16x32_bf16 a[52:55], a[228:231], v[92:95], a[52:55]
    s_xor_b32 m0, s35, 40960
    v_exp_f32 v175, v175
    v_mfma_f32_16x16x32_bf16 a[52:55], a[224:227], v[76:79], a[52:55]
    s_waitcnt lgkmcnt(0)
    s_cmp_eq_u32 s34, 7
    s_cbranch_scc1 L_sh102
    buffer_load_dwordx4 v241, s[16:19], s86 offen nt lds
L_shr102:
    v_cvt_pk_bf16_f32 v28, v172, v173
    v_cvt_pk_bf16_f32 v29, v174, v175
    v_fmamk_f32 v128, v128, 0x3e0293ee, v228
    v_mfma_f32_16x16x32_bf16 v[144:147], a[240:243], a[128:131], 0
    ds_read_b64_tr_b16 a[224:225], v245 offset:33024
    v_fmamk_f32 v129, v129, 0x3e0293ee, v228
    v_mfma_f32_16x16x32_bf16 v[144:147], a[244:247], a[132:135], v[144:147]
    ds_read_b64_tr_b16 a[226:227], v245 offset:37120
    v_fmamk_f32 v130, v130, 0x3e0293ee, v228
    v_mfma_f32_16x16x32_bf16 v[144:147], a[248:251], a[136:139], v[144:147]
    ds_read_b64_tr_b16 a[228:229], v245 offset:41216
    v_fmamk_f32 v131, v131, 0x3e0293ee, v228
    v_mfma_f32_16x16x32_bf16 v[144:147], a[252:255], a[140:143], v[144:147]
    v_exp_f32 v128, v128
    v_mfma_f32_16x16x32_bf16 v[148:151], a[252:255], a[156:159], 0
    ds_read_b64_tr_b16 a[230:231], v245 offset:45312
    v_fmamk_f32 v132, v132, 0x3e0293ee, v230
    v_mfma_f32_16x16x32_bf16 v[148:151], a[248:251], a[152:155], v[148:151]
    ds_read_b64_tr_b16 a[232:233], v245 offset:49408
    s_xor_b32 s86, s85, 21504
    v_mfma_f32_16x16x32_bf16 v[148:151], a[244:247], a[148:151], v[148:151]
    ds_read_b64_tr_b16 a[234:235], v245 offset:53504
    s_xor_b32 m0, s35, 41984
    v_mfma_f32_16x16x32_bf16 v[148:151], a[240:243], a[144:147], v[148:151]
    s_cmp_eq_u32 s34, 7
    s_cbranch_scc1 L_sh103
    buffer_load_dwordx4 v255, s[16:19], s86 offen nt lds
L_shr103:
    v_fmamk_f32 v133, v133, 0x3e0293ee, v230
    v_exp_f32 v129, v129
    v_exp_f32 v130, v130
    v_pk_fma_f32 v[134:135], v[134:135], s[88:89], v[230:231] op_sel_hi:[1,1,0]
    v_pk_fma_f32 v[136:137], v[136:137], s[88:89], v[232:233] op_sel_hi:[1,1,0]
    v_cvt_pk_bf16_f32 v18, v128, v129
    v_exp_f32 v131, v131
    v_mfma_f32_16x16x32_bf16 v[152:155], a[240:243], a[192:195], 0
    ds_read_b64_tr_b16 a[236:237], v245 offset:57600
    v_cvt_pk_bf16_f32 v19, v130, v131
    v_mfma_f32_16x16x32_bf16 v[152:155], a[244:247], a[196:199], v[152:155]
    ds_read_b64_tr_b16 a[238:239], v245 offset:61696
    v_fmamk_f32 v138, v138, 0x3e0293ee, v232
    v_mfma_f32_16x16x32_bf16 v[152:155], a[248:251], a[200:203], v[152:155]
    v_exp_f32 v132, v132
    v_mfma_f32_16x16x32_bf16 v[152:155], a[252:255], a[204:207], v[152:155]
    v_exp_f32 v133, v133
    v_mfma_f32_16x16x32_bf16 v[156:159], a[252:255], a[220:223], 0
    v_exp_f32 v134, v134
    v_mfma_f32_16x16x32_bf16 v[156:159], a[248:251], a[216:219], v[156:159]
    s_xor_b32 s86, s85, 28672
    v_exp_f32 v135, v135
    v_mfma_f32_16x16x32_bf16 v[156:159], a[244:247], a[212:215], v[156:159]
    s_xor_b32 m0, s35, 45056
    v_exp_f32 v136, v136
    v_mfma_f32_16x16x32_bf16 v[156:159], a[240:243], a[208:211], v[156:159]
    s_waitcnt lgkmcnt(0)
    s_cmp_eq_u32 s34, 7
    s_cbranch_scc1 L_sh104
    buffer_load_dwordx4 v241, s[16:19], s86 offen nt lds
L_shr104:
    v_cvt_pk_bf16_f32 v22, v132, v133
    v_mfma_f32_16x16x32_bf16 a[12:15], a[224:227], v[64:67], a[12:15]
    ds_read_b128 a[240:243], v237 offset:20480
    v_cvt_pk_bf16_f32 v23, v134, v135
    v_mfma_f32_16x16x32_bf16 a[12:15], a[228:231], v[80:83], a[12:15]
    ds_read_b128 a[244:247], v237 offset:20736
    v_fmamk_f32 v139, v139, 0x3e0293ee, v232
    v_mfma_f32_16x16x32_bf16 a[12:15], a[232:235], v[96:99], a[12:15]
    v_exp_f32 v137, v137
    v_mfma_f32_16x16x32_bf16 a[12:15], a[236:239], v[112:115], a[12:15]
    v_exp_f32 v138, v138
    v_mfma_f32_16x16x32_bf16 a[28:31], a[236:239], v[116:119], a[28:31]
    ds_read_b128 a[248:251], v237 offset:20992
    v_cvt_pk_bf16_f32 v26, v136, v137
    v_mfma_f32_16x16x32_bf16 a[28:31], a[232:235], v[100:103], a[28:31]
    ds_read_b128 a[252:255], v237 offset:21248
    v_fmamk_f32 v140, v140, 0x3e0293ee, v234
    v_mfma_f32_16x16x32_bf16 a[28:31], a[228:231], v[84:87], a[28:31]
    v_exp_f32 v139, v139
    v_mfma_f32_16x16x32_bf16 a[28:31], a[224:227], v[68:71], a[28:31]
    v_exp_f32 v140, v140
    v_fmamk_f32 v141, v141, 0x3e0293ee, v234
    v_cvt_pk_bf16_f32 v27, v138, v139
    v_exp_f32 v141, v141
    v_pk_fma_f32 v[142:143], v[142:143], s[88:89], v[234:235] op_sel_hi:[1,1,0]
    v_pk_fma_f32 v[144:145], v[144:145], s[88:89], v[228:229] op_sel_hi:[1,1,0]
    v_mfma_f32_16x16x32_bf16 a[44:47], a[224:227], v[72:75], a[44:47]
    v_exp_f32 v142, v142
    v_mfma_f32_16x16x32_bf16 a[44:47], a[228:231], v[88:91], a[44:47]
    s_xor_b32 s86, s85, 29696
    v_exp_f32 v143, v143
    v_mfma_f32_16x16x32_bf16 a[44:47], a[232:235], v[104:107], a[44:47]
    s_xor_b32 m0, s35, 46080
    v_exp_f32 v144, v144
    v_mfma_f32_16x16x32_bf16 a[44:47], a[236:239], v[120:123], a[44:47]
    s_cmp_eq_u32 s34, 7
    s_cbranch_scc1 L_sh105
    buffer_load_dwordx4 v255, s[16:19], s86 offen nt lds
L_shr105:
    v_cvt_pk_bf16_f32 v30, v140, v141
    v_mfma_f32_16x16x32_bf16 a[60:63], a[236:239], v[124:127], a[60:63]
    v_exp_f32 v145, v145
    v_mfma_f32_16x16x32_bf16 a[60:63], a[232:235], v[108:111], a[60:63]
    v_cvt_pk_bf16_f32 v31, v142, v143
    v_cvt_pk_bf16_f32 v32, v144, v145
    v_mfma_f32_16x16x32_bf16 a[60:63], a[228:231], v[92:95], a[60:63]
    v_accvgpr_read_b32 v212, a0
    v_accvgpr_read_b32 v213, a1
    v_mfma_f32_16x16x32_bf16 a[60:63], a[224:227], v[76:79], a[60:63]
    s_waitcnt lgkmcnt(0)
    v_accvgpr_read_b32 v214, a2
    v_accvgpr_read_b32 v215, a3
    v_fmamk_f32 v146, v146, 0x3e0293ee, v228
    v_mfma_f32_16x16x32_bf16 v[160:163], a[240:243], a[128:131], 0
    ds_read_b64_tr_b16 a[224:225], v244 offset:33280
    v_fmamk_f32 v147, v147, 0x3e0293ee, v228
    v_mfma_f32_16x16x32_bf16 v[160:163], a[244:247], a[132:135], v[160:163]
    ds_read_b64_tr_b16 a[226:227], v244 offset:37376
    v_accvgpr_read_b32 v216, a4
    v_mfma_f32_16x16x32_bf16 v[160:163], a[248:251], a[136:139], v[160:163]
    ds_read_b64_tr_b16 a[228:229], v244 offset:41472
    s_mov_b32 m0, s42
    v_mfma_f32_16x16x32_bf16 v[160:163], a[252:255], a[140:143], v[160:163]
    buffer_load_dwordx4 v246, s[12:15], s80 offen offset:0 nt lds
    v_accvgpr_read_b32 v217, a5
    v_exp_f32 v146, v146
    v_exp_f32 v147, v147
    v_pk_fma_f32 v[148:149], v[148:149], s[88:89], v[230:231] op_sel_hi:[1,1,0]
    v_pk_fma_f32 v[150:151], v[150:151], s[88:89], v[230:231] op_sel_hi:[1,1,0]
    v_pk_fma_f32 v[152:153], v[152:153], s[88:89], v[232:233] op_sel_hi:[1,1,0]
    v_mfma_f32_16x16x32_bf16 v[164:167], a[252:255], a[156:159], 0
    ds_read_b64_tr_b16 a[230:231], v244 offset:45568
    v_cvt_pk_bf16_f32 v33, v146, v147
    v_mfma_f32_16x16x32_bf16 v[164:167], a[248:251], a[152:155], v[164:167]
    ds_read_b64_tr_b16 a[232:233], v244 offset:49664
    v_accvgpr_read_b32 v218, a6
    v_mfma_f32_16x16x32_bf16 v[164:167], a[244:247], a[148:151], v[164:167]
    ds_read_b64_tr_b16 a[234:235], v244 offset:53760
    v_accvgpr_read_b32 v219, a7
    v_mfma_f32_16x16x32_bf16 v[164:167], a[240:243], a[144:147], v[164:167]
    v_exp_f32 v148, v148
    v_exp_f32 v149, v149
    v_mfma_f32_16x16x32_bf16 v[168:171], a[240:243], a[192:195], 0
    ds_read_b64_tr_b16 a[236:237], v244 offset:57856
    v_cvt_pk_bf16_f32 v36, v148, v149
    v_mfma_f32_16x16x32_bf16 v[168:171], a[244:247], a[196:199], v[168:171]
    ds_read_b64_tr_b16 a[238:239], v244 offset:61952
    v_accvgpr_read_b32 v220, a8
    v_mfma_f32_16x16x32_bf16 v[168:171], a[248:251], a[200:203], v[168:171]
    s_mov_b32 m0, s42
    v_exp_f32 v150, v150
    v_mfma_f32_16x16x32_bf16 v[168:171], a[252:255], a[204:207], v[168:171]
    buffer_load_dwordx4 v247, s[12:15], s80 offen offset:1024 nt lds
    v_accvgpr_read_b32 v221, a9
    v_exp_f32 v151, v151
    v_exp_f32 v152, v152
    v_pk_mul_f32 v[212:213], v[212:213], v[236:237] op_sel_hi:[1,0]
    v_pk_fma_f32 v[154:155], v[154:155], s[88:89], v[232:233] op_sel_hi:[1,1,0]
    v_pk_mul_f32 v[214:215], v[214:215], v[236:237] op_sel_hi:[1,0]
    v_pk_fma_f32 v[156:157], v[156:157], s[88:89], v[234:235] op_sel_hi:[1,1,0]
    v_pk_mul_f32 v[216:217], v[216:217], v[236:237] op_sel_hi:[1,0]
    v_mfma_f32_16x16x32_bf16 v[172:175], a[252:255], a[220:223], 0
    v_exp_f32 v153, v153
    v_mfma_f32_16x16x32_bf16 v[172:175], a[248:251], a[216:219], v[172:175]
    v_exp_f32 v154, v154
    v_mfma_f32_16x16x32_bf16 v[172:175], a[244:247], a[212:215], v[172:175]
    v_exp_f32 v155, v155
    v_mfma_f32_16x16x32_bf16 v[172:175], a[240:243], a[208:211], v[172:175]
    s_waitcnt lgkmcnt(0)
    v_exp_f32 v156, v156
    v_cvt_pk_bf16_f32 v37, v150, v151
    v_mfma_f32_16x16x32_bf16 a[64:67], a[224:227], v[64:67], a[64:67]
    ds_read_b128 a[240:243], v237 offset:24576
    v_cvt_pk_bf16_f32 v40, v152, v153
    v_mfma_f32_16x16x32_bf16 a[64:67], a[228:231], v[80:83], a[64:67]
    ds_read_b128 a[244:247], v237 offset:24832
    v_cvt_pk_bf16_f32 v180, v212, v213
    v_mfma_f32_16x16x32_bf16 a[64:67], a[232:235], v[96:99], a[64:67]
    s_mov_b32 m0, s42
    v_exp_f32 v157, v157
    v_mfma_f32_16x16x32_bf16 a[64:67], a[236:239], v[112:115], a[64:67]
    buffer_load_dwordx4 v246, s[12:15], s80 offen offset:2048 nt lds
    v_cvt_pk_bf16_f32 v41, v154, v155
    v_cvt_pk_bf16_f32 v181, v214, v215
    v_accvgpr_read_b32 v222, a10
    v_cvt_pk_bf16_f32 v44, v156, v157
    v_pk_fma_f32 v[158:159], v[158:159], s[88:89], v[234:235] op_sel_hi:[1,1,0]
    v_pk_mul_f32 v[218:219], v[218:219], v[236:237] op_sel_hi:[1,0]
    v_pk_fma_f32 v[160:161], v[160:161], s[88:89], v[228:229] op_sel_hi:[1,1,0]
    v_pk_mul_f32 v[220:221], v[220:221], v[236:237] op_sel_hi:[1,0]
    v_pk_fma_f32 v[162:163], v[162:163], s[88:89], v[228:229] op_sel_hi:[1,1,0]
    v_mfma_f32_16x16x32_bf16 a[80:83], a[236:239], v[116:119], a[80:83]
    ds_read_b128 a[248:251], v237 offset:25088
    v_accvgpr_read_b32 v223, a11
    v_mfma_f32_16x16x32_bf16 a[80:83], a[232:235], v[100:103], a[80:83]
    ds_read_b128 a[252:255], v237 offset:25344
    v_cvt_pk_bf16_f32 v182, v216, v217
    v_mfma_f32_16x16x32_bf16 a[80:83], a[228:231], v[84:87], a[80:83]
    v_exp_f32 v158, v158
    v_mfma_f32_16x16x32_bf16 a[80:83], a[224:227], v[68:71], a[80:83]
    v_exp_f32 v159, v159
    v_mfma_f32_16x16x32_bf16 a[96:99], a[224:227], v[72:75], a[96:99]
    v_exp_f32 v160, v160
    v_mfma_f32_16x16x32_bf16 a[96:99], a[228:231], v[88:91], a[96:99]
    v_exp_f32 v161, v161
    v_mfma_f32_16x16x32_bf16 a[96:99], a[232:235], v[104:107], a[96:99]
    v_exp_f32 v162, v162
    v_mfma_f32_16x16x32_bf16 a[96:99], a[236:239], v[120:123], a[96:99]
    v_exp_f32 v163, v163
    v_accvgpr_read_b32 v224, a12
    v_cvt_pk_bf16_f32 v45, v158, v159
    v_accvgpr_read_b32 v225, a13
    v_pk_mul_f32 v[222:223], v[222:223], v[236:237] op_sel_hi:[1,0]
    v_pk_fma_f32 v[164:165], v[164:165], s[88:89], v[230:231] op_sel_hi:[1,1,0]
    v_pk_mul_f32 v[224:225], v[224:225], v[236:237] op_sel_hi:[1,0]
    v_pk_fma_f32 v[166:167], v[166:167], s[88:89], v[230:231] op_sel_hi:[1,1,0]
    v_cvt_pk_bf16_f32 v183, v218, v219
    v_mfma_f32_16x16x32_bf16 a[112:115], a[236:239], v[124:127], a[112:115]
    v_exp_f32 v164, v164
    v_mfma_f32_16x16x32_bf16 a[112:115], a[232:235], v[108:111], a[112:115]
    v_exp_f32 v165, v165
    v_mfma_f32_16x16x32_bf16 a[112:115], a[228:231], v[92:95], a[112:115]
    s_mov_b32 m0, s42
    v_exp_f32 v166, v166
    v_mfma_f32_16x16x32_bf16 a[112:115], a[224:227], v[76:79], a[112:115]
    s_waitcnt lgkmcnt(0)
    buffer_load_dwordx4 v247, s[12:15], s80 offen offset:3072 nt lds
    v_accvgpr_read_b32 v226, a14
    v_accvgpr_read_b32 v227, a15
    v_cvt_pk_bf16_f32 v34, v160, v161
    v_pk_mul_f32 v[226:227], v[226:227], v[236:237] op_sel_hi:[1,0]
    v_pk_fma_f32 v[168:169], v[168:169], s[88:89], v[232:233] op_sel_hi:[1,1,0]
    v_cvt_pk_bf16_f32 v196, v220, v221
    v_accvgpr_read_b32 v212, a16
    v_mfma_f32_16x16x32_bf16 v[128:131], a[240:243], a[128:131], 0
    ds_read_b64_tr_b16 a[224:225], v245 offset:33280
    v_accvgpr_read_b32 v213, a17
    v_mfma_f32_16x16x32_bf16 v[128:131], a[244:247], a[132:135], v[128:131]
    ds_read_b64_tr_b16 a[226:227], v245 offset:37376
    v_cvt_pk_bf16_f32 v35, v162, v163
    v_mfma_f32_16x16x32_bf16 v[128:131], a[248:251], a[136:139], v[128:131]
    ds_read_b64_tr_b16 a[228:229], v245 offset:41472
    v_cvt_pk_bf16_f32 v197, v222, v223
    v_mfma_f32_16x16x32_bf16 v[128:131], a[252:255], a[140:143], v[128:131]
    s_mov_b64 vcc, s[74:75]
    v_exp_f32 v167, v167
    v_accvgpr_read_b32 v214, a18
    v_accvgpr_read_b32 v215, a19
    v_cvt_pk_bf16_f32 v38, v164, v165
    v_pk_mul_f32 v[212:213], v[212:213], v[238:239] op_sel_hi:[1,0]
    v_pk_mul_f32 v[214:215], v[214:215], v[238:239] op_sel_hi:[1,0]
    v_pk_fma_f32 v[170:171], v[170:171], s[88:89], v[232:233] op_sel_hi:[1,1,0]
    v_mfma_f32_16x16x32_bf16 v[132:135], a[252:255], a[156:159], 0
    ds_read_b64_tr_b16 a[230:231], v245 offset:45568
    v_cvt_pk_bf16_f32 v198, v224, v225
    v_mfma_f32_16x16x32_bf16 v[132:135], a[248:251], a[152:155], v[132:135]
    ds_read_b64_tr_b16 a[232:233], v245 offset:49664
    v_accvgpr_read_b32 v216, a20
    v_mfma_f32_16x16x32_bf16 v[132:135], a[244:247], a[148:151], v[132:135]
    ds_read_b64_tr_b16 a[234:235], v245 offset:53760
    s_mov_b32 m0, s43
    v_mfma_f32_16x16x32_bf16 v[132:135], a[240:243], a[144:147], v[132:135]
    buffer_load_dwordx4 v246, s[12:15], s81 offen offset:0 nt lds
    v_accvgpr_read_b32 v217, a21
    v_exp_f32 v168, v168
    v_cvt_pk_bf16_f32 v199, v226, v227
    v_pk_mul_f32 v[216:217], v[216:217], v[238:239] op_sel_hi:[1,0]
    v_pk_fma_f32 v[172:173], v[172:173], s[88:89], v[234:235] op_sel_hi:[1,1,0]
    v_mfma_f32_16x16x32_bf16 v[136:139], a[240:243], a[192:195], 0
    ds_read_b64_tr_b16 a[236:237], v245 offset:57856
    v_cvt_pk_bf16_f32 v39, v166, v167
    v_mfma_f32_16x16x32_bf16 v[136:139], a[244:247], a[196:199], v[136:139]
    ds_read_b64_tr_b16 a[238:239], v245 offset:61952
    v_accvgpr_read_b32 v218, a22
    v_mfma_f32_16x16x32_bf16 v[136:139], a[248:251], a[200:203], v[136:139]
    v_exp_f32 v169, v169
    v_mfma_f32_16x16x32_bf16 v[136:139], a[252:255], a[204:207], v[136:139]
    v_exp_f32 v170, v170
    v_cndmask_b32_dpp v176, v196, v180, vcc quad_perm:[1,0,3,2] row_mask:0xf bank_mask:0xf
    v_accvgpr_read_b32 v219, a23
    v_cndmask_b32_dpp v177, v197, v181, vcc quad_perm:[1,0,3,2] row_mask:0xf bank_mask:0xf
    v_pk_mul_f32 v[218:219], v[218:219], v[238:239] op_sel_hi:[1,0]
    v_pk_fma_f32 v[174:175], v[174:175], s[88:89], v[234:235] op_sel_hi:[1,1,0]
    v_pk_fma_f32 v[128:129], v[128:129], s[88:89], v[228:229] op_sel_hi:[1,1,0]
    v_cvt_pk_bf16_f32 v184, v212, v213
    v_cndmask_b32_dpp v178, v198, v182, vcc quad_perm:[1,0,3,2] row_mask:0xf bank_mask:0xf
    v_accvgpr_read_b32 v220, a24
    v_cvt_pk_bf16_f32 v42, v168, v169
    v_cndmask_b32_dpp v179, v199, v183, vcc quad_perm:[1,0,3,2] row_mask:0xf bank_mask:0xf
    v_exp_f32 v171, v171
    v_mfma_f32_16x16x32_bf16 v[140:143], a[252:255], a[220:223], 0
    s_mov_b64 vcc, s[76:77]
    v_exp_f32 v172, v172
    v_mfma_f32_16x16x32_bf16 v[140:143], a[248:251], a[216:219], v[140:143]
    v_exp_f32 v173, v173
    v_mfma_f32_16x16x32_bf16 v[140:143], a[244:247], a[212:215], v[140:143]
    s_mov_b32 m0, s43
    v_exp_f32 v174, v174
    v_mfma_f32_16x16x32_bf16 v[140:143], a[240:243], a[208:211], v[140:143]
    s_waitcnt lgkmcnt(0)
    buffer_load_dwordx4 v247, s[12:15], s81 offen offset:1024 nt lds
    v_cndmask_b32_dpp v196, v180, v196, vcc quad_perm:[1,0,3,2] row_mask:0xf bank_mask:0xf
    v_accvgpr_read_b32 v221, a25
    v_cndmask_b32_dpp v197, v181, v197, vcc quad_perm:[1,0,3,2] row_mask:0xf bank_mask:0xf
    v_pk_mul_f32 v[220:221], v[220:221], v[238:239] op_sel_hi:[1,0]
    v_pk_fma_f32 v[130:131], v[130:131], s[88:89], v[228:229] op_sel_hi:[1,1,0]
    v_cvt_pk_bf16_f32 v185, v214, v215
    v_cndmask_b32_dpp v198, v182, v198, vcc quad_perm:[1,0,3,2] row_mask:0xf bank_mask:0xf
    v_accvgpr_read_b32 v222, a26
    v_cndmask_b32_dpp v199, v183, v199, vcc quad_perm:[1,0,3,2] row_mask:0xf bank_mask:0xf
    v_cvt_pk_bf16_f32 v43, v170, v171
    v_permlane16_swap_b32 v176, v178
    v_mfma_f32_16x16x32_bf16 a[72:75], a[224:227], v[64:67], a[72:75]
    ds_read_b128 a[240:243], v237 offset:28672
    v_accvgpr_read_b32 v223, a27
    v_mfma_f32_16x16x32_bf16 a[72:75], a[228:231], v[80:83], a[72:75]
    ds_read_b128 a[244:247], v237 offset:28928
    v_cvt_pk_bf16_f32 v186, v216, v217
    v_mfma_f32_16x16x32_bf16 a[72:75], a[232:235], v[96:99], a[72:75]
    v_permlane16_swap_b32 v177, v179
    v_mfma_f32_16x16x32_bf16 a[72:75], a[236:239], v[112:115], a[72:75]
    buffer_store_dwordx4 v[176:179], v243, s[24:27], s52 offen offset:0 sc1
    v_exp_f32 v175, v175
    v_permlane16_swap_b32 v196, v198
    v_pk_mul_f32 v[222:223], v[222:223], v[238:239] op_sel_hi:[1,0]
    v_pk_fma_f32 v[132:133], v[132:133], s[88:89], v[230:231] op_sel_hi:[1,1,0]
    v_accvgpr_read_b32 v224, a28
    v_cvt_pk_bf16_f32 v46, v172, v173
    v_accvgpr_read_b32 v225, a29
    v_pk_mul_f32 v[224:225], v[224:225], v[238:239] op_sel_hi:[1,0]
    v_cvt_pk_bf16_f32 v187, v218, v219
    v_mfma_f32_16x16x32_bf16 a[88:91], a[236:239], v[116:119], a[88:91]
    ds_read_b128 a[248:251], v237 offset:29184
    v_accvgpr_read_b32 v226, a30
    v_mfma_f32_16x16x32_bf16 a[88:91], a[232:235], v[100:103], a[88:91]
    ds_read_b128 a[252:255], v237 offset:29440
    v_cvt_pk_bf16_f32 v47, v174, v175
    v_mfma_f32_16x16x32_bf16 a[88:91], a[228:231], v[84:87], a[88:91]
    s_mov_b32 m0, s43
    v_exp_f32 v128, v128
    v_mfma_f32_16x16x32_bf16 a[88:91], a[224:227], v[68:71], a[88:91]
    buffer_load_dwordx4 v246, s[12:15], s81 offen offset:2048 nt lds
    v_accvgpr_read_b32 v227, a31
    v_permlane16_swap_b32 v197, v199
    v_exp_f32 v129, v129
    v_pk_mul_f32 v[226:227], v[226:227], v[238:239] op_sel_hi:[1,0]
    v_pk_fma_f32 v[134:135], v[134:135], s[88:89], v[230:231] op_sel_hi:[1,1,0]
    v_cvt_pk_bf16_f32 v200, v220, v221
    v_accvgpr_read_b32 v212, a32
    v_exp_f32 v130, v130
    v_mfma_f32_16x16x32_bf16 a[104:107], a[224:227], v[72:75], a[104:107]
    s_mov_b64 vcc, s[74:75]
    v_exp_f32 v131, v131
    v_mfma_f32_16x16x32_bf16 a[104:107], a[228:231], v[88:91], a[104:107]
    v_exp_f32 v132, v132
    v_mfma_f32_16x16x32_bf16 a[104:107], a[232:235], v[104:107], a[104:107]
    v_exp_f32 v133, v133
    v_mfma_f32_16x16x32_bf16 a[104:107], a[236:239], v[120:123], a[104:107]
    buffer_store_dwordx4 v[196:199], v243, s[24:27], s52 offen offset:256 sc1
    v_exp_f32 v134, v134
    v_exp_f32 v135, v135
    v_pk_fma_f32 v[136:137], v[136:137], s[88:89], v[232:233] op_sel_hi:[1,1,0]
    v_cvt_pk_bf16_f32 v48, v128, v129
    v_accvgpr_read_b32 v213, a33
    v_pk_mul_f32 v[212:213], v[212:213], v[240:241] op_sel_hi:[1,0]
    v_cvt_pk_bf16_f32 v201, v222, v223
    v_accvgpr_read_b32 v214, a34
    v_mfma_f32_16x16x32_bf16 a[120:123], a[236:239], v[124:127], a[120:123]
    v_exp_f32 v136, v136
    v_mfma_f32_16x16x32_bf16 a[120:123], a[232:235], v[108:111], a[120:123]
    v_exp_f32 v137, v137
    v_mfma_f32_16x16x32_bf16 a[120:123], a[228:231], v[92:95], a[120:123]
    v_accvgpr_read_b32 v215, a35
    v_cvt_pk_bf16_f32 v49, v130, v131
    v_mfma_f32_16x16x32_bf16 a[120:123], a[224:227], v[76:79], a[120:123]
    s_waitcnt lgkmcnt(0)
    v_cvt_pk_bf16_f32 v202, v224, v225
    v_accvgpr_read_b32 v216, a36
    v_accvgpr_read_b32 v217, a37
    v_cvt_pk_bf16_f32 v52, v132, v133
    v_cvt_pk_bf16_f32 v203, v226, v227
    v_pk_mul_f32 v[214:215], v[214:215], v[240:241] op_sel_hi:[1,0]
    v_pk_mul_f32 v[216:217], v[216:217], v[240:241] op_sel_hi:[1,0]
    v_pk_fma_f32 v[138:139], v[138:139], s[88:89], v[232:233] op_sel_hi:[1,1,0]
    v_pk_fma_f32 v[140:141], v[140:141], s[88:89], v[234:235] op_sel_hi:[1,1,0]
    v_mfma_f32_16x16x32_bf16 v[144:147], a[240:243], a[128:131], 0
    ds_read_b64_tr_b16 a[224:225], v244 offset:33536
    v_accvgpr_read_b32 v218, a38
    v_mfma_f32_16x16x32_bf16 v[144:147], a[244:247], a[132:135], v[144:147]
    ds_read_b64_tr_b16 a[226:227], v244 offset:37632
    v_cndmask_b32_dpp v180, v200, v184, vcc quad_perm:[1,0,3,2] row_mask:0xf bank_mask:0xf
    v_mfma_f32_16x16x32_bf16 v[144:147], a[248:251], a[136:139], v[144:147]
    ds_read_b64_tr_b16 a[228:229], v244 offset:41728
    s_mov_b32 m0, s43
    v_mfma_f32_16x16x32_bf16 v[144:147], a[252:255], a[140:143], v[144:147]
    buffer_load_dwordx4 v247, s[12:15], s81 offen offset:3072 nt lds
    v_accvgpr_read_b32 v219, a39
    v_cndmask_b32_dpp v181, v201, v185, vcc quad_perm:[1,0,3,2] row_mask:0xf bank_mask:0xf
    v_cvt_pk_bf16_f32 v188, v212, v213
    v_cvt_pk_bf16_f32 v53, v134, v135
    v_pk_mul_f32 v[218:219], v[218:219], v[240:241] op_sel_hi:[1,0]
    v_pk_fma_f32 v[142:143], v[142:143], s[88:89], v[234:235] op_sel_hi:[1,1,0]
    v_cndmask_b32_dpp v182, v202, v186, vcc quad_perm:[1,0,3,2] row_mask:0xf bank_mask:0xf
    v_accvgpr_read_b32 v220, a40
    v_mfma_f32_16x16x32_bf16 v[148:151], a[252:255], a[156:159], 0
    ds_read_b64_tr_b16 a[230:231], v244 offset:45824
    v_cndmask_b32_dpp v183, v203, v187, vcc quad_perm:[1,0,3,2] row_mask:0xf bank_mask:0xf
    v_mfma_f32_16x16x32_bf16 v[148:151], a[248:251], a[152:155], v[148:151]
    ds_read_b64_tr_b16 a[232:233], v244 offset:49920
    s_mov_b64 vcc, s[76:77]
    v_mfma_f32_16x16x32_bf16 v[148:151], a[244:247], a[148:151], v[148:151]
    ds_read_b64_tr_b16 a[234:235], v244 offset:54016
    v_cndmask_b32_dpp v200, v184, v200, vcc quad_perm:[1,0,3,2] row_mask:0xf bank_mask:0xf
    v_mfma_f32_16x16x32_bf16 v[148:151], a[240:243], a[144:147], v[148:151]
    v_exp_f32 v138, v138
    v_accvgpr_read_b32 v221, a41
    v_cndmask_b32_dpp v201, v185, v201, vcc quad_perm:[1,0,3,2] row_mask:0xf bank_mask:0xf
    v_cvt_pk_bf16_f32 v189, v214, v215
    v_pk_mul_f32 v[220:221], v[220:221], v[240:241] op_sel_hi:[1,0]
    v_pk_fma_f32 v[144:145], v[144:145], s[88:89], v[228:229] op_sel_hi:[1,1,0]
    v_cndmask_b32_dpp v202, v186, v202, vcc quad_perm:[1,0,3,2] row_mask:0xf bank_mask:0xf
    v_cvt_pk_bf16_f32 v56, v136, v137
    v_accvgpr_read_b32 v222, a42
    v_cndmask_b32_dpp v203, v187, v203, vcc quad_perm:[1,0,3,2] row_mask:0xf bank_mask:0xf
    v_exp_f32 v139, v139
    v_permlane16_swap_b32 v180, v182
    v_mfma_f32_16x16x32_bf16 v[152:155], a[240:243], a[192:195], 0
    ds_read_b64_tr_b16 a[236:237], v244 offset:58112
    v_accvgpr_read_b32 v223, a43
    v_mfma_f32_16x16x32_bf16 v[152:155], a[244:247], a[196:199], v[152:155]
    ds_read_b64_tr_b16 a[238:239], v244 offset:62208
    v_cvt_pk_bf16_f32 v190, v216, v217
    v_mfma_f32_16x16x32_bf16 v[152:155], a[248:251], a[200:203], v[152:155]
    s_cmp_eq_u32 s34, 5
    v_permlane16_swap_b32 v181, v183
    v_mfma_f32_16x16x32_bf16 v[152:155], a[252:255], a[204:207], v[152:155]
    s_cselect_b32 s41, 0, 16777216
    buffer_store_dwordx4 v[180:183], v243, s[24:27], s53 offen offset:0 sc1
    v_exp_f32 v140, v140
    v_exp_f32 v141, v141
    v_pk_mul_f32 v[222:223], v[222:223], v[240:241] op_sel_hi:[1,0]
    v_pk_fma_f32 v[146:147], v[146:147], s[88:89], v[228:229] op_sel_hi:[1,1,0]
    v_accvgpr_read_b32 v224, a44
    v_cvt_pk_bf16_f32 v57, v138, v139
    v_accvgpr_read_b32 v225, a45
    v_pk_mul_f32 v[224:225], v[224:225], v[240:241] op_sel_hi:[1,0]
    v_permlane16_swap_b32 v200, v202
    v_mfma_f32_16x16x32_bf16 v[156:159], a[252:255], a[220:223], 0
    s_add_u32 s59, s59, s41
    v_exp_f32 v142, v142
    v_mfma_f32_16x16x32_bf16 v[156:159], a[248:251], a[216:219], v[156:159]
    s_cmp_eq_u32 s34, 5
    v_permlane16_swap_b32 v201, v203
    v_mfma_f32_16x16x32_bf16 v[156:159], a[244:247], a[212:215], v[156:159]
    s_cselect_b32 s41, s66, s59
    v_exp_f32 v143, v143
    v_mfma_f32_16x16x32_bf16 v[156:159], a[240:243], a[208:211], v[156:159]
    s_waitcnt lgkmcnt(0)
    buffer_store_dwordx4 v[200:203], v243, s[24:27], s53 offen offset:256 sc1
    v_exp_f32 v144, v144
    v_exp_f32 v145, v145
    v_pk_fma_f32 v[148:149], v[148:149], s[88:89], v[230:231] op_sel_hi:[1,1,0]
    v_cvt_pk_bf16_f32 v191, v218, v219
    v_accvgpr_read_b32 v226, a46
    v_cvt_pk_bf16_f32 v60, v140, v141
    v_accvgpr_read_b32 v227, a47
    v_pk_mul_f32 v[226:227], v[226:227], v[240:241] op_sel_hi:[1,0]
    v_cvt_pk_bf16_f32 v204, v220, v221
    v_mfma_f32_16x16x32_bf16 a[68:71], a[224:227], v[64:67], a[68:71]
    ds_read_b64_tr_b16 a[240:241], v245 offset:33536
    v_accvgpr_read_b32 v212, a48
    v_mfma_f32_16x16x32_bf16 a[68:71], a[228:231], v[80:83], a[68:71]
    ds_read_b64_tr_b16 a[242:243], v245 offset:37632
    v_cvt_pk_bf16_f32 v61, v142, v143
    v_mfma_f32_16x16x32_bf16 a[68:71], a[232:235], v[96:99], a[68:71]
    ds_read_b64_tr_b16 a[244:245], v245 offset:41728
    v_accvgpr_read_b32 v213, a49
    v_mfma_f32_16x16x32_bf16 a[68:71], a[236:239], v[112:115], a[68:71]
    s_mov_b64 vcc, s[74:75]
    v_exp_f32 v146, v146
    v_cvt_pk_bf16_f32 v205, v222, v223
    v_accvgpr_read_b32 v214, a50
    v_mfma_f32_16x16x32_bf16 a[84:87], a[236:239], v[116:119], a[84:87]
    ds_read_b64_tr_b16 a[246:247], v245 offset:45824
    v_cvt_pk_bf16_f32 v50, v144, v145
    v_mfma_f32_16x16x32_bf16 a[84:87], a[232:235], v[100:103], a[84:87]
    ds_read_b64_tr_b16 a[248:249], v245 offset:49920
    v_accvgpr_read_b32 v215, a51
    v_mfma_f32_16x16x32_bf16 a[84:87], a[228:231], v[84:87], a[84:87]
    ds_read_b64_tr_b16 a[250:251], v245 offset:54016
    v_cvt_pk_bf16_f32 v206, v224, v225
    v_mfma_f32_16x16x32_bf16 a[84:87], a[224:227], v[68:71], a[84:87]
    v_exp_f32 v147, v147
    v_accvgpr_read_b32 v216, a52
    v_exp_f32 v148, v148
    v_pk_mul_f32 v[212:213], v[212:213], v[242:243] op_sel_hi:[1,0]
    v_pk_fma_f32 v[150:151], v[150:151], s[88:89], v[230:231] op_sel_hi:[1,1,0]
    v_pk_mul_f32 v[214:215], v[214:215], v[242:243] op_sel_hi:[1,0]
    v_pk_fma_f32 v[152:153], v[152:153], s[88:89], v[232:233] op_sel_hi:[1,1,0]
    v_pk_fma_f32 v[154:155], v[154:155], s[88:89], v[232:233] op_sel_hi:[1,1,0]
    v_accvgpr_read_b32 v217, a53
    v_pk_mul_f32 v[216:217], v[216:217], v[242:243] op_sel_hi:[1,0]
    v_cvt_pk_bf16_f32 v51, v146, v147
    v_mfma_f32_16x16x32_bf16 a[100:103], a[224:227], v[72:75], a[100:103]
    ds_read_b64_tr_b16 a[252:253], v245 offset:58112
    v_cvt_pk_bf16_f32 v207, v226, v227
    v_mfma_f32_16x16x32_bf16 a[100:103], a[228:231], v[88:91], a[100:103]
    ds_read_b64_tr_b16 a[254:255], v245 offset:62208
    v_accvgpr_read_b32 v218, a54
    v_mfma_f32_16x16x32_bf16 a[100:103], a[232:235], v[104:107], a[100:103]
    s_add_u32 s16, s62, s41
    v_exp_f32 v149, v149
    v_mfma_f32_16x16x32_bf16 a[100:103], a[236:239], v[120:123], a[100:103]
    s_addc_u32 s17, s63, 0
    v_exp_f32 v150, v150
    v_cndmask_b32_dpp v184, v204, v188, vcc quad_perm:[1,0,3,2] row_mask:0xf bank_mask:0xf
    v_accvgpr_read_b32 v219, a55
    v_cndmask_b32_dpp v185, v205, v189, vcc quad_perm:[1,0,3,2] row_mask:0xf bank_mask:0xf
    v_pk_mul_f32 v[218:219], v[218:219], v[242:243] op_sel_hi:[1,0]
    v_pk_fma_f32 v[156:157], v[156:157], s[88:89], v[234:235] op_sel_hi:[1,1,0]
    v_cvt_pk_bf16_f32 v54, v148, v149
    v_cvt_pk_bf16_f32 v192, v212, v213
    v_exp_f32 v151, v151
    v_cndmask_b32_dpp v186, v206, v190, vcc quad_perm:[1,0,3,2] row_mask:0xf bank_mask:0xf
    v_mfma_f32_16x16x32_bf16 a[116:119], a[236:239], v[124:127], a[116:119]
    v_exp_f32 v152, v152
    v_mfma_f32_16x16x32_bf16 a[116:119], a[232:235], v[108:111], a[116:119]
    v_exp_f32 v153, v153
    v_mfma_f32_16x16x32_bf16 a[116:119], a[228:231], v[92:95], a[116:119]
    v_exp_f32 v154, v154
    v_mfma_f32_16x16x32_bf16 a[116:119], a[224:227], v[76:79], a[116:119]
    s_waitcnt lgkmcnt(0)
    v_exp_f32 v155, v155
    v_accvgpr_read_b32 v220, a56
    v_cndmask_b32_dpp v187, v207, v191, vcc quad_perm:[1,0,3,2] row_mask:0xf bank_mask:0xf
    s_mov_b64 vcc, s[76:77]
    v_pk_fma_f32 v[158:159], v[158:159], s[88:89], v[234:235] op_sel_hi:[1,1,0]
    v_cndmask_b32_dpp v204, v188, v204, vcc quad_perm:[1,0,3,2] row_mask:0xf bank_mask:0xf
    v_accvgpr_read_b32 v221, a57
    v_pk_mul_f32 v[220:221], v[220:221], v[242:243] op_sel_hi:[1,0]
    v_cndmask_b32_dpp v205, v189, v205, vcc quad_perm:[1,0,3,2] row_mask:0xf bank_mask:0xf
    v_cvt_pk_bf16_f32 v193, v214, v215
    v_cvt_pk_bf16_f32 v55, v150, v151
    v_cndmask_b32_dpp v206, v190, v206, vcc quad_perm:[1,0,3,2] row_mask:0xf bank_mask:0xf
    v_accvgpr_read_b32 v222, a58
    v_cndmask_b32_dpp v207, v191, v207, vcc quad_perm:[1,0,3,2] row_mask:0xf bank_mask:0xf
    v_mfma_f32_16x16x32_bf16 a[76:79], a[240:243], v[64:67], a[76:79]
    v_permlane16_swap_b32 v184, v186
    v_mfma_f32_16x16x32_bf16 a[76:79], a[244:247], v[80:83], a[76:79]
    v_permlane16_swap_b32 v185, v187
    v_mfma_f32_16x16x32_bf16 a[76:79], a[248:251], v[96:99], a[76:79]
    v_exp_f32 v156, v156
    v_mfma_f32_16x16x32_bf16 a[76:79], a[252:255], v[112:115], a[76:79]
    buffer_store_dwordx4 v[184:187], v243, s[24:27], s54 offen offset:0 sc1
    v_permlane16_swap_b32 v204, v206
    v_permlane16_swap_b32 v205, v207
    v_accvgpr_read_b32 v223, a59
    v_pk_mul_f32 v[222:223], v[222:223], v[242:243] op_sel_hi:[1,0]
    v_cvt_pk_bf16_f32 v194, v216, v217
    v_cvt_pk_bf16_f32 v58, v152, v153
    v_accvgpr_read_b32 v224, a60
    v_accvgpr_read_b32 v225, a61
    v_pk_mul_f32 v[224:225], v[224:225], v[242:243] op_sel_hi:[1,0]
    v_mfma_f32_16x16x32_bf16 a[92:95], a[252:255], v[116:119], a[92:95]
    v_exp_f32 v157, v157
    v_mfma_f32_16x16x32_bf16 a[92:95], a[248:251], v[100:103], a[92:95]
    v_exp_f32 v158, v158
    v_mfma_f32_16x16x32_bf16 a[92:95], a[244:247], v[84:87], a[92:95]
    v_exp_f32 v159, v159
    v_mfma_f32_16x16x32_bf16 a[92:95], a[240:243], v[68:71], a[92:95]
    buffer_store_dwordx4 v[204:207], v243, s[24:27], s54 offen offset:256 sc1
    v_cvt_pk_bf16_f32 v195, v218, v219
    v_accvgpr_read_b32 v226, a62
    v_cvt_pk_bf16_f32 v59, v154, v155
    v_accvgpr_read_b32 v227, a63
    v_pk_mul_f32 v[226:227], v[226:227], v[242:243] op_sel_hi:[1,0]
    v_cvt_pk_bf16_f32 v208, v220, v221
    v_mfma_f32_16x16x32_bf16 a[108:111], a[240:243], v[72:75], a[108:111]
    s_mov_b64 vcc, s[74:75]
    v_cvt_pk_bf16_f32 v62, v156, v157
    v_cvt_pk_bf16_f32 v209, v222, v223
    v_mfma_f32_16x16x32_bf16 a[108:111], a[244:247], v[88:91], a[108:111]
    v_cvt_pk_bf16_f32 v63, v158, v159
    v_cvt_pk_bf16_f32 v210, v224, v225
    v_mfma_f32_16x16x32_bf16 a[108:111], a[248:251], v[104:107], a[108:111]
    v_cvt_pk_bf16_f32 v211, v226, v227
    v_mfma_f32_16x16x32_bf16 a[108:111], a[252:255], v[120:123], a[108:111]
    v_mfma_f32_16x16x32_bf16 a[124:127], a[252:255], v[124:127], a[124:127]
    v_cndmask_b32_dpp v188, v208, v192, vcc quad_perm:[1,0,3,2] row_mask:0xf bank_mask:0xf
    v_cndmask_b32_dpp v189, v209, v193, vcc quad_perm:[1,0,3,2] row_mask:0xf bank_mask:0xf
    v_mfma_f32_16x16x32_bf16 a[124:127], a[248:251], v[108:111], a[124:127]
    v_cndmask_b32_dpp v190, v210, v194, vcc quad_perm:[1,0,3,2] row_mask:0xf bank_mask:0xf
    v_cndmask_b32_dpp v191, v211, v195, vcc quad_perm:[1,0,3,2] row_mask:0xf bank_mask:0xf
    v_mfma_f32_16x16x32_bf16 a[124:127], a[244:247], v[92:95], a[124:127]
    s_mov_b64 vcc, s[76:77]
    v_cndmask_b32_dpp v208, v192, v208, vcc quad_perm:[1,0,3,2] row_mask:0xf bank_mask:0xf
    v_cndmask_b32_dpp v209, v193, v209, vcc quad_perm:[1,0,3,2] row_mask:0xf bank_mask:0xf
    v_mfma_f32_16x16x32_bf16 a[124:127], a[240:243], v[76:79], a[124:127]
    v_cndmask_b32_dpp v210, v194, v210, vcc quad_perm:[1,0,3,2] row_mask:0xf bank_mask:0xf
    v_cndmask_b32_dpp v211, v195, v211, vcc quad_perm:[1,0,3,2] row_mask:0xf bank_mask:0xf
    s_waitcnt vmcnt(14)
    s_barrier
    v_mfma_f32_16x16x32_bf16 v[160:163], v[248:251], v[0:3], 0
    ds_read_b128 a[224:227], v237 offset:32768
    v_mfma_f32_16x16x32_bf16 v[160:163], v[248:251], v[16:19], v[160:163]
    ds_read_b128 a[228:231], v237 offset:33024
    v_mfma_f32_16x16x32_bf16 v[160:163], v[248:251], v[32:35], v[160:163]
    v_permlane16_swap_b32 v188, v190
    v_mfma_f32_16x16x32_bf16 v[160:163], v[248:251], v[48:51], v[160:163]
    v_permlane16_swap_b32 v189, v191
    v_mfma_f32_16x16x32_bf16 v[164:167], v[248:251], v[4:7], 0
    ds_read_b128 a[232:235], v237 offset:33280
    v_mfma_f32_16x16x32_bf16 v[164:167], v[248:251], v[20:23], v[164:167]
    ds_read_b128 a[236:239], v237 offset:33536
    v_mfma_f32_16x16x32_bf16 v[164:167], v[248:251], v[36:39], v[164:167]
    v_permlane16_swap_b32 v208, v210
    v_mfma_f32_16x16x32_bf16 v[164:167], v[248:251], v[52:55], v[164:167]
    buffer_store_dwordx4 v[188:191], v243, s[24:27], s55 offen offset:0 sc1
    v_permlane16_swap_b32 v209, v211
    v_mfma_f32_16x16x32_bf16 v[168:171], v[248:251], v[8:11], 0
    v_mfma_f32_16x16x32_bf16 v[168:171], v[248:251], v[24:27], v[168:171]
    v_mfma_f32_16x16x32_bf16 v[168:171], v[248:251], v[40:43], v[168:171]
    v_mfma_f32_16x16x32_bf16 v[168:171], v[248:251], v[56:59], v[168:171]
    buffer_store_dwordx4 v[208:211], v243, s[24:27], s55 offen offset:256 sc1
    v_mfma_f32_16x16x32_bf16 v[172:175], v[248:251], v[12:15], 0
    v_mfma_f32_16x16x32_bf16 v[172:175], v[248:251], v[28:31], v[172:175]
    v_mfma_f32_16x16x32_bf16 v[172:175], v[248:251], v[44:47], v[172:175]
    v_mfma_f32_16x16x32_bf16 v[172:175], v[248:251], v[60:63], v[172:175]
    s_waitcnt lgkmcnt(0)
    s_branch L_ph1f
L_sh67:
    buffer_load_dwordx4 v241, s[20:23], s86 offen  lds
    s_branch L_shr67
L_sh68:
    buffer_load_dwordx4 v255, s[20:23], s86 offen  lds
    s_branch L_shr68
L_sh69:
    buffer_load_dwordx4 v241, s[20:23], s86 offen  lds
    s_branch L_shr69
L_sh70:
    buffer_load_dwordx4 v255, s[20:23], s86 offen  lds
    s_branch L_shr70
L_sh71:
    buffer_load_dwordx4 v241, s[20:23], s86 offen  lds
    s_branch L_shr71
L_sh72:
    buffer_load_dwordx4 v255, s[20:23], s86 offen  lds
    s_branch L_shr72
L_sh73:
    buffer_load_dwordx4 v241, s[20:23], s86 offen  lds
    s_branch L_shr73
L_sh74:
    buffer_load_dwordx4 v255, s[20:23], s86 offen  lds
    s_branch L_shr74
L_sh80:
    buffer_load_dwordx4 v241, s[16:19], s86 offen  lds
    s_branch L_shr80
L_sh81:
    buffer_load_dwordx4 v255, s[16:19], s86 offen  lds
    s_branch L_shr81
L_sh82:
    buffer_load_dwordx4 v241, s[16:19], s86 offen  lds
    s_branch L_shr82
L_sh83:
    buffer_load_dwordx4 v255, s[16:19], s86 offen  lds
    s_branch L_shr83
L_sh84:
    buffer_load_dwordx4 v241, s[16:19], s86 offen  lds
    s_branch L_shr84
L_sh85:
    buffer_load_dwordx4 v255, s[16:19], s86 offen  lds
    s_branch L_shr85
L_sh86:
    buffer_load_dwordx4 v241, s[16:19], s86 offen  lds
    s_branch L_shr86
L_sh87:
    buffer_load_dwordx4 v255, s[16:19], s86 offen  lds
    s_branch L_shr87
L_sh90:
    buffer_load_dwordx4 v241, s[20:23], s86 offen  lds
    s_branch L_shr90
L_sh91:
    buffer_load_dwordx4 v255, s[20:23], s86 offen  lds
    s_branch L_shr91
L_sh92:
    buffer_load_dwordx4 v241, s[20:23], s86 offen  lds
    s_branch L_shr92
L_sh93:
    buffer_load_dwordx4 v255, s[20:23], s86 offen  lds
    s_branch L_shr93
L_sh94:
    buffer_load_dwordx4 v241, s[20:23], s86 offen  lds
    s_branch L_shr94
L_sh95:
    buffer_load_dwordx4 v255, s[20:23], s86 offen  lds
    s_branch L_shr95
L_sh96:
    buffer_load_dwordx4 v241, s[20:23], s86 offen  lds
    s_branch L_shr96
L_sh97:
    buffer_load_dwordx4 v255, s[20:23], s86 offen  lds
    s_branch L_shr97
L_sh98:
    buffer_load_dwordx4 v241, s[16:19], s86 offen  lds
    s_branch L_shr98
L_sh99:
    buffer_load_dwordx4 v255, s[16:19], s86 offen  lds
    s_branch L_shr99
L_sh100:
    buffer_load_dwordx4 v241, s[16:19], s86 offen  lds
    s_branch L_shr100
L_sh101:
    buffer_load_dwordx4 v255, s[16:19], s86 offen  lds
    s_branch L_shr101
L_sh102:
    buffer_load_dwordx4 v241, s[16:19], s86 offen  lds
    s_branch L_shr102
L_sh103:
    buffer_load_dwordx4 v255, s[16:19], s86 offen  lds
    s_branch L_shr103
L_sh104:
    buffer_load_dwordx4 v241, s[16:19], s86 offen  lds
    s_branch L_shr104
L_sh105:
    buffer_load_dwordx4 v255, s[16:19], s86 offen  lds
    s_branch L_shr105
L_ph5f:
L_last:
    ds_read_b64_tr_b16 a[224:225], v244 offset:32768
    ds_read_b64_tr_b16 a[226:227], v244 offset:36864
    ds_read_b64_tr_b16 a[228:229], v244 offset:40960
    ds_read_b64_tr_b16 a[230:231], v244 offset:45056
    ds_read_b64_tr_b16 a[232:233], v244 offset:49152
    ds_read_b64_tr_b16 a[234:235], v244 offset:53248
    ds_read_b64_tr_b16 a[236:237], v244 offset:57344
    ds_read_b64_tr_b16 a[238:239], v244 offset:61440
    s_xor_b32 s52, s58, s84
    s_xor_b32 s53, s52, 4096
    s_xor_b32 s54, s52, 16384
    s_xor_b32 s55, s52, 20480
    s_mov_b32 s26, 0x8000000
    v_max3_f32 v220, v160, v164, v168
    v_max_f32 v220, v220, v172
    v_cmp_lt_f32 vcc, 0x5f800000, v220
s_cbranch_vccnz L_chk106_redo
L_chk106:
    v_add_f32 v236, v229, v160
    v_add_f32 v238, v231, v164
    v_add_f32 v240, v233, v168
    v_add_f32 v242, v235, v172
    v_rcp_f32 v236, v236
    v_rcp_f32 v238, v238
    v_rcp_f32 v240, v240
    v_rcp_f32 v242, v242
    s_waitcnt lgkmcnt(0)
    v_mfma_f32_16x16x32_bf16 a[0:3], a[224:227], v[64:67], a[0:3]
    ds_read_b64_tr_b16 a[240:241], v245 offset:32768
    v_mfma_f32_16x16x32_bf16 a[0:3], a[228:231], v[80:83], a[0:3]
    ds_read_b64_tr_b16 a[242:243], v245 offset:36864
    v_mfma_f32_16x16x32_bf16 a[0:3], a[232:235], v[96:99], a[0:3]
    ds_read_b64_tr_b16 a[244:245], v245 offset:40960
    v_mfma_f32_16x16x32_bf16 a[0:3], a[236:239], v[112:115], a[0:3]
    v_mfma_f32_16x16x32_bf16 a[16:19], a[236:239], v[116:119], a[16:19]
    ds_read_b64_tr_b16 a[246:247], v245 offset:45056
    v_mfma_f32_16x16x32_bf16 a[16:19], a[232:235], v[100:103], a[16:19]
    ds_read_b64_tr_b16 a[248:249], v245 offset:49152
    v_mfma_f32_16x16x32_bf16 a[16:19], a[228:231], v[84:87], a[16:19]
    ds_read_b64_tr_b16 a[250:251], v245 offset:53248
    v_mfma_f32_16x16x32_bf16 a[16:19], a[224:227], v[68:71], a[16:19]
    v_mfma_f32_16x16x32_bf16 a[32:35], a[224:227], v[72:75], a[32:35]
    ds_read_b64_tr_b16 a[252:253], v245 offset:57344
    v_accvgpr_read_b32 v128, a0
    v_mfma_f32_16x16x32_bf16 a[32:35], a[228:231], v[88:91], a[32:35]
    ds_read_b64_tr_b16 a[254:255], v245 offset:61440
    v_accvgpr_read_b32 v129, a1
    v_mfma_f32_16x16x32_bf16 a[32:35], a[232:235], v[104:107], a[32:35]
    v_accvgpr_read_b32 v130, a2
    v_accvgpr_read_b32 v131, a3
    v_mfma_f32_16x16x32_bf16 a[32:35], a[236:239], v[120:123], a[32:35]
    v_accvgpr_read_b32 v132, a16
    v_accvgpr_read_b32 v133, a17
    v_mfma_f32_16x16x32_bf16 a[48:51], a[236:239], v[124:127], a[48:51]
    v_accvgpr_read_b32 v134, a18
    v_accvgpr_read_b32 v135, a19
    v_mfma_f32_16x16x32_bf16 a[48:51], a[232:235], v[108:111], a[48:51]
    v_mul_f32 v128, v128, v236
    v_mul_f32 v129, v129, v236
    v_mfma_f32_16x16x32_bf16 a[48:51], a[228:231], v[92:95], a[48:51]
    v_cvt_pk_bf16_f32 v180, v128, v129
    v_accvgpr_read_b32 v136, a32
    v_mfma_f32_16x16x32_bf16 a[48:51], a[224:227], v[76:79], a[48:51]
    s_waitcnt lgkmcnt(0)
    v_accvgpr_read_b32 v137, a33
    v_accvgpr_read_b32 v138, a34
    v_accvgpr_read_b32 v139, a35
    v_mul_f32 v130, v130, v236
    v_mul_f32 v131, v131, v236
    v_pk_mul_f32 v[132:133], v[132:133], v[238:239] op_sel_hi:[1,0]
    v_pk_mul_f32 v[134:135], v[134:135], v[238:239] op_sel_hi:[1,0]
    v_pk_mul_f32 v[136:137], v[136:137], v[240:241] op_sel_hi:[1,0]
    v_pk_mul_f32 v[138:139], v[138:139], v[240:241] op_sel_hi:[1,0]
    v_cvt_pk_bf16_f32 v181, v130, v131
    v_mfma_f32_16x16x32_bf16 a[8:11], a[240:243], v[64:67], a[8:11]
    ds_read_b64_tr_b16 a[224:225], v244 offset:33024
    v_cvt_pk_bf16_f32 v184, v132, v133
    v_mfma_f32_16x16x32_bf16 a[8:11], a[244:247], v[80:83], a[8:11]
    ds_read_b64_tr_b16 a[226:227], v244 offset:37120
    v_cvt_pk_bf16_f32 v185, v134, v135
    v_mfma_f32_16x16x32_bf16 a[8:11], a[248:251], v[96:99], a[8:11]
    ds_read_b64_tr_b16 a[228:229], v244 offset:41216
    v_accvgpr_read_b32 v140, a48
    v_mfma_f32_16x16x32_bf16 a[8:11], a[252:255], v[112:115], a[8:11]
    v_accvgpr_read_b32 v141, a49
    v_accvgpr_read_b32 v142, a50
    v_mfma_f32_16x16x32_bf16 a[24:27], a[252:255], v[116:119], a[24:27]
    ds_read_b64_tr_b16 a[230:231], v244 offset:45312
    v_accvgpr_read_b32 v143, a51
    v_mfma_f32_16x16x32_bf16 a[24:27], a[248:251], v[100:103], a[24:27]
    ds_read_b64_tr_b16 a[232:233], v244 offset:49408
    v_cvt_pk_bf16_f32 v188, v136, v137
    v_mfma_f32_16x16x32_bf16 a[24:27], a[244:247], v[84:87], a[24:27]
    ds_read_b64_tr_b16 a[234:235], v244 offset:53504
    v_cvt_pk_bf16_f32 v189, v138, v139
    v_mfma_f32_16x16x32_bf16 a[24:27], a[240:243], v[68:71], a[24:27]
    v_accvgpr_read_b32 v144, a8
    v_accvgpr_read_b32 v145, a9
    v_mfma_f32_16x16x32_bf16 a[40:43], a[240:243], v[72:75], a[40:43]
    ds_read_b64_tr_b16 a[236:237], v244 offset:57600
    v_accvgpr_read_b32 v146, a10
    v_mfma_f32_16x16x32_bf16 a[40:43], a[244:247], v[88:91], a[40:43]
    ds_read_b64_tr_b16 a[238:239], v244 offset:61696
    v_accvgpr_read_b32 v147, a11
    v_mfma_f32_16x16x32_bf16 a[40:43], a[248:251], v[104:107], a[40:43]
    v_accvgpr_read_b32 v148, a24
    v_accvgpr_read_b32 v149, a25
    v_mfma_f32_16x16x32_bf16 a[40:43], a[252:255], v[120:123], a[40:43]
    v_accvgpr_read_b32 v150, a26
    v_accvgpr_read_b32 v151, a27
    v_mul_f32 v140, v140, v242
    v_mul_f32 v141, v141, v242
    v_cvt_pk_bf16_f32 v192, v140, v141
    v_pk_mul_f32 v[142:143], v[142:143], v[242:243] op_sel_hi:[1,0]
    v_pk_mul_f32 v[144:145], v[144:145], v[236:237] op_sel_hi:[1,0]
    v_pk_mul_f32 v[146:147], v[146:147], v[236:237] op_sel_hi:[1,0]
    v_pk_mul_f32 v[148:149], v[148:149], v[238:239] op_sel_hi:[1,0]
    v_pk_mul_f32 v[150:151], v[150:151], v[238:239] op_sel_hi:[1,0]
    v_cvt_pk_bf16_f32 v193, v142, v143
    v_mfma_f32_16x16x32_bf16 a[56:59], a[252:255], v[124:127], a[56:59]
    v_cvt_pk_bf16_f32 v196, v144, v145
    v_cvt_pk_bf16_f32 v197, v146, v147
    v_mfma_f32_16x16x32_bf16 a[56:59], a[248:251], v[108:111], a[56:59]
    v_accvgpr_read_b32 v152, a40
    v_accvgpr_read_b32 v153, a41
    v_mfma_f32_16x16x32_bf16 a[56:59], a[244:247], v[92:95], a[56:59]
    v_accvgpr_read_b32 v154, a42
    v_accvgpr_read_b32 v155, a43
    v_mfma_f32_16x16x32_bf16 a[56:59], a[240:243], v[76:79], a[56:59]
    s_waitcnt lgkmcnt(0)
    v_cvt_pk_bf16_f32 v200, v148, v149
    v_cvt_pk_bf16_f32 v201, v150, v151
    v_mfma_f32_16x16x32_bf16 a[4:7], a[224:227], v[64:67], a[4:7]
    ds_read_b64_tr_b16 a[240:241], v245 offset:33024
    v_mul_f32 v152, v152, v240
    v_mfma_f32_16x16x32_bf16 a[4:7], a[228:231], v[80:83], a[4:7]
    ds_read_b64_tr_b16 a[242:243], v245 offset:37120
    v_mul_f32 v153, v153, v240
    v_mfma_f32_16x16x32_bf16 a[4:7], a[232:235], v[96:99], a[4:7]
    ds_read_b64_tr_b16 a[244:245], v245 offset:41216
    v_accvgpr_read_b32 v156, a56
    v_mfma_f32_16x16x32_bf16 a[4:7], a[236:239], v[112:115], a[4:7]
    v_accvgpr_read_b32 v157, a57
    v_accvgpr_read_b32 v158, a58
    v_mfma_f32_16x16x32_bf16 a[20:23], a[236:239], v[116:119], a[20:23]
    ds_read_b64_tr_b16 a[246:247], v245 offset:45312
    v_accvgpr_read_b32 v159, a59
    v_mfma_f32_16x16x32_bf16 a[20:23], a[232:235], v[100:103], a[20:23]
    ds_read_b64_tr_b16 a[248:249], v245 offset:49408
    v_cvt_pk_bf16_f32 v204, v152, v153
    v_mfma_f32_16x16x32_bf16 a[20:23], a[228:231], v[84:87], a[20:23]
    ds_read_b64_tr_b16 a[250:251], v245 offset:53504
    v_accvgpr_read_b32 v128, a4
    v_mfma_f32_16x16x32_bf16 a[20:23], a[224:227], v[68:71], a[20:23]
    v_accvgpr_read_b32 v129, a5
    v_accvgpr_read_b32 v130, a6
    v_accvgpr_read_b32 v131, a7
    v_mul_f32 v154, v154, v240
    v_mul_f32 v155, v155, v240
    v_pk_mul_f32 v[156:157], v[156:157], v[242:243] op_sel_hi:[1,0]
    v_pk_mul_f32 v[158:159], v[158:159], v[242:243] op_sel_hi:[1,0]
    v_pk_mul_f32 v[128:129], v[128:129], v[236:237] op_sel_hi:[1,0]
    v_pk_mul_f32 v[130:131], v[130:131], v[236:237] op_sel_hi:[1,0]
    v_cvt_pk_bf16_f32 v205, v154, v155
    v_mfma_f32_16x16x32_bf16 a[36:39], a[224:227], v[72:75], a[36:39]
    ds_read_b64_tr_b16 a[252:253], v245 offset:57600
    v_cvt_pk_bf16_f32 v208, v156, v157
    v_mfma_f32_16x16x32_bf16 a[36:39], a[228:231], v[88:91], a[36:39]
    ds_read_b64_tr_b16 a[254:255], v245 offset:61696
    v_cvt_pk_bf16_f32 v209, v158, v159
    v_mfma_f32_16x16x32_bf16 a[36:39], a[232:235], v[104:107], a[36:39]
    v_accvgpr_read_b32 v132, a20
    v_accvgpr_read_b32 v133, a21
    v_mfma_f32_16x16x32_bf16 a[36:39], a[236:239], v[120:123], a[36:39]
    v_accvgpr_read_b32 v134, a22
    v_accvgpr_read_b32 v135, a23
    v_mfma_f32_16x16x32_bf16 a[52:55], a[236:239], v[124:127], a[52:55]
    v_cvt_pk_bf16_f32 v182, v128, v129
    v_cvt_pk_bf16_f32 v183, v130, v131
    v_mfma_f32_16x16x32_bf16 a[52:55], a[232:235], v[108:111], a[52:55]
    v_mul_f32 v132, v132, v238
    v_mul_f32 v133, v133, v238
    v_mfma_f32_16x16x32_bf16 a[52:55], a[228:231], v[92:95], a[52:55]
    v_accvgpr_read_b32 v136, a36
    v_accvgpr_read_b32 v137, a37
    v_mfma_f32_16x16x32_bf16 a[52:55], a[224:227], v[76:79], a[52:55]
    s_waitcnt lgkmcnt(0)
    v_accvgpr_read_b32 v138, a38
    v_accvgpr_read_b32 v139, a39
    v_mfma_f32_16x16x32_bf16 a[12:15], a[240:243], v[64:67], a[12:15]
    ds_read_b64_tr_b16 a[224:225], v244 offset:33280
    v_cvt_pk_bf16_f32 v186, v132, v133
    v_mfma_f32_16x16x32_bf16 a[12:15], a[244:247], v[80:83], a[12:15]
    ds_read_b64_tr_b16 a[226:227], v244 offset:37376
    v_accvgpr_read_b32 v140, a52
    v_mfma_f32_16x16x32_bf16 a[12:15], a[248:251], v[96:99], a[12:15]
    ds_read_b64_tr_b16 a[228:229], v244 offset:41472
    v_accvgpr_read_b32 v141, a53
    v_mfma_f32_16x16x32_bf16 a[12:15], a[252:255], v[112:115], a[12:15]
    v_accvgpr_read_b32 v142, a54
    v_accvgpr_read_b32 v143, a55
    v_mul_f32 v134, v134, v238
    v_mul_f32 v135, v135, v238
    v_cvt_pk_bf16_f32 v187, v134, v135
    v_pk_mul_f32 v[136:137], v[136:137], v[240:241] op_sel_hi:[1,0]
    v_pk_mul_f32 v[138:139], v[138:139], v[240:241] op_sel_hi:[1,0]
    v_pk_mul_f32 v[140:141], v[140:141], v[242:243] op_sel_hi:[1,0]
    v_pk_mul_f32 v[142:143], v[142:143], v[242:243] op_sel_hi:[1,0]
    v_mfma_f32_16x16x32_bf16 a[28:31], a[252:255], v[116:119], a[28:31]
    ds_read_b64_tr_b16 a[230:231], v244 offset:45568
    v_cvt_pk_bf16_f32 v190, v136, v137
    v_mfma_f32_16x16x32_bf16 a[28:31], a[248:251], v[100:103], a[28:31]
    ds_read_b64_tr_b16 a[232:233], v244 offset:49664
    v_cvt_pk_bf16_f32 v191, v138, v139
    v_mfma_f32_16x16x32_bf16 a[28:31], a[244:247], v[84:87], a[28:31]
    ds_read_b64_tr_b16 a[234:235], v244 offset:53760
    v_accvgpr_read_b32 v144, a12
    v_mfma_f32_16x16x32_bf16 a[28:31], a[240:243], v[68:71], a[28:31]
    s_mov_b64 vcc, s[74:75]
    v_accvgpr_read_b32 v145, a13
    v_accvgpr_read_b32 v146, a14
    v_mfma_f32_16x16x32_bf16 a[44:47], a[240:243], v[72:75], a[44:47]
    ds_read_b64_tr_b16 a[236:237], v244 offset:57856
    v_accvgpr_read_b32 v147, a15
    v_mfma_f32_16x16x32_bf16 a[44:47], a[244:247], v[88:91], a[44:47]
    ds_read_b64_tr_b16 a[238:239], v244 offset:61952
    v_cvt_pk_bf16_f32 v194, v140, v141
    v_mfma_f32_16x16x32_bf16 a[44:47], a[248:251], v[104:107], a[44:47]
    v_cvt_pk_bf16_f32 v195, v142, v143
    v_accvgpr_read_b32 v148, a28
    v_mfma_f32_16x16x32_bf16 a[44:47], a[252:255], v[120:123], a[44:47]
    v_accvgpr_read_b32 v149, a29
    v_accvgpr_read_b32 v150, a30
    v_mfma_f32_16x16x32_bf16 a[60:63], a[252:255], v[124:127], a[60:63]
    v_accvgpr_read_b32 v151, a31
    v_mul_f32 v144, v144, v236
    v_mfma_f32_16x16x32_bf16 a[60:63], a[248:251], v[108:111], a[60:63]
    v_mul_f32 v145, v145, v236
    v_cvt_pk_bf16_f32 v198, v144, v145
    v_mfma_f32_16x16x32_bf16 a[60:63], a[244:247], v[92:95], a[60:63]
    v_accvgpr_read_b32 v152, a44
    v_accvgpr_read_b32 v153, a45
    v_mfma_f32_16x16x32_bf16 a[60:63], a[240:243], v[76:79], a[60:63]
    s_waitcnt lgkmcnt(0)
    v_accvgpr_read_b32 v154, a46
    v_accvgpr_read_b32 v155, a47
    v_mul_f32 v146, v146, v236
    v_mul_f32 v147, v147, v236
    v_cvt_pk_bf16_f32 v199, v146, v147
    v_pk_mul_f32 v[148:149], v[148:149], v[238:239] op_sel_hi:[1,0]
    v_pk_mul_f32 v[150:151], v[150:151], v[238:239] op_sel_hi:[1,0]
    v_pk_mul_f32 v[152:153], v[152:153], v[240:241] op_sel_hi:[1,0]
    v_pk_mul_f32 v[154:155], v[154:155], v[240:241] op_sel_hi:[1,0]
    v_mfma_f32_16x16x32_bf16 a[64:67], a[224:227], v[64:67], a[64:67]
    ds_read_b64_tr_b16 a[240:241], v245 offset:33280
    v_cndmask_b32_dpp v176, v196, v180, vcc quad_perm:[1,0,3,2] row_mask:0xf bank_mask:0xf
    v_mfma_f32_16x16x32_bf16 a[64:67], a[228:231], v[80:83], a[64:67]
    ds_read_b64_tr_b16 a[242:243], v245 offset:37376
    v_cndmask_b32_dpp v177, v197, v181, vcc quad_perm:[1,0,3,2] row_mask:0xf bank_mask:0xf
    v_mfma_f32_16x16x32_bf16 a[64:67], a[232:235], v[96:99], a[64:67]
    ds_read_b64_tr_b16 a[244:245], v245 offset:41472
    v_cndmask_b32_dpp v178, v198, v182, vcc quad_perm:[1,0,3,2] row_mask:0xf bank_mask:0xf
    v_mfma_f32_16x16x32_bf16 a[64:67], a[236:239], v[112:115], a[64:67]
    v_cvt_pk_bf16_f32 v202, v148, v149
    v_cvt_pk_bf16_f32 v203, v150, v151
    v_mfma_f32_16x16x32_bf16 a[80:83], a[236:239], v[116:119], a[80:83]
    ds_read_b64_tr_b16 a[246:247], v245 offset:45568
    v_cndmask_b32_dpp v179, v199, v183, vcc quad_perm:[1,0,3,2] row_mask:0xf bank_mask:0xf
    v_mfma_f32_16x16x32_bf16 a[80:83], a[232:235], v[100:103], a[80:83]
    ds_read_b64_tr_b16 a[248:249], v245 offset:49664
    s_mov_b64 vcc, s[76:77]
    v_mfma_f32_16x16x32_bf16 a[80:83], a[228:231], v[84:87], a[80:83]
    ds_read_b64_tr_b16 a[250:251], v245 offset:53760
    v_cndmask_b32_dpp v196, v180, v196, vcc quad_perm:[1,0,3,2] row_mask:0xf bank_mask:0xf
    v_mfma_f32_16x16x32_bf16 a[80:83], a[224:227], v[68:71], a[80:83]
    v_accvgpr_read_b32 v156, a60
    v_accvgpr_read_b32 v157, a61
    v_accvgpr_read_b32 v158, a62
    v_accvgpr_read_b32 v159, a63
    v_cndmask_b32_dpp v197, v181, v197, vcc quad_perm:[1,0,3,2] row_mask:0xf bank_mask:0xf
    v_pk_mul_f32 v[156:157], v[156:157], v[242:243] op_sel_hi:[1,0]
    v_pk_mul_f32 v[158:159], v[158:159], v[242:243] op_sel_hi:[1,0]
    v_cndmask_b32_dpp v198, v182, v198, vcc quad_perm:[1,0,3,2] row_mask:0xf bank_mask:0xf
    v_cndmask_b32_dpp v199, v183, v199, vcc quad_perm:[1,0,3,2] row_mask:0xf bank_mask:0xf
    v_permlane16_swap_b32 v176, v178
    v_cvt_pk_bf16_f32 v206, v152, v153
    v_cvt_pk_bf16_f32 v207, v154, v155
    v_mfma_f32_16x16x32_bf16 a[96:99], a[224:227], v[72:75], a[96:99]
    ds_read_b64_tr_b16 a[252:253], v245 offset:57856
    v_accvgpr_read_b32 v128, a64
    v_mfma_f32_16x16x32_bf16 a[96:99], a[228:231], v[88:91], a[96:99]
    ds_read_b64_tr_b16 a[254:255], v245 offset:61952
    v_accvgpr_read_b32 v129, a65
    v_mfma_f32_16x16x32_bf16 a[96:99], a[232:235], v[104:107], a[96:99]
    v_permlane16_swap_b32 v177, v179
    v_mfma_f32_16x16x32_bf16 a[96:99], a[236:239], v[120:123], a[96:99]
    buffer_store_dwordx4 v[176:179], v243, s[24:27], s52 offen offset:0 sc1
    v_permlane16_swap_b32 v196, v198
    v_permlane16_swap_b32 v197, v199
    v_pk_mul_f32 v[128:129], v[128:129], v[236:237] op_sel_hi:[1,0]
    v_accvgpr_read_b32 v130, a66
    v_accvgpr_read_b32 v131, a67
    v_pk_mul_f32 v[130:131], v[130:131], v[236:237] op_sel_hi:[1,0]
    v_cvt_pk_bf16_f32 v210, v156, v157
    v_cvt_pk_bf16_f32 v211, v158, v159
    v_mfma_f32_16x16x32_bf16 a[112:115], a[236:239], v[124:127], a[112:115]
    s_mov_b64 vcc, s[74:75]
    v_accvgpr_read_b32 v132, a80
    v_accvgpr_read_b32 v133, a81
    v_mfma_f32_16x16x32_bf16 a[112:115], a[232:235], v[108:111], a[112:115]
    v_accvgpr_read_b32 v134, a82
    v_accvgpr_read_b32 v135, a83
    v_mfma_f32_16x16x32_bf16 a[112:115], a[228:231], v[92:95], a[112:115]
    v_cvt_pk_bf16_f32 v4, v128, v129
    v_cvt_pk_bf16_f32 v5, v130, v131
    v_mfma_f32_16x16x32_bf16 a[112:115], a[224:227], v[76:79], a[112:115]
    s_waitcnt lgkmcnt(0)
    buffer_store_dwordx4 v[196:199], v243, s[24:27], s52 offen offset:256 sc1
    v_cndmask_b32_dpp v180, v200, v184, vcc quad_perm:[1,0,3,2] row_mask:0xf bank_mask:0xf
    v_cndmask_b32_dpp v181, v201, v185, vcc quad_perm:[1,0,3,2] row_mask:0xf bank_mask:0xf
    v_cndmask_b32_dpp v182, v202, v186, vcc quad_perm:[1,0,3,2] row_mask:0xf bank_mask:0xf
    v_accvgpr_read_b32 v136, a96
    v_pk_mul_f32 v[132:133], v[132:133], v[238:239] op_sel_hi:[1,0]
    v_pk_mul_f32 v[134:135], v[134:135], v[238:239] op_sel_hi:[1,0]
    v_mfma_f32_16x16x32_bf16 a[72:75], a[240:243], v[64:67], a[72:75]
    ds_read_b64_tr_b16 a[224:225], v244 offset:33536
    v_accvgpr_read_b32 v137, a97
    v_mfma_f32_16x16x32_bf16 a[72:75], a[244:247], v[80:83], a[72:75]
    ds_read_b64_tr_b16 a[226:227], v244 offset:37632
    v_accvgpr_read_b32 v138, a98
    v_mfma_f32_16x16x32_bf16 a[72:75], a[248:251], v[96:99], a[72:75]
    ds_read_b64_tr_b16 a[228:229], v244 offset:41728
    v_accvgpr_read_b32 v139, a99
    v_mfma_f32_16x16x32_bf16 a[72:75], a[252:255], v[112:115], a[72:75]
    v_cndmask_b32_dpp v183, v203, v187, vcc quad_perm:[1,0,3,2] row_mask:0xf bank_mask:0xf
    s_mov_b64 vcc, s[76:77]
    v_cndmask_b32_dpp v200, v184, v200, vcc quad_perm:[1,0,3,2] row_mask:0xf bank_mask:0xf
    v_cvt_pk_bf16_f32 v8, v132, v133
    v_cvt_pk_bf16_f32 v9, v134, v135
    v_pk_mul_f32 v[136:137], v[136:137], v[240:241] op_sel_hi:[1,0]
    v_pk_mul_f32 v[138:139], v[138:139], v[240:241] op_sel_hi:[1,0]
    v_mfma_f32_16x16x32_bf16 a[88:91], a[252:255], v[116:119], a[88:91]
    ds_read_b64_tr_b16 a[230:231], v244 offset:45824
    v_cndmask_b32_dpp v201, v185, v201, vcc quad_perm:[1,0,3,2] row_mask:0xf bank_mask:0xf
    v_mfma_f32_16x16x32_bf16 a[88:91], a[248:251], v[100:103], a[88:91]
    ds_read_b64_tr_b16 a[232:233], v244 offset:49920
    v_cndmask_b32_dpp v202, v186, v202, vcc quad_perm:[1,0,3,2] row_mask:0xf bank_mask:0xf
    v_mfma_f32_16x16x32_bf16 a[88:91], a[244:247], v[84:87], a[88:91]
    ds_read_b64_tr_b16 a[234:235], v244 offset:54016
    v_cndmask_b32_dpp v203, v187, v203, vcc quad_perm:[1,0,3,2] row_mask:0xf bank_mask:0xf
    v_mfma_f32_16x16x32_bf16 a[88:91], a[240:243], v[68:71], a[88:91]
    v_permlane16_swap_b32 v180, v182
    v_accvgpr_read_b32 v140, a112
    v_accvgpr_read_b32 v141, a113
    v_accvgpr_read_b32 v142, a114
    v_pk_mul_f32 v[140:141], v[140:141], v[242:243] op_sel_hi:[1,0]
    v_accvgpr_read_b32 v143, a115
    v_pk_mul_f32 v[142:143], v[142:143], v[242:243] op_sel_hi:[1,0]
    v_permlane16_swap_b32 v181, v183
    v_cvt_pk_bf16_f32 v12, v136, v137
    v_cvt_pk_bf16_f32 v13, v138, v139
    v_mfma_f32_16x16x32_bf16 a[104:107], a[240:243], v[72:75], a[104:107]
    ds_read_b64_tr_b16 a[236:237], v244 offset:58112
    v_accvgpr_read_b32 v144, a72
    v_mfma_f32_16x16x32_bf16 a[104:107], a[244:247], v[88:91], a[104:107]
    ds_read_b64_tr_b16 a[238:239], v244 offset:62208
    v_accvgpr_read_b32 v145, a73
    v_mfma_f32_16x16x32_bf16 a[104:107], a[248:251], v[104:107], a[104:107]
    v_permlane16_swap_b32 v200, v202
    v_mfma_f32_16x16x32_bf16 a[104:107], a[252:255], v[120:123], a[104:107]
    buffer_store_dwordx4 v[180:183], v243, s[24:27], s53 offen offset:0 sc1
    v_permlane16_swap_b32 v201, v203
    v_accvgpr_read_b32 v146, a74
    v_accvgpr_read_b32 v147, a75
    v_pk_mul_f32 v[144:145], v[144:145], v[236:237] op_sel_hi:[1,0]
    v_pk_mul_f32 v[146:147], v[146:147], v[236:237] op_sel_hi:[1,0]
    v_cvt_pk_bf16_f32 v16, v140, v141
    v_cvt_pk_bf16_f32 v17, v142, v143
    v_mfma_f32_16x16x32_bf16 a[120:123], a[252:255], v[124:127], a[120:123]
    s_mov_b64 vcc, s[74:75]
    v_accvgpr_read_b32 v148, a88
    v_accvgpr_read_b32 v149, a89
    v_mfma_f32_16x16x32_bf16 a[120:123], a[248:251], v[108:111], a[120:123]
    v_accvgpr_read_b32 v150, a90
    v_accvgpr_read_b32 v151, a91
    v_mfma_f32_16x16x32_bf16 a[120:123], a[244:247], v[92:95], a[120:123]
    v_cndmask_b32_dpp v184, v204, v188, vcc quad_perm:[1,0,3,2] row_mask:0xf bank_mask:0xf
    v_cndmask_b32_dpp v185, v205, v189, vcc quad_perm:[1,0,3,2] row_mask:0xf bank_mask:0xf
    v_mfma_f32_16x16x32_bf16 a[120:123], a[240:243], v[76:79], a[120:123]
    s_waitcnt lgkmcnt(0)
    buffer_store_dwordx4 v[200:203], v243, s[24:27], s53 offen offset:256 sc1
    v_cndmask_b32_dpp v186, v206, v190, vcc quad_perm:[1,0,3,2] row_mask:0xf bank_mask:0xf
    v_cvt_pk_bf16_f32 v20, v144, v145
    v_cvt_pk_bf16_f32 v21, v146, v147
    v_cndmask_b32_dpp v187, v207, v191, vcc quad_perm:[1,0,3,2] row_mask:0xf bank_mask:0xf
    v_pk_mul_f32 v[148:149], v[148:149], v[238:239] op_sel_hi:[1,0]
    v_pk_mul_f32 v[150:151], v[150:151], v[238:239] op_sel_hi:[1,0]
    v_mfma_f32_16x16x32_bf16 a[68:71], a[224:227], v[64:67], a[68:71]
    ds_read_b64_tr_b16 a[240:241], v245 offset:33536
    s_mov_b64 vcc, s[76:77]
    v_mfma_f32_16x16x32_bf16 a[68:71], a[228:231], v[80:83], a[68:71]
    ds_read_b64_tr_b16 a[242:243], v245 offset:37632
    v_cndmask_b32_dpp v204, v188, v204, vcc quad_perm:[1,0,3,2] row_mask:0xf bank_mask:0xf
    v_mfma_f32_16x16x32_bf16 a[68:71], a[232:235], v[96:99], a[68:71]
    ds_read_b64_tr_b16 a[244:245], v245 offset:41728
    v_accvgpr_read_b32 v152, a104
    v_mfma_f32_16x16x32_bf16 a[68:71], a[236:239], v[112:115], a[68:71]
    v_accvgpr_read_b32 v153, a105
    v_accvgpr_read_b32 v154, a106
    v_accvgpr_read_b32 v155, a107
    v_cndmask_b32_dpp v205, v189, v205, vcc quad_perm:[1,0,3,2] row_mask:0xf bank_mask:0xf
    v_cndmask_b32_dpp v206, v190, v206, vcc quad_perm:[1,0,3,2] row_mask:0xf bank_mask:0xf
    v_pk_mul_f32 v[152:153], v[152:153], v[240:241] op_sel_hi:[1,0]
    v_pk_mul_f32 v[154:155], v[154:155], v[240:241] op_sel_hi:[1,0]
    v_cndmask_b32_dpp v207, v191, v207, vcc quad_perm:[1,0,3,2] row_mask:0xf bank_mask:0xf
    v_permlane16_swap_b32 v184, v186
    v_cvt_pk_bf16_f32 v24, v148, v149
    v_cvt_pk_bf16_f32 v25, v150, v151
    v_mfma_f32_16x16x32_bf16 a[84:87], a[236:239], v[116:119], a[84:87]
    ds_read_b64_tr_b16 a[246:247], v245 offset:45824
    v_accvgpr_read_b32 v156, a120
    v_mfma_f32_16x16x32_bf16 a[84:87], a[232:235], v[100:103], a[84:87]
    ds_read_b64_tr_b16 a[248:249], v245 offset:49920
    v_accvgpr_read_b32 v157, a121
    v_mfma_f32_16x16x32_bf16 a[84:87], a[228:231], v[84:87], a[84:87]
    ds_read_b64_tr_b16 a[250:251], v245 offset:54016
    v_accvgpr_read_b32 v158, a122
    v_mfma_f32_16x16x32_bf16 a[84:87], a[224:227], v[68:71], a[84:87]
    v_permlane16_swap_b32 v185, v187
    v_accvgpr_read_b32 v159, a123
    v_permlane16_swap_b32 v204, v206
    v_pk_mul_f32 v[156:157], v[156:157], v[242:243] op_sel_hi:[1,0]
    v_pk_mul_f32 v[158:159], v[158:159], v[242:243] op_sel_hi:[1,0]
    v_cvt_pk_bf16_f32 v28, v152, v153
    v_cvt_pk_bf16_f32 v29, v154, v155
    v_mfma_f32_16x16x32_bf16 a[100:103], a[224:227], v[72:75], a[100:103]
    ds_read_b64_tr_b16 a[252:253], v245 offset:58112
    v_accvgpr_read_b32 v128, a68
    v_mfma_f32_16x16x32_bf16 a[100:103], a[228:231], v[88:91], a[100:103]
    ds_read_b64_tr_b16 a[254:255], v245 offset:62208
    v_accvgpr_read_b32 v129, a69
    v_mfma_f32_16x16x32_bf16 a[100:103], a[232:235], v[104:107], a[100:103]
    v_permlane16_swap_b32 v205, v207
    v_mfma_f32_16x16x32_bf16 a[100:103], a[236:239], v[120:123], a[100:103]
    s_mov_b64 vcc, s[74:75]
    buffer_store_dwordx4 v[184:187], v243, s[24:27], s54 offen offset:0 sc1
    v_accvgpr_read_b32 v130, a70
    v_accvgpr_read_b32 v131, a71
    v_cvt_pk_bf16_f32 v32, v156, v157
    v_cvt_pk_bf16_f32 v33, v158, v159
    v_pk_mul_f32 v[128:129], v[128:129], v[236:237] op_sel_hi:[1,0]
    v_pk_mul_f32 v[130:131], v[130:131], v[236:237] op_sel_hi:[1,0]
    v_mfma_f32_16x16x32_bf16 a[116:119], a[236:239], v[124:127], a[116:119]
    v_cndmask_b32_dpp v188, v208, v192, vcc quad_perm:[1,0,3,2] row_mask:0xf bank_mask:0xf
    v_cndmask_b32_dpp v189, v209, v193, vcc quad_perm:[1,0,3,2] row_mask:0xf bank_mask:0xf
    v_mfma_f32_16x16x32_bf16 a[116:119], a[232:235], v[108:111], a[116:119]
    v_cndmask_b32_dpp v190, v210, v194, vcc quad_perm:[1,0,3,2] row_mask:0xf bank_mask:0xf
    v_accvgpr_read_b32 v132, a84
    v_mfma_f32_16x16x32_bf16 a[116:119], a[228:231], v[92:95], a[116:119]
    v_accvgpr_read_b32 v133, a85
    v_accvgpr_read_b32 v134, a86
    v_mfma_f32_16x16x32_bf16 a[116:119], a[224:227], v[76:79], a[116:119]
    s_waitcnt lgkmcnt(0)
    buffer_store_dwordx4 v[204:207], v243, s[24:27], s54 offen offset:256 sc1
    v_accvgpr_read_b32 v135, a87
    v_cndmask_b32_dpp v191, v211, v195, vcc quad_perm:[1,0,3,2] row_mask:0xf bank_mask:0xf
    s_mov_b64 vcc, s[76:77]
    v_cndmask_b32_dpp v208, v192, v208, vcc quad_perm:[1,0,3,2] row_mask:0xf bank_mask:0xf
    v_pk_mul_f32 v[132:133], v[132:133], v[238:239] op_sel_hi:[1,0]
    v_pk_mul_f32 v[134:135], v[134:135], v[238:239] op_sel_hi:[1,0]
    v_cvt_pk_bf16_f32 v6, v128, v129
    v_cvt_pk_bf16_f32 v7, v130, v131
    v_mfma_f32_16x16x32_bf16 a[76:79], a[240:243], v[64:67], a[76:79]
    v_cndmask_b32_dpp v209, v193, v209, vcc quad_perm:[1,0,3,2] row_mask:0xf bank_mask:0xf
    v_cndmask_b32_dpp v210, v194, v210, vcc quad_perm:[1,0,3,2] row_mask:0xf bank_mask:0xf
    v_mfma_f32_16x16x32_bf16 a[76:79], a[244:247], v[80:83], a[76:79]
    v_cndmask_b32_dpp v211, v195, v211, vcc quad_perm:[1,0,3,2] row_mask:0xf bank_mask:0xf
    v_accvgpr_read_b32 v136, a100
    v_mfma_f32_16x16x32_bf16 a[76:79], a[248:251], v[96:99], a[76:79]
    v_permlane16_swap_b32 v188, v190
    v_mfma_f32_16x16x32_bf16 a[76:79], a[252:255], v[112:115], a[76:79]
    v_permlane16_swap_b32 v189, v191
    v_accvgpr_read_b32 v137, a101
    v_accvgpr_read_b32 v138, a102
    v_accvgpr_read_b32 v139, a103
    v_pk_mul_f32 v[136:137], v[136:137], v[240:241] op_sel_hi:[1,0]
    v_pk_mul_f32 v[138:139], v[138:139], v[240:241] op_sel_hi:[1,0]
    v_cvt_pk_bf16_f32 v10, v132, v133
    v_cvt_pk_bf16_f32 v11, v134, v135
    v_mfma_f32_16x16x32_bf16 a[92:95], a[252:255], v[116:119], a[92:95]
    v_permlane16_swap_b32 v208, v210
    v_mfma_f32_16x16x32_bf16 a[92:95], a[248:251], v[100:103], a[92:95]
    v_permlane16_swap_b32 v209, v211
    v_mfma_f32_16x16x32_bf16 a[92:95], a[244:247], v[84:87], a[92:95]
    v_accvgpr_read_b32 v140, a116
    v_accvgpr_read_b32 v141, a117
    v_mfma_f32_16x16x32_bf16 a[92:95], a[240:243], v[68:71], a[92:95]
    s_mov_b64 vcc, s[74:75]
    buffer_store_dwordx4 v[188:191], v243, s[24:27], s55 offen offset:0 sc1
    v_accvgpr_read_b32 v142, a118
    v_accvgpr_read_b32 v143, a119
    v_cvt_pk_bf16_f32 v14, v136, v137
    v_cvt_pk_bf16_f32 v15, v138, v139
    v_pk_mul_f32 v[140:141], v[140:141], v[242:243] op_sel_hi:[1,0]
    v_pk_mul_f32 v[142:143], v[142:143], v[242:243] op_sel_hi:[1,0]
    v_mfma_f32_16x16x32_bf16 a[108:111], a[240:243], v[72:75], a[108:111]
    v_accvgpr_read_b32 v144, a76
    v_accvgpr_read_b32 v145, a77
    v_mfma_f32_16x16x32_bf16 a[108:111], a[244:247], v[88:91], a[108:111]
    v_accvgpr_read_b32 v146, a78
    v_accvgpr_read_b32 v147, a79
    v_mfma_f32_16x16x32_bf16 a[108:111], a[248:251], v[104:107], a[108:111]
    v_cvt_pk_bf16_f32 v18, v140, v141
    v_cvt_pk_bf16_f32 v19, v142, v143
    v_mfma_f32_16x16x32_bf16 a[108:111], a[252:255], v[120:123], a[108:111]
    buffer_store_dwordx4 v[208:211], v243, s[24:27], s55 offen offset:256 sc1
    v_accvgpr_read_b32 v148, a92
    v_accvgpr_read_b32 v149, a93
    v_accvgpr_read_b32 v150, a94
    v_accvgpr_read_b32 v151, a95
    v_pk_mul_f32 v[144:145], v[144:145], v[236:237] op_sel_hi:[1,0]
    v_pk_mul_f32 v[146:147], v[146:147], v[236:237] op_sel_hi:[1,0]
    v_pk_mul_f32 v[148:149], v[148:149], v[238:239] op_sel_hi:[1,0]
    v_pk_mul_f32 v[150:151], v[150:151], v[238:239] op_sel_hi:[1,0]
    v_mfma_f32_16x16x32_bf16 a[124:127], a[252:255], v[124:127], a[124:127]
    v_cvt_pk_bf16_f32 v22, v144, v145
    v_cvt_pk_bf16_f32 v23, v146, v147
    v_mfma_f32_16x16x32_bf16 a[124:127], a[248:251], v[108:111], a[124:127]
    v_accvgpr_read_b32 v152, a108
    v_accvgpr_read_b32 v153, a109
    v_mfma_f32_16x16x32_bf16 a[124:127], a[244:247], v[92:95], a[124:127]
    v_accvgpr_read_b32 v154, a110
    v_accvgpr_read_b32 v155, a111
    v_mfma_f32_16x16x32_bf16 a[124:127], a[240:243], v[76:79], a[124:127]
    v_cndmask_b32_dpp v0, v20, v4, vcc quad_perm:[1,0,3,2] row_mask:0xf bank_mask:0xf
    v_cndmask_b32_dpp v1, v21, v5, vcc quad_perm:[1,0,3,2] row_mask:0xf bank_mask:0xf
    v_cndmask_b32_dpp v2, v22, v6, vcc quad_perm:[1,0,3,2] row_mask:0xf bank_mask:0xf
    v_cndmask_b32_dpp v3, v23, v7, vcc quad_perm:[1,0,3,2] row_mask:0xf bank_mask:0xf
    s_mov_b64 vcc, s[76:77]
    v_pk_mul_f32 v[152:153], v[152:153], v[240:241] op_sel_hi:[1,0]
    v_pk_mul_f32 v[154:155], v[154:155], v[240:241] op_sel_hi:[1,0]
    v_cndmask_b32_dpp v20, v4, v20, vcc quad_perm:[1,0,3,2] row_mask:0xf bank_mask:0xf
    v_cndmask_b32_dpp v21, v5, v21, vcc quad_perm:[1,0,3,2] row_mask:0xf bank_mask:0xf
    v_cndmask_b32_dpp v22, v6, v22, vcc quad_perm:[1,0,3,2] row_mask:0xf bank_mask:0xf
    v_cndmask_b32_dpp v23, v7, v23, vcc quad_perm:[1,0,3,2] row_mask:0xf bank_mask:0xf
    v_permlane16_swap_b32 v0, v2
    v_permlane16_swap_b32 v1, v3
    buffer_store_dwordx4 v[0:3], v243, s[24:27], s52 offen offset:128 sc1
    v_permlane16_swap_b32 v20, v22
    v_permlane16_swap_b32 v21, v23
    buffer_store_dwordx4 v[20:23], v243, s[24:27], s52 offen offset:384 sc1
    v_cvt_pk_bf16_f32 v26, v148, v149
    v_cvt_pk_bf16_f32 v27, v150, v151
    s_mov_b64 vcc, s[74:75]
    v_accvgpr_read_b32 v156, a124
    v_accvgpr_read_b32 v157, a125
    v_pk_mul_f32 v[156:157], v[156:157], v[242:243] op_sel_hi:[1,0]
    v_accvgpr_read_b32 v158, a126
    v_accvgpr_read_b32 v159, a127
    v_pk_mul_f32 v[158:159], v[158:159], v[242:243] op_sel_hi:[1,0]
    v_cndmask_b32_dpp v4, v24, v8, vcc quad_perm:[1,0,3,2] row_mask:0xf bank_mask:0xf
    v_cndmask_b32_dpp v5, v25, v9, vcc quad_perm:[1,0,3,2] row_mask:0xf bank_mask:0xf
    v_cndmask_b32_dpp v6, v26, v10, vcc quad_perm:[1,0,3,2] row_mask:0xf bank_mask:0xf
    v_cndmask_b32_dpp v7, v27, v11, vcc quad_perm:[1,0,3,2] row_mask:0xf bank_mask:0xf
    s_mov_b64 vcc, s[76:77]
    v_cndmask_b32_dpp v24, v8, v24, vcc quad_perm:[1,0,3,2] row_mask:0xf bank_mask:0xf
    v_cndmask_b32_dpp v25, v9, v25, vcc quad_perm:[1,0,3,2] row_mask:0xf bank_mask:0xf
    v_cndmask_b32_dpp v26, v10, v26, vcc quad_perm:[1,0,3,2] row_mask:0xf bank_mask:0xf
    v_cndmask_b32_dpp v27, v11, v27, vcc quad_perm:[1,0,3,2] row_mask:0xf bank_mask:0xf
    v_permlane16_swap_b32 v4, v6
    v_permlane16_swap_b32 v5, v7
    buffer_store_dwordx4 v[4:7], v243, s[24:27], s53 offen offset:128 sc1
    v_permlane16_swap_b32 v24, v26
    v_permlane16_swap_b32 v25, v27
    buffer_store_dwordx4 v[24:27], v243, s[24:27], s53 offen offset:384 sc1
    v_cvt_pk_bf16_f32 v30, v152, v153
    v_cvt_pk_bf16_f32 v31, v154, v155
    s_mov_b64 vcc, s[74:75]
    v_cvt_pk_bf16_f32 v34, v156, v157
    v_cndmask_b32_dpp v8, v28, v12, vcc quad_perm:[1,0,3,2] row_mask:0xf bank_mask:0xf
    v_cndmask_b32_dpp v9, v29, v13, vcc quad_perm:[1,0,3,2] row_mask:0xf bank_mask:0xf
    v_cndmask_b32_dpp v10, v30, v14, vcc quad_perm:[1,0,3,2] row_mask:0xf bank_mask:0xf
    v_cndmask_b32_dpp v11, v31, v15, vcc quad_perm:[1,0,3,2] row_mask:0xf bank_mask:0xf
    s_mov_b64 vcc, s[76:77]
    v_cndmask_b32_dpp v28, v12, v28, vcc quad_perm:[1,0,3,2] row_mask:0xf bank_mask:0xf
    v_cndmask_b32_dpp v29, v13, v29, vcc quad_perm:[1,0,3,2] row_mask:0xf bank_mask:0xf
    v_cndmask_b32_dpp v30, v14, v30, vcc quad_perm:[1,0,3,2] row_mask:0xf bank_mask:0xf
    v_cndmask_b32_dpp v31, v15, v31, vcc quad_perm:[1,0,3,2] row_mask:0xf bank_mask:0xf
    v_permlane16_swap_b32 v8, v10
    v_permlane16_swap_b32 v9, v11
    buffer_store_dwordx4 v[8:11], v243, s[24:27], s54 offen offset:128 sc1
    v_permlane16_swap_b32 v28, v30
    v_permlane16_swap_b32 v29, v31
    buffer_store_dwordx4 v[28:31], v243, s[24:27], s54 offen offset:384 sc1
    v_cvt_pk_bf16_f32 v35, v158, v159
    s_mov_b64 vcc, s[74:75]
    s_nop 0
    v_cndmask_b32_dpp v12, v32, v16, vcc quad_perm:[1,0,3,2] row_mask:0xf bank_mask:0xf
    v_cndmask_b32_dpp v13, v33, v17, vcc quad_perm:[1,0,3,2] row_mask:0xf bank_mask:0xf
    v_cndmask_b32_dpp v14, v34, v18, vcc quad_perm:[1,0,3,2] row_mask:0xf bank_mask:0xf
    v_cndmask_b32_dpp v15, v35, v19, vcc quad_perm:[1,0,3,2] row_mask:0xf bank_mask:0xf
    s_mov_b64 vcc, s[76:77]
    v_cndmask_b32_dpp v32, v16, v32, vcc quad_perm:[1,0,3,2] row_mask:0xf bank_mask:0xf
    v_cndmask_b32_dpp v33, v17, v33, vcc quad_perm:[1,0,3,2] row_mask:0xf bank_mask:0xf
    v_cndmask_b32_dpp v34, v18, v34, vcc quad_perm:[1,0,3,2] row_mask:0xf bank_mask:0xf
    v_cndmask_b32_dpp v35, v19, v35, vcc quad_perm:[1,0,3,2] row_mask:0xf bank_mask:0xf
    v_permlane16_swap_b32 v12, v14
    v_permlane16_swap_b32 v13, v15
    buffer_store_dwordx4 v[12:15], v243, s[24:27], s55 offen offset:128 sc1
    v_permlane16_swap_b32 v32, v34
    v_permlane16_swap_b32 v33, v35
    buffer_store_dwordx4 v[32:35], v243, s[24:27], s55 offen offset:384 sc1
L_end:
    s_endpgm
L_chk56_redo:
    s_xor_b32 s39, s57, s84
    s_call_b64 s[72:73], L_redo0
    s_branch L_chk56
L_chk58_redo:
    s_xor_b32 s39, s58, s84
    s_call_b64 s[72:73], L_redo1
    s_branch L_chk58
L_chk61_redo:
    s_xor_b32 s39, s57, s84
    s_call_b64 s[72:73], L_redo0
    s_branch L_chk61
L_chk63_redo:
    s_xor_b32 s39, s58, s84
    s_call_b64 s[72:73], L_redo1
    s_branch L_chk63
L_chk66_redo:
    s_xor_b32 s39, s57, s84
    s_call_b64 s[72:73], L_redo0
    s_branch L_chk66
L_chk76_redo:
    s_xor_b32 s39, s58, s84
    s_call_b64 s[72:73], L_redo1
    s_branch L_chk76
L_chk79_redo:
    s_xor_b32 s39, s57, s84
    s_call_b64 s[72:73], L_redo0
    s_branch L_chk79
L_chk89_redo:
    s_xor_b32 s39, s58, s84
    s_call_b64 s[72:73], L_redo1
    s_branch L_chk89
L_chk106_redo:
    s_xor_b32 s39, s58, s84
    s_call_b64 s[72:73], L_redo1
    s_branch L_chk106
L_redo0:
    s_mov_b32 s31, 0x20000
    v_mbcnt_lo_u32_b32 v144, -1, 0
    v_mbcnt_hi_u32_b32 v144, -1, v144
    v_and_b32 v145, 15, v144
    v_and_b32 v144, 48, v144
    v_lshl_add_u32 v144, v145, 8, v144
    s_mov_b32 s28, s4
    s_and_b32 s29, s5, 0xffff
    s_mov_b32 s30, 0x8000000
    s_xor_b32 s40, s39, 0
    buffer_load_dwordx4 v[64:67], v144, s[28:31], s40 offen offset:0
    buffer_load_dwordx4 v[68:71], v144, s[28:31], s40 offen offset:64
    buffer_load_dwordx4 v[72:75], v144, s[28:31], s40 offen offset:128
    buffer_load_dwordx4 v[76:79], v144, s[28:31], s40 offen offset:192
    s_mov_b32 s28, s6
    s_and_b32 s29, s7, 0xffff
    s_mov_b32 s30, 0x4000000
    s_lshr_b32 s40, s39, 17
    s_lshl_b32 s40, s40, 16
    s_xor_b32 s40, s40, s87
    s_xor_b32 s40, s40, 0
    buffer_load_dwordx4 v[80:83], v144, s[28:31], s40 offen offset:0
    buffer_load_dwordx4 v[84:87], v144, s[28:31], s40 offen offset:64
    buffer_load_dwordx4 v[88:91], v144, s[28:31], s40 offen offset:128
    buffer_load_dwordx4 v[92:95], v144, s[28:31], s40 offen offset:192
    s_waitcnt vmcnt(0)
    v_mfma_f32_16x16x32_bf16 v[96:99], v[80:83], v[64:67], 0
    v_mfma_f32_16x16x32_bf16 v[96:99], v[84:87], v[68:71], v[96:99]
    v_mfma_f32_16x16x32_bf16 v[96:99], v[88:91], v[72:75], v[96:99]
    v_mfma_f32_16x16x32_bf16 v[96:99], v[92:95], v[76:79], v[96:99]
    s_xor_b32 s40, s40, 8192
    buffer_load_dwordx4 v[80:83], v144, s[28:31], s40 offen offset:0
    buffer_load_dwordx4 v[84:87], v144, s[28:31], s40 offen offset:64
    buffer_load_dwordx4 v[88:91], v144, s[28:31], s40 offen offset:128
    buffer_load_dwordx4 v[92:95], v144, s[28:31], s40 offen offset:192
    s_waitcnt vmcnt(0)
    v_mfma_f32_16x16x32_bf16 v[100:103], v[80:83], v[64:67], 0
    v_mfma_f32_16x16x32_bf16 v[100:103], v[84:87], v[68:71], v[100:103]
    v_mfma_f32_16x16x32_bf16 v[100:103], v[88:91], v[72:75], v[100:103]
    v_mfma_f32_16x16x32_bf16 v[100:103], v[92:95], v[76:79], v[100:103]
    s_xor_b32 s40, s40, 24576
    buffer_load_dwordx4 v[80:83], v144, s[28:31], s40 offen offset:0
    buffer_load_dwordx4 v[84:87], v144, s[28:31], s40 offen offset:64
    buffer_load_dwordx4 v[88:91], v144, s[28:31], s40 offen offset:128
    buffer_load_dwordx4 v[92:95], v144, s[28:31], s40 offen offset:192
    s_waitcnt vmcnt(0)
    v_mfma_f32_16x16x32_bf16 v[104:107], v[80:83], v[64:67], 0
    v_mfma_f32_16x16x32_bf16 v[104:107], v[84:87], v[68:71], v[104:107]
    v_mfma_f32_16x16x32_bf16 v[104:107], v[88:91], v[72:75], v[104:107]
    v_mfma_f32_16x16x32_bf16 v[104:107], v[92:95], v[76:79], v[104:107]
    s_xor_b32 s40, s40, 8192
    buffer_load_dwordx4 v[80:83], v144, s[28:31], s40 offen offset:0
    buffer_load_dwordx4 v[84:87], v144, s[28:31], s40 offen offset:64
    buffer_load_dwordx4 v[88:91], v144, s[28:31], s40 offen offset:128
    buffer_load_dwordx4 v[92:95], v144, s[28:31], s40 offen offset:192
    s_waitcnt vmcnt(0)
    v_mfma_f32_16x16x32_bf16 v[108:111], v[80:83], v[64:67], 0
    v_mfma_f32_16x16x32_bf16 v[108:111], v[84:87], v[68:71], v[108:111]
    v_mfma_f32_16x16x32_bf16 v[108:111], v[88:91], v[72:75], v[108:111]
    v_mfma_f32_16x16x32_bf16 v[108:111], v[92:95], v[76:79], v[108:111]
    s_xor_b32 s40, s40, 57344
    buffer_load_dwordx4 v[80:83], v144, s[28:31], s40 offen offset:0
    buffer_load_dwordx4 v[84:87], v144, s[28:31], s40 offen offset:64
    buffer_load_dwordx4 v[88:91], v144, s[28:31], s40 offen offset:128
    buffer_load_dwordx4 v[92:95], v144, s[28:31], s40 offen offset:192
    s_waitcnt vmcnt(0)
    v_mfma_f32_16x16x32_bf16 v[112:115], v[80:83], v[64:67], 0
    v_mfma_f32_16x16x32_bf16 v[112:115], v[84:87], v[68:71], v[112:115]
    v_mfma_f32_16x16x32_bf16 v[112:115], v[88:91], v[72:75], v[112:115]
    v_mfma_f32_16x16x32_bf16 v[112:115], v[92:95], v[76:79], v[112:115]
    s_xor_b32 s40, s40, 8192
    buffer_load_dwordx4 v[80:83], v144, s[28:31], s40 offen offset:0
    buffer_load_dwordx4 v[84:87], v144, s[28:31], s40 offen offset:64
    buffer_load_dwordx4 v[88:91], v144, s[28:31], s40 offen offset:128
    buffer_load_dwordx4 v[92:95], v144, s[28:31], s40 offen offset:192
    s_waitcnt vmcnt(0)
    v_mfma_f32_16x16x32_bf16 v[116:119], v[80:83], v[64:67], 0
    v_mfma_f32_16x16x32_bf16 v[116:119], v[84:87], v[68:71], v[116:119]
    v_mfma_f32_16x16x32_bf16 v[116:119], v[88:91], v[72:75], v[116:119]
    v_mfma_f32_16x16x32_bf16 v[116:119], v[92:95], v[76:79], v[116:119]
    s_xor_b32 s40, s40, 24576
    buffer_load_dwordx4 v[80:83], v144, s[28:31], s40 offen offset:0
    buffer_load_dwordx4 v[84:87], v144, s[28:31], s40 offen offset:64
    buffer_load_dwordx4 v[88:91], v144, s[28:31], s40 offen offset:128
    buffer_load_dwordx4 v[92:95], v144, s[28:31], s40 offen offset:192
    s_waitcnt vmcnt(0)
    v_mfma_f32_16x16x32_bf16 v[120:123], v[80:83], v[64:67], 0
    v_mfma_f32_16x16x32_bf16 v[120:123], v[84:87], v[68:71], v[120:123]
    v_mfma_f32_16x16x32_bf16 v[120:123], v[88:91], v[72:75], v[120:123]
    v_mfma_f32_16x16x32_bf16 v[120:123], v[92:95], v[76:79], v[120:123]
    s_xor_b32 s40, s40, 8192
    buffer_load_dwordx4 v[80:83], v144, s[28:31], s40 offen offset:0
    buffer_load_dwordx4 v[84:87], v144, s[28:31], s40 offen offset:64
    buffer_load_dwordx4 v[88:91], v144, s[28:31], s40 offen offset:128
    buffer_load_dwordx4 v[92:95], v144, s[28:31], s40 offen offset:192
    s_waitcnt vmcnt(0)
    v_mfma_f32_16x16x32_bf16 v[124:127], v[80:83], v[64:67], 0
    v_mfma_f32_16x16x32_bf16 v[124:127], v[84:87], v[68:71], v[124:127]
    v_mfma_f32_16x16x32_bf16 v[124:127], v[88:91], v[72:75], v[124:127]
    v_mfma_f32_16x16x32_bf16 v[124:127], v[92:95], v[76:79], v[124:127]
    v_max_f32 v146, v96, v97
    v_max3_f32 v146, v146, v98, v99
    v_max3_f32 v146, v146, v100, v101
    v_max3_f32 v146, v146, v102, v103
    v_max3_f32 v146, v146, v104, v105
    v_max3_f32 v146, v146, v106, v107
    v_max3_f32 v146, v146, v108, v109
    v_max3_f32 v146, v146, v110, v111
    v_max3_f32 v146, v146, v112, v113
    v_max3_f32 v146, v146, v114, v115
    v_max3_f32 v146, v146, v116, v117
    v_max3_f32 v146, v146, v118, v119
    v_max3_f32 v146, v146, v120, v121
    v_max3_f32 v146, v146, v122, v123
    v_max3_f32 v146, v146, v124, v125
    v_max3_f32 v146, v146, v126, v127
    v_mov_b32 v147, v146
    s_nop 1
    v_permlane32_swap_b32 v146, v147
    v_max_f32 v146, v146, v147
    v_mov_b32 v147, v146
    s_nop 1
    v_permlane16_swap_b32 v146, v147
    v_max_f32 v146, v146, v147
    v_mul_f32 v146, 0xbe0293ee, v146
    v_min_f32 v146, v146, v228
    v_sub_f32 v148, v146, v228
    v_exp_f32 v148, v148
    v_mov_b32 v228, v146
    v_fmamk_f32 v96, v96, 0x3e0293ee, v228
    v_fmamk_f32 v97, v97, 0x3e0293ee, v228
    v_fmamk_f32 v98, v98, 0x3e0293ee, v228
    v_fmamk_f32 v99, v99, 0x3e0293ee, v228
    v_fmamk_f32 v100, v100, 0x3e0293ee, v228
    v_fmamk_f32 v101, v101, 0x3e0293ee, v228
    v_fmamk_f32 v102, v102, 0x3e0293ee, v228
    v_fmamk_f32 v103, v103, 0x3e0293ee, v228
    v_fmamk_f32 v104, v104, 0x3e0293ee, v228
    v_fmamk_f32 v105, v105, 0x3e0293ee, v228
    v_fmamk_f32 v106, v106, 0x3e0293ee, v228
    v_fmamk_f32 v107, v107, 0x3e0293ee, v228
    v_fmamk_f32 v108, v108, 0x3e0293ee, v228
    v_fmamk_f32 v109, v109, 0x3e0293ee, v228
    v_fmamk_f32 v110, v110, 0x3e0293ee, v228
    v_fmamk_f32 v111, v111, 0x3e0293ee, v228
    v_fmamk_f32 v112, v112, 0x3e0293ee, v228
    v_fmamk_f32 v113, v113, 0x3e0293ee, v228
    v_fmamk_f32 v114, v114, 0x3e0293ee, v228
    v_fmamk_f32 v115, v115, 0x3e0293ee, v228
    v_fmamk_f32 v116, v116, 0x3e0293ee, v228
    v_fmamk_f32 v117, v117, 0x3e0293ee, v228
    v_fmamk_f32 v118, v118, 0x3e0293ee, v228
    v_fmamk_f32 v119, v119, 0x3e0293ee, v228
    v_fmamk_f32 v120, v120, 0x3e0293ee, v228
    v_fmamk_f32 v121, v121, 0x3e0293ee, v228
    v_fmamk_f32 v122, v122, 0x3e0293ee, v228
    v_fmamk_f32 v123, v123, 0x3e0293ee, v228
    v_fmamk_f32 v124, v124, 0x3e0293ee, v228
    v_fmamk_f32 v125, v125, 0x3e0293ee, v228
    v_fmamk_f32 v126, v126, 0x3e0293ee, v228
    v_fmamk_f32 v127, v127, 0x3e0293ee, v228
    v_exp_f32 v96, v96
    v_exp_f32 v97, v97
    v_exp_f32 v98, v98
    v_exp_f32 v99, v99
    v_exp_f32 v100, v100
    v_exp_f32 v101, v101
    v_exp_f32 v102, v102
    v_exp_f32 v103, v103
    v_exp_f32 v104, v104
    v_exp_f32 v105, v105
    v_exp_f32 v106, v106
    v_exp_f32 v107, v107
    v_exp_f32 v108, v108
    v_exp_f32 v109, v109
    v_exp_f32 v110, v110
    v_exp_f32 v111, v111
    v_exp_f32 v112, v112
    v_exp_f32 v113, v113
    v_exp_f32 v114, v114
    v_exp_f32 v115, v115
    v_exp_f32 v116, v116
    v_exp_f32 v117, v117
    v_exp_f32 v118, v118
    v_exp_f32 v119, v119
    v_exp_f32 v120, v120
    v_exp_f32 v121, v121
    v_exp_f32 v122, v122
    v_exp_f32 v123, v123
    v_exp_f32 v124, v124
    v_exp_f32 v125, v125
    v_exp_f32 v126, v126
    v_exp_f32 v127, v127
    v_cvt_pk_bf16_f32 v0, v96, v97
    v_cvt_pk_bf16_f32 v1, v98, v99
    v_cvt_pk_bf16_f32 v2, v100, v101
    v_cvt_pk_bf16_f32 v3, v102, v103
    v_cvt_pk_bf16_f32 v16, v104, v105
    v_cvt_pk_bf16_f32 v17, v106, v107
    v_cvt_pk_bf16_f32 v18, v108, v109
    v_cvt_pk_bf16_f32 v19, v110, v111
    v_cvt_pk_bf16_f32 v32, v112, v113
    v_cvt_pk_bf16_f32 v33, v114, v115
    v_cvt_pk_bf16_f32 v34, v116, v117
    v_cvt_pk_bf16_f32 v35, v118, v119
    v_cvt_pk_bf16_f32 v48, v120, v121
    v_cvt_pk_bf16_f32 v49, v122, v123
    v_cvt_pk_bf16_f32 v50, v124, v125
    v_cvt_pk_bf16_f32 v51, v126, v127
    v_mfma_f32_16x16x32_bf16 v[160:163], v[248:251], v[0:3], 0
    v_mfma_f32_16x16x32_bf16 v[160:163], v[248:251], v[16:19], v[160:163]
    v_mfma_f32_16x16x32_bf16 v[160:163], v[248:251], v[32:35], v[160:163]
    v_mfma_f32_16x16x32_bf16 v[160:163], v[248:251], v[48:51], v[160:163]
    s_mov_b32 s28, s4
    s_and_b32 s29, s5, 0xffff
    s_mov_b32 s30, 0x8000000
    s_xor_b32 s40, s39, 4096
    buffer_load_dwordx4 v[64:67], v144, s[28:31], s40 offen offset:0
    buffer_load_dwordx4 v[68:71], v144, s[28:31], s40 offen offset:64
    buffer_load_dwordx4 v[72:75], v144, s[28:31], s40 offen offset:128
    buffer_load_dwordx4 v[76:79], v144, s[28:31], s40 offen offset:192
    s_mov_b32 s28, s6
    s_and_b32 s29, s7, 0xffff
    s_mov_b32 s30, 0x4000000
    s_lshr_b32 s40, s39, 17
    s_lshl_b32 s40, s40, 16
    s_xor_b32 s40, s40, s87
    s_xor_b32 s40, s40, 0
    buffer_load_dwordx4 v[80:83], v144, s[28:31], s40 offen offset:0
    buffer_load_dwordx4 v[84:87], v144, s[28:31], s40 offen offset:64
    buffer_load_dwordx4 v[88:91], v144, s[28:31], s40 offen offset:128
    buffer_load_dwordx4 v[92:95], v144, s[28:31], s40 offen offset:192
    s_waitcnt vmcnt(0)
    v_mfma_f32_16x16x32_bf16 v[96:99], v[80:83], v[64:67], 0
    v_mfma_f32_16x16x32_bf16 v[96:99], v[84:87], v[68:71], v[96:99]
    v_mfma_f32_16x16x32_bf16 v[96:99], v[88:91], v[72:75], v[96:99]
    v_mfma_f32_16x16x32_bf16 v[96:99], v[92:95], v[76:79], v[96:99]
    s_xor_b32 s40, s40, 8192
    buffer_load_dwordx4 v[80:83], v144, s[28:31], s40 offen offset:0
    buffer_load_dwordx4 v[84:87], v144, s[28:31], s40 offen offset:64
    buffer_load_dwordx4 v[88:91], v144, s[28:31], s40 offen offset:128
    buffer_load_dwordx4 v[92:95], v144, s[28:31], s40 offen offset:192
    s_waitcnt vmcnt(0)
    v_mfma_f32_16x16x32_bf16 v[100:103], v[80:83], v[64:67], 0
    v_mfma_f32_16x16x32_bf16 v[100:103], v[84:87], v[68:71], v[100:103]
    v_mfma_f32_16x16x32_bf16 v[100:103], v[88:91], v[72:75], v[100:103]
    v_mfma_f32_16x16x32_bf16 v[100:103], v[92:95], v[76:79], v[100:103]
    s_xor_b32 s40, s40, 24576
    buffer_load_dwordx4 v[80:83], v144, s[28:31], s40 offen offset:0
    buffer_load_dwordx4 v[84:87], v144, s[28:31], s40 offen offset:64
    buffer_load_dwordx4 v[88:91], v144, s[28:31], s40 offen offset:128
    buffer_load_dwordx4 v[92:95], v144, s[28:31], s40 offen offset:192
    s_waitcnt vmcnt(0)
    v_mfma_f32_16x16x32_bf16 v[104:107], v[80:83], v[64:67], 0
    v_mfma_f32_16x16x32_bf16 v[104:107], v[84:87], v[68:71], v[104:107]
    v_mfma_f32_16x16x32_bf16 v[104:107], v[88:91], v[72:75], v[104:107]
    v_mfma_f32_16x16x32_bf16 v[104:107], v[92:95], v[76:79], v[104:107]
    s_xor_b32 s40, s40, 8192
    buffer_load_dwordx4 v[80:83], v144, s[28:31], s40 offen offset:0
    buffer_load_dwordx4 v[84:87], v144, s[28:31], s40 offen offset:64
    buffer_load_dwordx4 v[88:91], v144, s[28:31], s40 offen offset:128
    buffer_load_dwordx4 v[92:95], v144, s[28:31], s40 offen offset:192
    s_waitcnt vmcnt(0)
    v_mfma_f32_16x16x32_bf16 v[108:111], v[80:83], v[64:67], 0
    v_mfma_f32_16x16x32_bf16 v[108:111], v[84:87], v[68:71], v[108:111]
    v_mfma_f32_16x16x32_bf16 v[108:111], v[88:91], v[72:75], v[108:111]
    v_mfma_f32_16x16x32_bf16 v[108:111], v[92:95], v[76:79], v[108:111]
    s_xor_b32 s40, s40, 57344
    buffer_load_dwordx4 v[80:83], v144, s[28:31], s40 offen offset:0
    buffer_load_dwordx4 v[84:87], v144, s[28:31], s40 offen offset:64
    buffer_load_dwordx4 v[88:91], v144, s[28:31], s40 offen offset:128
    buffer_load_dwordx4 v[92:95], v144, s[28:31], s40 offen offset:192
    s_waitcnt vmcnt(0)
    v_mfma_f32_16x16x32_bf16 v[112:115], v[80:83], v[64:67], 0
    v_mfma_f32_16x16x32_bf16 v[112:115], v[84:87], v[68:71], v[112:115]
    v_mfma_f32_16x16x32_bf16 v[112:115], v[88:91], v[72:75], v[112:115]
    v_mfma_f32_16x16x32_bf16 v[112:115], v[92:95], v[76:79], v[112:115]
    s_xor_b32 s40, s40, 8192
    buffer_load_dwordx4 v[80:83], v144, s[28:31], s40 offen offset:0
    buffer_load_dwordx4 v[84:87], v144, s[28:31], s40 offen offset:64
    buffer_load_dwordx4 v[88:91], v144, s[28:31], s40 offen offset:128
    buffer_load_dwordx4 v[92:95], v144, s[28:31], s40 offen offset:192
    s_waitcnt vmcnt(0)
    v_mfma_f32_16x16x32_bf16 v[116:119], v[80:83], v[64:67], 0
    v_mfma_f32_16x16x32_bf16 v[116:119], v[84:87], v[68:71], v[116:119]
    v_mfma_f32_16x16x32_bf16 v[116:119], v[88:91], v[72:75], v[116:119]
    v_mfma_f32_16x16x32_bf16 v[116:119], v[92:95], v[76:79], v[116:119]
    s_xor_b32 s40, s40, 24576
    buffer_load_dwordx4 v[80:83], v144, s[28:31], s40 offen offset:0
    buffer_load_dwordx4 v[84:87], v144, s[28:31], s40 offen offset:64
    buffer_load_dwordx4 v[88:91], v144, s[28:31], s40 offen offset:128
    buffer_load_dwordx4 v[92:95], v144, s[28:31], s40 offen offset:192
    s_waitcnt vmcnt(0)
    v_mfma_f32_16x16x32_bf16 v[120:123], v[80:83], v[64:67], 0
    v_mfma_f32_16x16x32_bf16 v[120:123], v[84:87], v[68:71], v[120:123]
    v_mfma_f32_16x16x32_bf16 v[120:123], v[88:91], v[72:75], v[120:123]
    v_mfma_f32_16x16x32_bf16 v[120:123], v[92:95], v[76:79], v[120:123]
    s_xor_b32 s40, s40, 8192
    buffer_load_dwordx4 v[80:83], v144, s[28:31], s40 offen offset:0
    buffer_load_dwordx4 v[84:87], v144, s[28:31], s40 offen offset:64
    buffer_load_dwordx4 v[88:91], v144, s[28:31], s40 offen offset:128
    buffer_load_dwordx4 v[92:95], v144, s[28:31], s40 offen offset:192
    s_waitcnt vmcnt(0)
    v_mfma_f32_16x16x32_bf16 v[124:127], v[80:83], v[64:67], 0
    v_mfma_f32_16x16x32_bf16 v[124:127], v[84:87], v[68:71], v[124:127]
    v_mfma_f32_16x16x32_bf16 v[124:127], v[88:91], v[72:75], v[124:127]
    v_mfma_f32_16x16x32_bf16 v[124:127], v[92:95], v[76:79], v[124:127]
    v_max_f32 v146, v96, v97
    v_max3_f32 v146, v146, v98, v99
    v_max3_f32 v146, v146, v100, v101
    v_max3_f32 v146, v146, v102, v103
    v_max3_f32 v146, v146, v104, v105
    v_max3_f32 v146, v146, v106, v107
    v_max3_f32 v146, v146, v108, v109
    v_max3_f32 v146, v146, v110, v111
    v_max3_f32 v146, v146, v112, v113
    v_max3_f32 v146, v146, v114, v115
    v_max3_f32 v146, v146, v116, v117
    v_max3_f32 v146, v146, v118, v119
    v_max3_f32 v146, v146, v120, v121
    v_max3_f32 v146, v146, v122, v123
    v_max3_f32 v146, v146, v124, v125
    v_max3_f32 v146, v146, v126, v127
    v_mov_b32 v147, v146
    s_nop 1
    v_permlane32_swap_b32 v146, v147
    v_max_f32 v146, v146, v147
    v_mov_b32 v147, v146
    s_nop 1
    v_permlane16_swap_b32 v146, v147
    v_max_f32 v146, v146, v147
    v_mul_f32 v146, 0xbe0293ee, v146
    v_min_f32 v146, v146, v230
    v_sub_f32 v148, v146, v230
    v_exp_f32 v148, v148
    v_mov_b32 v230, v146
    v_fmamk_f32 v96, v96, 0x3e0293ee, v230
    v_fmamk_f32 v97, v97, 0x3e0293ee, v230
    v_fmamk_f32 v98, v98, 0x3e0293ee, v230
    v_fmamk_f32 v99, v99, 0x3e0293ee, v230
    v_fmamk_f32 v100, v100, 0x3e0293ee, v230
    v_fmamk_f32 v101, v101, 0x3e0293ee, v230
    v_fmamk_f32 v102, v102, 0x3e0293ee, v230
    v_fmamk_f32 v103, v103, 0x3e0293ee, v230
    v_fmamk_f32 v104, v104, 0x3e0293ee, v230
    v_fmamk_f32 v105, v105, 0x3e0293ee, v230
    v_fmamk_f32 v106, v106, 0x3e0293ee, v230
    v_fmamk_f32 v107, v107, 0x3e0293ee, v230
    v_fmamk_f32 v108, v108, 0x3e0293ee, v230
    v_fmamk_f32 v109, v109, 0x3e0293ee, v230
    v_fmamk_f32 v110, v110, 0x3e0293ee, v230
    v_fmamk_f32 v111, v111, 0x3e0293ee, v230
    v_fmamk_f32 v112, v112, 0x3e0293ee, v230
    v_fmamk_f32 v113, v113, 0x3e0293ee, v230
    v_fmamk_f32 v114, v114, 0x3e0293ee, v230
    v_fmamk_f32 v115, v115, 0x3e0293ee, v230
    v_fmamk_f32 v116, v116, 0x3e0293ee, v230
    v_fmamk_f32 v117, v117, 0x3e0293ee, v230
    v_fmamk_f32 v118, v118, 0x3e0293ee, v230
    v_fmamk_f32 v119, v119, 0x3e0293ee, v230
    v_fmamk_f32 v120, v120, 0x3e0293ee, v230
    v_fmamk_f32 v121, v121, 0x3e0293ee, v230
    v_fmamk_f32 v122, v122, 0x3e0293ee, v230
    v_fmamk_f32 v123, v123, 0x3e0293ee, v230
    v_fmamk_f32 v124, v124, 0x3e0293ee, v230
    v_fmamk_f32 v125, v125, 0x3e0293ee, v230
    v_fmamk_f32 v126, v126, 0x3e0293ee, v230
    v_fmamk_f32 v127, v127, 0x3e0293ee, v230
    v_exp_f32 v96, v96
    v_exp_f32 v97, v97
    v_exp_f32 v98, v98
    v_exp_f32 v99, v99
    v_exp_f32 v100, v100
    v_exp_f32 v101, v101
    v_exp_f32 v102, v102
    v_exp_f32 v103, v103
    v_exp_f32 v104, v104
    v_exp_f32 v105, v105
    v_exp_f32 v106, v106
    v_exp_f32 v107, v107
    v_exp_f32 v108, v108
    v_exp_f32 v109, v109
    v_exp_f32 v110, v110
    v_exp_f32 v111, v111
    v_exp_f32 v112, v112
    v_exp_f32 v113, v113
    v_exp_f32 v114, v114
    v_exp_f32 v115, v115
    v_exp_f32 v116, v116
    v_exp_f32 v117, v117
    v_exp_f32 v118, v118
    v_exp_f32 v119, v119
    v_exp_f32 v120, v120
    v_exp_f32 v121, v121
    v_exp_f32 v122, v122
    v_exp_f32 v123, v123
    v_exp_f32 v124, v124
    v_exp_f32 v125, v125
    v_exp_f32 v126, v126
    v_exp_f32 v127, v127
    v_cvt_pk_bf16_f32 v4, v96, v97
    v_cvt_pk_bf16_f32 v5, v98, v99
    v_cvt_pk_bf16_f32 v6, v100, v101
    v_cvt_pk_bf16_f32 v7, v102, v103
    v_cvt_pk_bf16_f32 v20, v104, v105
    v_cvt_pk_bf16_f32 v21, v106, v107
    v_cvt_pk_bf16_f32 v22, v108, v109
    v_cvt_pk_bf16_f32 v23, v110, v111
    v_cvt_pk_bf16_f32 v36, v112, v113
    v_cvt_pk_bf16_f32 v37, v114, v115
    v_cvt_pk_bf16_f32 v38, v116, v117
    v_cvt_pk_bf16_f32 v39, v118, v119
    v_cvt_pk_bf16_f32 v52, v120, v121
    v_cvt_pk_bf16_f32 v53, v122, v123
    v_cvt_pk_bf16_f32 v54, v124, v125
    v_cvt_pk_bf16_f32 v55, v126, v127
    v_mfma_f32_16x16x32_bf16 v[164:167], v[248:251], v[4:7], 0
    v_mfma_f32_16x16x32_bf16 v[164:167], v[248:251], v[20:23], v[164:167]
    v_mfma_f32_16x16x32_bf16 v[164:167], v[248:251], v[36:39], v[164:167]
    v_mfma_f32_16x16x32_bf16 v[164:167], v[248:251], v[52:55], v[164:167]
    s_mov_b32 s28, s4
    s_and_b32 s29, s5, 0xffff
    s_mov_b32 s30, 0x8000000
    s_xor_b32 s40, s39, 16384
    buffer_load_dwordx4 v[64:67], v144, s[28:31], s40 offen offset:0
    buffer_load_dwordx4 v[68:71], v144, s[28:31], s40 offen offset:64
    buffer_load_dwordx4 v[72:75], v144, s[28:31], s40 offen offset:128
    buffer_load_dwordx4 v[76:79], v144, s[28:31], s40 offen offset:192
    s_mov_b32 s28, s6
    s_and_b32 s29, s7, 0xffff
    s_mov_b32 s30, 0x4000000
    s_lshr_b32 s40, s39, 17
    s_lshl_b32 s40, s40, 16
    s_xor_b32 s40, s40, s87
    s_xor_b32 s40, s40, 0
    buffer_load_dwordx4 v[80:83], v144, s[28:31], s40 offen offset:0
    buffer_load_dwordx4 v[84:87], v144, s[28:31], s40 offen offset:64
    buffer_load_dwordx4 v[88:91], v144, s[28:31], s40 offen offset:128
    buffer_load_dwordx4 v[92:95], v144, s[28:31], s40 offen offset:192
    s_waitcnt vmcnt(0)
    v_mfma_f32_16x16x32_bf16 v[96:99], v[80:83], v[64:67], 0
    v_mfma_f32_16x16x32_bf16 v[96:99], v[84:87], v[68:71], v[96:99]
    v_mfma_f32_16x16x32_bf16 v[96:99], v[88:91], v[72:75], v[96:99]
    v_mfma_f32_16x16x32_bf16 v[96:99], v[92:95], v[76:79], v[96:99]
    s_xor_b32 s40, s40, 8192
    buffer_load_dwordx4 v[80:83], v144, s[28:31], s40 offen offset:0
    buffer_load_dwordx4 v[84:87], v144, s[28:31], s40 offen offset:64
    buffer_load_dwordx4 v[88:91], v144, s[28:31], s40 offen offset:128
    buffer_load_dwordx4 v[92:95], v144, s[28:31], s40 offen offset:192
    s_waitcnt vmcnt(0)
    v_mfma_f32_16x16x32_bf16 v[100:103], v[80:83], v[64:67], 0
    v_mfma_f32_16x16x32_bf16 v[100:103], v[84:87], v[68:71], v[100:103]
    v_mfma_f32_16x16x32_bf16 v[100:103], v[88:91], v[72:75], v[100:103]
    v_mfma_f32_16x16x32_bf16 v[100:103], v[92:95], v[76:79], v[100:103]
    s_xor_b32 s40, s40, 24576
    buffer_load_dwordx4 v[80:83], v144, s[28:31], s40 offen offset:0
    buffer_load_dwordx4 v[84:87], v144, s[28:31], s40 offen offset:64
    buffer_load_dwordx4 v[88:91], v144, s[28:31], s40 offen offset:128
    buffer_load_dwordx4 v[92:95], v144, s[28:31], s40 offen offset:192
    s_waitcnt vmcnt(0)
    v_mfma_f32_16x16x32_bf16 v[104:107], v[80:83], v[64:67], 0
    v_mfma_f32_16x16x32_bf16 v[104:107], v[84:87], v[68:71], v[104:107]
    v_mfma_f32_16x16x32_bf16 v[104:107], v[88:91], v[72:75], v[104:107]
    v_mfma_f32_16x16x32_bf16 v[104:107], v[92:95], v[76:79], v[104:107]
    s_xor_b32 s40, s40, 8192
    buffer_load_dwordx4 v[80:83], v144, s[28:31], s40 offen offset:0
    buffer_load_dwordx4 v[84:87], v144, s[28:31], s40 offen offset:64
    buffer_load_dwordx4 v[88:91], v144, s[28:31], s40 offen offset:128
    buffer_load_dwordx4 v[92:95], v144, s[28:31], s40 offen offset:192
    s_waitcnt vmcnt(0)
    v_mfma_f32_16x16x32_bf16 v[108:111], v[80:83], v[64:67], 0
    v_mfma_f32_16x16x32_bf16 v[108:111], v[84:87], v[68:71], v[108:111]
    v_mfma_f32_16x16x32_bf16 v[108:111], v[88:91], v[72:75], v[108:111]
    v_mfma_f32_16x16x32_bf16 v[108:111], v[92:95], v[76:79], v[108:111]
    s_xor_b32 s40, s40, 57344
    buffer_load_dwordx4 v[80:83], v144, s[28:31], s40 offen offset:0
    buffer_load_dwordx4 v[84:87], v144, s[28:31], s40 offen offset:64
    buffer_load_dwordx4 v[88:91], v144, s[28:31], s40 offen offset:128
    buffer_load_dwordx4 v[92:95], v144, s[28:31], s40 offen offset:192
    s_waitcnt vmcnt(0)
    v_mfma_f32_16x16x32_bf16 v[112:115], v[80:83], v[64:67], 0
    v_mfma_f32_16x16x32_bf16 v[112:115], v[84:87], v[68:71], v[112:115]
    v_mfma_f32_16x16x32_bf16 v[112:115], v[88:91], v[72:75], v[112:115]
    v_mfma_f32_16x16x32_bf16 v[112:115], v[92:95], v[76:79], v[112:115]
    s_xor_b32 s40, s40, 8192
    buffer_load_dwordx4 v[80:83], v144, s[28:31], s40 offen offset:0
    buffer_load_dwordx4 v[84:87], v144, s[28:31], s40 offen offset:64
    buffer_load_dwordx4 v[88:91], v144, s[28:31], s40 offen offset:128
    buffer_load_dwordx4 v[92:95], v144, s[28:31], s40 offen offset:192
    s_waitcnt vmcnt(0)
    v_mfma_f32_16x16x32_bf16 v[116:119], v[80:83], v[64:67], 0
    v_mfma_f32_16x16x32_bf16 v[116:119], v[84:87], v[68:71], v[116:119]
    v_mfma_f32_16x16x32_bf16 v[116:119], v[88:91], v[72:75], v[116:119]
    v_mfma_f32_16x16x32_bf16 v[116:119], v[92:95], v[76:79], v[116:119]
    s_xor_b32 s40, s40, 24576
    buffer_load_dwordx4 v[80:83], v144, s[28:31], s40 offen offset:0
    buffer_load_dwordx4 v[84:87], v144, s[28:31], s40 offen offset:64
    buffer_load_dwordx4 v[88:91], v144, s[28:31], s40 offen offset:128
    buffer_load_dwordx4 v[92:95], v144, s[28:31], s40 offen offset:192
    s_waitcnt vmcnt(0)
    v_mfma_f32_16x16x32_bf16 v[120:123], v[80:83], v[64:67], 0
    v_mfma_f32_16x16x32_bf16 v[120:123], v[84:87], v[68:71], v[120:123]
    v_mfma_f32_16x16x32_bf16 v[120:123], v[88:91], v[72:75], v[120:123]
    v_mfma_f32_16x16x32_bf16 v[120:123], v[92:95], v[76:79], v[120:123]
    s_xor_b32 s40, s40, 8192
    buffer_load_dwordx4 v[80:83], v144, s[28:31], s40 offen offset:0
    buffer_load_dwordx4 v[84:87], v144, s[28:31], s40 offen offset:64
    buffer_load_dwordx4 v[88:91], v144, s[28:31], s40 offen offset:128
    buffer_load_dwordx4 v[92:95], v144, s[28:31], s40 offen offset:192
    s_waitcnt vmcnt(0)
    v_mfma_f32_16x16x32_bf16 v[124:127], v[80:83], v[64:67], 0
    v_mfma_f32_16x16x32_bf16 v[124:127], v[84:87], v[68:71], v[124:127]
    v_mfma_f32_16x16x32_bf16 v[124:127], v[88:91], v[72:75], v[124:127]
    v_mfma_f32_16x16x32_bf16 v[124:127], v[92:95], v[76:79], v[124:127]
    v_max_f32 v146, v96, v97
    v_max3_f32 v146, v146, v98, v99
    v_max3_f32 v146, v146, v100, v101
    v_max3_f32 v146, v146, v102, v103
    v_max3_f32 v146, v146, v104, v105
    v_max3_f32 v146, v146, v106, v107
    v_max3_f32 v146, v146, v108, v109
    v_max3_f32 v146, v146, v110, v111
    v_max3_f32 v146, v146, v112, v113
    v_max3_f32 v146, v146, v114, v115
    v_max3_f32 v146, v146, v116, v117
    v_max3_f32 v146, v146, v118, v119
    v_max3_f32 v146, v146, v120, v121
    v_max3_f32 v146, v146, v122, v123
    v_max3_f32 v146, v146, v124, v125
    v_max3_f32 v146, v146, v126, v127
    v_mov_b32 v147, v146
    s_nop 1
    v_permlane32_swap_b32 v146, v147
    v_max_f32 v146, v146, v147
    v_mov_b32 v147, v146
    s_nop 1
    v_permlane16_swap_b32 v146, v147
    v_max_f32 v146, v146, v147
    v_mul_f32 v146, 0xbe0293ee, v146
    v_min_f32 v146, v146, v232
    v_sub_f32 v148, v146, v232
    v_exp_f32 v148, v148
    v_mov_b32 v232, v146
    v_fmamk_f32 v96, v96, 0x3e0293ee, v232
    v_fmamk_f32 v97, v97, 0x3e0293ee, v232
    v_fmamk_f32 v98, v98, 0x3e0293ee, v232
    v_fmamk_f32 v99, v99, 0x3e0293ee, v232
    v_fmamk_f32 v100, v100, 0x3e0293ee, v232
    v_fmamk_f32 v101, v101, 0x3e0293ee, v232
    v_fmamk_f32 v102, v102, 0x3e0293ee, v232
    v_fmamk_f32 v103, v103, 0x3e0293ee, v232
    v_fmamk_f32 v104, v104, 0x3e0293ee, v232
    v_fmamk_f32 v105, v105, 0x3e0293ee, v232
    v_fmamk_f32 v106, v106, 0x3e0293ee, v232
    v_fmamk_f32 v107, v107, 0x3e0293ee, v232
    v_fmamk_f32 v108, v108, 0x3e0293ee, v232
    v_fmamk_f32 v109, v109, 0x3e0293ee, v232
    v_fmamk_f32 v110, v110, 0x3e0293ee, v232
    v_fmamk_f32 v111, v111, 0x3e0293ee, v232
    v_fmamk_f32 v112, v112, 0x3e0293ee, v232
    v_fmamk_f32 v113, v113, 0x3e0293ee, v232
    v_fmamk_f32 v114, v114, 0x3e0293ee, v232
    v_fmamk_f32 v115, v115, 0x3e0293ee, v232
    v_fmamk_f32 v116, v116, 0x3e0293ee, v232
    v_fmamk_f32 v117, v117, 0x3e0293ee, v232
    v_fmamk_f32 v118, v118, 0x3e0293ee, v232
    v_fmamk_f32 v119, v119, 0x3e0293ee, v232
    v_fmamk_f32 v120, v120, 0x3e0293ee, v232
    v_fmamk_f32 v121, v121, 0x3e0293ee, v232
    v_fmamk_f32 v122, v122, 0x3e0293ee, v232
    v_fmamk_f32 v123, v123, 0x3e0293ee, v232
    v_fmamk_f32 v124, v124, 0x3e0293ee, v232
    v_fmamk_f32 v125, v125, 0x3e0293ee, v232
    v_fmamk_f32 v126, v126, 0x3e0293ee, v232
    v_fmamk_f32 v127, v127, 0x3e0293ee, v232
    v_exp_f32 v96, v96
    v_exp_f32 v97, v97
    v_exp_f32 v98, v98
    v_exp_f32 v99, v99
    v_exp_f32 v100, v100
    v_exp_f32 v101, v101
    v_exp_f32 v102, v102
    v_exp_f32 v103, v103
    v_exp_f32 v104, v104
    v_exp_f32 v105, v105
    v_exp_f32 v106, v106
    v_exp_f32 v107, v107
    v_exp_f32 v108, v108
    v_exp_f32 v109, v109
    v_exp_f32 v110, v110
    v_exp_f32 v111, v111
    v_exp_f32 v112, v112
    v_exp_f32 v113, v113
    v_exp_f32 v114, v114
    v_exp_f32 v115, v115
    v_exp_f32 v116, v116
    v_exp_f32 v117, v117
    v_exp_f32 v118, v118
    v_exp_f32 v119, v119
    v_exp_f32 v120, v120
    v_exp_f32 v121, v121
    v_exp_f32 v122, v122
    v_exp_f32 v123, v123
    v_exp_f32 v124, v124
    v_exp_f32 v125, v125
    v_exp_f32 v126, v126
    v_exp_f32 v127, v127
    v_cvt_pk_bf16_f32 v8, v96, v97
    v_cvt_pk_bf16_f32 v9, v98, v99
    v_cvt_pk_bf16_f32 v10, v100, v101
    v_cvt_pk_bf16_f32 v11, v102, v103
    v_cvt_pk_bf16_f32 v24, v104, v105
    v_cvt_pk_bf16_f32 v25, v106, v107
    v_cvt_pk_bf16_f32 v26, v108, v109
    v_cvt_pk_bf16_f32 v27, v110, v111
    v_cvt_pk_bf16_f32 v40, v112, v113
    v_cvt_pk_bf16_f32 v41, v114, v115
    v_cvt_pk_bf16_f32 v42, v116, v117
    v_cvt_pk_bf16_f32 v43, v118, v119
    v_cvt_pk_bf16_f32 v56, v120, v121
    v_cvt_pk_bf16_f32 v57, v122, v123
    v_cvt_pk_bf16_f32 v58, v124, v125
    v_cvt_pk_bf16_f32 v59, v126, v127
    v_mfma_f32_16x16x32_bf16 v[168:171], v[248:251], v[8:11], 0
    v_mfma_f32_16x16x32_bf16 v[168:171], v[248:251], v[24:27], v[168:171]
    v_mfma_f32_16x16x32_bf16 v[168:171], v[248:251], v[40:43], v[168:171]
    v_mfma_f32_16x16x32_bf16 v[168:171], v[248:251], v[56:59], v[168:171]
    s_mov_b32 s28, s4
    s_and_b32 s29, s5, 0xffff
    s_mov_b32 s30, 0x8000000
    s_xor_b32 s40, s39, 20480
    buffer_load_dwordx4 v[64:67], v144, s[28:31], s40 offen offset:0
    buffer_load_dwordx4 v[68:71], v144, s[28:31], s40 offen offset:64
    buffer_load_dwordx4 v[72:75], v144, s[28:31], s40 offen offset:128
    buffer_load_dwordx4 v[76:79], v144, s[28:31], s40 offen offset:192
    s_mov_b32 s28, s6
    s_and_b32 s29, s7, 0xffff
    s_mov_b32 s30, 0x4000000
    s_lshr_b32 s40, s39, 17
    s_lshl_b32 s40, s40, 16
    s_xor_b32 s40, s40, s87
    s_xor_b32 s40, s40, 0
    buffer_load_dwordx4 v[80:83], v144, s[28:31], s40 offen offset:0
    buffer_load_dwordx4 v[84:87], v144, s[28:31], s40 offen offset:64
    buffer_load_dwordx4 v[88:91], v144, s[28:31], s40 offen offset:128
    buffer_load_dwordx4 v[92:95], v144, s[28:31], s40 offen offset:192
    s_waitcnt vmcnt(0)
    v_mfma_f32_16x16x32_bf16 v[96:99], v[80:83], v[64:67], 0
    v_mfma_f32_16x16x32_bf16 v[96:99], v[84:87], v[68:71], v[96:99]
    v_mfma_f32_16x16x32_bf16 v[96:99], v[88:91], v[72:75], v[96:99]
    v_mfma_f32_16x16x32_bf16 v[96:99], v[92:95], v[76:79], v[96:99]
    s_xor_b32 s40, s40, 8192
    buffer_load_dwordx4 v[80:83], v144, s[28:31], s40 offen offset:0
    buffer_load_dwordx4 v[84:87], v144, s[28:31], s40 offen offset:64
    buffer_load_dwordx4 v[88:91], v144, s[28:31], s40 offen offset:128
    buffer_load_dwordx4 v[92:95], v144, s[28:31], s40 offen offset:192
    s_waitcnt vmcnt(0)
    v_mfma_f32_16x16x32_bf16 v[100:103], v[80:83], v[64:67], 0
    v_mfma_f32_16x16x32_bf16 v[100:103], v[84:87], v[68:71], v[100:103]
    v_mfma_f32_16x16x32_bf16 v[100:103], v[88:91], v[72:75], v[100:103]
    v_mfma_f32_16x16x32_bf16 v[100:103], v[92:95], v[76:79], v[100:103]
    s_xor_b32 s40, s40, 24576
    buffer_load_dwordx4 v[80:83], v144, s[28:31], s40 offen offset:0
    buffer_load_dwordx4 v[84:87], v144, s[28:31], s40 offen offset:64
    buffer_load_dwordx4 v[88:91], v144, s[28:31], s40 offen offset:128
    buffer_load_dwordx4 v[92:95], v144, s[28:31], s40 offen offset:192
    s_waitcnt vmcnt(0)
    v_mfma_f32_16x16x32_bf16 v[104:107], v[80:83], v[64:67], 0
    v_mfma_f32_16x16x32_bf16 v[104:107], v[84:87], v[68:71], v[104:107]
    v_mfma_f32_16x16x32_bf16 v[104:107], v[88:91], v[72:75], v[104:107]
    v_mfma_f32_16x16x32_bf16 v[104:107], v[92:95], v[76:79], v[104:107]
    s_xor_b32 s40, s40, 8192
    buffer_load_dwordx4 v[80:83], v144, s[28:31], s40 offen offset:0
    buffer_load_dwordx4 v[84:87], v144, s[28:31], s40 offen offset:64
    buffer_load_dwordx4 v[88:91], v144, s[28:31], s40 offen offset:128
    buffer_load_dwordx4 v[92:95], v144, s[28:31], s40 offen offset:192
    s_waitcnt vmcnt(0)
    v_mfma_f32_16x16x32_bf16 v[108:111], v[80:83], v[64:67], 0
    v_mfma_f32_16x16x32_bf16 v[108:111], v[84:87], v[68:71], v[108:111]
    v_mfma_f32_16x16x32_bf16 v[108:111], v[88:91], v[72:75], v[108:111]
    v_mfma_f32_16x16x32_bf16 v[108:111], v[92:95], v[76:79], v[108:111]
    s_xor_b32 s40, s40, 57344
    buffer_load_dwordx4 v[80:83], v144, s[28:31], s40 offen offset:0
    buffer_load_dwordx4 v[84:87], v144, s[28:31], s40 offen offset:64
    buffer_load_dwordx4 v[88:91], v144, s[28:31], s40 offen offset:128
    buffer_load_dwordx4 v[92:95], v144, s[28:31], s40 offen offset:192
    s_waitcnt vmcnt(0)
    v_mfma_f32_16x16x32_bf16 v[112:115], v[80:83], v[64:67], 0
    v_mfma_f32_16x16x32_bf16 v[112:115], v[84:87], v[68:71], v[112:115]
    v_mfma_f32_16x16x32_bf16 v[112:115], v[88:91], v[72:75], v[112:115]
    v_mfma_f32_16x16x32_bf16 v[112:115], v[92:95], v[76:79], v[112:115]
    s_xor_b32 s40, s40, 8192
    buffer_load_dwordx4 v[80:83], v144, s[28:31], s40 offen offset:0
    buffer_load_dwordx4 v[84:87], v144, s[28:31], s40 offen offset:64
    buffer_load_dwordx4 v[88:91], v144, s[28:31], s40 offen offset:128
    buffer_load_dwordx4 v[92:95], v144, s[28:31], s40 offen offset:192
    s_waitcnt vmcnt(0)
    v_mfma_f32_16x16x32_bf16 v[116:119], v[80:83], v[64:67], 0
    v_mfma_f32_16x16x32_bf16 v[116:119], v[84:87], v[68:71], v[116:119]
    v_mfma_f32_16x16x32_bf16 v[116:119], v[88:91], v[72:75], v[116:119]
    v_mfma_f32_16x16x32_bf16 v[116:119], v[92:95], v[76:79], v[116:119]
    s_xor_b32 s40, s40, 24576
    buffer_load_dwordx4 v[80:83], v144, s[28:31], s40 offen offset:0
    buffer_load_dwordx4 v[84:87], v144, s[28:31], s40 offen offset:64
    buffer_load_dwordx4 v[88:91], v144, s[28:31], s40 offen offset:128
    buffer_load_dwordx4 v[92:95], v144, s[28:31], s40 offen offset:192
    s_waitcnt vmcnt(0)
    v_mfma_f32_16x16x32_bf16 v[120:123], v[80:83], v[64:67], 0
    v_mfma_f32_16x16x32_bf16 v[120:123], v[84:87], v[68:71], v[120:123]
    v_mfma_f32_16x16x32_bf16 v[120:123], v[88:91], v[72:75], v[120:123]
    v_mfma_f32_16x16x32_bf16 v[120:123], v[92:95], v[76:79], v[120:123]
    s_xor_b32 s40, s40, 8192
    buffer_load_dwordx4 v[80:83], v144, s[28:31], s40 offen offset:0
    buffer_load_dwordx4 v[84:87], v144, s[28:31], s40 offen offset:64
    buffer_load_dwordx4 v[88:91], v144, s[28:31], s40 offen offset:128
    buffer_load_dwordx4 v[92:95], v144, s[28:31], s40 offen offset:192
    s_waitcnt vmcnt(0)
    v_mfma_f32_16x16x32_bf16 v[124:127], v[80:83], v[64:67], 0
    v_mfma_f32_16x16x32_bf16 v[124:127], v[84:87], v[68:71], v[124:127]
    v_mfma_f32_16x16x32_bf16 v[124:127], v[88:91], v[72:75], v[124:127]
    v_mfma_f32_16x16x32_bf16 v[124:127], v[92:95], v[76:79], v[124:127]
    v_max_f32 v146, v96, v97
    v_max3_f32 v146, v146, v98, v99
    v_max3_f32 v146, v146, v100, v101
    v_max3_f32 v146, v146, v102, v103
    v_max3_f32 v146, v146, v104, v105
    v_max3_f32 v146, v146, v106, v107
    v_max3_f32 v146, v146, v108, v109
    v_max3_f32 v146, v146, v110, v111
    v_max3_f32 v146, v146, v112, v113
    v_max3_f32 v146, v146, v114, v115
    v_max3_f32 v146, v146, v116, v117
    v_max3_f32 v146, v146, v118, v119
    v_max3_f32 v146, v146, v120, v121
    v_max3_f32 v146, v146, v122, v123
    v_max3_f32 v146, v146, v124, v125
    v_max3_f32 v146, v146, v126, v127
    v_mov_b32 v147, v146
    s_nop 1
    v_permlane32_swap_b32 v146, v147
    v_max_f32 v146, v146, v147
    v_mov_b32 v147, v146
    s_nop 1
    v_permlane16_swap_b32 v146, v147
    v_max_f32 v146, v146, v147
    v_mul_f32 v146, 0xbe0293ee, v146
    v_min_f32 v146, v146, v234
    v_sub_f32 v148, v146, v234
    v_exp_f32 v148, v148
    v_mov_b32 v234, v146
    v_fmamk_f32 v96, v96, 0x3e0293ee, v234
    v_fmamk_f32 v97, v97, 0x3e0293ee, v234
    v_fmamk_f32 v98, v98, 0x3e0293ee, v234
    v_fmamk_f32 v99, v99, 0x3e0293ee, v234
    v_fmamk_f32 v100, v100, 0x3e0293ee, v234
    v_fmamk_f32 v101, v101, 0x3e0293ee, v234
    v_fmamk_f32 v102, v102, 0x3e0293ee, v234
    v_fmamk_f32 v103, v103, 0x3e0293ee, v234
    v_fmamk_f32 v104, v104, 0x3e0293ee, v234
    v_fmamk_f32 v105, v105, 0x3e0293ee, v234
    v_fmamk_f32 v106, v106, 0x3e0293ee, v234
    v_fmamk_f32 v107, v107, 0x3e0293ee, v234
    v_fmamk_f32 v108, v108, 0x3e0293ee, v234
    v_fmamk_f32 v109, v109, 0x3e0293ee, v234
    v_fmamk_f32 v110, v110, 0x3e0293ee, v234
    v_fmamk_f32 v111, v111, 0x3e0293ee, v234
    v_fmamk_f32 v112, v112, 0x3e0293ee, v234
    v_fmamk_f32 v113, v113, 0x3e0293ee, v234
    v_fmamk_f32 v114, v114, 0x3e0293ee, v234
    v_fmamk_f32 v115, v115, 0x3e0293ee, v234
    v_fmamk_f32 v116, v116, 0x3e0293ee, v234
    v_fmamk_f32 v117, v117, 0x3e0293ee, v234
    v_fmamk_f32 v118, v118, 0x3e0293ee, v234
    v_fmamk_f32 v119, v119, 0x3e0293ee, v234
    v_fmamk_f32 v120, v120, 0x3e0293ee, v234
    v_fmamk_f32 v121, v121, 0x3e0293ee, v234
    v_fmamk_f32 v122, v122, 0x3e0293ee, v234
    v_fmamk_f32 v123, v123, 0x3e0293ee, v234
    v_fmamk_f32 v124, v124, 0x3e0293ee, v234
    v_fmamk_f32 v125, v125, 0x3e0293ee, v234
    v_fmamk_f32 v126, v126, 0x3e0293ee, v234
    v_fmamk_f32 v127, v127, 0x3e0293ee, v234
    v_exp_f32 v96, v96
    v_exp_f32 v97, v97
    v_exp_f32 v98, v98
    v_exp_f32 v99, v99
    v_exp_f32 v100, v100
    v_exp_f32 v101, v101
    v_exp_f32 v102, v102
    v_exp_f32 v103, v103
    v_exp_f32 v104, v104
    v_exp_f32 v105, v105
    v_exp_f32 v106, v106
    v_exp_f32 v107, v107
    v_exp_f32 v108, v108
    v_exp_f32 v109, v109
    v_exp_f32 v110, v110
    v_exp_f32 v111, v111
    v_exp_f32 v112, v112
    v_exp_f32 v113, v113
    v_exp_f32 v114, v114
    v_exp_f32 v115, v115
    v_exp_f32 v116, v116
    v_exp_f32 v117, v117
    v_exp_f32 v118, v118
    v_exp_f32 v119, v119
    v_exp_f32 v120, v120
    v_exp_f32 v121, v121
    v_exp_f32 v122, v122
    v_exp_f32 v123, v123
    v_exp_f32 v124, v124
    v_exp_f32 v125, v125
    v_exp_f32 v126, v126
    v_exp_f32 v127, v127
    v_cvt_pk_bf16_f32 v12, v96, v97
    v_cvt_pk_bf16_f32 v13, v98, v99
    v_cvt_pk_bf16_f32 v14, v100, v101
    v_cvt_pk_bf16_f32 v15, v102, v103
    v_cvt_pk_bf16_f32 v28, v104, v105
    v_cvt_pk_bf16_f32 v29, v106, v107
    v_cvt_pk_bf16_f32 v30, v108, v109
    v_cvt_pk_bf16_f32 v31, v110, v111
    v_cvt_pk_bf16_f32 v44, v112, v113
    v_cvt_pk_bf16_f32 v45, v114, v115
    v_cvt_pk_bf16_f32 v46, v116, v117
    v_cvt_pk_bf16_f32 v47, v118, v119
    v_cvt_pk_bf16_f32 v60, v120, v121
    v_cvt_pk_bf16_f32 v61, v122, v123
    v_cvt_pk_bf16_f32 v62, v124, v125
    v_cvt_pk_bf16_f32 v63, v126, v127
    v_mfma_f32_16x16x32_bf16 v[172:175], v[248:251], v[12:15], 0
    v_mfma_f32_16x16x32_bf16 v[172:175], v[248:251], v[28:31], v[172:175]
    v_mfma_f32_16x16x32_bf16 v[172:175], v[248:251], v[44:47], v[172:175]
    v_mfma_f32_16x16x32_bf16 v[172:175], v[248:251], v[60:63], v[172:175]
    s_nop 7
    s_setpc_b64 s[72:73]
L_redo1:
    s_mov_b32 s31, 0x20000
    v_mbcnt_lo_u32_b32 v144, -1, 0
    v_mbcnt_hi_u32_b32 v144, -1, v144
    v_and_b32 v145, 15, v144
    v_and_b32 v144, 48, v144
    v_lshl_add_u32 v144, v145, 8, v144
    s_mov_b32 s28, s4
    s_and_b32 s29, s5, 0xffff
    s_mov_b32 s30, 0x8000000
    s_xor_b32 s40, s39, 0
    buffer_load_dwordx4 v[0:3], v144, s[28:31], s40 offen offset:0
    buffer_load_dwordx4 v[4:7], v144, s[28:31], s40 offen offset:64
    buffer_load_dwordx4 v[8:11], v144, s[28:31], s40 offen offset:128
    buffer_load_dwordx4 v[12:15], v144, s[28:31], s40 offen offset:192
    s_mov_b32 s28, s6
    s_and_b32 s29, s7, 0xffff
    s_mov_b32 s30, 0x4000000
    s_lshr_b32 s40, s39, 17
    s_lshl_b32 s40, s40, 16
    s_xor_b32 s40, s40, s87
    s_xor_b32 s40, s40, 4096
    buffer_load_dwordx4 v[16:19], v144, s[28:31], s40 offen offset:0
    buffer_load_dwordx4 v[20:23], v144, s[28:31], s40 offen offset:64
    buffer_load_dwordx4 v[24:27], v144, s[28:31], s40 offen offset:128
    buffer_load_dwordx4 v[28:31], v144, s[28:31], s40 offen offset:192
    s_waitcnt vmcnt(0)
    v_mfma_f32_16x16x32_bf16 v[32:35], v[16:19], v[0:3], 0
    v_mfma_f32_16x16x32_bf16 v[32:35], v[20:23], v[4:7], v[32:35]
    v_mfma_f32_16x16x32_bf16 v[32:35], v[24:27], v[8:11], v[32:35]
    v_mfma_f32_16x16x32_bf16 v[32:35], v[28:31], v[12:15], v[32:35]
    s_xor_b32 s40, s40, 8192
    buffer_load_dwordx4 v[16:19], v144, s[28:31], s40 offen offset:0
    buffer_load_dwordx4 v[20:23], v144, s[28:31], s40 offen offset:64
    buffer_load_dwordx4 v[24:27], v144, s[28:31], s40 offen offset:128
    buffer_load_dwordx4 v[28:31], v144, s[28:31], s40 offen offset:192
    s_waitcnt vmcnt(0)
    v_mfma_f32_16x16x32_bf16 v[36:39], v[16:19], v[0:3], 0
    v_mfma_f32_16x16x32_bf16 v[36:39], v[20:23], v[4:7], v[36:39]
    v_mfma_f32_16x16x32_bf16 v[36:39], v[24:27], v[8:11], v[36:39]
    v_mfma_f32_16x16x32_bf16 v[36:39], v[28:31], v[12:15], v[36:39]
    s_xor_b32 s40, s40, 24576
    buffer_load_dwordx4 v[16:19], v144, s[28:31], s40 offen offset:0
    buffer_load_dwordx4 v[20:23], v144, s[28:31], s40 offen offset:64
    buffer_load_dwordx4 v[24:27], v144, s[28:31], s40 offen offset:128
    buffer_load_dwordx4 v[28:31], v144, s[28:31], s40 offen offset:192
    s_waitcnt vmcnt(0)
    v_mfma_f32_16x16x32_bf16 v[40:43], v[16:19], v[0:3], 0
    v_mfma_f32_16x16x32_bf16 v[40:43], v[20:23], v[4:7], v[40:43]
    v_mfma_f32_16x16x32_bf16 v[40:43], v[24:27], v[8:11], v[40:43]
    v_mfma_f32_16x16x32_bf16 v[40:43], v[28:31], v[12:15], v[40:43]
    s_xor_b32 s40, s40, 8192
    buffer_load_dwordx4 v[16:19], v144, s[28:31], s40 offen offset:0
    buffer_load_dwordx4 v[20:23], v144, s[28:31], s40 offen offset:64
    buffer_load_dwordx4 v[24:27], v144, s[28:31], s40 offen offset:128
    buffer_load_dwordx4 v[28:31], v144, s[28:31], s40 offen offset:192
    s_waitcnt vmcnt(0)
    v_mfma_f32_16x16x32_bf16 v[44:47], v[16:19], v[0:3], 0
    v_mfma_f32_16x16x32_bf16 v[44:47], v[20:23], v[4:7], v[44:47]
    v_mfma_f32_16x16x32_bf16 v[44:47], v[24:27], v[8:11], v[44:47]
    v_mfma_f32_16x16x32_bf16 v[44:47], v[28:31], v[12:15], v[44:47]
    s_xor_b32 s40, s40, 57344
    buffer_load_dwordx4 v[16:19], v144, s[28:31], s40 offen offset:0
    buffer_load_dwordx4 v[20:23], v144, s[28:31], s40 offen offset:64
    buffer_load_dwordx4 v[24:27], v144, s[28:31], s40 offen offset:128
    buffer_load_dwordx4 v[28:31], v144, s[28:31], s40 offen offset:192
    s_waitcnt vmcnt(0)
    v_mfma_f32_16x16x32_bf16 v[48:51], v[16:19], v[0:3], 0
    v_mfma_f32_16x16x32_bf16 v[48:51], v[20:23], v[4:7], v[48:51]
    v_mfma_f32_16x16x32_bf16 v[48:51], v[24:27], v[8:11], v[48:51]
    v_mfma_f32_16x16x32_bf16 v[48:51], v[28:31], v[12:15], v[48:51]
    s_xor_b32 s40, s40, 8192
    buffer_load_dwordx4 v[16:19], v144, s[28:31], s40 offen offset:0
    buffer_load_dwordx4 v[20:23], v144, s[28:31], s40 offen offset:64
    buffer_load_dwordx4 v[24:27], v144, s[28:31], s40 offen offset:128
    buffer_load_dwordx4 v[28:31], v144, s[28:31], s40 offen offset:192
    s_waitcnt vmcnt(0)
    v_mfma_f32_16x16x32_bf16 v[52:55], v[16:19], v[0:3], 0
    v_mfma_f32_16x16x32_bf16 v[52:55], v[20:23], v[4:7], v[52:55]
    v_mfma_f32_16x16x32_bf16 v[52:55], v[24:27], v[8:11], v[52:55]
    v_mfma_f32_16x16x32_bf16 v[52:55], v[28:31], v[12:15], v[52:55]
    s_xor_b32 s40, s40, 24576
    buffer_load_dwordx4 v[16:19], v144, s[28:31], s40 offen offset:0
    buffer_load_dwordx4 v[20:23], v144, s[28:31], s40 offen offset:64
    buffer_load_dwordx4 v[24:27], v144, s[28:31], s40 offen offset:128
    buffer_load_dwordx4 v[28:31], v144, s[28:31], s40 offen offset:192
    s_waitcnt vmcnt(0)
    v_mfma_f32_16x16x32_bf16 v[56:59], v[16:19], v[0:3], 0
    v_mfma_f32_16x16x32_bf16 v[56:59], v[20:23], v[4:7], v[56:59]
    v_mfma_f32_16x16x32_bf16 v[56:59], v[24:27], v[8:11], v[56:59]
    v_mfma_f32_16x16x32_bf16 v[56:59], v[28:31], v[12:15], v[56:59]
    s_xor_b32 s40, s40, 8192
    buffer_load_dwordx4 v[16:19], v144, s[28:31], s40 offen offset:0
    buffer_load_dwordx4 v[20:23], v144, s[28:31], s40 offen offset:64
    buffer_load_dwordx4 v[24:27], v144, s[28:31], s40 offen offset:128
    buffer_load_dwordx4 v[28:31], v144, s[28:31], s40 offen offset:192
    s_waitcnt vmcnt(0)
    v_mfma_f32_16x16x32_bf16 v[60:63], v[16:19], v[0:3], 0
    v_mfma_f32_16x16x32_bf16 v[60:63], v[20:23], v[4:7], v[60:63]
    v_mfma_f32_16x16x32_bf16 v[60:63], v[24:27], v[8:11], v[60:63]
    v_mfma_f32_16x16x32_bf16 v[60:63], v[28:31], v[12:15], v[60:63]
    v_max_f32 v146, v32, v33
    v_max3_f32 v146, v146, v34, v35
    v_max3_f32 v146, v146, v36, v37
    v_max3_f32 v146, v146, v38, v39
    v_max3_f32 v146, v146, v40, v41
    v_max3_f32 v146, v146, v42, v43
    v_max3_f32 v146, v146, v44, v45
    v_max3_f32 v146, v146, v46, v47
    v_max3_f32 v146, v146, v48, v49
    v_max3_f32 v146, v146, v50, v51
    v_max3_f32 v146, v146, v52, v53
    v_max3_f32 v146, v146, v54, v55
    v_max3_f32 v146, v146, v56, v57
    v_max3_f32 v146, v146, v58, v59
    v_max3_f32 v146, v146, v60, v61
    v_max3_f32 v146, v146, v62, v63
    v_mov_b32 v147, v146
    s_nop 1
    v_permlane32_swap_b32 v146, v147
    v_max_f32 v146, v146, v147
    v_mov_b32 v147, v146
    s_nop 1
    v_permlane16_swap_b32 v146, v147
    v_max_f32 v146, v146, v147
    v_mul_f32 v146, 0xbe0293ee, v146
    v_min_f32 v146, v146, v228
    v_sub_f32 v148, v146, v228
    v_exp_f32 v148, v148
    v_mov_b32 v228, v146
    v_mul_f32 v229, v229, v148
    v_accvgpr_read_b32 v16, a0
    v_accvgpr_read_b32 v17, a1
    v_accvgpr_read_b32 v18, a2
    v_accvgpr_read_b32 v19, a3
    v_accvgpr_read_b32 v20, a4
    v_accvgpr_read_b32 v21, a5
    v_accvgpr_read_b32 v22, a6
    v_accvgpr_read_b32 v23, a7
    v_accvgpr_read_b32 v24, a8
    v_accvgpr_read_b32 v25, a9
    v_accvgpr_read_b32 v26, a10
    v_accvgpr_read_b32 v27, a11
    v_accvgpr_read_b32 v28, a12
    v_accvgpr_read_b32 v29, a13
    v_accvgpr_read_b32 v30, a14
    v_accvgpr_read_b32 v31, a15
    v_mul_f32 v16, v16, v148
    v_mul_f32 v17, v17, v148
    v_mul_f32 v18, v18, v148
    v_mul_f32 v19, v19, v148
    v_mul_f32 v20, v20, v148
    v_mul_f32 v21, v21, v148
    v_mul_f32 v22, v22, v148
    v_mul_f32 v23, v23, v148
    v_mul_f32 v24, v24, v148
    v_mul_f32 v25, v25, v148
    v_mul_f32 v26, v26, v148
    v_mul_f32 v27, v27, v148
    v_mul_f32 v28, v28, v148
    v_mul_f32 v29, v29, v148
    v_mul_f32 v30, v30, v148
    v_mul_f32 v31, v31, v148
    v_accvgpr_write_b32 a0, v16
    v_accvgpr_write_b32 a1, v17
    v_accvgpr_write_b32 a2, v18
    v_accvgpr_write_b32 a3, v19
    v_accvgpr_write_b32 a4, v20
    v_accvgpr_write_b32 a5, v21
    v_accvgpr_write_b32 a6, v22
    v_accvgpr_write_b32 a7, v23
    v_accvgpr_write_b32 a8, v24
    v_accvgpr_write_b32 a9, v25
    v_accvgpr_write_b32 a10, v26
    v_accvgpr_write_b32 a11, v27
    v_accvgpr_write_b32 a12, v28
    v_accvgpr_write_b32 a13, v29
    v_accvgpr_write_b32 a14, v30
    v_accvgpr_write_b32 a15, v31
    v_accvgpr_read_b32 v16, a64
    v_accvgpr_read_b32 v17, a65
    v_accvgpr_read_b32 v18, a66
    v_accvgpr_read_b32 v19, a67
    v_accvgpr_read_b32 v20, a68
    v_accvgpr_read_b32 v21, a69
    v_accvgpr_read_b32 v22, a70
    v_accvgpr_read_b32 v23, a71
    v_accvgpr_read_b32 v24, a72
    v_accvgpr_read_b32 v25, a73
    v_accvgpr_read_b32 v26, a74
    v_accvgpr_read_b32 v27, a75
    v_accvgpr_read_b32 v28, a76
    v_accvgpr_read_b32 v29, a77
    v_accvgpr_read_b32 v30, a78
    v_accvgpr_read_b32 v31, a79
    v_mul_f32 v16, v16, v148
    v_mul_f32 v17, v17, v148
    v_mul_f32 v18, v18, v148
    v_mul_f32 v19, v19, v148
    v_mul_f32 v20, v20, v148
    v_mul_f32 v21, v21, v148
    v_mul_f32 v22, v22, v148
    v_mul_f32 v23, v23, v148
    v_mul_f32 v24, v24, v148
    v_mul_f32 v25, v25, v148
    v_mul_f32 v26, v26, v148
    v_mul_f32 v27, v27, v148
    v_mul_f32 v28, v28, v148
    v_mul_f32 v29, v29, v148
    v_mul_f32 v30, v30, v148
    v_mul_f32 v31, v31, v148
    v_accvgpr_write_b32 a64, v16
    v_accvgpr_write_b32 a65, v17
    v_accvgpr_write_b32 a66, v18
    v_accvgpr_write_b32 a67, v19
    v_accvgpr_write_b32 a68, v20
    v_accvgpr_write_b32 a69, v21
    v_accvgpr_write_b32 a70, v22
    v_accvgpr_write_b32 a71, v23
    v_accvgpr_write_b32 a72, v24
    v_accvgpr_write_b32 a73, v25
    v_accvgpr_write_b32 a74, v26
    v_accvgpr_write_b32 a75, v27
    v_accvgpr_write_b32 a76, v28
    v_accvgpr_write_b32 a77, v29
    v_accvgpr_write_b32 a78, v30
    v_accvgpr_write_b32 a79, v31
    v_fmamk_f32 v32, v32, 0x3e0293ee, v228
    v_fmamk_f32 v33, v33, 0x3e0293ee, v228
    v_fmamk_f32 v34, v34, 0x3e0293ee, v228
    v_fmamk_f32 v35, v35, 0x3e0293ee, v228
    v_fmamk_f32 v36, v36, 0x3e0293ee, v228
    v_fmamk_f32 v37, v37, 0x3e0293ee, v228
    v_fmamk_f32 v38, v38, 0x3e0293ee, v228
    v_fmamk_f32 v39, v39, 0x3e0293ee, v228
    v_fmamk_f32 v40, v40, 0x3e0293ee, v228
    v_fmamk_f32 v41, v41, 0x3e0293ee, v228
    v_fmamk_f32 v42, v42, 0x3e0293ee, v228
    v_fmamk_f32 v43, v43, 0x3e0293ee, v228
    v_fmamk_f32 v44, v44, 0x3e0293ee, v228
    v_fmamk_f32 v45, v45, 0x3e0293ee, v228
    v_fmamk_f32 v46, v46, 0x3e0293ee, v228
    v_fmamk_f32 v47, v47, 0x3e0293ee, v228
    v_fmamk_f32 v48, v48, 0x3e0293ee, v228
    v_fmamk_f32 v49, v49, 0x3e0293ee, v228
    v_fmamk_f32 v50, v50, 0x3e0293ee, v228
    v_fmamk_f32 v51, v51, 0x3e0293ee, v228
    v_fmamk_f32 v52, v52, 0x3e0293ee, v228
    v_fmamk_f32 v53, v53, 0x3e0293ee, v228
    v_fmamk_f32 v54, v54, 0x3e0293ee, v228
    v_fmamk_f32 v55, v55, 0x3e0293ee, v228
    v_fmamk_f32 v56, v56, 0x3e0293ee, v228
    v_fmamk_f32 v57, v57, 0x3e0293ee, v228
    v_fmamk_f32 v58, v58, 0x3e0293ee, v228
    v_fmamk_f32 v59, v59, 0x3e0293ee, v228
    v_fmamk_f32 v60, v60, 0x3e0293ee, v228
    v_fmamk_f32 v61, v61, 0x3e0293ee, v228
    v_fmamk_f32 v62, v62, 0x3e0293ee, v228
    v_fmamk_f32 v63, v63, 0x3e0293ee, v228
    v_exp_f32 v32, v32
    v_exp_f32 v33, v33
    v_exp_f32 v34, v34
    v_exp_f32 v35, v35
    v_exp_f32 v36, v36
    v_exp_f32 v37, v37
    v_exp_f32 v38, v38
    v_exp_f32 v39, v39
    v_exp_f32 v40, v40
    v_exp_f32 v41, v41
    v_exp_f32 v42, v42
    v_exp_f32 v43, v43
    v_exp_f32 v44, v44
    v_exp_f32 v45, v45
    v_exp_f32 v46, v46
    v_exp_f32 v47, v47
    v_exp_f32 v48, v48
    v_exp_f32 v49, v49
    v_exp_f32 v50, v50
    v_exp_f32 v51, v51
    v_exp_f32 v52, v52
    v_exp_f32 v53, v53
    v_exp_f32 v54, v54
    v_exp_f32 v55, v55
    v_exp_f32 v56, v56
    v_exp_f32 v57, v57
    v_exp_f32 v58, v58
    v_exp_f32 v59, v59
    v_exp_f32 v60, v60
    v_exp_f32 v61, v61
    v_exp_f32 v62, v62
    v_exp_f32 v63, v63
    v_cvt_pk_bf16_f32 v64, v32, v33
    v_cvt_pk_bf16_f32 v65, v34, v35
    v_cvt_pk_bf16_f32 v66, v36, v37
    v_cvt_pk_bf16_f32 v67, v38, v39
    v_cvt_pk_bf16_f32 v80, v40, v41
    v_cvt_pk_bf16_f32 v81, v42, v43
    v_cvt_pk_bf16_f32 v82, v44, v45
    v_cvt_pk_bf16_f32 v83, v46, v47
    v_cvt_pk_bf16_f32 v96, v48, v49
    v_cvt_pk_bf16_f32 v97, v50, v51
    v_cvt_pk_bf16_f32 v98, v52, v53
    v_cvt_pk_bf16_f32 v99, v54, v55
    v_cvt_pk_bf16_f32 v112, v56, v57
    v_cvt_pk_bf16_f32 v113, v58, v59
    v_cvt_pk_bf16_f32 v114, v60, v61
    v_cvt_pk_bf16_f32 v115, v62, v63
    v_mfma_f32_16x16x32_bf16 v[160:163], v[248:251], v[64:67], 0
    v_mfma_f32_16x16x32_bf16 v[160:163], v[248:251], v[80:83], v[160:163]
    v_mfma_f32_16x16x32_bf16 v[160:163], v[248:251], v[96:99], v[160:163]
    v_mfma_f32_16x16x32_bf16 v[160:163], v[248:251], v[112:115], v[160:163]
    s_mov_b32 s28, s4
    s_and_b32 s29, s5, 0xffff
    s_mov_b32 s30, 0x8000000
    s_xor_b32 s40, s39, 4096
    buffer_load_dwordx4 v[0:3], v144, s[28:31], s40 offen offset:0
    buffer_load_dwordx4 v[4:7], v144, s[28:31], s40 offen offset:64
    buffer_load_dwordx4 v[8:11], v144, s[28:31], s40 offen offset:128
    buffer_load_dwordx4 v[12:15], v144, s[28:31], s40 offen offset:192
    s_mov_b32 s28, s6
    s_and_b32 s29, s7, 0xffff
    s_mov_b32 s30, 0x4000000
    s_lshr_b32 s40, s39, 17
    s_lshl_b32 s40, s40, 16
    s_xor_b32 s40, s40, s87
    s_xor_b32 s40, s40, 4096
    buffer_load_dwordx4 v[16:19], v144, s[28:31], s40 offen offset:0
    buffer_load_dwordx4 v[20:23], v144, s[28:31], s40 offen offset:64
    buffer_load_dwordx4 v[24:27], v144, s[28:31], s40 offen offset:128
    buffer_load_dwordx4 v[28:31], v144, s[28:31], s40 offen offset:192
    s_waitcnt vmcnt(0)
    v_mfma_f32_16x16x32_bf16 v[32:35], v[16:19], v[0:3], 0
    v_mfma_f32_16x16x32_bf16 v[32:35], v[20:23], v[4:7], v[32:35]
    v_mfma_f32_16x16x32_bf16 v[32:35], v[24:27], v[8:11], v[32:35]
    v_mfma_f32_16x16x32_bf16 v[32:35], v[28:31], v[12:15], v[32:35]
    s_xor_b32 s40, s40, 8192
    buffer_load_dwordx4 v[16:19], v144, s[28:31], s40 offen offset:0
    buffer_load_dwordx4 v[20:23], v144, s[28:31], s40 offen offset:64
    buffer_load_dwordx4 v[24:27], v144, s[28:31], s40 offen offset:128
    buffer_load_dwordx4 v[28:31], v144, s[28:31], s40 offen offset:192
    s_waitcnt vmcnt(0)
    v_mfma_f32_16x16x32_bf16 v[36:39], v[16:19], v[0:3], 0
    v_mfma_f32_16x16x32_bf16 v[36:39], v[20:23], v[4:7], v[36:39]
    v_mfma_f32_16x16x32_bf16 v[36:39], v[24:27], v[8:11], v[36:39]
    v_mfma_f32_16x16x32_bf16 v[36:39], v[28:31], v[12:15], v[36:39]
    s_xor_b32 s40, s40, 24576
    buffer_load_dwordx4 v[16:19], v144, s[28:31], s40 offen offset:0
    buffer_load_dwordx4 v[20:23], v144, s[28:31], s40 offen offset:64
    buffer_load_dwordx4 v[24:27], v144, s[28:31], s40 offen offset:128
    buffer_load_dwordx4 v[28:31], v144, s[28:31], s40 offen offset:192
    s_waitcnt vmcnt(0)
    v_mfma_f32_16x16x32_bf16 v[40:43], v[16:19], v[0:3], 0
    v_mfma_f32_16x16x32_bf16 v[40:43], v[20:23], v[4:7], v[40:43]
    v_mfma_f32_16x16x32_bf16 v[40:43], v[24:27], v[8:11], v[40:43]
    v_mfma_f32_16x16x32_bf16 v[40:43], v[28:31], v[12:15], v[40:43]
    s_xor_b32 s40, s40, 8192
    buffer_load_dwordx4 v[16:19], v144, s[28:31], s40 offen offset:0
    buffer_load_dwordx4 v[20:23], v144, s[28:31], s40 offen offset:64
    buffer_load_dwordx4 v[24:27], v144, s[28:31], s40 offen offset:128
    buffer_load_dwordx4 v[28:31], v144, s[28:31], s40 offen offset:192
    s_waitcnt vmcnt(0)
    v_mfma_f32_16x16x32_bf16 v[44:47], v[16:19], v[0:3], 0
    v_mfma_f32_16x16x32_bf16 v[44:47], v[20:23], v[4:7], v[44:47]
    v_mfma_f32_16x16x32_bf16 v[44:47], v[24:27], v[8:11], v[44:47]
    v_mfma_f32_16x16x32_bf16 v[44:47], v[28:31], v[12:15], v[44:47]
    s_xor_b32 s40, s40, 57344
    buffer_load_dwordx4 v[16:19], v144, s[28:31], s40 offen offset:0
    buffer_load_dwordx4 v[20:23], v144, s[28:31], s40 offen offset:64
    buffer_load_dwordx4 v[24:27], v144, s[28:31], s40 offen offset:128
    buffer_load_dwordx4 v[28:31], v144, s[28:31], s40 offen offset:192
    s_waitcnt vmcnt(0)
    v_mfma_f32_16x16x32_bf16 v[48:51], v[16:19], v[0:3], 0
    v_mfma_f32_16x16x32_bf16 v[48:51], v[20:23], v[4:7], v[48:51]
    v_mfma_f32_16x16x32_bf16 v[48:51], v[24:27], v[8:11], v[48:51]
    v_mfma_f32_16x16x32_bf16 v[48:51], v[28:31], v[12:15], v[48:51]
    s_xor_b32 s40, s40, 8192
    buffer_load_dwordx4 v[16:19], v144, s[28:31], s40 offen offset:0
    buffer_load_dwordx4 v[20:23], v144, s[28:31], s40 offen offset:64
    buffer_load_dwordx4 v[24:27], v144, s[28:31], s40 offen offset:128
    buffer_load_dwordx4 v[28:31], v144, s[28:31], s40 offen offset:192
    s_waitcnt vmcnt(0)
    v_mfma_f32_16x16x32_bf16 v[52:55], v[16:19], v[0:3], 0
    v_mfma_f32_16x16x32_bf16 v[52:55], v[20:23], v[4:7], v[52:55]
    v_mfma_f32_16x16x32_bf16 v[52:55], v[24:27], v[8:11], v[52:55]
    v_mfma_f32_16x16x32_bf16 v[52:55], v[28:31], v[12:15], v[52:55]
    s_xor_b32 s40, s40, 24576
    buffer_load_dwordx4 v[16:19], v144, s[28:31], s40 offen offset:0
    buffer_load_dwordx4 v[20:23], v144, s[28:31], s40 offen offset:64
    buffer_load_dwordx4 v[24:27], v144, s[28:31], s40 offen offset:128
    buffer_load_dwordx4 v[28:31], v144, s[28:31], s40 offen offset:192
    s_waitcnt vmcnt(0)
    v_mfma_f32_16x16x32_bf16 v[56:59], v[16:19], v[0:3], 0
    v_mfma_f32_16x16x32_bf16 v[56:59], v[20:23], v[4:7], v[56:59]
    v_mfma_f32_16x16x32_bf16 v[56:59], v[24:27], v[8:11], v[56:59]
    v_mfma_f32_16x16x32_bf16 v[56:59], v[28:31], v[12:15], v[56:59]
    s_xor_b32 s40, s40, 8192
    buffer_load_dwordx4 v[16:19], v144, s[28:31], s40 offen offset:0
    buffer_load_dwordx4 v[20:23], v144, s[28:31], s40 offen offset:64
    buffer_load_dwordx4 v[24:27], v144, s[28:31], s40 offen offset:128
    buffer_load_dwordx4 v[28:31], v144, s[28:31], s40 offen offset:192
    s_waitcnt vmcnt(0)
    v_mfma_f32_16x16x32_bf16 v[60:63], v[16:19], v[0:3], 0
    v_mfma_f32_16x16x32_bf16 v[60:63], v[20:23], v[4:7], v[60:63]
    v_mfma_f32_16x16x32_bf16 v[60:63], v[24:27], v[8:11], v[60:63]
    v_mfma_f32_16x16x32_bf16 v[60:63], v[28:31], v[12:15], v[60:63]
    v_max_f32 v146, v32, v33
    v_max3_f32 v146, v146, v34, v35
    v_max3_f32 v146, v146, v36, v37
    v_max3_f32 v146, v146, v38, v39
    v_max3_f32 v146, v146, v40, v41
    v_max3_f32 v146, v146, v42, v43
    v_max3_f32 v146, v146, v44, v45
    v_max3_f32 v146, v146, v46, v47
    v_max3_f32 v146, v146, v48, v49
    v_max3_f32 v146, v146, v50, v51
    v_max3_f32 v146, v146, v52, v53
    v_max3_f32 v146, v146, v54, v55
    v_max3_f32 v146, v146, v56, v57
    v_max3_f32 v146, v146, v58, v59
    v_max3_f32 v146, v146, v60, v61
    v_max3_f32 v146, v146, v62, v63
    v_mov_b32 v147, v146
    s_nop 1
    v_permlane32_swap_b32 v146, v147
    v_max_f32 v146, v146, v147
    v_mov_b32 v147, v146
    s_nop 1
    v_permlane16_swap_b32 v146, v147
    v_max_f32 v146, v146, v147
    v_mul_f32 v146, 0xbe0293ee, v146
    v_min_f32 v146, v146, v230
    v_sub_f32 v148, v146, v230
    v_exp_f32 v148, v148
    v_mov_b32 v230, v146
    v_mul_f32 v231, v231, v148
    v_accvgpr_read_b32 v16, a16
    v_accvgpr_read_b32 v17, a17
    v_accvgpr_read_b32 v18, a18
    v_accvgpr_read_b32 v19, a19
    v_accvgpr_read_b32 v20, a20
    v_accvgpr_read_b32 v21, a21
    v_accvgpr_read_b32 v22, a22
    v_accvgpr_read_b32 v23, a23
    v_accvgpr_read_b32 v24, a24
    v_accvgpr_read_b32 v25, a25
    v_accvgpr_read_b32 v26, a26
    v_accvgpr_read_b32 v27, a27
    v_accvgpr_read_b32 v28, a28
    v_accvgpr_read_b32 v29, a29
    v_accvgpr_read_b32 v30, a30
    v_accvgpr_read_b32 v31, a31
    v_mul_f32 v16, v16, v148
    v_mul_f32 v17, v17, v148
    v_mul_f32 v18, v18, v148
    v_mul_f32 v19, v19, v148
    v_mul_f32 v20, v20, v148
    v_mul_f32 v21, v21, v148
    v_mul_f32 v22, v22, v148
    v_mul_f32 v23, v23, v148
    v_mul_f32 v24, v24, v148
    v_mul_f32 v25, v25, v148
    v_mul_f32 v26, v26, v148
    v_mul_f32 v27, v27, v148
    v_mul_f32 v28, v28, v148
    v_mul_f32 v29, v29, v148
    v_mul_f32 v30, v30, v148
    v_mul_f32 v31, v31, v148
    v_accvgpr_write_b32 a16, v16
    v_accvgpr_write_b32 a17, v17
    v_accvgpr_write_b32 a18, v18
    v_accvgpr_write_b32 a19, v19
    v_accvgpr_write_b32 a20, v20
    v_accvgpr_write_b32 a21, v21
    v_accvgpr_write_b32 a22, v22
    v_accvgpr_write_b32 a23, v23
    v_accvgpr_write_b32 a24, v24
    v_accvgpr_write_b32 a25, v25
    v_accvgpr_write_b32 a26, v26
    v_accvgpr_write_b32 a27, v27
    v_accvgpr_write_b32 a28, v28
    v_accvgpr_write_b32 a29, v29
    v_accvgpr_write_b32 a30, v30
    v_accvgpr_write_b32 a31, v31
    v_accvgpr_read_b32 v16, a80
    v_accvgpr_read_b32 v17, a81
    v_accvgpr_read_b32 v18, a82
    v_accvgpr_read_b32 v19, a83
    v_accvgpr_read_b32 v20, a84
    v_accvgpr_read_b32 v21, a85
    v_accvgpr_read_b32 v22, a86
    v_accvgpr_read_b32 v23, a87
    v_accvgpr_read_b32 v24, a88
    v_accvgpr_read_b32 v25, a89
    v_accvgpr_read_b32 v26, a90
    v_accvgpr_read_b32 v27, a91
    v_accvgpr_read_b32 v28, a92
    v_accvgpr_read_b32 v29, a93
    v_accvgpr_read_b32 v30, a94
    v_accvgpr_read_b32 v31, a95
    v_mul_f32 v16, v16, v148
    v_mul_f32 v17, v17, v148
    v_mul_f32 v18, v18, v148
    v_mul_f32 v19, v19, v148
    v_mul_f32 v20, v20, v148
    v_mul_f32 v21, v21, v148
    v_mul_f32 v22, v22, v148
    v_mul_f32 v23, v23, v148
    v_mul_f32 v24, v24, v148
    v_mul_f32 v25, v25, v148
    v_mul_f32 v26, v26, v148
    v_mul_f32 v27, v27, v148
    v_mul_f32 v28, v28, v148
    v_mul_f32 v29, v29, v148
    v_mul_f32 v30, v30, v148
    v_mul_f32 v31, v31, v148
    v_accvgpr_write_b32 a80, v16
    v_accvgpr_write_b32 a81, v17
    v_accvgpr_write_b32 a82, v18
    v_accvgpr_write_b32 a83, v19
    v_accvgpr_write_b32 a84, v20
    v_accvgpr_write_b32 a85, v21
    v_accvgpr_write_b32 a86, v22
    v_accvgpr_write_b32 a87, v23
    v_accvgpr_write_b32 a88, v24
    v_accvgpr_write_b32 a89, v25
    v_accvgpr_write_b32 a90, v26
    v_accvgpr_write_b32 a91, v27
    v_accvgpr_write_b32 a92, v28
    v_accvgpr_write_b32 a93, v29
    v_accvgpr_write_b32 a94, v30
    v_accvgpr_write_b32 a95, v31
    v_fmamk_f32 v32, v32, 0x3e0293ee, v230
    v_fmamk_f32 v33, v33, 0x3e0293ee, v230
    v_fmamk_f32 v34, v34, 0x3e0293ee, v230
    v_fmamk_f32 v35, v35, 0x3e0293ee, v230
    v_fmamk_f32 v36, v36, 0x3e0293ee, v230
    v_fmamk_f32 v37, v37, 0x3e0293ee, v230
    v_fmamk_f32 v38, v38, 0x3e0293ee, v230
    v_fmamk_f32 v39, v39, 0x3e0293ee, v230
    v_fmamk_f32 v40, v40, 0x3e0293ee, v230
    v_fmamk_f32 v41, v41, 0x3e0293ee, v230
    v_fmamk_f32 v42, v42, 0x3e0293ee, v230
    v_fmamk_f32 v43, v43, 0x3e0293ee, v230
    v_fmamk_f32 v44, v44, 0x3e0293ee, v230
    v_fmamk_f32 v45, v45, 0x3e0293ee, v230
    v_fmamk_f32 v46, v46, 0x3e0293ee, v230
    v_fmamk_f32 v47, v47, 0x3e0293ee, v230
    v_fmamk_f32 v48, v48, 0x3e0293ee, v230
    v_fmamk_f32 v49, v49, 0x3e0293ee, v230
    v_fmamk_f32 v50, v50, 0x3e0293ee, v230
    v_fmamk_f32 v51, v51, 0x3e0293ee, v230
    v_fmamk_f32 v52, v52, 0x3e0293ee, v230
    v_fmamk_f32 v53, v53, 0x3e0293ee, v230
    v_fmamk_f32 v54, v54, 0x3e0293ee, v230
    v_fmamk_f32 v55, v55, 0x3e0293ee, v230
    v_fmamk_f32 v56, v56, 0x3e0293ee, v230
    v_fmamk_f32 v57, v57, 0x3e0293ee, v230
    v_fmamk_f32 v58, v58, 0x3e0293ee, v230
    v_fmamk_f32 v59, v59, 0x3e0293ee, v230
    v_fmamk_f32 v60, v60, 0x3e0293ee, v230
    v_fmamk_f32 v61, v61, 0x3e0293ee, v230
    v_fmamk_f32 v62, v62, 0x3e0293ee, v230
    v_fmamk_f32 v63, v63, 0x3e0293ee, v230
    v_exp_f32 v32, v32
    v_exp_f32 v33, v33
    v_exp_f32 v34, v34
    v_exp_f32 v35, v35
    v_exp_f32 v36, v36
    v_exp_f32 v37, v37
    v_exp_f32 v38, v38
    v_exp_f32 v39, v39
    v_exp_f32 v40, v40
    v_exp_f32 v41, v41
    v_exp_f32 v42, v42
    v_exp_f32 v43, v43
    v_exp_f32 v44, v44
    v_exp_f32 v45, v45
    v_exp_f32 v46, v46
    v_exp_f32 v47, v47
    v_exp_f32 v48, v48
    v_exp_f32 v49, v49
    v_exp_f32 v50, v50
    v_exp_f32 v51, v51
    v_exp_f32 v52, v52
    v_exp_f32 v53, v53
    v_exp_f32 v54, v54
    v_exp_f32 v55, v55
    v_exp_f32 v56, v56
    v_exp_f32 v57, v57
    v_exp_f32 v58, v58
    v_exp_f32 v59, v59
    v_exp_f32 v60, v60
    v_exp_f32 v61, v61
    v_exp_f32 v62, v62
    v_exp_f32 v63, v63
    v_cvt_pk_bf16_f32 v68, v32, v33
    v_cvt_pk_bf16_f32 v69, v34, v35
    v_cvt_pk_bf16_f32 v70, v36, v37
    v_cvt_pk_bf16_f32 v71, v38, v39
    v_cvt_pk_bf16_f32 v84, v40, v41
    v_cvt_pk_bf16_f32 v85, v42, v43
    v_cvt_pk_bf16_f32 v86, v44, v45
    v_cvt_pk_bf16_f32 v87, v46, v47
    v_cvt_pk_bf16_f32 v100, v48, v49
    v_cvt_pk_bf16_f32 v101, v50, v51
    v_cvt_pk_bf16_f32 v102, v52, v53
    v_cvt_pk_bf16_f32 v103, v54, v55
    v_cvt_pk_bf16_f32 v116, v56, v57
    v_cvt_pk_bf16_f32 v117, v58, v59
    v_cvt_pk_bf16_f32 v118, v60, v61
    v_cvt_pk_bf16_f32 v119, v62, v63
    v_mfma_f32_16x16x32_bf16 v[164:167], v[248:251], v[68:71], 0
    v_mfma_f32_16x16x32_bf16 v[164:167], v[248:251], v[84:87], v[164:167]
    v_mfma_f32_16x16x32_bf16 v[164:167], v[248:251], v[100:103], v[164:167]
    v_mfma_f32_16x16x32_bf16 v[164:167], v[248:251], v[116:119], v[164:167]
    s_mov_b32 s28, s4
    s_and_b32 s29, s5, 0xffff
    s_mov_b32 s30, 0x8000000
    s_xor_b32 s40, s39, 16384
    buffer_load_dwordx4 v[0:3], v144, s[28:31], s40 offen offset:0
    buffer_load_dwordx4 v[4:7], v144, s[28:31], s40 offen offset:64
    buffer_load_dwordx4 v[8:11], v144, s[28:31], s40 offen offset:128
    buffer_load_dwordx4 v[12:15], v144, s[28:31], s40 offen offset:192
    s_mov_b32 s28, s6
    s_and_b32 s29, s7, 0xffff
    s_mov_b32 s30, 0x4000000
    s_lshr_b32 s40, s39, 17
    s_lshl_b32 s40, s40, 16
    s_xor_b32 s40, s40, s87
    s_xor_b32 s40, s40, 4096
    buffer_load_dwordx4 v[16:19], v144, s[28:31], s40 offen offset:0
    buffer_load_dwordx4 v[20:23], v144, s[28:31], s40 offen offset:64
    buffer_load_dwordx4 v[24:27], v144, s[28:31], s40 offen offset:128
    buffer_load_dwordx4 v[28:31], v144, s[28:31], s40 offen offset:192
    s_waitcnt vmcnt(0)
    v_mfma_f32_16x16x32_bf16 v[32:35], v[16:19], v[0:3], 0
    v_mfma_f32_16x16x32_bf16 v[32:35], v[20:23], v[4:7], v[32:35]
    v_mfma_f32_16x16x32_bf16 v[32:35], v[24:27], v[8:11], v[32:35]
    v_mfma_f32_16x16x32_bf16 v[32:35], v[28:31], v[12:15], v[32:35]
    s_xor_b32 s40, s40, 8192
    buffer_load_dwordx4 v[16:19], v144, s[28:31], s40 offen offset:0
    buffer_load_dwordx4 v[20:23], v144, s[28:31], s40 offen offset:64
    buffer_load_dwordx4 v[24:27], v144, s[28:31], s40 offen offset:128
    buffer_load_dwordx4 v[28:31], v144, s[28:31], s40 offen offset:192
    s_waitcnt vmcnt(0)
    v_mfma_f32_16x16x32_bf16 v[36:39], v[16:19], v[0:3], 0
    v_mfma_f32_16x16x32_bf16 v[36:39], v[20:23], v[4:7], v[36:39]
    v_mfma_f32_16x16x32_bf16 v[36:39], v[24:27], v[8:11], v[36:39]
    v_mfma_f32_16x16x32_bf16 v[36:39], v[28:31], v[12:15], v[36:39]
    s_xor_b32 s40, s40, 24576
    buffer_load_dwordx4 v[16:19], v144, s[28:31], s40 offen offset:0
    buffer_load_dwordx4 v[20:23], v144, s[28:31], s40 offen offset:64
    buffer_load_dwordx4 v[24:27], v144, s[28:31], s40 offen offset:128
    buffer_load_dwordx4 v[28:31], v144, s[28:31], s40 offen offset:192
    s_waitcnt vmcnt(0)
    v_mfma_f32_16x16x32_bf16 v[40:43], v[16:19], v[0:3], 0
    v_mfma_f32_16x16x32_bf16 v[40:43], v[20:23], v[4:7], v[40:43]
    v_mfma_f32_16x16x32_bf16 v[40:43], v[24:27], v[8:11], v[40:43]
    v_mfma_f32_16x16x32_bf16 v[40:43], v[28:31], v[12:15], v[40:43]
    s_xor_b32 s40, s40, 8192
    buffer_load_dwordx4 v[16:19], v144, s[28:31], s40 offen offset:0
    buffer_load_dwordx4 v[20:23], v144, s[28:31], s40 offen offset:64
    buffer_load_dwordx4 v[24:27], v144, s[28:31], s40 offen offset:128
    buffer_load_dwordx4 v[28:31], v144, s[28:31], s40 offen offset:192
    s_waitcnt vmcnt(0)
    v_mfma_f32_16x16x32_bf16 v[44:47], v[16:19], v[0:3], 0
    v_mfma_f32_16x16x32_bf16 v[44:47], v[20:23], v[4:7], v[44:47]
    v_mfma_f32_16x16x32_bf16 v[44:47], v[24:27], v[8:11], v[44:47]
    v_mfma_f32_16x16x32_bf16 v[44:47], v[28:31], v[12:15], v[44:47]
    s_xor_b32 s40, s40, 57344
    buffer_load_dwordx4 v[16:19], v144, s[28:31], s40 offen offset:0
    buffer_load_dwordx4 v[20:23], v144, s[28:31], s40 offen offset:64
    buffer_load_dwordx4 v[24:27], v144, s[28:31], s40 offen offset:128
    buffer_load_dwordx4 v[28:31], v144, s[28:31], s40 offen offset:192
    s_waitcnt vmcnt(0)
    v_mfma_f32_16x16x32_bf16 v[48:51], v[16:19], v[0:3], 0
    v_mfma_f32_16x16x32_bf16 v[48:51], v[20:23], v[4:7], v[48:51]
    v_mfma_f32_16x16x32_bf16 v[48:51], v[24:27], v[8:11], v[48:51]
    v_mfma_f32_16x16x32_bf16 v[48:51], v[28:31], v[12:15], v[48:51]
    s_xor_b32 s40, s40, 8192
    buffer_load_dwordx4 v[16:19], v144, s[28:31], s40 offen offset:0
    buffer_load_dwordx4 v[20:23], v144, s[28:31], s40 offen offset:64
    buffer_load_dwordx4 v[24:27], v144, s[28:31], s40 offen offset:128
    buffer_load_dwordx4 v[28:31], v144, s[28:31], s40 offen offset:192
    s_waitcnt vmcnt(0)
    v_mfma_f32_16x16x32_bf16 v[52:55], v[16:19], v[0:3], 0
    v_mfma_f32_16x16x32_bf16 v[52:55], v[20:23], v[4:7], v[52:55]
    v_mfma_f32_16x16x32_bf16 v[52:55], v[24:27], v[8:11], v[52:55]
    v_mfma_f32_16x16x32_bf16 v[52:55], v[28:31], v[12:15], v[52:55]
    s_xor_b32 s40, s40, 24576
    buffer_load_dwordx4 v[16:19], v144, s[28:31], s40 offen offset:0
    buffer_load_dwordx4 v[20:23], v144, s[28:31], s40 offen offset:64
    buffer_load_dwordx4 v[24:27], v144, s[28:31], s40 offen offset:128
    buffer_load_dwordx4 v[28:31], v144, s[28:31], s40 offen offset:192
    s_waitcnt vmcnt(0)
    v_mfma_f32_16x16x32_bf16 v[56:59], v[16:19], v[0:3], 0
    v_mfma_f32_16x16x32_bf16 v[56:59], v[20:23], v[4:7], v[56:59]
    v_mfma_f32_16x16x32_bf16 v[56:59], v[24:27], v[8:11], v[56:59]
    v_mfma_f32_16x16x32_bf16 v[56:59], v[28:31], v[12:15], v[56:59]
    s_xor_b32 s40, s40, 8192
    buffer_load_dwordx4 v[16:19], v144, s[28:31], s40 offen offset:0
    buffer_load_dwordx4 v[20:23], v144, s[28:31], s40 offen offset:64
    buffer_load_dwordx4 v[24:27], v144, s[28:31], s40 offen offset:128
    buffer_load_dwordx4 v[28:31], v144, s[28:31], s40 offen offset:192
    s_waitcnt vmcnt(0)
    v_mfma_f32_16x16x32_bf16 v[60:63], v[16:19], v[0:3], 0
    v_mfma_f32_16x16x32_bf16 v[60:63], v[20:23], v[4:7], v[60:63]
    v_mfma_f32_16x16x32_bf16 v[60:63], v[24:27], v[8:11], v[60:63]
    v_mfma_f32_16x16x32_bf16 v[60:63], v[28:31], v[12:15], v[60:63]
    v_max_f32 v146, v32, v33
    v_max3_f32 v146, v146, v34, v35
    v_max3_f32 v146, v146, v36, v37
    v_max3_f32 v146, v146, v38, v39
    v_max3_f32 v146, v146, v40, v41
    v_max3_f32 v146, v146, v42, v43
    v_max3_f32 v146, v146, v44, v45
    v_max3_f32 v146, v146, v46, v47
    v_max3_f32 v146, v146, v48, v49
    v_max3_f32 v146, v146, v50, v51
    v_max3_f32 v146, v146, v52, v53
    v_max3_f32 v146, v146, v54, v55
    v_max3_f32 v146, v146, v56, v57
    v_max3_f32 v146, v146, v58, v59
    v_max3_f32 v146, v146, v60, v61
    v_max3_f32 v146, v146, v62, v63
    v_mov_b32 v147, v146
    s_nop 1
    v_permlane32_swap_b32 v146, v147
    v_max_f32 v146, v146, v147
    v_mov_b32 v147, v146
    s_nop 1
    v_permlane16_swap_b32 v146, v147
    v_max_f32 v146, v146, v147
    v_mul_f32 v146, 0xbe0293ee, v146
    v_min_f32 v146, v146, v232
    v_sub_f32 v148, v146, v232
    v_exp_f32 v148, v148
    v_mov_b32 v232, v146
    v_mul_f32 v233, v233, v148
    v_accvgpr_read_b32 v16, a32
    v_accvgpr_read_b32 v17, a33
    v_accvgpr_read_b32 v18, a34
    v_accvgpr_read_b32 v19, a35
    v_accvgpr_read_b32 v20, a36
    v_accvgpr_read_b32 v21, a37
    v_accvgpr_read_b32 v22, a38
    v_accvgpr_read_b32 v23, a39
    v_accvgpr_read_b32 v24, a40
    v_accvgpr_read_b32 v25, a41
    v_accvgpr_read_b32 v26, a42
    v_accvgpr_read_b32 v27, a43
    v_accvgpr_read_b32 v28, a44
    v_accvgpr_read_b32 v29, a45
    v_accvgpr_read_b32 v30, a46
    v_accvgpr_read_b32 v31, a47
    v_mul_f32 v16, v16, v148
    v_mul_f32 v17, v17, v148
    v_mul_f32 v18, v18, v148
    v_mul_f32 v19, v19, v148
    v_mul_f32 v20, v20, v148
    v_mul_f32 v21, v21, v148
    v_mul_f32 v22, v22, v148
    v_mul_f32 v23, v23, v148
    v_mul_f32 v24, v24, v148
    v_mul_f32 v25, v25, v148
    v_mul_f32 v26, v26, v148
    v_mul_f32 v27, v27, v148
    v_mul_f32 v28, v28, v148
    v_mul_f32 v29, v29, v148
    v_mul_f32 v30, v30, v148
    v_mul_f32 v31, v31, v148
    v_accvgpr_write_b32 a32, v16
    v_accvgpr_write_b32 a33, v17
    v_accvgpr_write_b32 a34, v18
    v_accvgpr_write_b32 a35, v19
    v_accvgpr_write_b32 a36, v20
    v_accvgpr_write_b32 a37, v21
    v_accvgpr_write_b32 a38, v22
    v_accvgpr_write_b32 a39, v23
    v_accvgpr_write_b32 a40, v24
    v_accvgpr_write_b32 a41, v25
    v_accvgpr_write_b32 a42, v26
    v_accvgpr_write_b32 a43, v27
    v_accvgpr_write_b32 a44, v28
    v_accvgpr_write_b32 a45, v29
    v_accvgpr_write_b32 a46, v30
    v_accvgpr_write_b32 a47, v31
    v_accvgpr_read_b32 v16, a96
    v_accvgpr_read_b32 v17, a97
    v_accvgpr_read_b32 v18, a98
    v_accvgpr_read_b32 v19, a99
    v_accvgpr_read_b32 v20, a100
    v_accvgpr_read_b32 v21, a101
    v_accvgpr_read_b32 v22, a102
    v_accvgpr_read_b32 v23, a103
    v_accvgpr_read_b32 v24, a104
    v_accvgpr_read_b32 v25, a105
    v_accvgpr_read_b32 v26, a106
    v_accvgpr_read_b32 v27, a107
    v_accvgpr_read_b32 v28, a108
    v_accvgpr_read_b32 v29, a109
    v_accvgpr_read_b32 v30, a110
    v_accvgpr_read_b32 v31, a111
    v_mul_f32 v16, v16, v148
    v_mul_f32 v17, v17, v148
    v_mul_f32 v18, v18, v148
    v_mul_f32 v19, v19, v148
    v_mul_f32 v20, v20, v148
    v_mul_f32 v21, v21, v148
    v_mul_f32 v22, v22, v148
    v_mul_f32 v23, v23, v148
    v_mul_f32 v24, v24, v148
    v_mul_f32 v25, v25, v148
    v_mul_f32 v26, v26, v148
    v_mul_f32 v27, v27, v148
    v_mul_f32 v28, v28, v148
    v_mul_f32 v29, v29, v148
    v_mul_f32 v30, v30, v148
    v_mul_f32 v31, v31, v148
    v_accvgpr_write_b32 a96, v16
    v_accvgpr_write_b32 a97, v17
    v_accvgpr_write_b32 a98, v18
    v_accvgpr_write_b32 a99, v19
    v_accvgpr_write_b32 a100, v20
    v_accvgpr_write_b32 a101, v21
    v_accvgpr_write_b32 a102, v22
    v_accvgpr_write_b32 a103, v23
    v_accvgpr_write_b32 a104, v24
    v_accvgpr_write_b32 a105, v25
    v_accvgpr_write_b32 a106, v26
    v_accvgpr_write_b32 a107, v27
    v_accvgpr_write_b32 a108, v28
    v_accvgpr_write_b32 a109, v29
    v_accvgpr_write_b32 a110, v30
    v_accvgpr_write_b32 a111, v31
    v_fmamk_f32 v32, v32, 0x3e0293ee, v232
    v_fmamk_f32 v33, v33, 0x3e0293ee, v232
    v_fmamk_f32 v34, v34, 0x3e0293ee, v232
    v_fmamk_f32 v35, v35, 0x3e0293ee, v232
    v_fmamk_f32 v36, v36, 0x3e0293ee, v232
    v_fmamk_f32 v37, v37, 0x3e0293ee, v232
    v_fmamk_f32 v38, v38, 0x3e0293ee, v232
    v_fmamk_f32 v39, v39, 0x3e0293ee, v232
    v_fmamk_f32 v40, v40, 0x3e0293ee, v232
    v_fmamk_f32 v41, v41, 0x3e0293ee, v232
    v_fmamk_f32 v42, v42, 0x3e0293ee, v232
    v_fmamk_f32 v43, v43, 0x3e0293ee, v232
    v_fmamk_f32 v44, v44, 0x3e0293ee, v232
    v_fmamk_f32 v45, v45, 0x3e0293ee, v232
    v_fmamk_f32 v46, v46, 0x3e0293ee, v232
    v_fmamk_f32 v47, v47, 0x3e0293ee, v232
    v_fmamk_f32 v48, v48, 0x3e0293ee, v232
    v_fmamk_f32 v49, v49, 0x3e0293ee, v232
    v_fmamk_f32 v50, v50, 0x3e0293ee, v232
    v_fmamk_f32 v51, v51, 0x3e0293ee, v232
    v_fmamk_f32 v52, v52, 0x3e0293ee, v232
    v_fmamk_f32 v53, v53, 0x3e0293ee, v232
    v_fmamk_f32 v54, v54, 0x3e0293ee, v232
    v_fmamk_f32 v55, v55, 0x3e0293ee, v232
    v_fmamk_f32 v56, v56, 0x3e0293ee, v232
    v_fmamk_f32 v57, v57, 0x3e0293ee, v232
    v_fmamk_f32 v58, v58, 0x3e0293ee, v232
    v_fmamk_f32 v59, v59, 0x3e0293ee, v232
    v_fmamk_f32 v60, v60, 0x3e0293ee, v232
    v_fmamk_f32 v61, v61, 0x3e0293ee, v232
    v_fmamk_f32 v62, v62, 0x3e0293ee, v232
    v_fmamk_f32 v63, v63, 0x3e0293ee, v232
    v_exp_f32 v32, v32
    v_exp_f32 v33, v33
    v_exp_f32 v34, v34
    v_exp_f32 v35, v35
    v_exp_f32 v36, v36
    v_exp_f32 v37, v37
    v_exp_f32 v38, v38
    v_exp_f32 v39, v39
    v_exp_f32 v40, v40
    v_exp_f32 v41, v41
    v_exp_f32 v42, v42
    v_exp_f32 v43, v43
    v_exp_f32 v44, v44
    v_exp_f32 v45, v45
    v_exp_f32 v46, v46
    v_exp_f32 v47, v47
    v_exp_f32 v48, v48
    v_exp_f32 v49, v49
    v_exp_f32 v50, v50
    v_exp_f32 v51, v51
    v_exp_f32 v52, v52
    v_exp_f32 v53, v53
    v_exp_f32 v54, v54
    v_exp_f32 v55, v55
    v_exp_f32 v56, v56
    v_exp_f32 v57, v57
    v_exp_f32 v58, v58
    v_exp_f32 v59, v59
    v_exp_f32 v60, v60
    v_exp_f32 v61, v61
    v_exp_f32 v62, v62
    v_exp_f32 v63, v63
    v_cvt_pk_bf16_f32 v72, v32, v33
    v_cvt_pk_bf16_f32 v73, v34, v35
    v_cvt_pk_bf16_f32 v74, v36, v37
    v_cvt_pk_bf16_f32 v75, v38, v39
    v_cvt_pk_bf16_f32 v88, v40, v41
    v_cvt_pk_bf16_f32 v89, v42, v43
    v_cvt_pk_bf16_f32 v90, v44, v45
    v_cvt_pk_bf16_f32 v91, v46, v47
    v_cvt_pk_bf16_f32 v104, v48, v49
    v_cvt_pk_bf16_f32 v105, v50, v51
    v_cvt_pk_bf16_f32 v106, v52, v53
    v_cvt_pk_bf16_f32 v107, v54, v55
    v_cvt_pk_bf16_f32 v120, v56, v57
    v_cvt_pk_bf16_f32 v121, v58, v59
    v_cvt_pk_bf16_f32 v122, v60, v61
    v_cvt_pk_bf16_f32 v123, v62, v63
    v_mfma_f32_16x16x32_bf16 v[168:171], v[248:251], v[72:75], 0
    v_mfma_f32_16x16x32_bf16 v[168:171], v[248:251], v[88:91], v[168:171]
    v_mfma_f32_16x16x32_bf16 v[168:171], v[248:251], v[104:107], v[168:171]
    v_mfma_f32_16x16x32_bf16 v[168:171], v[248:251], v[120:123], v[168:171]
    s_mov_b32 s28, s4
    s_and_b32 s29, s5, 0xffff
    s_mov_b32 s30, 0x8000000
    s_xor_b32 s40, s39, 20480
    buffer_load_dwordx4 v[0:3], v144, s[28:31], s40 offen offset:0
    buffer_load_dwordx4 v[4:7], v144, s[28:31], s40 offen offset:64
    buffer_load_dwordx4 v[8:11], v144, s[28:31], s40 offen offset:128
    buffer_load_dwordx4 v[12:15], v144, s[28:31], s40 offen offset:192
    s_mov_b32 s28, s6
    s_and_b32 s29, s7, 0xffff
    s_mov_b32 s30, 0x4000000
    s_lshr_b32 s40, s39, 17
    s_lshl_b32 s40, s40, 16
    s_xor_b32 s40, s40, s87
    s_xor_b32 s40, s40, 4096
    buffer_load_dwordx4 v[16:19], v144, s[28:31], s40 offen offset:0
    buffer_load_dwordx4 v[20:23], v144, s[28:31], s40 offen offset:64
    buffer_load_dwordx4 v[24:27], v144, s[28:31], s40 offen offset:128
    buffer_load_dwordx4 v[28:31], v144, s[28:31], s40 offen offset:192
    s_waitcnt vmcnt(0)
    v_mfma_f32_16x16x32_bf16 v[32:35], v[16:19], v[0:3], 0
    v_mfma_f32_16x16x32_bf16 v[32:35], v[20:23], v[4:7], v[32:35]
    v_mfma_f32_16x16x32_bf16 v[32:35], v[24:27], v[8:11], v[32:35]
    v_mfma_f32_16x16x32_bf16 v[32:35], v[28:31], v[12:15], v[32:35]
    s_xor_b32 s40, s40, 8192
    buffer_load_dwordx4 v[16:19], v144, s[28:31], s40 offen offset:0
    buffer_load_dwordx4 v[20:23], v144, s[28:31], s40 offen offset:64
    buffer_load_dwordx4 v[24:27], v144, s[28:31], s40 offen offset:128
    buffer_load_dwordx4 v[28:31], v144, s[28:31], s40 offen offset:192
    s_waitcnt vmcnt(0)
    v_mfma_f32_16x16x32_bf16 v[36:39], v[16:19], v[0:3], 0
    v_mfma_f32_16x16x32_bf16 v[36:39], v[20:23], v[4:7], v[36:39]
    v_mfma_f32_16x16x32_bf16 v[36:39], v[24:27], v[8:11], v[36:39]
    v_mfma_f32_16x16x32_bf16 v[36:39], v[28:31], v[12:15], v[36:39]
    s_xor_b32 s40, s40, 24576
    buffer_load_dwordx4 v[16:19], v144, s[28:31], s40 offen offset:0
    buffer_load_dwordx4 v[20:23], v144, s[28:31], s40 offen offset:64
    buffer_load_dwordx4 v[24:27], v144, s[28:31], s40 offen offset:128
    buffer_load_dwordx4 v[28:31], v144, s[28:31], s40 offen offset:192
    s_waitcnt vmcnt(0)
    v_mfma_f32_16x16x32_bf16 v[40:43], v[16:19], v[0:3], 0
    v_mfma_f32_16x16x32_bf16 v[40:43], v[20:23], v[4:7], v[40:43]
    v_mfma_f32_16x16x32_bf16 v[40:43], v[24:27], v[8:11], v[40:43]
    v_mfma_f32_16x16x32_bf16 v[40:43], v[28:31], v[12:15], v[40:43]
    s_xor_b32 s40, s40, 8192
    buffer_load_dwordx4 v[16:19], v144, s[28:31], s40 offen offset:0
    buffer_load_dwordx4 v[20:23], v144, s[28:31], s40 offen offset:64
    buffer_load_dwordx4 v[24:27], v144, s[28:31], s40 offen offset:128
    buffer_load_dwordx4 v[28:31], v144, s[28:31], s40 offen offset:192
    s_waitcnt vmcnt(0)
    v_mfma_f32_16x16x32_bf16 v[44:47], v[16:19], v[0:3], 0
    v_mfma_f32_16x16x32_bf16 v[44:47], v[20:23], v[4:7], v[44:47]
    v_mfma_f32_16x16x32_bf16 v[44:47], v[24:27], v[8:11], v[44:47]
    v_mfma_f32_16x16x32_bf16 v[44:47], v[28:31], v[12:15], v[44:47]
    s_xor_b32 s40, s40, 57344
    buffer_load_dwordx4 v[16:19], v144, s[28:31], s40 offen offset:0
    buffer_load_dwordx4 v[20:23], v144, s[28:31], s40 offen offset:64
    buffer_load_dwordx4 v[24:27], v144, s[28:31], s40 offen offset:128
    buffer_load_dwordx4 v[28:31], v144, s[28:31], s40 offen offset:192
    s_waitcnt vmcnt(0)
    v_mfma_f32_16x16x32_bf16 v[48:51], v[16:19], v[0:3], 0
    v_mfma_f32_16x16x32_bf16 v[48:51], v[20:23], v[4:7], v[48:51]
    v_mfma_f32_16x16x32_bf16 v[48:51], v[24:27], v[8:11], v[48:51]
    v_mfma_f32_16x16x32_bf16 v[48:51], v[28:31], v[12:15], v[48:51]
    s_xor_b32 s40, s40, 8192
    buffer_load_dwordx4 v[16:19], v144, s[28:31], s40 offen offset:0
    buffer_load_dwordx4 v[20:23], v144, s[28:31], s40 offen offset:64
    buffer_load_dwordx4 v[24:27], v144, s[28:31], s40 offen offset:128
    buffer_load_dwordx4 v[28:31], v144, s[28:31], s40 offen offset:192
    s_waitcnt vmcnt(0)
    v_mfma_f32_16x16x32_bf16 v[52:55], v[16:19], v[0:3], 0
    v_mfma_f32_16x16x32_bf16 v[52:55], v[20:23], v[4:7], v[52:55]
    v_mfma_f32_16x16x32_bf16 v[52:55], v[24:27], v[8:11], v[52:55]
    v_mfma_f32_16x16x32_bf16 v[52:55], v[28:31], v[12:15], v[52:55]
    s_xor_b32 s40, s40, 24576
    buffer_load_dwordx4 v[16:19], v144, s[28:31], s40 offen offset:0
    buffer_load_dwordx4 v[20:23], v144, s[28:31], s40 offen offset:64
    buffer_load_dwordx4 v[24:27], v144, s[28:31], s40 offen offset:128
    buffer_load_dwordx4 v[28:31], v144, s[28:31], s40 offen offset:192
    s_waitcnt vmcnt(0)
    v_mfma_f32_16x16x32_bf16 v[56:59], v[16:19], v[0:3], 0
    v_mfma_f32_16x16x32_bf16 v[56:59], v[20:23], v[4:7], v[56:59]
    v_mfma_f32_16x16x32_bf16 v[56:59], v[24:27], v[8:11], v[56:59]
    v_mfma_f32_16x16x32_bf16 v[56:59], v[28:31], v[12:15], v[56:59]
    s_xor_b32 s40, s40, 8192
    buffer_load_dwordx4 v[16:19], v144, s[28:31], s40 offen offset:0
    buffer_load_dwordx4 v[20:23], v144, s[28:31], s40 offen offset:64
    buffer_load_dwordx4 v[24:27], v144, s[28:31], s40 offen offset:128
    buffer_load_dwordx4 v[28:31], v144, s[28:31], s40 offen offset:192
    s_waitcnt vmcnt(0)
    v_mfma_f32_16x16x32_bf16 v[60:63], v[16:19], v[0:3], 0
    v_mfma_f32_16x16x32_bf16 v[60:63], v[20:23], v[4:7], v[60:63]
    v_mfma_f32_16x16x32_bf16 v[60:63], v[24:27], v[8:11], v[60:63]
    v_mfma_f32_16x16x32_bf16 v[60:63], v[28:31], v[12:15], v[60:63]
    v_max_f32 v146, v32, v33
    v_max3_f32 v146, v146, v34, v35
    v_max3_f32 v146, v146, v36, v37
    v_max3_f32 v146, v146, v38, v39
    v_max3_f32 v146, v146, v40, v41
    v_max3_f32 v146, v146, v42, v43
    v_max3_f32 v146, v146, v44, v45
    v_max3_f32 v146, v146, v46, v47
    v_max3_f32 v146, v146, v48, v49
    v_max3_f32 v146, v146, v50, v51
    v_max3_f32 v146, v146, v52, v53
    v_max3_f32 v146, v146, v54, v55
    v_max3_f32 v146, v146, v56, v57
    v_max3_f32 v146, v146, v58, v59
    v_max3_f32 v146, v146, v60, v61
    v_max3_f32 v146, v146, v62, v63
    v_mov_b32 v147, v146
    s_nop 1
    v_permlane32_swap_b32 v146, v147
    v_max_f32 v146, v146, v147
    v_mov_b32 v147, v146
    s_nop 1
    v_permlane16_swap_b32 v146, v147
    v_max_f32 v146, v146, v147
    v_mul_f32 v146, 0xbe0293ee, v146
    v_min_f32 v146, v146, v234
    v_sub_f32 v148, v146, v234
    v_exp_f32 v148, v148
    v_mov_b32 v234, v146
    v_mul_f32 v235, v235, v148
    v_accvgpr_read_b32 v16, a48
    v_accvgpr_read_b32 v17, a49
    v_accvgpr_read_b32 v18, a50
    v_accvgpr_read_b32 v19, a51
    v_accvgpr_read_b32 v20, a52
    v_accvgpr_read_b32 v21, a53
    v_accvgpr_read_b32 v22, a54
    v_accvgpr_read_b32 v23, a55
    v_accvgpr_read_b32 v24, a56
    v_accvgpr_read_b32 v25, a57
    v_accvgpr_read_b32 v26, a58
    v_accvgpr_read_b32 v27, a59
    v_accvgpr_read_b32 v28, a60
    v_accvgpr_read_b32 v29, a61
    v_accvgpr_read_b32 v30, a62
    v_accvgpr_read_b32 v31, a63
    v_mul_f32 v16, v16, v148
    v_mul_f32 v17, v17, v148
    v_mul_f32 v18, v18, v148
    v_mul_f32 v19, v19, v148
    v_mul_f32 v20, v20, v148
    v_mul_f32 v21, v21, v148
    v_mul_f32 v22, v22, v148
    v_mul_f32 v23, v23, v148
    v_mul_f32 v24, v24, v148
    v_mul_f32 v25, v25, v148
    v_mul_f32 v26, v26, v148
    v_mul_f32 v27, v27, v148
    v_mul_f32 v28, v28, v148
    v_mul_f32 v29, v29, v148
    v_mul_f32 v30, v30, v148
    v_mul_f32 v31, v31, v148
    v_accvgpr_write_b32 a48, v16
    v_accvgpr_write_b32 a49, v17
    v_accvgpr_write_b32 a50, v18
    v_accvgpr_write_b32 a51, v19
    v_accvgpr_write_b32 a52, v20
    v_accvgpr_write_b32 a53, v21
    v_accvgpr_write_b32 a54, v22
    v_accvgpr_write_b32 a55, v23
    v_accvgpr_write_b32 a56, v24
    v_accvgpr_write_b32 a57, v25
    v_accvgpr_write_b32 a58, v26
    v_accvgpr_write_b32 a59, v27
    v_accvgpr_write_b32 a60, v28
    v_accvgpr_write_b32 a61, v29
    v_accvgpr_write_b32 a62, v30
    v_accvgpr_write_b32 a63, v31
    v_accvgpr_read_b32 v16, a112
    v_accvgpr_read_b32 v17, a113
    v_accvgpr_read_b32 v18, a114
    v_accvgpr_read_b32 v19, a115
    v_accvgpr_read_b32 v20, a116
    v_accvgpr_read_b32 v21, a117
    v_accvgpr_read_b32 v22, a118
    v_accvgpr_read_b32 v23, a119
    v_accvgpr_read_b32 v24, a120
    v_accvgpr_read_b32 v25, a121
    v_accvgpr_read_b32 v26, a122
    v_accvgpr_read_b32 v27, a123
    v_accvgpr_read_b32 v28, a124
    v_accvgpr_read_b32 v29, a125
    v_accvgpr_read_b32 v30, a126
    v_accvgpr_read_b32 v31, a127
    v_mul_f32 v16, v16, v148
    v_mul_f32 v17, v17, v148
    v_mul_f32 v18, v18, v148
    v_mul_f32 v19, v19, v148
    v_mul_f32 v20, v20, v148
    v_mul_f32 v21, v21, v148
    v_mul_f32 v22, v22, v148
    v_mul_f32 v23, v23, v148
    v_mul_f32 v24, v24, v148
    v_mul_f32 v25, v25, v148
    v_mul_f32 v26, v26, v148
    v_mul_f32 v27, v27, v148
    v_mul_f32 v28, v28, v148
    v_mul_f32 v29, v29, v148
    v_mul_f32 v30, v30, v148
    v_mul_f32 v31, v31, v148
    v_accvgpr_write_b32 a112, v16
    v_accvgpr_write_b32 a113, v17
    v_accvgpr_write_b32 a114, v18
    v_accvgpr_write_b32 a115, v19
    v_accvgpr_write_b32 a116, v20
    v_accvgpr_write_b32 a117, v21
    v_accvgpr_write_b32 a118, v22
    v_accvgpr_write_b32 a119, v23
    v_accvgpr_write_b32 a120, v24
    v_accvgpr_write_b32 a121, v25
    v_accvgpr_write_b32 a122, v26
    v_accvgpr_write_b32 a123, v27
    v_accvgpr_write_b32 a124, v28
    v_accvgpr_write_b32 a125, v29
    v_accvgpr_write_b32 a126, v30
    v_accvgpr_write_b32 a127, v31
    v_fmamk_f32 v32, v32, 0x3e0293ee, v234
    v_fmamk_f32 v33, v33, 0x3e0293ee, v234
    v_fmamk_f32 v34, v34, 0x3e0293ee, v234
    v_fmamk_f32 v35, v35, 0x3e0293ee, v234
    v_fmamk_f32 v36, v36, 0x3e0293ee, v234
    v_fmamk_f32 v37, v37, 0x3e0293ee, v234
    v_fmamk_f32 v38, v38, 0x3e0293ee, v234
    v_fmamk_f32 v39, v39, 0x3e0293ee, v234
    v_fmamk_f32 v40, v40, 0x3e0293ee, v234
    v_fmamk_f32 v41, v41, 0x3e0293ee, v234
    v_fmamk_f32 v42, v42, 0x3e0293ee, v234
    v_fmamk_f32 v43, v43, 0x3e0293ee, v234
    v_fmamk_f32 v44, v44, 0x3e0293ee, v234
    v_fmamk_f32 v45, v45, 0x3e0293ee, v234
    v_fmamk_f32 v46, v46, 0x3e0293ee, v234
    v_fmamk_f32 v47, v47, 0x3e0293ee, v234
    v_fmamk_f32 v48, v48, 0x3e0293ee, v234
    v_fmamk_f32 v49, v49, 0x3e0293ee, v234
    v_fmamk_f32 v50, v50, 0x3e0293ee, v234
    v_fmamk_f32 v51, v51, 0x3e0293ee, v234
    v_fmamk_f32 v52, v52, 0x3e0293ee, v234
    v_fmamk_f32 v53, v53, 0x3e0293ee, v234
    v_fmamk_f32 v54, v54, 0x3e0293ee, v234
    v_fmamk_f32 v55, v55, 0x3e0293ee, v234
    v_fmamk_f32 v56, v56, 0x3e0293ee, v234
    v_fmamk_f32 v57, v57, 0x3e0293ee, v234
    v_fmamk_f32 v58, v58, 0x3e0293ee, v234
    v_fmamk_f32 v59, v59, 0x3e0293ee, v234
    v_fmamk_f32 v60, v60, 0x3e0293ee, v234
    v_fmamk_f32 v61, v61, 0x3e0293ee, v234
    v_fmamk_f32 v62, v62, 0x3e0293ee, v234
    v_fmamk_f32 v63, v63, 0x3e0293ee, v234
    v_exp_f32 v32, v32
    v_exp_f32 v33, v33
    v_exp_f32 v34, v34
    v_exp_f32 v35, v35
    v_exp_f32 v36, v36
    v_exp_f32 v37, v37
    v_exp_f32 v38, v38
    v_exp_f32 v39, v39
    v_exp_f32 v40, v40
    v_exp_f32 v41, v41
    v_exp_f32 v42, v42
    v_exp_f32 v43, v43
    v_exp_f32 v44, v44
    v_exp_f32 v45, v45
    v_exp_f32 v46, v46
    v_exp_f32 v47, v47
    v_exp_f32 v48, v48
    v_exp_f32 v49, v49
    v_exp_f32 v50, v50
    v_exp_f32 v51, v51
    v_exp_f32 v52, v52
    v_exp_f32 v53, v53
    v_exp_f32 v54, v54
    v_exp_f32 v55, v55
    v_exp_f32 v56, v56
    v_exp_f32 v57, v57
    v_exp_f32 v58, v58
    v_exp_f32 v59, v59
    v_exp_f32 v60, v60
    v_exp_f32 v61, v61
    v_exp_f32 v62, v62
    v_exp_f32 v63, v63
    v_cvt_pk_bf16_f32 v76, v32, v33
    v_cvt_pk_bf16_f32 v77, v34, v35
    v_cvt_pk_bf16_f32 v78, v36, v37
    v_cvt_pk_bf16_f32 v79, v38, v39
    v_cvt_pk_bf16_f32 v92, v40, v41
    v_cvt_pk_bf16_f32 v93, v42, v43
    v_cvt_pk_bf16_f32 v94, v44, v45
    v_cvt_pk_bf16_f32 v95, v46, v47
    v_cvt_pk_bf16_f32 v108, v48, v49
    v_cvt_pk_bf16_f32 v109, v50, v51
    v_cvt_pk_bf16_f32 v110, v52, v53
    v_cvt_pk_bf16_f32 v111, v54, v55
    v_cvt_pk_bf16_f32 v124, v56, v57
    v_cvt_pk_bf16_f32 v125, v58, v59
    v_cvt_pk_bf16_f32 v126, v60, v61
    v_cvt_pk_bf16_f32 v127, v62, v63
    v_mfma_f32_16x16x32_bf16 v[172:175], v[248:251], v[76:79], 0
    v_mfma_f32_16x16x32_bf16 v[172:175], v[248:251], v[92:95], v[172:175]
    v_mfma_f32_16x16x32_bf16 v[172:175], v[248:251], v[108:111], v[172:175]
    v_mfma_f32_16x16x32_bf16 v[172:175], v[248:251], v[124:127], v[172:175]
    s_nop 7
    s_setpc_b64 s[72:73]
.section .rodata,"a"
.p2align 6
.amdhsa_kernel standalone__gqa_softmax__near_ridge_kernel
  .amdhsa_next_free_vgpr 512
  .amdhsa_next_free_sgpr 90
  .amdhsa_accum_offset 256
  .amdhsa_group_segment_fixed_size 0
  .amdhsa_kernarg_size 48
  .amdhsa_user_sgpr_count 2
  .amdhsa_user_sgpr_kernarg_segment_ptr 1
  .amdhsa_system_sgpr_workgroup_id_x 1
.end_amdhsa_kernel
```
